```python
import torch

def _softmax(x, axis=-1):
    return torch.softmax(x, dim=axis)
def _gelu(x):
    return torch.nn.functional.gelu(x, approximate="tanh")
def _silu(x):
    return torch.nn.functional.silu(x)
def _sigmoid(x):
    return torch.sigmoid(x)
def _layernorm(x, axis=-1, eps=1e-5):
    m = x.mean(dim=axis, keepdim=True)
    v = x.var(dim=axis, keepdim=True, unbiased=False)
    return (x - m) / torch.sqrt(v + eps)
def _scatter_add(tgt, idx, src, axis=0):
    return tgt.clone().index_add_(axis, idx, src)
def _segment_sum(src, seg, n):
    out = torch.zeros((n,) + src.shape[1:], dtype=src.dtype)
    return out.index_add_(0, seg, src)
def _pad(x, pw):
    flat = tuple(v for pair in reversed(pw) for v in pair)
    return torch.nn.functional.pad(x, flat)

kernel_name = 'concat_heads__gqa_block_cached__mha_block_cached__near_ridge'

def setup_inputs():

    _w = (lambda a: (lambda t: t.to(torch.bfloat16) if t.is_floating_point() else t)(torch.as_tensor(a)))
    def _A_setup():
        B, Sq, D = 8, 96, 448
        Hq, Hkv, Sk, Dh = 16, 8, 512, 256
        assert Hq % Hkv == 0, (Hq, Hkv)
        return {
            "x": _w((lambda *s: torch.randn(*s, dtype=torch.bfloat16) * 0.8)(B, Sq, D)),
            "k_cache": _w((lambda *s: torch.randn(*s, dtype=torch.bfloat16) * 0.8)(B, Hkv, Sk, Dh)),
            "v_cache": _w((lambda *s: torch.randn(*s, dtype=torch.bfloat16) * 0.05)(B, Hkv, Sk, Dh)),
            "wq": _w((lambda *s: torch.randn(*s, dtype=torch.bfloat16) * 0.8)(D, Hq * Dh) * (D ** -0.5)),
            "wo": _w((lambda *s: torch.randn(*s, dtype=torch.bfloat16) * 0.05)(Hq * Dh, D) * ((Hq * Dh) ** -0.5)),
        }
    _A_in = _A_setup()

    def _B_setup():
        B, Sq, D = 8, 96, 448
        H, Sk, Dh = 16, 512, 256
        return {
            "x": _w((lambda *s: torch.randn(*s, dtype=torch.bfloat16) * 0.8)(B, Sq, D)),
            "k_cache": _w((lambda *s: torch.randn(*s, dtype=torch.bfloat16) * 0.8)(B, H, Sk, Dh)),
            "v_cache": _w((lambda *s: torch.randn(*s, dtype=torch.bfloat16) * 0.05)(B, H, Sk, Dh)),
            "wq": _w((lambda *s: torch.randn(*s, dtype=torch.bfloat16) * 0.8)(D, H * Dh) * (D ** -0.5)),
            "wo": _w((lambda *s: torch.randn(*s, dtype=torch.bfloat16) * 0.05)(H * Dh, D) * ((H * Dh) ** -0.5)),
        }
    _B_in = _B_setup()

    return {
        "A_x": _A_in["x"],
        "A_k_cache": _A_in["k_cache"],
        "A_v_cache": _A_in["v_cache"],
        "A_wq": _A_in["wq"],
        "A_wo": _A_in["wo"],
        "B_x": _B_in["x"],
        "B_k_cache": _B_in["k_cache"],
        "B_v_cache": _B_in["v_cache"],
        "B_wq": _B_in["wq"],
        "B_wo": _B_in["wo"],
    }

def reference(A_x, A_k_cache, A_v_cache, A_wq, A_wo, B_x, B_k_cache, B_v_cache, B_wq, B_wo):
    def _A_ref(x, k_cache, v_cache, wq, wo):
        B, Sq, D = x.shape
        Hq, Dh = 16, 256
        Hkv = k_cache.shape[1]
        rep = Hq // Hkv
        q = (lambda x, *d: x.permute(*d))((x @ wq).reshape(B, Sq, Hq, Dh), 0, 2, 1, 3)
        k = (lambda x, n, axis: torch.repeat_interleave(x, n, dim=axis))(k_cache, rep, axis=1)
        v = (lambda x, n, axis: torch.repeat_interleave(x, n, dim=axis))(v_cache, rep, axis=1)
        scores = torch.einsum("bhqd,bhkd->bhqk", q, k) * (Dh ** -0.5)
        p = _softmax(scores, axis=-1)
        o = torch.einsum("bhqk,bhkd->bhqd", p, v)
        return (lambda x, *d: x.permute(*d))(o, 0, 2, 1, 3).reshape(B, Sq, Hq * Dh) @ wo

    def _B_ref(x, k_cache, v_cache, wq, wo):
        B, Sq, D = x.shape
        H, Dh = 16, 256
        q = (lambda x, *d: x.permute(*d))((x @ wq).reshape(B, Sq, H, Dh), 0, 2, 1, 3)
        scores = torch.einsum("bhqd,bhkd->bhqk", q, k_cache) * (Dh ** -0.5)
        p = _softmax(scores, axis=-1)
        o = torch.einsum("bhqk,bhkd->bhqd", p, v_cache)
        return (lambda x, *d: x.permute(*d))(o, 0, 2, 1, 3).reshape(B, Sq, H * Dh) @ wo

    a = _A_ref(A_x, A_k_cache, A_v_cache, A_wq, A_wo)
    b = _B_ref(B_x, B_k_cache, B_v_cache, B_wq, B_wo)
    return torch.concatenate([a, b], axis=-1)
```

```asm
; @launch grid=(256,1,1) block=(256,1,1) lds=163840
.amdgcn_target "amdgcn-amd-amdhsa--gfx950"
.text
.globl concat_heads__gqa_block_cached__mha_block_cached__near_ridge_kernel
.p2align 8
.type concat_heads__gqa_block_cached__mha_block_cached__near_ridge_kernel,@function
concat_heads__gqa_block_cached__mha_block_cached__near_ridge_kernel:
  s_cmp_ge_u32 s2, 256
  s_cbranch_scc1 L_end
  s_load_dwordx8 s[64:71], s[0:1], 0
  s_load_dwordx2 s[72:73], s[0:1], 32
  s_load_dwordx8 s[76:83], s[0:1], 40
  s_load_dwordx2 s[84:85], s[0:1], 72
  s_load_dwordx2 s[86:87], s[0:1], 96
  v_lshrrev_b32 v1, 6, v0
  v_and_b32 v0, 63, v0
  v_readfirstlane_b32 s3, v1
  s_and_b32 s4, s2, 7
  s_lshr_b32 s8, s2, 3
  s_lshr_b32 s5, s8, 4
  s_lshr_b32 s6, s8, 1
  s_and_b32 s6, s6, 7
  s_and_b32 s9, s8, 1
  s_lshl_b32 s7, s4, 1
  s_add_u32 s7, s7, s9
  s_lshl_b32 s10, s6, 3
  s_add_u32 s10, s10, s4
  s_lshl_b32 s11, s6, 4
  s_add_u32 s11, s11, s7
  s_cmp_eq_u32 s5, 0
  s_cselect_b32 s10, s10, s11
  s_lshl_b32 s36, s5, 7
  s_add_u32 s11, s11, s36
  s_mov_b32 s9, 0
  s_cmp_eq_u32 s3, 3
  s_cbranch_scc0 L_cons
L_loader:
  v_lshrrev_b32 v2, 5, v0
  v_and_b32 v3, 31, v0
  v_add_u32 v4, 0, v2
  v_lshlrev_b32 v4, 2, v4
  v_xor_b32 v4, v4, v3
  v_lshlrev_b32 v4, 4, v4
  v_lshlrev_b32 v5, 13, v2
  v_add_u32 v4, v4, v5
  v_add_u32 v20, 0, v4
  v_add_u32 v4, 2, v2
  v_lshlrev_b32 v4, 2, v4
  v_xor_b32 v4, v4, v3
  v_lshlrev_b32 v4, 4, v4
  v_lshlrev_b32 v5, 13, v2
  v_add_u32 v4, v4, v5
  v_add_u32 v21, 15360, v4
  v_add_u32 v4, 0, v2
  v_lshlrev_b32 v4, 2, v4
  v_xor_b32 v4, v4, v3
  v_lshlrev_b32 v4, 4, v4
  v_lshlrev_b32 v5, 13, v2
  v_add_u32 v4, v4, v5
  v_add_u32 v22, 30720, v4
  v_add_u32 v4, 2, v2
  v_lshlrev_b32 v4, 2, v4
  v_xor_b32 v4, v4, v3
  v_lshlrev_b32 v4, 4, v4
  v_lshlrev_b32 v5, 13, v2
  v_add_u32 v4, v4, v5
  v_add_u32 v23, 46080, v4
  s_add_u32 s33, s6, s4
  s_and_b32 s33, s33, 7
  s_lshl_b32 s33, s33, 15
  v_lshlrev_b32 v8, 4, v0
  v_add_u32 v8, 147456, v8
  v_lshlrev_b32 v9, 3, v0
  v_add_u32 v9, 150528, v9
  v_cmp_gt_u32 vcc, 4, v0
  s_nop 1
  v_cndmask_b32 v8, v9, v8, vcc
  s_mov_b32 s38, 0
  v_mov_b32 v4, 0
  v_mov_b32 v5, 0
  ds_write_b64 v8, v[4:5] offset:0
  v_mov_b32 v6, 147512
  ds_write_b64 v6, v[4:5]
  s_mul_i32 s8, s9, 524288
  v_lshrrev_b32 v4, 3, v0
  v_mul_u32_u24 v4, 896, v4
  v_and_b32 v5, 7, v0
  v_lshrrev_b32 v6, 4, v0
  v_add_u32 v56, 0, v6
  v_xor_b32 v56, v56, v5
  v_lshlrev_b32 v56, 4, v56
  v_add_u32 v54, v56, v4
  v_add_u32 v56, 4, v6
  v_xor_b32 v56, v56, v5
  v_lshlrev_b32 v56, 4, v56
  v_add_u32 v55, v56, v4
  s_waitcnt lgkmcnt(0)
  s_cmp_eq_u32 s5, 0
  s_cselect_b64 s[64:65], s[64:65], s[76:77]
  s_cselect_b64 s[70:71], s[70:71], s[82:83]
  s_mul_i32 s36, s6, 86016
  s_add_u32 s12, s64, s36
  s_addc_u32 s13, s65, 0
  s_and_b32 s13, s13, 0xffff
  s_mov_b32 s14, 86016
  s_mov_b32 s15, 0x20000
  s_lshl_b32 s36, s7, 9
  s_sub_u32 s37, 3670016, s36
  s_add_u32 s24, s70, s36
  s_addc_u32 s25, s71, 0
  s_and_b32 s25, s25, 0xffff
  s_mov_b32 s26, s37
  s_mov_b32 s27, 0x20000
  s_lshl_b32 s34, s9, 7
  s_mov_b32 m0, 0
  s_add_u32 s40, s34, 0
  buffer_load_dwordx4 v54, s[12:15], s40 offen lds
  s_mov_b32 m0, 1024
  s_add_u32 s40, s34, 7168
  buffer_load_dwordx4 v55, s[12:15], s40 offen lds
  s_mov_b32 m0, 2048
  s_add_u32 s40, s34, 14336
  buffer_load_dwordx4 v54, s[12:15], s40 offen lds
  s_mov_b32 m0, 3072
  s_add_u32 s40, s34, 21504
  buffer_load_dwordx4 v55, s[12:15], s40 offen lds
  s_mov_b32 m0, 16384
  s_add_u32 s40, s34, 28672
  buffer_load_dwordx4 v54, s[12:15], s40 offen lds
  s_mov_b32 m0, 17408
  s_add_u32 s40, s34, 35840
  buffer_load_dwordx4 v55, s[12:15], s40 offen lds
  s_mov_b32 m0, 18432
  s_add_u32 s40, s34, 43008
  buffer_load_dwordx4 v54, s[12:15], s40 offen lds
  s_mov_b32 m0, 19456
  s_add_u32 s40, s34, 50176
  buffer_load_dwordx4 v55, s[12:15], s40 offen lds
  s_mov_b32 m0, 32768
  s_add_u32 s40, s34, 57344
  buffer_load_dwordx4 v54, s[12:15], s40 offen lds
  s_mov_b32 m0, 33792
  s_add_u32 s40, s34, 64512
  buffer_load_dwordx4 v55, s[12:15], s40 offen lds
  s_mov_b32 m0, 34816
  s_add_u32 s40, s34, 71680
  buffer_load_dwordx4 v54, s[12:15], s40 offen lds
  s_mov_b32 m0, 35840
  s_add_u32 s40, s34, 78848
  buffer_load_dwordx4 v55, s[12:15], s40 offen lds
  s_add_u32 s34, s34, 128
  s_cmp_eq_u32 s34, 896
  s_cselect_b32 s34, 0, s34
  s_mov_b32 m0, 114688
  s_add_u32 s40, s8, 0
  buffer_load_dwordx4 v20, s[24:27], s40 offen nt lds
  buffer_load_dwordx4 v21, s[24:27], s40 offen offset:1024 nt lds
  buffer_load_dwordx4 v22, s[24:27], s40 offen offset:2048 nt lds
  buffer_load_dwordx4 v23, s[24:27], s40 offen offset:3072 nt lds
  s_mov_b32 m0, 118784
  s_add_u32 s40, s8, 65536
  buffer_load_dwordx4 v20, s[24:27], s40 offen nt lds
  buffer_load_dwordx4 v21, s[24:27], s40 offen offset:1024 nt lds
  buffer_load_dwordx4 v22, s[24:27], s40 offen offset:2048 nt lds
  buffer_load_dwordx4 v23, s[24:27], s40 offen offset:3072 nt lds
  s_add_u32 s8, s8, 131072
  s_cmp_eq_u32 s8, 3670016
  s_cselect_b32 s8, 0, s8
  s_mov_b32 m0, 122880
  s_add_u32 s40, s8, 0
  buffer_load_dwordx4 v20, s[24:27], s40 offen nt lds
  buffer_load_dwordx4 v21, s[24:27], s40 offen offset:1024 nt lds
  buffer_load_dwordx4 v22, s[24:27], s40 offen offset:2048 nt lds
  buffer_load_dwordx4 v23, s[24:27], s40 offen offset:3072 nt lds
  s_mov_b32 m0, 126976
  s_add_u32 s40, s8, 65536
  buffer_load_dwordx4 v20, s[24:27], s40 offen nt lds
  buffer_load_dwordx4 v21, s[24:27], s40 offen offset:1024 nt lds
  buffer_load_dwordx4 v22, s[24:27], s40 offen offset:2048 nt lds
  buffer_load_dwordx4 v23, s[24:27], s40 offen offset:3072 nt lds
  s_add_u32 s8, s8, 131072
  s_cmp_eq_u32 s8, 3670016
  s_cselect_b32 s8, 0, s8
  s_mov_b32 m0, 131072
  s_add_u32 s40, s8, 0
  buffer_load_dwordx4 v20, s[24:27], s40 offen nt lds
  buffer_load_dwordx4 v21, s[24:27], s40 offen offset:1024 nt lds
  buffer_load_dwordx4 v22, s[24:27], s40 offen offset:2048 nt lds
  buffer_load_dwordx4 v23, s[24:27], s40 offen offset:3072 nt lds
  s_mov_b32 m0, 135168
  s_add_u32 s40, s8, 65536
  buffer_load_dwordx4 v20, s[24:27], s40 offen nt lds
  buffer_load_dwordx4 v21, s[24:27], s40 offen offset:1024 nt lds
  buffer_load_dwordx4 v22, s[24:27], s40 offen offset:2048 nt lds
  buffer_load_dwordx4 v23, s[24:27], s40 offen offset:3072 nt lds
  s_add_u32 s8, s8, 131072
  s_cmp_eq_u32 s8, 3670016
  s_cselect_b32 s8, 0, s8
  s_waitcnt vmcnt(32)
  s_cmp_eq_u32 s5, 0
  s_cselect_b64 s[66:67], s[66:67], s[78:79]
  s_cselect_b64 s[68:69], s[68:69], s[80:81]
  s_cselect_b64 s[72:73], s[72:73], s[84:85]
  s_lshl_b32 s36, s10, 18
  s_add_u32 s16, s66, s36
  s_addc_u32 s17, s67, 0
  s_and_b32 s17, s17, 0xffff
  s_mov_b32 s18, 262144
  s_mov_b32 s19, 0x20000
  s_add_u32 s20, s68, s36
  s_addc_u32 s21, s69, 0
  s_and_b32 s21, s21, 0xffff
  s_mov_b32 s22, 262144
  s_mov_b32 s23, 0x20000
  s_mul_i32 s36, s7, 229376
  s_add_u32 s28, s72, s36
  s_addc_u32 s29, s73, 0
  s_and_b32 s29, s29, 0xffff
  s_mov_b32 s30, 229376
  s_mov_b32 s31, 0x20000
  s_load_dwordx4 s[80:83], s[0:1], 80
  s_waitcnt lgkmcnt(0)
  s_barrier
  s_cmp_eq_u32 s2, 0
  s_cbranch_scc0 L_nononce
  s_memrealtime s[74:75]
  s_waitcnt lgkmcnt(0)
  s_or_b32 s74, s74, 1
  v_mov_b32 v57, s74
  v_mov_b32 v58, 0
  s_mov_b64 exec, 1
  global_store_dword v58, v57, s[82:83] sc0 sc1
  s_mov_b64 exec, -1
L_nononce:
  s_getpc_b64 s[76:77]
L_pcref:
  s_sub_u32 s76, s76, (L_pcref - concat_heads__gqa_block_cached__mha_block_cached__near_ridge_kernel)
  s_subb_u32 s77, s77, 0
  s_lshr_b32 s78, s2, 3
  s_mul_i32 s78, s78, 3072
  s_min_u32 s78, s78, (L_kend - concat_heads__gqa_block_cached__mha_block_cached__near_ridge_kernel - 3072)
  s_add_u32 s76, s76, s78
  s_addc_u32 s77, s77, 0
  v_lshlrev_b32 v56, 4, v0
  global_load_dwordx4 v[176:179], v56, s[76:77] offset:0
  global_load_dwordx4 v[180:183], v56, s[76:77] offset:1024
  global_load_dwordx4 v[184:187], v56, s[76:77] offset:2048
  s_mov_b32 m0, 139264
  s_add_u32 s40, s8, 0
  buffer_load_dwordx4 v20, s[24:27], s40 offen nt lds
  buffer_load_dwordx4 v21, s[24:27], s40 offen offset:1024 nt lds
  buffer_load_dwordx4 v22, s[24:27], s40 offen offset:2048 nt lds
  buffer_load_dwordx4 v23, s[24:27], s40 offen offset:3072 nt lds
  s_waitcnt vmcnt(32)
  s_mov_b32 m0, 143360
  s_add_u32 s40, s8, 65536
  buffer_load_dwordx4 v20, s[24:27], s40 offen nt lds
  buffer_load_dwordx4 v21, s[24:27], s40 offen offset:1024 nt lds
  buffer_load_dwordx4 v22, s[24:27], s40 offen offset:2048 nt lds
  buffer_load_dwordx4 v23, s[24:27], s40 offen offset:3072 nt lds
  s_add_u32 s8, s8, 131072
  s_cmp_eq_u32 s8, 3670016
  s_cselect_b32 s8, 0, s8
  s_waitcnt vmcnt(32)
  s_mov_b32 m0, 4096
  s_add_u32 s40, s34, 0
  buffer_load_dwordx4 v54, s[12:15], s40 offen lds
  s_mov_b32 m0, 5120
  s_add_u32 s40, s34, 7168
  buffer_load_dwordx4 v55, s[12:15], s40 offen lds
  s_mov_b32 m0, 6144
  s_add_u32 s40, s34, 14336
  buffer_load_dwordx4 v54, s[12:15], s40 offen lds
  s_mov_b32 m0, 7168
  s_add_u32 s40, s34, 21504
  buffer_load_dwordx4 v55, s[12:15], s40 offen lds
  s_waitcnt vmcnt(32)
  s_mov_b32 m0, 20480
  s_add_u32 s40, s34, 28672
  buffer_load_dwordx4 v54, s[12:15], s40 offen lds
  s_mov_b32 m0, 21504
  s_add_u32 s40, s34, 35840
  buffer_load_dwordx4 v55, s[12:15], s40 offen lds
  s_mov_b32 m0, 22528
  s_add_u32 s40, s34, 43008
  buffer_load_dwordx4 v54, s[12:15], s40 offen lds
  s_mov_b32 m0, 23552
  s_add_u32 s40, s34, 50176
  buffer_load_dwordx4 v55, s[12:15], s40 offen lds
  s_waitcnt vmcnt(32)
  v_mov_b32 v9, 1
  ds_max_u32 v8, v9 offset:0
  s_mov_b32 m0, 36864
  s_add_u32 s40, s34, 57344
  buffer_load_dwordx4 v54, s[12:15], s40 offen lds
  s_mov_b32 m0, 37888
  s_add_u32 s40, s34, 64512
  buffer_load_dwordx4 v55, s[12:15], s40 offen lds
  s_mov_b32 m0, 38912
  s_add_u32 s40, s34, 71680
  buffer_load_dwordx4 v54, s[12:15], s40 offen lds
  s_mov_b32 m0, 39936
  s_add_u32 s40, s34, 78848
  buffer_load_dwordx4 v55, s[12:15], s40 offen lds
  s_waitcnt vmcnt(32)
  s_add_u32 s34, s34, 128
  s_cmp_eq_u32 s34, 896
  s_cselect_b32 s34, 0, s34
  s_mov_b32 m0, 155648
  s_add_u32 s40, s8, 0
  buffer_load_dwordx4 v20, s[24:27], s40 offen nt lds
  buffer_load_dwordx4 v21, s[24:27], s40 offen offset:1024 nt lds
  buffer_load_dwordx4 v22, s[24:27], s40 offen offset:2048 nt lds
  buffer_load_dwordx4 v23, s[24:27], s40 offen offset:3072 nt lds
  s_waitcnt vmcnt(32)
  v_mov_b32 v9, 2
  ds_max_u32 v8, v9 offset:0
  s_mov_b32 m0, 159744
  s_add_u32 s40, s8, 65536
  buffer_load_dwordx4 v20, s[24:27], s40 offen nt lds
  buffer_load_dwordx4 v21, s[24:27], s40 offen offset:1024 nt lds
  buffer_load_dwordx4 v22, s[24:27], s40 offen offset:2048 nt lds
  buffer_load_dwordx4 v23, s[24:27], s40 offen offset:3072 nt lds
  s_add_u32 s8, s8, 131072
  s_cmp_eq_u32 s8, 3670016
  s_cselect_b32 s8, 0, s8
  s_waitcnt vmcnt(32)
  s_mov_b32 m0, 49152
  s_add_u32 s40, s8, 0
  buffer_load_dwordx4 v20, s[24:27], s40 offen nt lds
  buffer_load_dwordx4 v21, s[24:27], s40 offen offset:1024 nt lds
  buffer_load_dwordx4 v22, s[24:27], s40 offen offset:2048 nt lds
  buffer_load_dwordx4 v23, s[24:27], s40 offen offset:3072 nt lds
  s_waitcnt vmcnt(32)
  v_mov_b32 v9, 3
  ds_max_u32 v8, v9 offset:0
  s_mov_b32 m0, 53248
  s_add_u32 s40, s8, 65536
  buffer_load_dwordx4 v20, s[24:27], s40 offen nt lds
  buffer_load_dwordx4 v21, s[24:27], s40 offen offset:1024 nt lds
  buffer_load_dwordx4 v22, s[24:27], s40 offen offset:2048 nt lds
  buffer_load_dwordx4 v23, s[24:27], s40 offen offset:3072 nt lds
  s_add_u32 s8, s8, 131072
  s_cmp_eq_u32 s8, 3670016
  s_cselect_b32 s8, 0, s8
  s_waitcnt vmcnt(32)
  s_mov_b32 m0, 57344
  s_add_u32 s40, s8, 0
  buffer_load_dwordx4 v20, s[24:27], s40 offen nt lds
  buffer_load_dwordx4 v21, s[24:27], s40 offen offset:1024 nt lds
  buffer_load_dwordx4 v22, s[24:27], s40 offen offset:2048 nt lds
  buffer_load_dwordx4 v23, s[24:27], s40 offen offset:3072 nt lds
  s_waitcnt vmcnt(32)
  v_mov_b32 v9, 4
  ds_max_u32 v8, v9 offset:0
  s_mov_b32 m0, 61440
  s_add_u32 s40, s8, 65536
  buffer_load_dwordx4 v20, s[24:27], s40 offen nt lds
  buffer_load_dwordx4 v21, s[24:27], s40 offen offset:1024 nt lds
  buffer_load_dwordx4 v22, s[24:27], s40 offen offset:2048 nt lds
  buffer_load_dwordx4 v23, s[24:27], s40 offen offset:3072 nt lds
  s_add_u32 s8, s8, 131072
  s_cmp_eq_u32 s8, 3670016
  s_cselect_b32 s8, 0, s8
  s_waitcnt vmcnt(32)
  v_add_u32 v4, 0, v2
  v_xor_b32 v4, v4, v3
  v_lshlrev_b32 v4, 4, v4
  v_lshlrev_b32 v5, 9, v2
  v_add_u32 v10, v4, v5
  v_add_u32 v4, 2, v2
  v_xor_b32 v4, v4, v3
  v_lshlrev_b32 v4, 4, v4
  v_lshlrev_b32 v5, 9, v2
  v_add_u32 v11, v4, v5
  v_add_u32 v4, 4, v2
  v_xor_b32 v4, v4, v3
  v_lshlrev_b32 v4, 4, v4
  v_lshlrev_b32 v5, 9, v2
  v_add_u32 v12, v4, v5
  v_add_u32 v4, 6, v2
  v_xor_b32 v4, v4, v3
  v_lshlrev_b32 v4, 4, v4
  v_lshlrev_b32 v5, 9, v2
  v_add_u32 v13, v4, v5
  v_add_u32 v4, 8, v2
  v_xor_b32 v4, v4, v3
  v_lshlrev_b32 v4, 4, v4
  v_lshlrev_b32 v5, 9, v2
  v_add_u32 v14, v4, v5
  v_add_u32 v4, 10, v2
  v_xor_b32 v4, v4, v3
  v_lshlrev_b32 v4, 4, v4
  v_lshlrev_b32 v5, 9, v2
  v_add_u32 v15, v4, v5
  v_add_u32 v4, 12, v2
  v_xor_b32 v4, v4, v3
  v_lshlrev_b32 v4, 4, v4
  v_lshlrev_b32 v5, 9, v2
  v_add_u32 v16, v4, v5
  v_add_u32 v4, 14, v2
  v_xor_b32 v4, v4, v3
  v_lshlrev_b32 v4, 4, v4
  v_lshlrev_b32 v5, 9, v2
  v_add_u32 v17, v4, v5
  v_lshrrev_b32 v4, 4, v0
  v_and_b32 v5, 15, v0
  v_lshlrev_b32 v6, 2, v4
  v_xor_b32 v5, v5, v6
  v_lshlrev_b32 v5, 4, v5
  v_lshl_add_u32 v4, v4, 9, v5
  v_add_u32 v24, 0, v4
  v_add_u32 v25, 1024, v4
  v_add_u32 v26, 2048, v4
  v_add_u32 v27, 3072, v4
  v_lshrrev_b32 v4, 3, v0
  v_and_b32 v5, 7, v0
  v_lshrrev_b32 v6, 4, v0
  v_and_b32 v6, 1, v6
  v_lshlrev_b32 v6, 2, v6
  v_xor_b32 v5, v5, v6
  v_lshlrev_b32 v5, 4, v5
  v_mul_u32_u24 v4, 896, v4
  v_add_u32 v4, v4, v5
  v_add_u32 v30, 0, v4
  v_add_u32 v31, 6144, v4
  v_add_u32 v32, 12288, v4
  v_add_u32 v33, 18432, v4
  v_lshlrev_b32 v44, 4, v0
  s_mul_i32 s36, s6, 14336
  s_mov_b32 m0, 65536
  s_add_u32 s40, s8, 0
  buffer_load_dwordx4 v20, s[24:27], s40 offen nt lds
  buffer_load_dwordx4 v21, s[24:27], s40 offen offset:1024 nt lds
  buffer_load_dwordx4 v22, s[24:27], s40 offen offset:2048 nt lds
  buffer_load_dwordx4 v23, s[24:27], s40 offen offset:3072 nt lds
  s_waitcnt vmcnt(32)
  s_mov_b32 m0, 69632
  s_add_u32 s40, s8, 65536
  buffer_load_dwordx4 v20, s[24:27], s40 offen nt lds
  buffer_load_dwordx4 v21, s[24:27], s40 offen offset:1024 nt lds
  buffer_load_dwordx4 v22, s[24:27], s40 offen offset:2048 nt lds
  buffer_load_dwordx4 v23, s[24:27], s40 offen offset:3072 nt lds
  s_add_u32 s8, s8, 131072
  s_cmp_eq_u32 s8, 3670016
  s_cselect_b32 s8, 0, s8
  s_waitcnt vmcnt(32)
  s_mov_b32 m0, 8192
  s_add_u32 s40, s34, 0
  buffer_load_dwordx4 v54, s[12:15], s40 offen lds
  s_mov_b32 m0, 9216
  s_add_u32 s40, s34, 7168
  buffer_load_dwordx4 v55, s[12:15], s40 offen lds
  s_mov_b32 m0, 10240
  s_add_u32 s40, s34, 14336
  buffer_load_dwordx4 v54, s[12:15], s40 offen lds
  s_mov_b32 m0, 11264
  s_add_u32 s40, s34, 21504
  buffer_load_dwordx4 v55, s[12:15], s40 offen lds
  s_waitcnt vmcnt(32)
  s_mov_b32 m0, 24576
  s_add_u32 s40, s34, 28672
  buffer_load_dwordx4 v54, s[12:15], s40 offen lds
  s_mov_b32 m0, 25600
  s_add_u32 s40, s34, 35840
  buffer_load_dwordx4 v55, s[12:15], s40 offen lds
  s_mov_b32 m0, 26624
  s_add_u32 s40, s34, 43008
  buffer_load_dwordx4 v54, s[12:15], s40 offen lds
  s_mov_b32 m0, 27648
  s_add_u32 s40, s34, 50176
  buffer_load_dwordx4 v55, s[12:15], s40 offen lds
  s_waitcnt vmcnt(32)
  v_mov_b32 v9, 5
  ds_max_u32 v8, v9 offset:0
  s_mov_b32 m0, 40960
  s_add_u32 s40, s34, 57344
  buffer_load_dwordx4 v54, s[12:15], s40 offen lds
  s_mov_b32 m0, 41984
  s_add_u32 s40, s34, 64512
  buffer_load_dwordx4 v55, s[12:15], s40 offen lds
  s_mov_b32 m0, 43008
  s_add_u32 s40, s34, 71680
  buffer_load_dwordx4 v54, s[12:15], s40 offen lds
  s_mov_b32 m0, 44032
  s_add_u32 s40, s34, 78848
  buffer_load_dwordx4 v55, s[12:15], s40 offen lds
  s_waitcnt vmcnt(32)
  s_add_u32 s34, s34, 128
  s_cmp_eq_u32 s34, 896
  s_cselect_b32 s34, 0, s34
  s_mov_b32 m0, 73728
  s_add_u32 s40, s8, 0
  buffer_load_dwordx4 v20, s[24:27], s40 offen nt lds
  buffer_load_dwordx4 v21, s[24:27], s40 offen offset:1024 nt lds
  buffer_load_dwordx4 v22, s[24:27], s40 offen offset:2048 nt lds
  buffer_load_dwordx4 v23, s[24:27], s40 offen offset:3072 nt lds
  s_waitcnt vmcnt(32)
  v_mov_b32 v9, 6
  ds_max_u32 v8, v9 offset:0
  s_mov_b32 m0, 77824
  s_add_u32 s40, s8, 65536
  buffer_load_dwordx4 v20, s[24:27], s40 offen nt lds
  buffer_load_dwordx4 v21, s[24:27], s40 offen offset:1024 nt lds
  buffer_load_dwordx4 v22, s[24:27], s40 offen offset:2048 nt lds
  buffer_load_dwordx4 v23, s[24:27], s40 offen offset:3072 nt lds
  s_add_u32 s8, s8, 131072
  s_cmp_eq_u32 s8, 3670016
  s_cselect_b32 s8, 0, s8
  s_waitcnt vmcnt(32)
  s_mov_b32 m0, 81920
  s_add_u32 s40, s8, 0
  buffer_load_dwordx4 v20, s[24:27], s40 offen nt lds
  buffer_load_dwordx4 v21, s[24:27], s40 offen offset:1024 nt lds
  buffer_load_dwordx4 v22, s[24:27], s40 offen offset:2048 nt lds
  buffer_load_dwordx4 v23, s[24:27], s40 offen offset:3072 nt lds
  s_waitcnt vmcnt(32)
  v_mov_b32 v9, 7
  ds_max_u32 v8, v9 offset:0
  s_mov_b32 m0, 86016
  s_add_u32 s40, s8, 65536
  buffer_load_dwordx4 v20, s[24:27], s40 offen nt lds
  buffer_load_dwordx4 v21, s[24:27], s40 offen offset:1024 nt lds
  buffer_load_dwordx4 v22, s[24:27], s40 offen offset:2048 nt lds
  buffer_load_dwordx4 v23, s[24:27], s40 offen offset:3072 nt lds
  s_add_u32 s8, s8, 131072
  s_cmp_eq_u32 s8, 3670016
  s_cselect_b32 s8, 0, s8
  s_waitcnt vmcnt(32)
  s_mov_b32 m0, 90112
  s_add_u32 s40, s8, 0
  buffer_load_dwordx4 v20, s[24:27], s40 offen nt lds
  buffer_load_dwordx4 v21, s[24:27], s40 offen offset:1024 nt lds
  buffer_load_dwordx4 v22, s[24:27], s40 offen offset:2048 nt lds
  buffer_load_dwordx4 v23, s[24:27], s40 offen offset:3072 nt lds
  s_waitcnt vmcnt(32)
  v_mov_b32 v9, 8
  ds_max_u32 v8, v9 offset:0
  s_mov_b32 m0, 94208
  s_add_u32 s40, s8, 65536
  buffer_load_dwordx4 v20, s[24:27], s40 offen nt lds
  buffer_load_dwordx4 v21, s[24:27], s40 offen offset:1024 nt lds
  buffer_load_dwordx4 v22, s[24:27], s40 offen offset:2048 nt lds
  buffer_load_dwordx4 v23, s[24:27], s40 offen offset:3072 nt lds
  s_add_u32 s8, s8, 131072
  s_cmp_eq_u32 s8, 3670016
  s_cselect_b32 s8, 0, s8
  s_waitcnt vmcnt(32)
  s_mov_b32 m0, 98304
  s_add_u32 s40, s8, 0
  buffer_load_dwordx4 v20, s[24:27], s40 offen nt lds
  buffer_load_dwordx4 v21, s[24:27], s40 offen offset:1024 nt lds
  buffer_load_dwordx4 v22, s[24:27], s40 offen offset:2048 nt lds
  buffer_load_dwordx4 v23, s[24:27], s40 offen offset:3072 nt lds
  s_waitcnt vmcnt(32)
  s_mov_b32 m0, 102400
  s_add_u32 s40, s8, 65536
  buffer_load_dwordx4 v20, s[24:27], s40 offen nt lds
  buffer_load_dwordx4 v21, s[24:27], s40 offen offset:1024 nt lds
  buffer_load_dwordx4 v22, s[24:27], s40 offen offset:2048 nt lds
  buffer_load_dwordx4 v23, s[24:27], s40 offen offset:3072 nt lds
  s_add_u32 s8, s8, 131072
  s_cmp_eq_u32 s8, 3670016
  s_cselect_b32 s8, 0, s8
  s_waitcnt vmcnt(32)
  s_mov_b32 m0, 12288
  s_add_u32 s40, s34, 0
  buffer_load_dwordx4 v54, s[12:15], s40 offen lds
  s_mov_b32 m0, 13312
  s_add_u32 s40, s34, 7168
  buffer_load_dwordx4 v55, s[12:15], s40 offen lds
  s_mov_b32 m0, 14336
  s_add_u32 s40, s34, 14336
  buffer_load_dwordx4 v54, s[12:15], s40 offen lds
  s_mov_b32 m0, 15360
  s_add_u32 s40, s34, 21504
  buffer_load_dwordx4 v55, s[12:15], s40 offen lds
  s_waitcnt vmcnt(32)
  s_mov_b32 m0, 28672
  s_add_u32 s40, s34, 28672
  buffer_load_dwordx4 v54, s[12:15], s40 offen lds
  s_mov_b32 m0, 29696
  s_add_u32 s40, s34, 35840
  buffer_load_dwordx4 v55, s[12:15], s40 offen lds
  s_mov_b32 m0, 30720
  s_add_u32 s40, s34, 43008
  buffer_load_dwordx4 v54, s[12:15], s40 offen lds
  s_mov_b32 m0, 31744
  s_add_u32 s40, s34, 50176
  buffer_load_dwordx4 v55, s[12:15], s40 offen lds
  s_waitcnt vmcnt(32)
  v_mov_b32 v9, 9
  ds_max_u32 v8, v9 offset:0
  s_mov_b32 m0, 45056
  s_add_u32 s40, s34, 57344
  buffer_load_dwordx4 v54, s[12:15], s40 offen lds
  s_mov_b32 m0, 46080
  s_add_u32 s40, s34, 64512
  buffer_load_dwordx4 v55, s[12:15], s40 offen lds
  s_mov_b32 m0, 47104
  s_add_u32 s40, s34, 71680
  buffer_load_dwordx4 v54, s[12:15], s40 offen lds
  s_mov_b32 m0, 48128
  s_add_u32 s40, s34, 78848
  buffer_load_dwordx4 v55, s[12:15], s40 offen lds
  s_waitcnt vmcnt(32)
  s_add_u32 s34, s34, 128
  s_cmp_eq_u32 s34, 896
  s_cselect_b32 s34, 0, s34
  s_mov_b32 m0, 106496
  s_add_u32 s40, s8, 0
  buffer_load_dwordx4 v20, s[24:27], s40 offen nt lds
  buffer_load_dwordx4 v21, s[24:27], s40 offen offset:1024 nt lds
  buffer_load_dwordx4 v22, s[24:27], s40 offen offset:2048 nt lds
  buffer_load_dwordx4 v23, s[24:27], s40 offen offset:3072 nt lds
  s_waitcnt vmcnt(32)
  v_mov_b32 v9, 10
  ds_max_u32 v8, v9 offset:0
  s_mov_b32 m0, 110592
  s_add_u32 s40, s8, 65536
  buffer_load_dwordx4 v20, s[24:27], s40 offen nt lds
  buffer_load_dwordx4 v21, s[24:27], s40 offen offset:1024 nt lds
  buffer_load_dwordx4 v22, s[24:27], s40 offen offset:2048 nt lds
  buffer_load_dwordx4 v23, s[24:27], s40 offen offset:3072 nt lds
  s_add_u32 s8, s8, 131072
  s_cmp_eq_u32 s8, 3670016
  s_cselect_b32 s8, 0, s8
  s_waitcnt vmcnt(32)
  s_cmp_ge_u32 s38, 1
  s_cbranch_scc1 L_fr_0
  ds_read_b32 v52, v8 offset:8
  s_waitcnt lgkmcnt(0)
  v_readlane_b32 s38, v52, 0
  v_readlane_b32 s37, v52, 1
  v_readlane_b32 s41, v52, 2
  s_nop 0
  s_min_u32 s38, s38, s37
  s_min_u32 s38, s38, s41
  s_cmp_ge_u32 s38, 1
  s_cbranch_scc1 L_fr_0
  s_waitcnt vmcnt(20)
  v_mov_b32 v9, 12
  ds_max_u32 v8, v9 offset:0
L_sp_0:
  ds_read_b32 v52, v8 offset:8
  s_waitcnt lgkmcnt(0)
  v_readlane_b32 s38, v52, 0
  v_readlane_b32 s37, v52, 1
  v_readlane_b32 s41, v52, 2
  s_nop 0
  s_min_u32 s38, s38, s37
  s_min_u32 s38, s38, s41
  s_cmp_ge_u32 s38, 1
  s_cbranch_scc0 L_sp_0
L_fr_0:
  s_mov_b32 m0, 114688
  s_add_u32 s40, s8, 0
  buffer_load_dwordx4 v20, s[24:27], s40 offen nt lds
  buffer_load_dwordx4 v21, s[24:27], s40 offen offset:1024 nt lds
  buffer_load_dwordx4 v22, s[24:27], s40 offen offset:2048 nt lds
  buffer_load_dwordx4 v23, s[24:27], s40 offen offset:3072 nt lds
  s_waitcnt vmcnt(32)
  v_mov_b32 v9, 11
  ds_max_u32 v8, v9 offset:0
  s_mov_b32 m0, 118784
  s_add_u32 s40, s8, 65536
  buffer_load_dwordx4 v20, s[24:27], s40 offen nt lds
  buffer_load_dwordx4 v21, s[24:27], s40 offen offset:1024 nt lds
  buffer_load_dwordx4 v22, s[24:27], s40 offen offset:2048 nt lds
  buffer_load_dwordx4 v23, s[24:27], s40 offen offset:3072 nt lds
  s_add_u32 s8, s8, 131072
  s_cmp_eq_u32 s8, 3670016
  s_cselect_b32 s8, 0, s8
  s_waitcnt vmcnt(32)
  s_cmp_ge_u32 s38, 2
  s_cbranch_scc1 L_fr_1
  ds_read_b32 v52, v8 offset:8
  s_waitcnt lgkmcnt(0)
  v_readlane_b32 s38, v52, 0
  v_readlane_b32 s37, v52, 1
  v_readlane_b32 s41, v52, 2
  s_nop 0
  s_min_u32 s38, s38, s37
  s_min_u32 s38, s38, s41
  s_cmp_ge_u32 s38, 2
  s_cbranch_scc1 L_fr_1
  s_waitcnt vmcnt(8)
  v_mov_b32 v9, 13
  ds_max_u32 v8, v9 offset:0
L_sp_1:
  ds_read_b32 v52, v8 offset:8
  s_waitcnt lgkmcnt(0)
  v_readlane_b32 s38, v52, 0
  v_readlane_b32 s37, v52, 1
  v_readlane_b32 s41, v52, 2
  s_nop 0
  s_min_u32 s38, s38, s37
  s_min_u32 s38, s38, s41
  s_cmp_ge_u32 s38, 2
  s_cbranch_scc0 L_sp_1
L_fr_1:
  s_mov_b32 m0, 122880
  s_add_u32 s40, s8, 0
  buffer_load_dwordx4 v20, s[24:27], s40 offen nt lds
  buffer_load_dwordx4 v21, s[24:27], s40 offen offset:1024 nt lds
  buffer_load_dwordx4 v22, s[24:27], s40 offen offset:2048 nt lds
  buffer_load_dwordx4 v23, s[24:27], s40 offen offset:3072 nt lds
  s_waitcnt vmcnt(32)
  v_mov_b32 v9, 12
  ds_max_u32 v8, v9 offset:0
  s_mov_b32 m0, 126976
  s_add_u32 s40, s8, 65536
  buffer_load_dwordx4 v20, s[24:27], s40 offen nt lds
  buffer_load_dwordx4 v21, s[24:27], s40 offen offset:1024 nt lds
  buffer_load_dwordx4 v22, s[24:27], s40 offen offset:2048 nt lds
  buffer_load_dwordx4 v23, s[24:27], s40 offen offset:3072 nt lds
  s_add_u32 s8, s8, 131072
  s_cmp_eq_u32 s8, 3670016
  s_cselect_b32 s8, 0, s8
  s_waitcnt vmcnt(32)
  s_cmp_ge_u32 s38, 3
  s_cbranch_scc1 L_fr_2
  ds_read_b32 v52, v8 offset:8
  s_waitcnt lgkmcnt(0)
  v_readlane_b32 s38, v52, 0
  v_readlane_b32 s37, v52, 1
  v_readlane_b32 s41, v52, 2
  s_nop 0
  s_min_u32 s38, s38, s37
  s_min_u32 s38, s38, s41
  s_cmp_ge_u32 s38, 3
  s_cbranch_scc1 L_fr_2
  s_waitcnt vmcnt(8)
  v_mov_b32 v9, 14
  ds_max_u32 v8, v9 offset:0
L_sp_2:
  ds_read_b32 v52, v8 offset:8
  s_waitcnt lgkmcnt(0)
  v_readlane_b32 s38, v52, 0
  v_readlane_b32 s37, v52, 1
  v_readlane_b32 s41, v52, 2
  s_nop 0
  s_min_u32 s38, s38, s37
  s_min_u32 s38, s38, s41
  s_cmp_ge_u32 s38, 3
  s_cbranch_scc0 L_sp_2
L_fr_2:
  s_mov_b32 m0, 131072
  s_add_u32 s40, s8, 0
  buffer_load_dwordx4 v20, s[24:27], s40 offen nt lds
  buffer_load_dwordx4 v21, s[24:27], s40 offen offset:1024 nt lds
  buffer_load_dwordx4 v22, s[24:27], s40 offen offset:2048 nt lds
  buffer_load_dwordx4 v23, s[24:27], s40 offen offset:3072 nt lds
  s_waitcnt vmcnt(32)
  s_mov_b32 m0, 135168
  s_add_u32 s40, s8, 65536
  buffer_load_dwordx4 v20, s[24:27], s40 offen nt lds
  buffer_load_dwordx4 v21, s[24:27], s40 offen offset:1024 nt lds
  buffer_load_dwordx4 v22, s[24:27], s40 offen offset:2048 nt lds
  buffer_load_dwordx4 v23, s[24:27], s40 offen offset:3072 nt lds
  s_add_u32 s8, s8, 131072
  s_cmp_eq_u32 s8, 3670016
  s_cselect_b32 s8, 0, s8
  s_waitcnt vmcnt(32)
  s_cmp_ge_u32 s38, 4
  s_cbranch_scc1 L_fr_3
  ds_read_b32 v52, v8 offset:8
  s_waitcnt lgkmcnt(0)
  v_readlane_b32 s38, v52, 0
  v_readlane_b32 s37, v52, 1
  v_readlane_b32 s41, v52, 2
  s_nop 0
  s_min_u32 s38, s38, s37
  s_min_u32 s38, s38, s41
  s_cmp_ge_u32 s38, 4
  s_cbranch_scc1 L_fr_3
  s_waitcnt vmcnt(8)
  v_mov_b32 v9, 15
  ds_max_u32 v8, v9 offset:0
L_sp_3:
  ds_read_b32 v52, v8 offset:8
  s_waitcnt lgkmcnt(0)
  v_readlane_b32 s38, v52, 0
  v_readlane_b32 s37, v52, 1
  v_readlane_b32 s41, v52, 2
  s_nop 0
  s_min_u32 s38, s38, s37
  s_min_u32 s38, s38, s41
  s_cmp_ge_u32 s38, 4
  s_cbranch_scc0 L_sp_3
L_fr_3:
  s_mov_b32 m0, 0
  s_add_u32 s40, s34, 0
  buffer_load_dwordx4 v54, s[12:15], s40 offen lds
  s_mov_b32 m0, 1024
  s_add_u32 s40, s34, 7168
  buffer_load_dwordx4 v55, s[12:15], s40 offen lds
  s_mov_b32 m0, 2048
  s_add_u32 s40, s34, 14336
  buffer_load_dwordx4 v54, s[12:15], s40 offen lds
  s_mov_b32 m0, 3072
  s_add_u32 s40, s34, 21504
  buffer_load_dwordx4 v55, s[12:15], s40 offen lds
  s_waitcnt vmcnt(32)
  s_mov_b32 m0, 16384
  s_add_u32 s40, s34, 28672
  buffer_load_dwordx4 v54, s[12:15], s40 offen lds
  s_mov_b32 m0, 17408
  s_add_u32 s40, s34, 35840
  buffer_load_dwordx4 v55, s[12:15], s40 offen lds
  s_mov_b32 m0, 18432
  s_add_u32 s40, s34, 43008
  buffer_load_dwordx4 v54, s[12:15], s40 offen lds
  s_mov_b32 m0, 19456
  s_add_u32 s40, s34, 50176
  buffer_load_dwordx4 v55, s[12:15], s40 offen lds
  s_waitcnt vmcnt(32)
  v_mov_b32 v9, 13
  ds_max_u32 v8, v9 offset:0
  s_mov_b32 m0, 32768
  s_add_u32 s40, s34, 57344
  buffer_load_dwordx4 v54, s[12:15], s40 offen lds
  s_mov_b32 m0, 33792
  s_add_u32 s40, s34, 64512
  buffer_load_dwordx4 v55, s[12:15], s40 offen lds
  s_mov_b32 m0, 34816
  s_add_u32 s40, s34, 71680
  buffer_load_dwordx4 v54, s[12:15], s40 offen lds
  s_mov_b32 m0, 35840
  s_add_u32 s40, s34, 78848
  buffer_load_dwordx4 v55, s[12:15], s40 offen lds
  s_waitcnt vmcnt(32)
  s_add_u32 s34, s34, 128
  s_cmp_eq_u32 s34, 896
  s_cselect_b32 s34, 0, s34
  s_mov_b32 m0, 139264
  s_add_u32 s40, s8, 0
  buffer_load_dwordx4 v20, s[24:27], s40 offen nt lds
  buffer_load_dwordx4 v21, s[24:27], s40 offen offset:1024 nt lds
  buffer_load_dwordx4 v22, s[24:27], s40 offen offset:2048 nt lds
  buffer_load_dwordx4 v23, s[24:27], s40 offen offset:3072 nt lds
  s_waitcnt vmcnt(32)
  v_mov_b32 v9, 14
  ds_max_u32 v8, v9 offset:0
  s_mov_b32 m0, 143360
  s_add_u32 s40, s8, 65536
  buffer_load_dwordx4 v20, s[24:27], s40 offen nt lds
  buffer_load_dwordx4 v21, s[24:27], s40 offen offset:1024 nt lds
  buffer_load_dwordx4 v22, s[24:27], s40 offen offset:2048 nt lds
  buffer_load_dwordx4 v23, s[24:27], s40 offen offset:3072 nt lds
  s_add_u32 s8, s8, 131072
  s_cmp_eq_u32 s8, 3670016
  s_cselect_b32 s8, 0, s8
  s_waitcnt vmcnt(32)
  s_cmp_ge_u32 s38, 5
  s_cbranch_scc1 L_fr_4
  ds_read_b32 v52, v8 offset:8
  s_waitcnt lgkmcnt(0)
  v_readlane_b32 s38, v52, 0
  v_readlane_b32 s37, v52, 1
  v_readlane_b32 s41, v52, 2
  s_nop 0
  s_min_u32 s38, s38, s37
  s_min_u32 s38, s38, s41
  s_cmp_ge_u32 s38, 5
  s_cbranch_scc1 L_fr_4
  s_waitcnt vmcnt(20)
  v_mov_b32 v9, 16
  ds_max_u32 v8, v9 offset:0
L_sp_4:
  ds_read_b32 v52, v8 offset:8
  s_waitcnt lgkmcnt(0)
  v_readlane_b32 s38, v52, 0
  v_readlane_b32 s37, v52, 1
  v_readlane_b32 s41, v52, 2
  s_nop 0
  s_min_u32 s38, s38, s37
  s_min_u32 s38, s38, s41
  s_cmp_ge_u32 s38, 5
  s_cbranch_scc0 L_sp_4
L_fr_4:
  s_mov_b32 m0, 155648
  s_add_u32 s40, s8, 0
  buffer_load_dwordx4 v20, s[24:27], s40 offen nt lds
  buffer_load_dwordx4 v21, s[24:27], s40 offen offset:1024 nt lds
  buffer_load_dwordx4 v22, s[24:27], s40 offen offset:2048 nt lds
  buffer_load_dwordx4 v23, s[24:27], s40 offen offset:3072 nt lds
  s_waitcnt vmcnt(32)
  v_mov_b32 v9, 15
  ds_max_u32 v8, v9 offset:0
  s_mov_b32 m0, 159744
  s_add_u32 s40, s8, 65536
  buffer_load_dwordx4 v20, s[24:27], s40 offen nt lds
  buffer_load_dwordx4 v21, s[24:27], s40 offen offset:1024 nt lds
  buffer_load_dwordx4 v22, s[24:27], s40 offen offset:2048 nt lds
  buffer_load_dwordx4 v23, s[24:27], s40 offen offset:3072 nt lds
  s_add_u32 s8, s8, 131072
  s_cmp_eq_u32 s8, 3670016
  s_cselect_b32 s8, 0, s8
  s_waitcnt vmcnt(32)
  s_cmp_ge_u32 s38, 10
  s_cbranch_scc1 L_fr_5
  ds_read_b32 v52, v8 offset:8
  s_waitcnt lgkmcnt(0)
  v_readlane_b32 s38, v52, 0
  v_readlane_b32 s37, v52, 1
  v_readlane_b32 s41, v52, 2
  s_nop 0
  s_min_u32 s38, s38, s37
  s_min_u32 s38, s38, s41
  s_cmp_ge_u32 s38, 10
  s_cbranch_scc1 L_fr_5
  s_waitcnt vmcnt(8)
  v_mov_b32 v9, 17
  ds_max_u32 v8, v9 offset:0
L_sp_5:
  ds_read_b32 v52, v8 offset:8
  s_waitcnt lgkmcnt(0)
  v_readlane_b32 s38, v52, 0
  v_readlane_b32 s37, v52, 1
  v_readlane_b32 s41, v52, 2
  s_nop 0
  s_min_u32 s38, s38, s37
  s_min_u32 s38, s38, s41
  s_cmp_ge_u32 s38, 10
  s_cbranch_scc0 L_sp_5
L_fr_5:
  s_mov_b32 m0, 81920
  s_add_u32 s40, s8, 0
  buffer_load_dwordx4 v20, s[24:27], s40 offen nt lds
  buffer_load_dwordx4 v21, s[24:27], s40 offen offset:1024 nt lds
  buffer_load_dwordx4 v22, s[24:27], s40 offen offset:2048 nt lds
  buffer_load_dwordx4 v23, s[24:27], s40 offen offset:3072 nt lds
  s_waitcnt vmcnt(32)
  v_mov_b32 v9, 16
  ds_max_u32 v8, v9 offset:0
  s_mov_b32 m0, 86016
  s_add_u32 s40, s8, 65536
  buffer_load_dwordx4 v20, s[24:27], s40 offen nt lds
  buffer_load_dwordx4 v21, s[24:27], s40 offen offset:1024 nt lds
  buffer_load_dwordx4 v22, s[24:27], s40 offen offset:2048 nt lds
  buffer_load_dwordx4 v23, s[24:27], s40 offen offset:3072 nt lds
  s_add_u32 s8, s8, 131072
  s_cmp_eq_u32 s8, 3670016
  s_cselect_b32 s8, 0, s8
  s_waitcnt vmcnt(32)
  s_cmp_ge_u32 s38, 11
  s_cbranch_scc1 L_fr_6
  ds_read_b32 v52, v8 offset:8
  s_waitcnt lgkmcnt(0)
  v_readlane_b32 s38, v52, 0
  v_readlane_b32 s37, v52, 1
  v_readlane_b32 s41, v52, 2
  s_nop 0
  s_min_u32 s38, s38, s37
  s_min_u32 s38, s38, s41
  s_cmp_ge_u32 s38, 11
  s_cbranch_scc1 L_fr_6
  s_waitcnt vmcnt(8)
  v_mov_b32 v9, 18
  ds_max_u32 v8, v9 offset:0
L_sp_6:
  ds_read_b32 v52, v8 offset:8
  s_waitcnt lgkmcnt(0)
  v_readlane_b32 s38, v52, 0
  v_readlane_b32 s37, v52, 1
  v_readlane_b32 s41, v52, 2
  s_nop 0
  s_min_u32 s38, s38, s37
  s_min_u32 s38, s38, s41
  s_cmp_ge_u32 s38, 11
  s_cbranch_scc0 L_sp_6
L_fr_6:
  s_mov_b32 m0, 90112
  s_add_u32 s40, s8, 0
  buffer_load_dwordx4 v20, s[24:27], s40 offen nt lds
  buffer_load_dwordx4 v21, s[24:27], s40 offen offset:1024 nt lds
  buffer_load_dwordx4 v22, s[24:27], s40 offen offset:2048 nt lds
  buffer_load_dwordx4 v23, s[24:27], s40 offen offset:3072 nt lds
  s_waitcnt vmcnt(32)
  s_mov_b32 m0, 94208
  s_add_u32 s40, s8, 65536
  buffer_load_dwordx4 v20, s[24:27], s40 offen nt lds
  buffer_load_dwordx4 v21, s[24:27], s40 offen offset:1024 nt lds
  buffer_load_dwordx4 v22, s[24:27], s40 offen offset:2048 nt lds
  buffer_load_dwordx4 v23, s[24:27], s40 offen offset:3072 nt lds
  s_add_u32 s8, s8, 131072
  s_cmp_eq_u32 s8, 3670016
  s_cselect_b32 s8, 0, s8
  s_waitcnt vmcnt(32)
  s_cmp_ge_u32 s38, 12
  s_cbranch_scc1 L_fr_7
  ds_read_b32 v52, v8 offset:8
  s_waitcnt lgkmcnt(0)
  v_readlane_b32 s38, v52, 0
  v_readlane_b32 s37, v52, 1
  v_readlane_b32 s41, v52, 2
  s_nop 0
  s_min_u32 s38, s38, s37
  s_min_u32 s38, s38, s41
  s_cmp_ge_u32 s38, 12
  s_cbranch_scc1 L_fr_7
  s_waitcnt vmcnt(8)
  v_mov_b32 v9, 19
  ds_max_u32 v8, v9 offset:0
L_sp_7:
  ds_read_b32 v52, v8 offset:8
  s_waitcnt lgkmcnt(0)
  v_readlane_b32 s38, v52, 0
  v_readlane_b32 s37, v52, 1
  v_readlane_b32 s41, v52, 2
  s_nop 0
  s_min_u32 s38, s38, s37
  s_min_u32 s38, s38, s41
  s_cmp_ge_u32 s38, 12
  s_cbranch_scc0 L_sp_7
L_fr_7:
  s_mov_b32 m0, 4096
  s_add_u32 s40, s34, 0
  buffer_load_dwordx4 v54, s[12:15], s40 offen lds
  s_mov_b32 m0, 5120
  s_add_u32 s40, s34, 7168
  buffer_load_dwordx4 v55, s[12:15], s40 offen lds
  s_mov_b32 m0, 6144
  s_add_u32 s40, s34, 14336
  buffer_load_dwordx4 v54, s[12:15], s40 offen lds
  s_mov_b32 m0, 7168
  s_add_u32 s40, s34, 21504
  buffer_load_dwordx4 v55, s[12:15], s40 offen lds
  s_waitcnt vmcnt(32)
  s_mov_b32 m0, 20480
  s_add_u32 s40, s34, 28672
  buffer_load_dwordx4 v54, s[12:15], s40 offen lds
  s_mov_b32 m0, 21504
  s_add_u32 s40, s34, 35840
  buffer_load_dwordx4 v55, s[12:15], s40 offen lds
  s_mov_b32 m0, 22528
  s_add_u32 s40, s34, 43008
  buffer_load_dwordx4 v54, s[12:15], s40 offen lds
  s_mov_b32 m0, 23552
  s_add_u32 s40, s34, 50176
  buffer_load_dwordx4 v55, s[12:15], s40 offen lds
  s_waitcnt vmcnt(32)
  v_mov_b32 v9, 17
  ds_max_u32 v8, v9 offset:0
  s_mov_b32 m0, 36864
  s_add_u32 s40, s34, 57344
  buffer_load_dwordx4 v54, s[12:15], s40 offen lds
  s_mov_b32 m0, 37888
  s_add_u32 s40, s34, 64512
  buffer_load_dwordx4 v55, s[12:15], s40 offen lds
  s_mov_b32 m0, 38912
  s_add_u32 s40, s34, 71680
  buffer_load_dwordx4 v54, s[12:15], s40 offen lds
  s_mov_b32 m0, 39936
  s_add_u32 s40, s34, 78848
  buffer_load_dwordx4 v55, s[12:15], s40 offen lds
  s_waitcnt vmcnt(32)
  s_add_u32 s34, s34, 128
  s_cmp_eq_u32 s34, 896
  s_cselect_b32 s34, 0, s34
  s_mov_b32 m0, 98304
  s_add_u32 s40, s8, 0
  buffer_load_dwordx4 v20, s[24:27], s40 offen nt lds
  buffer_load_dwordx4 v21, s[24:27], s40 offen offset:1024 nt lds
  buffer_load_dwordx4 v22, s[24:27], s40 offen offset:2048 nt lds
  buffer_load_dwordx4 v23, s[24:27], s40 offen offset:3072 nt lds
  s_waitcnt vmcnt(32)
  v_mov_b32 v9, 18
  ds_max_u32 v8, v9 offset:0
  s_mov_b32 m0, 102400
  s_add_u32 s40, s8, 65536
  buffer_load_dwordx4 v20, s[24:27], s40 offen nt lds
  buffer_load_dwordx4 v21, s[24:27], s40 offen offset:1024 nt lds
  buffer_load_dwordx4 v22, s[24:27], s40 offen offset:2048 nt lds
  buffer_load_dwordx4 v23, s[24:27], s40 offen offset:3072 nt lds
  s_add_u32 s8, s8, 131072
  s_cmp_eq_u32 s8, 3670016
  s_cselect_b32 s8, 0, s8
  s_waitcnt vmcnt(32)
  s_cmp_ge_u32 s38, 13
  s_cbranch_scc1 L_fr_8
  ds_read_b32 v52, v8 offset:8
  s_waitcnt lgkmcnt(0)
  v_readlane_b32 s38, v52, 0
  v_readlane_b32 s37, v52, 1
  v_readlane_b32 s41, v52, 2
  s_nop 0
  s_min_u32 s38, s38, s37
  s_min_u32 s38, s38, s41
  s_cmp_ge_u32 s38, 13
  s_cbranch_scc1 L_fr_8
  s_waitcnt vmcnt(20)
  v_mov_b32 v9, 20
  ds_max_u32 v8, v9 offset:0
L_sp_8:
  ds_read_b32 v52, v8 offset:8
  s_waitcnt lgkmcnt(0)
  v_readlane_b32 s38, v52, 0
  v_readlane_b32 s37, v52, 1
  v_readlane_b32 s41, v52, 2
  s_nop 0
  s_min_u32 s38, s38, s37
  s_min_u32 s38, s38, s41
  s_cmp_ge_u32 s38, 13
  s_cbranch_scc0 L_sp_8
L_fr_8:
  s_mov_b32 m0, 106496
  s_add_u32 s40, s8, 0
  buffer_load_dwordx4 v20, s[24:27], s40 offen nt lds
  buffer_load_dwordx4 v21, s[24:27], s40 offen offset:1024 nt lds
  buffer_load_dwordx4 v22, s[24:27], s40 offen offset:2048 nt lds
  buffer_load_dwordx4 v23, s[24:27], s40 offen offset:3072 nt lds
  s_waitcnt vmcnt(32)
  v_mov_b32 v9, 19
  ds_max_u32 v8, v9 offset:0
  s_mov_b32 m0, 110592
  s_add_u32 s40, s8, 65536
  buffer_load_dwordx4 v20, s[24:27], s40 offen nt lds
  buffer_load_dwordx4 v21, s[24:27], s40 offen offset:1024 nt lds
  buffer_load_dwordx4 v22, s[24:27], s40 offen offset:2048 nt lds
  buffer_load_dwordx4 v23, s[24:27], s40 offen offset:3072 nt lds
  s_add_u32 s8, s8, 131072
  s_cmp_eq_u32 s8, 3670016
  s_cselect_b32 s8, 0, s8
  s_waitcnt vmcnt(32)
  s_cmp_ge_u32 s38, 14
  s_cbranch_scc1 L_fr_9
  ds_read_b32 v52, v8 offset:8
  s_waitcnt lgkmcnt(0)
  v_readlane_b32 s38, v52, 0
  v_readlane_b32 s37, v52, 1
  v_readlane_b32 s41, v52, 2
  s_nop 0
  s_min_u32 s38, s38, s37
  s_min_u32 s38, s38, s41
  s_cmp_ge_u32 s38, 14
  s_cbranch_scc1 L_fr_9
  s_waitcnt vmcnt(8)
  v_mov_b32 v9, 21
  ds_max_u32 v8, v9 offset:0
L_sp_9:
  ds_read_b32 v52, v8 offset:8
  s_waitcnt lgkmcnt(0)
  v_readlane_b32 s38, v52, 0
  v_readlane_b32 s37, v52, 1
  v_readlane_b32 s41, v52, 2
  s_nop 0
  s_min_u32 s38, s38, s37
  s_min_u32 s38, s38, s41
  s_cmp_ge_u32 s38, 14
  s_cbranch_scc0 L_sp_9
L_fr_9:
  s_mov_b32 m0, 114688
  s_add_u32 s40, s8, 0
  buffer_load_dwordx4 v20, s[24:27], s40 offen nt lds
  buffer_load_dwordx4 v21, s[24:27], s40 offen offset:1024 nt lds
  buffer_load_dwordx4 v22, s[24:27], s40 offen offset:2048 nt lds
  buffer_load_dwordx4 v23, s[24:27], s40 offen offset:3072 nt lds
  s_waitcnt vmcnt(32)
  v_mov_b32 v9, 20
  ds_max_u32 v8, v9 offset:0
  s_mov_b32 m0, 118784
  s_add_u32 s40, s8, 65536
  buffer_load_dwordx4 v20, s[24:27], s40 offen nt lds
  buffer_load_dwordx4 v21, s[24:27], s40 offen offset:1024 nt lds
  buffer_load_dwordx4 v22, s[24:27], s40 offen offset:2048 nt lds
  buffer_load_dwordx4 v23, s[24:27], s40 offen offset:3072 nt lds
  s_add_u32 s8, s8, 131072
  s_cmp_eq_u32 s8, 3670016
  s_cselect_b32 s8, 0, s8
  s_waitcnt vmcnt(32)
  s_cmp_ge_u32 s38, 15
  s_cbranch_scc1 L_fr_10
  ds_read_b32 v52, v8 offset:8
  s_waitcnt lgkmcnt(0)
  v_readlane_b32 s38, v52, 0
  v_readlane_b32 s37, v52, 1
  v_readlane_b32 s41, v52, 2
  s_nop 0
  s_min_u32 s38, s38, s37
  s_min_u32 s38, s38, s41
  s_cmp_ge_u32 s38, 15
  s_cbranch_scc1 L_fr_10
  s_waitcnt vmcnt(8)
  v_mov_b32 v9, 22
  ds_max_u32 v8, v9 offset:0
L_sp_10:
  ds_read_b32 v52, v8 offset:8
  s_waitcnt lgkmcnt(0)
  v_readlane_b32 s38, v52, 0
  v_readlane_b32 s37, v52, 1
  v_readlane_b32 s41, v52, 2
  s_nop 0
  s_min_u32 s38, s38, s37
  s_min_u32 s38, s38, s41
  s_cmp_ge_u32 s38, 15
  s_cbranch_scc0 L_sp_10
L_fr_10:
  s_mov_b32 m0, 122880
  s_add_u32 s40, s8, 0
  buffer_load_dwordx4 v20, s[24:27], s40 offen nt lds
  buffer_load_dwordx4 v21, s[24:27], s40 offen offset:1024 nt lds
  buffer_load_dwordx4 v22, s[24:27], s40 offen offset:2048 nt lds
  buffer_load_dwordx4 v23, s[24:27], s40 offen offset:3072 nt lds
  s_waitcnt vmcnt(32)
  s_mov_b32 m0, 126976
  s_add_u32 s40, s8, 65536
  buffer_load_dwordx4 v20, s[24:27], s40 offen nt lds
  buffer_load_dwordx4 v21, s[24:27], s40 offen offset:1024 nt lds
  buffer_load_dwordx4 v22, s[24:27], s40 offen offset:2048 nt lds
  buffer_load_dwordx4 v23, s[24:27], s40 offen offset:3072 nt lds
  s_add_u32 s8, s8, 131072
  s_cmp_eq_u32 s8, 3670016
  s_cselect_b32 s8, 0, s8
  s_waitcnt vmcnt(32)
  s_cmp_ge_u32 s38, 16
  s_cbranch_scc1 L_fr_11
  ds_read_b32 v52, v8 offset:8
  s_waitcnt lgkmcnt(0)
  v_readlane_b32 s38, v52, 0
  v_readlane_b32 s37, v52, 1
  v_readlane_b32 s41, v52, 2
  s_nop 0
  s_min_u32 s38, s38, s37
  s_min_u32 s38, s38, s41
  s_cmp_ge_u32 s38, 16
  s_cbranch_scc1 L_fr_11
  s_waitcnt vmcnt(8)
  v_mov_b32 v9, 23
  ds_max_u32 v8, v9 offset:0
L_sp_11:
  ds_read_b32 v52, v8 offset:8
  s_waitcnt lgkmcnt(0)
  v_readlane_b32 s38, v52, 0
  v_readlane_b32 s37, v52, 1
  v_readlane_b32 s41, v52, 2
  s_nop 0
  s_min_u32 s38, s38, s37
  s_min_u32 s38, s38, s41
  s_cmp_ge_u32 s38, 16
  s_cbranch_scc0 L_sp_11
L_fr_11:
  s_mov_b32 m0, 8192
  s_add_u32 s40, s34, 0
  buffer_load_dwordx4 v54, s[12:15], s40 offen lds
  s_mov_b32 m0, 9216
  s_add_u32 s40, s34, 7168
  buffer_load_dwordx4 v55, s[12:15], s40 offen lds
  s_mov_b32 m0, 10240
  s_add_u32 s40, s34, 14336
  buffer_load_dwordx4 v54, s[12:15], s40 offen lds
  s_mov_b32 m0, 11264
  s_add_u32 s40, s34, 21504
  buffer_load_dwordx4 v55, s[12:15], s40 offen lds
  s_waitcnt vmcnt(32)
  s_mov_b32 m0, 24576
  s_add_u32 s40, s34, 28672
  buffer_load_dwordx4 v54, s[12:15], s40 offen lds
  s_mov_b32 m0, 25600
  s_add_u32 s40, s34, 35840
  buffer_load_dwordx4 v55, s[12:15], s40 offen lds
  s_mov_b32 m0, 26624
  s_add_u32 s40, s34, 43008
  buffer_load_dwordx4 v54, s[12:15], s40 offen lds
  s_mov_b32 m0, 27648
  s_add_u32 s40, s34, 50176
  buffer_load_dwordx4 v55, s[12:15], s40 offen lds
  s_waitcnt vmcnt(32)
  v_mov_b32 v9, 21
  ds_max_u32 v8, v9 offset:0
  s_mov_b32 m0, 40960
  s_add_u32 s40, s34, 57344
  buffer_load_dwordx4 v54, s[12:15], s40 offen lds
  s_mov_b32 m0, 41984
  s_add_u32 s40, s34, 64512
  buffer_load_dwordx4 v55, s[12:15], s40 offen lds
  s_mov_b32 m0, 43008
  s_add_u32 s40, s34, 71680
  buffer_load_dwordx4 v54, s[12:15], s40 offen lds
  s_mov_b32 m0, 44032
  s_add_u32 s40, s34, 78848
  buffer_load_dwordx4 v55, s[12:15], s40 offen lds
  s_waitcnt vmcnt(32)
  s_add_u32 s34, s34, 128
  s_cmp_eq_u32 s34, 896
  s_cselect_b32 s34, 0, s34
  s_mov_b32 m0, 131072
  s_add_u32 s40, s8, 0
  buffer_load_dwordx4 v20, s[24:27], s40 offen nt lds
  buffer_load_dwordx4 v21, s[24:27], s40 offen offset:1024 nt lds
  buffer_load_dwordx4 v22, s[24:27], s40 offen offset:2048 nt lds
  buffer_load_dwordx4 v23, s[24:27], s40 offen offset:3072 nt lds
  s_waitcnt vmcnt(32)
  v_mov_b32 v9, 22
  ds_max_u32 v8, v9 offset:0
  s_mov_b32 m0, 135168
  s_add_u32 s40, s8, 65536
  buffer_load_dwordx4 v20, s[24:27], s40 offen nt lds
  buffer_load_dwordx4 v21, s[24:27], s40 offen offset:1024 nt lds
  buffer_load_dwordx4 v22, s[24:27], s40 offen offset:2048 nt lds
  buffer_load_dwordx4 v23, s[24:27], s40 offen offset:3072 nt lds
  s_add_u32 s8, s8, 131072
  s_cmp_eq_u32 s8, 3670016
  s_cselect_b32 s8, 0, s8
  s_waitcnt vmcnt(32)
  s_cmp_ge_u32 s38, 17
  s_cbranch_scc1 L_fr_12
  ds_read_b32 v52, v8 offset:8
  s_waitcnt lgkmcnt(0)
  v_readlane_b32 s38, v52, 0
  v_readlane_b32 s37, v52, 1
  v_readlane_b32 s41, v52, 2
  s_nop 0
  s_min_u32 s38, s38, s37
  s_min_u32 s38, s38, s41
  s_cmp_ge_u32 s38, 17
  s_cbranch_scc1 L_fr_12
  s_waitcnt vmcnt(20)
  v_mov_b32 v9, 24
  ds_max_u32 v8, v9 offset:0
L_sp_12:
  ds_read_b32 v52, v8 offset:8
  s_waitcnt lgkmcnt(0)
  v_readlane_b32 s38, v52, 0
  v_readlane_b32 s37, v52, 1
  v_readlane_b32 s41, v52, 2
  s_nop 0
  s_min_u32 s38, s38, s37
  s_min_u32 s38, s38, s41
  s_cmp_ge_u32 s38, 17
  s_cbranch_scc0 L_sp_12
L_fr_12:
  s_mov_b32 m0, 139264
  s_add_u32 s40, s8, 0
  buffer_load_dwordx4 v20, s[24:27], s40 offen nt lds
  buffer_load_dwordx4 v21, s[24:27], s40 offen offset:1024 nt lds
  buffer_load_dwordx4 v22, s[24:27], s40 offen offset:2048 nt lds
  buffer_load_dwordx4 v23, s[24:27], s40 offen offset:3072 nt lds
  s_waitcnt vmcnt(32)
  v_mov_b32 v9, 23
  ds_max_u32 v8, v9 offset:0
  s_mov_b32 m0, 143360
  s_add_u32 s40, s8, 65536
  buffer_load_dwordx4 v20, s[24:27], s40 offen nt lds
  buffer_load_dwordx4 v21, s[24:27], s40 offen offset:1024 nt lds
  buffer_load_dwordx4 v22, s[24:27], s40 offen offset:2048 nt lds
  buffer_load_dwordx4 v23, s[24:27], s40 offen offset:3072 nt lds
  s_add_u32 s8, s8, 131072
  s_cmp_eq_u32 s8, 3670016
  s_cselect_b32 s8, 0, s8
  s_waitcnt vmcnt(32)
  s_cmp_ge_u32 s38, 18
  s_cbranch_scc1 L_fr_13
  ds_read_b32 v52, v8 offset:8
  s_waitcnt lgkmcnt(0)
  v_readlane_b32 s38, v52, 0
  v_readlane_b32 s37, v52, 1
  v_readlane_b32 s41, v52, 2
  s_nop 0
  s_min_u32 s38, s38, s37
  s_min_u32 s38, s38, s41
  s_cmp_ge_u32 s38, 18
  s_cbranch_scc1 L_fr_13
  s_waitcnt vmcnt(8)
  v_mov_b32 v9, 25
  ds_max_u32 v8, v9 offset:0
L_sp_13:
  ds_read_b32 v52, v8 offset:8
  s_waitcnt lgkmcnt(0)
  v_readlane_b32 s38, v52, 0
  v_readlane_b32 s37, v52, 1
  v_readlane_b32 s41, v52, 2
  s_nop 0
  s_min_u32 s38, s38, s37
  s_min_u32 s38, s38, s41
  s_cmp_ge_u32 s38, 18
  s_cbranch_scc0 L_sp_13
L_fr_13:
  s_mov_b32 m0, 155648
  s_add_u32 s40, s8, 0
  buffer_load_dwordx4 v20, s[24:27], s40 offen nt lds
  buffer_load_dwordx4 v21, s[24:27], s40 offen offset:1024 nt lds
  buffer_load_dwordx4 v22, s[24:27], s40 offen offset:2048 nt lds
  buffer_load_dwordx4 v23, s[24:27], s40 offen offset:3072 nt lds
  s_waitcnt vmcnt(32)
  v_mov_b32 v9, 24
  ds_max_u32 v8, v9 offset:0
  s_mov_b32 m0, 159744
  s_add_u32 s40, s8, 65536
  buffer_load_dwordx4 v20, s[24:27], s40 offen nt lds
  buffer_load_dwordx4 v21, s[24:27], s40 offen offset:1024 nt lds
  buffer_load_dwordx4 v22, s[24:27], s40 offen offset:2048 nt lds
  buffer_load_dwordx4 v23, s[24:27], s40 offen offset:3072 nt lds
  s_add_u32 s8, s8, 131072
  s_cmp_eq_u32 s8, 3670016
  s_cselect_b32 s8, 0, s8
  s_waitcnt vmcnt(32)
  s_cmp_ge_u32 s38, 19
  s_cbranch_scc1 L_fr_14
  ds_read_b32 v52, v8 offset:8
  s_waitcnt lgkmcnt(0)
  v_readlane_b32 s38, v52, 0
  v_readlane_b32 s37, v52, 1
  v_readlane_b32 s41, v52, 2
  s_nop 0
  s_min_u32 s38, s38, s37
  s_min_u32 s38, s38, s41
  s_cmp_ge_u32 s38, 19
  s_cbranch_scc1 L_fr_14
  s_waitcnt vmcnt(8)
  v_mov_b32 v9, 26
  ds_max_u32 v8, v9 offset:0
L_sp_14:
  ds_read_b32 v52, v8 offset:8
  s_waitcnt lgkmcnt(0)
  v_readlane_b32 s38, v52, 0
  v_readlane_b32 s37, v52, 1
  v_readlane_b32 s41, v52, 2
  s_nop 0
  s_min_u32 s38, s38, s37
  s_min_u32 s38, s38, s41
  s_cmp_ge_u32 s38, 19
  s_cbranch_scc0 L_sp_14
L_fr_14:
  s_mov_b32 m0, 81920
  s_add_u32 s40, s8, 0
  buffer_load_dwordx4 v20, s[24:27], s40 offen nt lds
  buffer_load_dwordx4 v21, s[24:27], s40 offen offset:1024 nt lds
  buffer_load_dwordx4 v22, s[24:27], s40 offen offset:2048 nt lds
  buffer_load_dwordx4 v23, s[24:27], s40 offen offset:3072 nt lds
  s_waitcnt vmcnt(32)
  s_mov_b32 m0, 86016
  s_add_u32 s40, s8, 65536
  buffer_load_dwordx4 v20, s[24:27], s40 offen nt lds
  buffer_load_dwordx4 v21, s[24:27], s40 offen offset:1024 nt lds
  buffer_load_dwordx4 v22, s[24:27], s40 offen offset:2048 nt lds
  buffer_load_dwordx4 v23, s[24:27], s40 offen offset:3072 nt lds
  s_add_u32 s8, s8, 131072
  s_cmp_eq_u32 s8, 3670016
  s_cselect_b32 s8, 0, s8
  s_waitcnt vmcnt(32)
  s_cmp_ge_u32 s38, 7
  s_cbranch_scc1 L_fr_15
  ds_read_b32 v52, v8 offset:8
  s_waitcnt lgkmcnt(0)
  v_readlane_b32 s38, v52, 0
  v_readlane_b32 s37, v52, 1
  v_readlane_b32 s41, v52, 2
  s_nop 0
  s_min_u32 s38, s38, s37
  s_min_u32 s38, s38, s41
  s_cmp_ge_u32 s38, 7
  s_cbranch_scc1 L_fr_15
  s_waitcnt vmcnt(8)
  v_mov_b32 v9, 27
  ds_max_u32 v8, v9 offset:0
L_sp_15:
  ds_read_b32 v52, v8 offset:8
  s_waitcnt lgkmcnt(0)
  v_readlane_b32 s38, v52, 0
  v_readlane_b32 s37, v52, 1
  v_readlane_b32 s41, v52, 2
  s_nop 0
  s_min_u32 s38, s38, s37
  s_min_u32 s38, s38, s41
  s_cmp_ge_u32 s38, 7
  s_cbranch_scc0 L_sp_15
L_fr_15:
  s_mov_b32 m0, 49152
  s_add_u32 s40, s33, 0
  s_and_b32 s40, s40, 262143
  buffer_load_dwordx4 v10, s[16:19], s40 offen nt lds
  buffer_load_dwordx4 v11, s[16:19], s40 offen offset:1024 nt lds
  buffer_load_dwordx4 v12, s[16:19], s40 offen offset:2048 nt lds
  buffer_load_dwordx4 v13, s[16:19], s40 offen offset:3072 nt lds
  s_waitcnt vmcnt(24)
  v_mov_b32 v9, 25
  ds_max_u32 v8, v9 offset:0
  s_mov_b32 m0, 53248
  s_add_u32 s40, s33, 4096
  s_and_b32 s40, s40, 262143
  buffer_load_dwordx4 v14, s[16:19], s40 offen nt lds
  buffer_load_dwordx4 v15, s[16:19], s40 offen offset:1024 nt lds
  buffer_load_dwordx4 v16, s[16:19], s40 offen offset:2048 nt lds
  buffer_load_dwordx4 v17, s[16:19], s40 offen offset:3072 nt lds
  s_waitcnt vmcnt(24)
  v_mov_b32 v9, 26
  ds_max_u32 v8, v9 offset:0
  s_mov_b32 m0, 57344
  s_add_u32 s40, s33, 8192
  s_and_b32 s40, s40, 262143
  buffer_load_dwordx4 v10, s[16:19], s40 offen nt lds
  buffer_load_dwordx4 v11, s[16:19], s40 offen offset:1024 nt lds
  buffer_load_dwordx4 v12, s[16:19], s40 offen offset:2048 nt lds
  buffer_load_dwordx4 v13, s[16:19], s40 offen offset:3072 nt lds
  s_waitcnt vmcnt(24)
  s_mov_b32 m0, 61440
  s_add_u32 s40, s33, 12288
  s_and_b32 s40, s40, 262143
  buffer_load_dwordx4 v14, s[16:19], s40 offen nt lds
  buffer_load_dwordx4 v15, s[16:19], s40 offen offset:1024 nt lds
  buffer_load_dwordx4 v16, s[16:19], s40 offen offset:2048 nt lds
  buffer_load_dwordx4 v17, s[16:19], s40 offen offset:3072 nt lds
  s_waitcnt vmcnt(24)
  v_mov_b32 v9, 27
  ds_max_u32 v8, v9 offset:0
  s_cmp_ge_u32 s38, 9
  s_cbranch_scc1 L_fr_16
  ds_read_b32 v52, v8 offset:8
  s_waitcnt lgkmcnt(0)
  v_readlane_b32 s38, v52, 0
  v_readlane_b32 s37, v52, 1
  v_readlane_b32 s41, v52, 2
  s_nop 0
  s_min_u32 s38, s38, s37
  s_min_u32 s38, s38, s41
  s_cmp_ge_u32 s38, 9
  s_cbranch_scc1 L_fr_16
  s_waitcnt vmcnt(16)
  v_mov_b32 v9, 28
  ds_max_u32 v8, v9 offset:0
L_sp_16:
  ds_read_b32 v52, v8 offset:8
  s_waitcnt lgkmcnt(0)
  v_readlane_b32 s38, v52, 0
  v_readlane_b32 s37, v52, 1
  v_readlane_b32 s41, v52, 2
  s_nop 0
  s_min_u32 s38, s38, s37
  s_min_u32 s38, s38, s41
  s_cmp_ge_u32 s38, 9
  s_cbranch_scc0 L_sp_16
L_fr_16:
  s_mov_b32 m0, 65536
  s_add_u32 s40, s33, 16384
  s_and_b32 s40, s40, 262143
  buffer_load_dwordx4 v10, s[16:19], s40 offen nt lds
  buffer_load_dwordx4 v11, s[16:19], s40 offen offset:1024 nt lds
  buffer_load_dwordx4 v12, s[16:19], s40 offen offset:2048 nt lds
  buffer_load_dwordx4 v13, s[16:19], s40 offen offset:3072 nt lds
  s_waitcnt vmcnt(24)
  s_mov_b32 m0, 69632
  s_add_u32 s40, s33, 20480
  s_and_b32 s40, s40, 262143
  buffer_load_dwordx4 v14, s[16:19], s40 offen nt lds
  buffer_load_dwordx4 v15, s[16:19], s40 offen offset:1024 nt lds
  buffer_load_dwordx4 v16, s[16:19], s40 offen offset:2048 nt lds
  buffer_load_dwordx4 v17, s[16:19], s40 offen offset:3072 nt lds
  s_waitcnt vmcnt(24)
  v_mov_b32 v9, 28
  ds_max_u32 v8, v9 offset:0
  s_mov_b32 m0, 73728
  s_add_u32 s40, s33, 24576
  s_and_b32 s40, s40, 262143
  buffer_load_dwordx4 v10, s[16:19], s40 offen nt lds
  buffer_load_dwordx4 v11, s[16:19], s40 offen offset:1024 nt lds
  buffer_load_dwordx4 v12, s[16:19], s40 offen offset:2048 nt lds
  buffer_load_dwordx4 v13, s[16:19], s40 offen offset:3072 nt lds
  s_waitcnt vmcnt(24)
  s_mov_b32 m0, 77824
  s_add_u32 s40, s33, 28672
  s_and_b32 s40, s40, 262143
  buffer_load_dwordx4 v14, s[16:19], s40 offen nt lds
  buffer_load_dwordx4 v15, s[16:19], s40 offen offset:1024 nt lds
  buffer_load_dwordx4 v16, s[16:19], s40 offen offset:2048 nt lds
  buffer_load_dwordx4 v17, s[16:19], s40 offen offset:3072 nt lds
  s_waitcnt vmcnt(24)
  s_cmp_ge_u32 s38, 25
  s_cbranch_scc1 L_fr_17
  ds_read_b32 v52, v8 offset:8
  s_waitcnt lgkmcnt(0)
  v_readlane_b32 s38, v52, 0
  v_readlane_b32 s37, v52, 1
  v_readlane_b32 s41, v52, 2
  s_nop 0
  s_min_u32 s38, s38, s37
  s_min_u32 s38, s38, s41
  s_cmp_ge_u32 s38, 25
  s_cbranch_scc1 L_fr_17
  s_waitcnt vmcnt(16)
  v_mov_b32 v7, 1
  ds_max_u32 v8, v7 offset:4
L_sp_17:
  ds_read_b32 v52, v8 offset:8
  s_waitcnt lgkmcnt(0)
  v_readlane_b32 s38, v52, 0
  v_readlane_b32 s37, v52, 1
  v_readlane_b32 s41, v52, 2
  s_nop 0
  s_min_u32 s38, s38, s37
  s_min_u32 s38, s38, s41
  s_cmp_ge_u32 s38, 25
  s_cbranch_scc0 L_sp_17
L_fr_17:
  s_mov_b32 m0, 0
  s_add_u32 s40, s33, 32768
  s_and_b32 s40, s40, 262143
  buffer_load_dwordx4 v10, s[16:19], s40 offen nt lds
  buffer_load_dwordx4 v11, s[16:19], s40 offen offset:1024 nt lds
  buffer_load_dwordx4 v12, s[16:19], s40 offen offset:2048 nt lds
  buffer_load_dwordx4 v13, s[16:19], s40 offen offset:3072 nt lds
  s_waitcnt vmcnt(24)
  s_mov_b32 m0, 4096
  s_add_u32 s40, s33, 36864
  s_and_b32 s40, s40, 262143
  buffer_load_dwordx4 v14, s[16:19], s40 offen nt lds
  buffer_load_dwordx4 v15, s[16:19], s40 offen offset:1024 nt lds
  buffer_load_dwordx4 v16, s[16:19], s40 offen offset:2048 nt lds
  buffer_load_dwordx4 v17, s[16:19], s40 offen offset:3072 nt lds
  s_waitcnt vmcnt(24)
  v_mov_b32 v7, 1
  ds_max_u32 v8, v7 offset:4
  s_mov_b32 m0, 8192
  s_add_u32 s40, s33, 40960
  s_and_b32 s40, s40, 262143
  buffer_load_dwordx4 v10, s[16:19], s40 offen nt lds
  buffer_load_dwordx4 v11, s[16:19], s40 offen offset:1024 nt lds
  buffer_load_dwordx4 v12, s[16:19], s40 offen offset:2048 nt lds
  buffer_load_dwordx4 v13, s[16:19], s40 offen offset:3072 nt lds
  s_waitcnt vmcnt(24)
  s_mov_b32 m0, 12288
  s_add_u32 s40, s33, 45056
  s_and_b32 s40, s40, 262143
  buffer_load_dwordx4 v14, s[16:19], s40 offen nt lds
  buffer_load_dwordx4 v15, s[16:19], s40 offen offset:1024 nt lds
  buffer_load_dwordx4 v16, s[16:19], s40 offen offset:2048 nt lds
  buffer_load_dwordx4 v17, s[16:19], s40 offen offset:3072 nt lds
  s_waitcnt vmcnt(24)
  s_cmp_ge_u32 s38, 25
  s_cbranch_scc1 L_fr_18
  ds_read_b32 v52, v8 offset:8
  s_waitcnt lgkmcnt(0)
  v_readlane_b32 s38, v52, 0
  v_readlane_b32 s37, v52, 1
  v_readlane_b32 s41, v52, 2
  s_nop 0
  s_min_u32 s38, s38, s37
  s_min_u32 s38, s38, s41
  s_cmp_ge_u32 s38, 25
  s_cbranch_scc1 L_fr_18
  s_waitcnt vmcnt(16)
  v_mov_b32 v7, 2
  ds_max_u32 v8, v7 offset:4
L_sp_18:
  ds_read_b32 v52, v8 offset:8
  s_waitcnt lgkmcnt(0)
  v_readlane_b32 s38, v52, 0
  v_readlane_b32 s37, v52, 1
  v_readlane_b32 s41, v52, 2
  s_nop 0
  s_min_u32 s38, s38, s37
  s_min_u32 s38, s38, s41
  s_cmp_ge_u32 s38, 25
  s_cbranch_scc0 L_sp_18
L_fr_18:
  s_mov_b32 m0, 16384
  s_add_u32 s40, s33, 49152
  s_and_b32 s40, s40, 262143
  buffer_load_dwordx4 v10, s[16:19], s40 offen nt lds
  buffer_load_dwordx4 v11, s[16:19], s40 offen offset:1024 nt lds
  buffer_load_dwordx4 v12, s[16:19], s40 offen offset:2048 nt lds
  buffer_load_dwordx4 v13, s[16:19], s40 offen offset:3072 nt lds
  s_waitcnt vmcnt(24)
  s_mov_b32 m0, 20480
  s_add_u32 s40, s33, 53248
  s_and_b32 s40, s40, 262143
  buffer_load_dwordx4 v14, s[16:19], s40 offen nt lds
  buffer_load_dwordx4 v15, s[16:19], s40 offen offset:1024 nt lds
  buffer_load_dwordx4 v16, s[16:19], s40 offen offset:2048 nt lds
  buffer_load_dwordx4 v17, s[16:19], s40 offen offset:3072 nt lds
  s_waitcnt vmcnt(24)
  v_mov_b32 v7, 2
  ds_max_u32 v8, v7 offset:4
  s_mov_b32 m0, 24576
  s_add_u32 s40, s33, 57344
  s_and_b32 s40, s40, 262143
  buffer_load_dwordx4 v10, s[16:19], s40 offen nt lds
  buffer_load_dwordx4 v11, s[16:19], s40 offen offset:1024 nt lds
  buffer_load_dwordx4 v12, s[16:19], s40 offen offset:2048 nt lds
  buffer_load_dwordx4 v13, s[16:19], s40 offen offset:3072 nt lds
  s_waitcnt vmcnt(24)
  s_mov_b32 m0, 28672
  s_add_u32 s40, s33, 61440
  s_and_b32 s40, s40, 262143
  buffer_load_dwordx4 v14, s[16:19], s40 offen nt lds
  buffer_load_dwordx4 v15, s[16:19], s40 offen offset:1024 nt lds
  buffer_load_dwordx4 v16, s[16:19], s40 offen offset:2048 nt lds
  buffer_load_dwordx4 v17, s[16:19], s40 offen offset:3072 nt lds
  s_waitcnt vmcnt(24)
  s_cmp_ge_u32 s38, 25
  s_cbranch_scc1 L_fr_19
  ds_read_b32 v52, v8 offset:8
  s_waitcnt lgkmcnt(0)
  v_readlane_b32 s38, v52, 0
  v_readlane_b32 s37, v52, 1
  v_readlane_b32 s41, v52, 2
  s_nop 0
  s_min_u32 s38, s38, s37
  s_min_u32 s38, s38, s41
  s_cmp_ge_u32 s38, 25
  s_cbranch_scc1 L_fr_19
  s_waitcnt vmcnt(16)
  v_mov_b32 v7, 3
  ds_max_u32 v8, v7 offset:4
L_sp_19:
  ds_read_b32 v52, v8 offset:8
  s_waitcnt lgkmcnt(0)
  v_readlane_b32 s38, v52, 0
  v_readlane_b32 s37, v52, 1
  v_readlane_b32 s41, v52, 2
  s_nop 0
  s_min_u32 s38, s38, s37
  s_min_u32 s38, s38, s41
  s_cmp_ge_u32 s38, 25
  s_cbranch_scc0 L_sp_19
L_fr_19:
  s_mov_b32 m0, 32768
  s_add_u32 s40, s33, 65536
  s_and_b32 s40, s40, 262143
  buffer_load_dwordx4 v10, s[16:19], s40 offen nt lds
  buffer_load_dwordx4 v11, s[16:19], s40 offen offset:1024 nt lds
  buffer_load_dwordx4 v12, s[16:19], s40 offen offset:2048 nt lds
  buffer_load_dwordx4 v13, s[16:19], s40 offen offset:3072 nt lds
  s_waitcnt vmcnt(24)
  s_mov_b32 m0, 36864
  s_add_u32 s40, s33, 69632
  s_and_b32 s40, s40, 262143
  buffer_load_dwordx4 v14, s[16:19], s40 offen nt lds
  buffer_load_dwordx4 v15, s[16:19], s40 offen offset:1024 nt lds
  buffer_load_dwordx4 v16, s[16:19], s40 offen offset:2048 nt lds
  buffer_load_dwordx4 v17, s[16:19], s40 offen offset:3072 nt lds
  s_waitcnt vmcnt(24)
  v_mov_b32 v7, 3
  ds_max_u32 v8, v7 offset:4
  s_mov_b32 m0, 40960
  s_add_u32 s40, s33, 73728
  s_and_b32 s40, s40, 262143
  buffer_load_dwordx4 v10, s[16:19], s40 offen nt lds
  buffer_load_dwordx4 v11, s[16:19], s40 offen offset:1024 nt lds
  buffer_load_dwordx4 v12, s[16:19], s40 offen offset:2048 nt lds
  buffer_load_dwordx4 v13, s[16:19], s40 offen offset:3072 nt lds
  s_waitcnt vmcnt(24)
  s_mov_b32 m0, 45056
  s_add_u32 s40, s33, 77824
  s_and_b32 s40, s40, 262143
  buffer_load_dwordx4 v14, s[16:19], s40 offen nt lds
  buffer_load_dwordx4 v15, s[16:19], s40 offen offset:1024 nt lds
  buffer_load_dwordx4 v16, s[16:19], s40 offen offset:2048 nt lds
  buffer_load_dwordx4 v17, s[16:19], s40 offen offset:3072 nt lds
  s_waitcnt vmcnt(24)
  s_cmp_ge_u32 s38, 22
  s_cbranch_scc1 L_fr_20
  ds_read_b32 v52, v8 offset:8
  s_waitcnt lgkmcnt(0)
  v_readlane_b32 s38, v52, 0
  v_readlane_b32 s37, v52, 1
  v_readlane_b32 s41, v52, 2
  s_nop 0
  s_min_u32 s38, s38, s37
  s_min_u32 s38, s38, s41
  s_cmp_ge_u32 s38, 22
  s_cbranch_scc1 L_fr_20
  s_waitcnt vmcnt(16)
  v_mov_b32 v7, 4
  ds_max_u32 v8, v7 offset:4
L_sp_20:
  ds_read_b32 v52, v8 offset:8
  s_waitcnt lgkmcnt(0)
  v_readlane_b32 s38, v52, 0
  v_readlane_b32 s37, v52, 1
  v_readlane_b32 s41, v52, 2
  s_nop 0
  s_min_u32 s38, s38, s37
  s_min_u32 s38, s38, s41
  s_cmp_ge_u32 s38, 22
  s_cbranch_scc0 L_sp_20
L_fr_20:
  s_mov_b32 m0, 98304
  s_add_u32 s40, s33, 81920
  s_and_b32 s40, s40, 262143
  buffer_load_dwordx4 v10, s[16:19], s40 offen nt lds
  buffer_load_dwordx4 v11, s[16:19], s40 offen offset:1024 nt lds
  buffer_load_dwordx4 v12, s[16:19], s40 offen offset:2048 nt lds
  buffer_load_dwordx4 v13, s[16:19], s40 offen offset:3072 nt lds
  s_waitcnt vmcnt(24)
  s_mov_b32 m0, 102400
  s_add_u32 s40, s33, 86016
  s_and_b32 s40, s40, 262143
  buffer_load_dwordx4 v14, s[16:19], s40 offen nt lds
  buffer_load_dwordx4 v15, s[16:19], s40 offen offset:1024 nt lds
  buffer_load_dwordx4 v16, s[16:19], s40 offen offset:2048 nt lds
  buffer_load_dwordx4 v17, s[16:19], s40 offen offset:3072 nt lds
  s_waitcnt vmcnt(24)
  v_mov_b32 v7, 4
  ds_max_u32 v8, v7 offset:4
  s_mov_b32 m0, 106496
  s_add_u32 s40, s33, 90112
  s_and_b32 s40, s40, 262143
  buffer_load_dwordx4 v10, s[16:19], s40 offen nt lds
  buffer_load_dwordx4 v11, s[16:19], s40 offen offset:1024 nt lds
  buffer_load_dwordx4 v12, s[16:19], s40 offen offset:2048 nt lds
  buffer_load_dwordx4 v13, s[16:19], s40 offen offset:3072 nt lds
  s_waitcnt vmcnt(24)
  s_mov_b32 m0, 110592
  s_add_u32 s40, s33, 94208
  s_and_b32 s40, s40, 262143
  buffer_load_dwordx4 v14, s[16:19], s40 offen nt lds
  buffer_load_dwordx4 v15, s[16:19], s40 offen offset:1024 nt lds
  buffer_load_dwordx4 v16, s[16:19], s40 offen offset:2048 nt lds
  buffer_load_dwordx4 v17, s[16:19], s40 offen offset:3072 nt lds
  s_waitcnt vmcnt(24)
  s_cmp_ge_u32 s38, 24
  s_cbranch_scc1 L_fr_21
  ds_read_b32 v52, v8 offset:8
  s_waitcnt lgkmcnt(0)
  v_readlane_b32 s38, v52, 0
  v_readlane_b32 s37, v52, 1
  v_readlane_b32 s41, v52, 2
  s_nop 0
  s_min_u32 s38, s38, s37
  s_min_u32 s38, s38, s41
  s_cmp_ge_u32 s38, 24
  s_cbranch_scc1 L_fr_21
  s_waitcnt vmcnt(16)
  v_mov_b32 v7, 5
  ds_max_u32 v8, v7 offset:4
L_sp_21:
  ds_read_b32 v52, v8 offset:8
  s_waitcnt lgkmcnt(0)
  v_readlane_b32 s38, v52, 0
  v_readlane_b32 s37, v52, 1
  v_readlane_b32 s41, v52, 2
  s_nop 0
  s_min_u32 s38, s38, s37
  s_min_u32 s38, s38, s41
  s_cmp_ge_u32 s38, 24
  s_cbranch_scc0 L_sp_21
L_fr_21:
  s_mov_b32 m0, 114688
  s_add_u32 s40, s33, 98304
  s_and_b32 s40, s40, 262143
  buffer_load_dwordx4 v10, s[16:19], s40 offen nt lds
  buffer_load_dwordx4 v11, s[16:19], s40 offen offset:1024 nt lds
  buffer_load_dwordx4 v12, s[16:19], s40 offen offset:2048 nt lds
  buffer_load_dwordx4 v13, s[16:19], s40 offen offset:3072 nt lds
  s_waitcnt vmcnt(24)
  s_mov_b32 m0, 118784
  s_add_u32 s40, s33, 102400
  s_and_b32 s40, s40, 262143
  buffer_load_dwordx4 v14, s[16:19], s40 offen nt lds
  buffer_load_dwordx4 v15, s[16:19], s40 offen offset:1024 nt lds
  buffer_load_dwordx4 v16, s[16:19], s40 offen offset:2048 nt lds
  buffer_load_dwordx4 v17, s[16:19], s40 offen offset:3072 nt lds
  s_waitcnt vmcnt(24)
  v_mov_b32 v7, 5
  ds_max_u32 v8, v7 offset:4
  s_mov_b32 m0, 122880
  s_add_u32 s40, s33, 106496
  s_and_b32 s40, s40, 262143
  buffer_load_dwordx4 v10, s[16:19], s40 offen nt lds
  buffer_load_dwordx4 v11, s[16:19], s40 offen offset:1024 nt lds
  buffer_load_dwordx4 v12, s[16:19], s40 offen offset:2048 nt lds
  buffer_load_dwordx4 v13, s[16:19], s40 offen offset:3072 nt lds
  s_waitcnt vmcnt(24)
  s_mov_b32 m0, 126976
  s_add_u32 s40, s33, 110592
  s_and_b32 s40, s40, 262143
  buffer_load_dwordx4 v14, s[16:19], s40 offen nt lds
  buffer_load_dwordx4 v15, s[16:19], s40 offen offset:1024 nt lds
  buffer_load_dwordx4 v16, s[16:19], s40 offen offset:2048 nt lds
  buffer_load_dwordx4 v17, s[16:19], s40 offen offset:3072 nt lds
  s_waitcnt vmcnt(24)
  s_cmp_ge_u32 s38, 26
  s_cbranch_scc1 L_fr_22
  ds_read_b32 v52, v8 offset:8
  s_waitcnt lgkmcnt(0)
  v_readlane_b32 s38, v52, 0
  v_readlane_b32 s37, v52, 1
  v_readlane_b32 s41, v52, 2
  s_nop 0
  s_min_u32 s38, s38, s37
  s_min_u32 s38, s38, s41
  s_cmp_ge_u32 s38, 26
  s_cbranch_scc1 L_fr_22
  s_waitcnt vmcnt(16)
  v_mov_b32 v7, 6
  ds_max_u32 v8, v7 offset:4
L_sp_22:
  ds_read_b32 v52, v8 offset:8
  s_waitcnt lgkmcnt(0)
  v_readlane_b32 s38, v52, 0
  v_readlane_b32 s37, v52, 1
  v_readlane_b32 s41, v52, 2
  s_nop 0
  s_min_u32 s38, s38, s37
  s_min_u32 s38, s38, s41
  s_cmp_ge_u32 s38, 26
  s_cbranch_scc0 L_sp_22
L_fr_22:
  s_mov_b32 m0, 131072
  s_add_u32 s40, s33, 114688
  s_and_b32 s40, s40, 262143
  buffer_load_dwordx4 v10, s[16:19], s40 offen nt lds
  buffer_load_dwordx4 v11, s[16:19], s40 offen offset:1024 nt lds
  buffer_load_dwordx4 v12, s[16:19], s40 offen offset:2048 nt lds
  buffer_load_dwordx4 v13, s[16:19], s40 offen offset:3072 nt lds
  s_waitcnt vmcnt(24)
  s_mov_b32 m0, 135168
  s_add_u32 s40, s33, 118784
  s_and_b32 s40, s40, 262143
  buffer_load_dwordx4 v14, s[16:19], s40 offen nt lds
  buffer_load_dwordx4 v15, s[16:19], s40 offen offset:1024 nt lds
  buffer_load_dwordx4 v16, s[16:19], s40 offen offset:2048 nt lds
  buffer_load_dwordx4 v17, s[16:19], s40 offen offset:3072 nt lds
  s_waitcnt vmcnt(24)
  v_mov_b32 v7, 6
  ds_max_u32 v8, v7 offset:4
  s_mov_b32 m0, 139264
  s_add_u32 s40, s33, 122880
  s_and_b32 s40, s40, 262143
  buffer_load_dwordx4 v10, s[16:19], s40 offen nt lds
  buffer_load_dwordx4 v11, s[16:19], s40 offen offset:1024 nt lds
  buffer_load_dwordx4 v12, s[16:19], s40 offen offset:2048 nt lds
  buffer_load_dwordx4 v13, s[16:19], s40 offen offset:3072 nt lds
  s_waitcnt vmcnt(24)
  s_mov_b32 m0, 143360
  s_add_u32 s40, s33, 126976
  s_and_b32 s40, s40, 262143
  buffer_load_dwordx4 v14, s[16:19], s40 offen nt lds
  buffer_load_dwordx4 v15, s[16:19], s40 offen offset:1024 nt lds
  buffer_load_dwordx4 v16, s[16:19], s40 offen offset:2048 nt lds
  buffer_load_dwordx4 v17, s[16:19], s40 offen offset:3072 nt lds
  s_waitcnt vmcnt(24)
  s_cmp_ge_u32 s38, 28
  s_cbranch_scc1 L_fr_23
  ds_read_b32 v52, v8 offset:8
  s_waitcnt lgkmcnt(0)
  v_readlane_b32 s38, v52, 0
  v_readlane_b32 s37, v52, 1
  v_readlane_b32 s41, v52, 2
  s_nop 0
  s_min_u32 s38, s38, s37
  s_min_u32 s38, s38, s41
  s_cmp_ge_u32 s38, 28
  s_cbranch_scc1 L_fr_23
  s_waitcnt vmcnt(16)
  v_mov_b32 v7, 7
  ds_max_u32 v8, v7 offset:4
L_sp_23:
  ds_read_b32 v52, v8 offset:8
  s_waitcnt lgkmcnt(0)
  v_readlane_b32 s38, v52, 0
  v_readlane_b32 s37, v52, 1
  v_readlane_b32 s41, v52, 2
  s_nop 0
  s_min_u32 s38, s38, s37
  s_min_u32 s38, s38, s41
  s_cmp_ge_u32 s38, 28
  s_cbranch_scc0 L_sp_23
L_fr_23:
  s_mov_b32 m0, 81920
  s_add_u32 s40, s33, 131072
  s_and_b32 s40, s40, 262143
  buffer_load_dwordx4 v10, s[16:19], s40 offen nt lds
  buffer_load_dwordx4 v11, s[16:19], s40 offen offset:1024 nt lds
  buffer_load_dwordx4 v12, s[16:19], s40 offen offset:2048 nt lds
  buffer_load_dwordx4 v13, s[16:19], s40 offen offset:3072 nt lds
  s_waitcnt vmcnt(24)
  s_mov_b32 m0, 86016
  s_add_u32 s40, s33, 135168
  s_and_b32 s40, s40, 262143
  buffer_load_dwordx4 v14, s[16:19], s40 offen nt lds
  buffer_load_dwordx4 v15, s[16:19], s40 offen offset:1024 nt lds
  buffer_load_dwordx4 v16, s[16:19], s40 offen offset:2048 nt lds
  buffer_load_dwordx4 v17, s[16:19], s40 offen offset:3072 nt lds
  s_waitcnt vmcnt(24)
  v_mov_b32 v7, 7
  ds_max_u32 v8, v7 offset:4
  s_mov_b32 m0, 90112
  s_add_u32 s40, s33, 139264
  s_and_b32 s40, s40, 262143
  buffer_load_dwordx4 v10, s[16:19], s40 offen nt lds
  buffer_load_dwordx4 v11, s[16:19], s40 offen offset:1024 nt lds
  buffer_load_dwordx4 v12, s[16:19], s40 offen offset:2048 nt lds
  buffer_load_dwordx4 v13, s[16:19], s40 offen offset:3072 nt lds
  s_waitcnt vmcnt(24)
  s_mov_b32 m0, 94208
  s_add_u32 s40, s33, 143360
  s_and_b32 s40, s40, 262143
  buffer_load_dwordx4 v14, s[16:19], s40 offen nt lds
  buffer_load_dwordx4 v15, s[16:19], s40 offen offset:1024 nt lds
  buffer_load_dwordx4 v16, s[16:19], s40 offen offset:2048 nt lds
  buffer_load_dwordx4 v17, s[16:19], s40 offen offset:3072 nt lds
  s_waitcnt vmcnt(24)
  s_cmp_ge_u32 s38, 29
  s_cbranch_scc1 L_fr_24
  ds_read_b32 v52, v8 offset:8
  s_waitcnt lgkmcnt(0)
  v_readlane_b32 s38, v52, 0
  v_readlane_b32 s37, v52, 1
  v_readlane_b32 s41, v52, 2
  s_nop 0
  s_min_u32 s38, s38, s37
  s_min_u32 s38, s38, s41
  s_cmp_ge_u32 s38, 29
  s_cbranch_scc1 L_fr_24
  s_waitcnt vmcnt(16)
  v_mov_b32 v7, 8
  ds_max_u32 v8, v7 offset:4
L_sp_24:
  ds_read_b32 v52, v8 offset:8
  s_waitcnt lgkmcnt(0)
  v_readlane_b32 s38, v52, 0
  v_readlane_b32 s37, v52, 1
  v_readlane_b32 s41, v52, 2
  s_nop 0
  s_min_u32 s38, s38, s37
  s_min_u32 s38, s38, s41
  s_cmp_ge_u32 s38, 29
  s_cbranch_scc0 L_sp_24
L_fr_24:
  s_mov_b32 m0, 49152
  s_add_u32 s40, s33, 147456
  s_and_b32 s40, s40, 262143
  buffer_load_dwordx4 v10, s[16:19], s40 offen nt lds
  buffer_load_dwordx4 v11, s[16:19], s40 offen offset:1024 nt lds
  buffer_load_dwordx4 v12, s[16:19], s40 offen offset:2048 nt lds
  buffer_load_dwordx4 v13, s[16:19], s40 offen offset:3072 nt lds
  s_waitcnt vmcnt(24)
  s_mov_b32 m0, 53248
  s_add_u32 s40, s33, 151552
  s_and_b32 s40, s40, 262143
  buffer_load_dwordx4 v14, s[16:19], s40 offen nt lds
  buffer_load_dwordx4 v15, s[16:19], s40 offen offset:1024 nt lds
  buffer_load_dwordx4 v16, s[16:19], s40 offen offset:2048 nt lds
  buffer_load_dwordx4 v17, s[16:19], s40 offen offset:3072 nt lds
  s_waitcnt vmcnt(24)
  v_mov_b32 v7, 8
  ds_max_u32 v8, v7 offset:4
  s_mov_b32 m0, 57344
  s_add_u32 s40, s33, 155648
  s_and_b32 s40, s40, 262143
  buffer_load_dwordx4 v10, s[16:19], s40 offen nt lds
  buffer_load_dwordx4 v11, s[16:19], s40 offen offset:1024 nt lds
  buffer_load_dwordx4 v12, s[16:19], s40 offen offset:2048 nt lds
  buffer_load_dwordx4 v13, s[16:19], s40 offen offset:3072 nt lds
  s_waitcnt vmcnt(24)
  s_mov_b32 m0, 61440
  s_add_u32 s40, s33, 159744
  s_and_b32 s40, s40, 262143
  buffer_load_dwordx4 v14, s[16:19], s40 offen nt lds
  buffer_load_dwordx4 v15, s[16:19], s40 offen offset:1024 nt lds
  buffer_load_dwordx4 v16, s[16:19], s40 offen offset:2048 nt lds
  buffer_load_dwordx4 v17, s[16:19], s40 offen offset:3072 nt lds
  s_waitcnt vmcnt(24)
  s_cmp_ge_u32 s38, 30
  s_cbranch_scc1 L_fr_25
  ds_read_b32 v52, v8 offset:8
  s_waitcnt lgkmcnt(0)
  v_readlane_b32 s38, v52, 0
  v_readlane_b32 s37, v52, 1
  v_readlane_b32 s41, v52, 2
  s_nop 0
  s_min_u32 s38, s38, s37
  s_min_u32 s38, s38, s41
  s_cmp_ge_u32 s38, 30
  s_cbranch_scc1 L_fr_25
  s_waitcnt vmcnt(16)
  v_mov_b32 v7, 9
  ds_max_u32 v8, v7 offset:4
L_sp_25:
  ds_read_b32 v52, v8 offset:8
  s_waitcnt lgkmcnt(0)
  v_readlane_b32 s38, v52, 0
  v_readlane_b32 s37, v52, 1
  v_readlane_b32 s41, v52, 2
  s_nop 0
  s_min_u32 s38, s38, s37
  s_min_u32 s38, s38, s41
  s_cmp_ge_u32 s38, 30
  s_cbranch_scc0 L_sp_25
L_fr_25:
  s_mov_b32 m0, 65536
  s_add_u32 s40, s33, 163840
  s_and_b32 s40, s40, 262143
  buffer_load_dwordx4 v10, s[16:19], s40 offen nt lds
  buffer_load_dwordx4 v11, s[16:19], s40 offen offset:1024 nt lds
  buffer_load_dwordx4 v12, s[16:19], s40 offen offset:2048 nt lds
  buffer_load_dwordx4 v13, s[16:19], s40 offen offset:3072 nt lds
  s_waitcnt vmcnt(24)
  s_mov_b32 m0, 69632
  s_add_u32 s40, s33, 167936
  s_and_b32 s40, s40, 262143
  buffer_load_dwordx4 v14, s[16:19], s40 offen nt lds
  buffer_load_dwordx4 v15, s[16:19], s40 offen offset:1024 nt lds
  buffer_load_dwordx4 v16, s[16:19], s40 offen offset:2048 nt lds
  buffer_load_dwordx4 v17, s[16:19], s40 offen offset:3072 nt lds
  s_waitcnt vmcnt(24)
  v_mov_b32 v7, 9
  ds_max_u32 v8, v7 offset:4
  s_mov_b32 m0, 73728
  s_add_u32 s40, s33, 172032
  s_and_b32 s40, s40, 262143
  buffer_load_dwordx4 v10, s[16:19], s40 offen nt lds
  buffer_load_dwordx4 v11, s[16:19], s40 offen offset:1024 nt lds
  buffer_load_dwordx4 v12, s[16:19], s40 offen offset:2048 nt lds
  buffer_load_dwordx4 v13, s[16:19], s40 offen offset:3072 nt lds
  s_waitcnt vmcnt(24)
  s_mov_b32 m0, 77824
  s_add_u32 s40, s33, 176128
  s_and_b32 s40, s40, 262143
  buffer_load_dwordx4 v14, s[16:19], s40 offen nt lds
  buffer_load_dwordx4 v15, s[16:19], s40 offen offset:1024 nt lds
  buffer_load_dwordx4 v16, s[16:19], s40 offen offset:2048 nt lds
  buffer_load_dwordx4 v17, s[16:19], s40 offen offset:3072 nt lds
  s_waitcnt vmcnt(24)
  s_cmp_ge_u32 s38, 31
  s_cbranch_scc1 L_fr_26
  ds_read_b32 v52, v8 offset:8
  s_waitcnt lgkmcnt(0)
  v_readlane_b32 s38, v52, 0
  v_readlane_b32 s37, v52, 1
  v_readlane_b32 s41, v52, 2
  s_nop 0
  s_min_u32 s38, s38, s37
  s_min_u32 s38, s38, s41
  s_cmp_ge_u32 s38, 31
  s_cbranch_scc1 L_fr_26
  s_waitcnt vmcnt(16)
  v_mov_b32 v7, 10
  ds_max_u32 v8, v7 offset:4
L_sp_26:
  ds_read_b32 v52, v8 offset:8
  s_waitcnt lgkmcnt(0)
  v_readlane_b32 s38, v52, 0
  v_readlane_b32 s37, v52, 1
  v_readlane_b32 s41, v52, 2
  s_nop 0
  s_min_u32 s38, s38, s37
  s_min_u32 s38, s38, s41
  s_cmp_ge_u32 s38, 31
  s_cbranch_scc0 L_sp_26
L_fr_26:
  s_mov_b32 m0, 0
  s_add_u32 s40, s33, 180224
  s_and_b32 s40, s40, 262143
  buffer_load_dwordx4 v10, s[16:19], s40 offen nt lds
  buffer_load_dwordx4 v11, s[16:19], s40 offen offset:1024 nt lds
  buffer_load_dwordx4 v12, s[16:19], s40 offen offset:2048 nt lds
  buffer_load_dwordx4 v13, s[16:19], s40 offen offset:3072 nt lds
  s_waitcnt vmcnt(24)
  s_mov_b32 m0, 4096
  s_add_u32 s40, s33, 184320
  s_and_b32 s40, s40, 262143
  buffer_load_dwordx4 v14, s[16:19], s40 offen nt lds
  buffer_load_dwordx4 v15, s[16:19], s40 offen offset:1024 nt lds
  buffer_load_dwordx4 v16, s[16:19], s40 offen offset:2048 nt lds
  buffer_load_dwordx4 v17, s[16:19], s40 offen offset:3072 nt lds
  s_waitcnt vmcnt(24)
  v_mov_b32 v7, 10
  ds_max_u32 v8, v7 offset:4
  s_mov_b32 m0, 8192
  s_add_u32 s40, s33, 188416
  s_and_b32 s40, s40, 262143
  buffer_load_dwordx4 v10, s[16:19], s40 offen nt lds
  buffer_load_dwordx4 v11, s[16:19], s40 offen offset:1024 nt lds
  buffer_load_dwordx4 v12, s[16:19], s40 offen offset:2048 nt lds
  buffer_load_dwordx4 v13, s[16:19], s40 offen offset:3072 nt lds
  s_waitcnt vmcnt(24)
  s_mov_b32 m0, 12288
  s_add_u32 s40, s33, 192512
  s_and_b32 s40, s40, 262143
  buffer_load_dwordx4 v14, s[16:19], s40 offen nt lds
  buffer_load_dwordx4 v15, s[16:19], s40 offen offset:1024 nt lds
  buffer_load_dwordx4 v16, s[16:19], s40 offen offset:2048 nt lds
  buffer_load_dwordx4 v17, s[16:19], s40 offen offset:3072 nt lds
  s_waitcnt vmcnt(24)
  s_cmp_ge_u32 s38, 32
  s_cbranch_scc1 L_fr_27
  ds_read_b32 v52, v8 offset:8
  s_waitcnt lgkmcnt(0)
  v_readlane_b32 s38, v52, 0
  v_readlane_b32 s37, v52, 1
  v_readlane_b32 s41, v52, 2
  s_nop 0
  s_min_u32 s38, s38, s37
  s_min_u32 s38, s38, s41
  s_cmp_ge_u32 s38, 32
  s_cbranch_scc1 L_fr_27
  s_waitcnt vmcnt(16)
  v_mov_b32 v7, 11
  ds_max_u32 v8, v7 offset:4
L_sp_27:
  ds_read_b32 v52, v8 offset:8
  s_waitcnt lgkmcnt(0)
  v_readlane_b32 s38, v52, 0
  v_readlane_b32 s37, v52, 1
  v_readlane_b32 s41, v52, 2
  s_nop 0
  s_min_u32 s38, s38, s37
  s_min_u32 s38, s38, s41
  s_cmp_ge_u32 s38, 32
  s_cbranch_scc0 L_sp_27
L_fr_27:
  s_mov_b32 m0, 16384
  s_add_u32 s40, s33, 196608
  s_and_b32 s40, s40, 262143
  buffer_load_dwordx4 v10, s[16:19], s40 offen nt lds
  buffer_load_dwordx4 v11, s[16:19], s40 offen offset:1024 nt lds
  buffer_load_dwordx4 v12, s[16:19], s40 offen offset:2048 nt lds
  buffer_load_dwordx4 v13, s[16:19], s40 offen offset:3072 nt lds
  s_waitcnt vmcnt(24)
  s_mov_b32 m0, 20480
  s_add_u32 s40, s33, 200704
  s_and_b32 s40, s40, 262143
  buffer_load_dwordx4 v14, s[16:19], s40 offen nt lds
  buffer_load_dwordx4 v15, s[16:19], s40 offen offset:1024 nt lds
  buffer_load_dwordx4 v16, s[16:19], s40 offen offset:2048 nt lds
  buffer_load_dwordx4 v17, s[16:19], s40 offen offset:3072 nt lds
  s_waitcnt vmcnt(24)
  v_mov_b32 v7, 11
  ds_max_u32 v8, v7 offset:4
  s_mov_b32 m0, 24576
  s_add_u32 s40, s33, 204800
  s_and_b32 s40, s40, 262143
  buffer_load_dwordx4 v10, s[16:19], s40 offen nt lds
  buffer_load_dwordx4 v11, s[16:19], s40 offen offset:1024 nt lds
  buffer_load_dwordx4 v12, s[16:19], s40 offen offset:2048 nt lds
  buffer_load_dwordx4 v13, s[16:19], s40 offen offset:3072 nt lds
  s_waitcnt vmcnt(24)
  s_mov_b32 m0, 28672
  s_add_u32 s40, s33, 208896
  s_and_b32 s40, s40, 262143
  buffer_load_dwordx4 v14, s[16:19], s40 offen nt lds
  buffer_load_dwordx4 v15, s[16:19], s40 offen offset:1024 nt lds
  buffer_load_dwordx4 v16, s[16:19], s40 offen offset:2048 nt lds
  buffer_load_dwordx4 v17, s[16:19], s40 offen offset:3072 nt lds
  s_waitcnt vmcnt(24)
  s_cmp_ge_u32 s38, 33
  s_cbranch_scc1 L_fr_28
  ds_read_b32 v52, v8 offset:8
  s_waitcnt lgkmcnt(0)
  v_readlane_b32 s38, v52, 0
  v_readlane_b32 s37, v52, 1
  v_readlane_b32 s41, v52, 2
  s_nop 0
  s_min_u32 s38, s38, s37
  s_min_u32 s38, s38, s41
  s_cmp_ge_u32 s38, 33
  s_cbranch_scc1 L_fr_28
  s_waitcnt vmcnt(16)
  v_mov_b32 v7, 12
  ds_max_u32 v8, v7 offset:4
L_sp_28:
  ds_read_b32 v52, v8 offset:8
  s_waitcnt lgkmcnt(0)
  v_readlane_b32 s38, v52, 0
  v_readlane_b32 s37, v52, 1
  v_readlane_b32 s41, v52, 2
  s_nop 0
  s_min_u32 s38, s38, s37
  s_min_u32 s38, s38, s41
  s_cmp_ge_u32 s38, 33
  s_cbranch_scc0 L_sp_28
L_fr_28:
  s_mov_b32 m0, 32768
  s_add_u32 s40, s33, 212992
  s_and_b32 s40, s40, 262143
  buffer_load_dwordx4 v10, s[16:19], s40 offen nt lds
  buffer_load_dwordx4 v11, s[16:19], s40 offen offset:1024 nt lds
  buffer_load_dwordx4 v12, s[16:19], s40 offen offset:2048 nt lds
  buffer_load_dwordx4 v13, s[16:19], s40 offen offset:3072 nt lds
  s_waitcnt vmcnt(24)
  s_mov_b32 m0, 36864
  s_add_u32 s40, s33, 217088
  s_and_b32 s40, s40, 262143
  buffer_load_dwordx4 v14, s[16:19], s40 offen nt lds
  buffer_load_dwordx4 v15, s[16:19], s40 offen offset:1024 nt lds
  buffer_load_dwordx4 v16, s[16:19], s40 offen offset:2048 nt lds
  buffer_load_dwordx4 v17, s[16:19], s40 offen offset:3072 nt lds
  s_waitcnt vmcnt(24)
  v_mov_b32 v7, 12
  ds_max_u32 v8, v7 offset:4
  s_mov_b32 m0, 40960
  s_add_u32 s40, s33, 221184
  s_and_b32 s40, s40, 262143
  buffer_load_dwordx4 v10, s[16:19], s40 offen nt lds
  buffer_load_dwordx4 v11, s[16:19], s40 offen offset:1024 nt lds
  buffer_load_dwordx4 v12, s[16:19], s40 offen offset:2048 nt lds
  buffer_load_dwordx4 v13, s[16:19], s40 offen offset:3072 nt lds
  s_waitcnt vmcnt(24)
  s_mov_b32 m0, 45056
  s_add_u32 s40, s33, 225280
  s_and_b32 s40, s40, 262143
  buffer_load_dwordx4 v14, s[16:19], s40 offen nt lds
  buffer_load_dwordx4 v15, s[16:19], s40 offen offset:1024 nt lds
  buffer_load_dwordx4 v16, s[16:19], s40 offen offset:2048 nt lds
  buffer_load_dwordx4 v17, s[16:19], s40 offen offset:3072 nt lds
  s_waitcnt vmcnt(24)
  s_cmp_ge_u32 s38, 34
  s_cbranch_scc1 L_fr_29
  ds_read_b32 v52, v8 offset:8
  s_waitcnt lgkmcnt(0)
  v_readlane_b32 s38, v52, 0
  v_readlane_b32 s37, v52, 1
  v_readlane_b32 s41, v52, 2
  s_nop 0
  s_min_u32 s38, s38, s37
  s_min_u32 s38, s38, s41
  s_cmp_ge_u32 s38, 34
  s_cbranch_scc1 L_fr_29
  s_waitcnt vmcnt(16)
  v_mov_b32 v7, 13
  ds_max_u32 v8, v7 offset:4
L_sp_29:
  ds_read_b32 v52, v8 offset:8
  s_waitcnt lgkmcnt(0)
  v_readlane_b32 s38, v52, 0
  v_readlane_b32 s37, v52, 1
  v_readlane_b32 s41, v52, 2
  s_nop 0
  s_min_u32 s38, s38, s37
  s_min_u32 s38, s38, s41
  s_cmp_ge_u32 s38, 34
  s_cbranch_scc0 L_sp_29
L_fr_29:
  s_mov_b32 m0, 98304
  s_add_u32 s40, s33, 229376
  s_and_b32 s40, s40, 262143
  buffer_load_dwordx4 v10, s[16:19], s40 offen nt lds
  buffer_load_dwordx4 v11, s[16:19], s40 offen offset:1024 nt lds
  buffer_load_dwordx4 v12, s[16:19], s40 offen offset:2048 nt lds
  buffer_load_dwordx4 v13, s[16:19], s40 offen offset:3072 nt lds
  s_waitcnt vmcnt(24)
  s_mov_b32 m0, 102400
  s_add_u32 s40, s33, 233472
  s_and_b32 s40, s40, 262143
  buffer_load_dwordx4 v14, s[16:19], s40 offen nt lds
  buffer_load_dwordx4 v15, s[16:19], s40 offen offset:1024 nt lds
  buffer_load_dwordx4 v16, s[16:19], s40 offen offset:2048 nt lds
  buffer_load_dwordx4 v17, s[16:19], s40 offen offset:3072 nt lds
  s_waitcnt vmcnt(24)
  v_mov_b32 v7, 13
  ds_max_u32 v8, v7 offset:4
  s_mov_b32 m0, 106496
  s_add_u32 s40, s33, 237568
  s_and_b32 s40, s40, 262143
  buffer_load_dwordx4 v10, s[16:19], s40 offen nt lds
  buffer_load_dwordx4 v11, s[16:19], s40 offen offset:1024 nt lds
  buffer_load_dwordx4 v12, s[16:19], s40 offen offset:2048 nt lds
  buffer_load_dwordx4 v13, s[16:19], s40 offen offset:3072 nt lds
  s_waitcnt vmcnt(24)
  s_mov_b32 m0, 110592
  s_add_u32 s40, s33, 241664
  s_and_b32 s40, s40, 262143
  buffer_load_dwordx4 v14, s[16:19], s40 offen nt lds
  buffer_load_dwordx4 v15, s[16:19], s40 offen offset:1024 nt lds
  buffer_load_dwordx4 v16, s[16:19], s40 offen offset:2048 nt lds
  buffer_load_dwordx4 v17, s[16:19], s40 offen offset:3072 nt lds
  s_waitcnt vmcnt(24)
  s_cmp_ge_u32 s38, 35
  s_cbranch_scc1 L_fr_30
  ds_read_b32 v52, v8 offset:8
  s_waitcnt lgkmcnt(0)
  v_readlane_b32 s38, v52, 0
  v_readlane_b32 s37, v52, 1
  v_readlane_b32 s41, v52, 2
  s_nop 0
  s_min_u32 s38, s38, s37
  s_min_u32 s38, s38, s41
  s_cmp_ge_u32 s38, 35
  s_cbranch_scc1 L_fr_30
  s_waitcnt vmcnt(16)
  v_mov_b32 v7, 14
  ds_max_u32 v8, v7 offset:4
L_sp_30:
  ds_read_b32 v52, v8 offset:8
  s_waitcnt lgkmcnt(0)
  v_readlane_b32 s38, v52, 0
  v_readlane_b32 s37, v52, 1
  v_readlane_b32 s41, v52, 2
  s_nop 0
  s_min_u32 s38, s38, s37
  s_min_u32 s38, s38, s41
  s_cmp_ge_u32 s38, 35
  s_cbranch_scc0 L_sp_30
L_fr_30:
  s_mov_b32 m0, 114688
  s_add_u32 s40, s33, 245760
  s_and_b32 s40, s40, 262143
  buffer_load_dwordx4 v10, s[16:19], s40 offen nt lds
  buffer_load_dwordx4 v11, s[16:19], s40 offen offset:1024 nt lds
  buffer_load_dwordx4 v12, s[16:19], s40 offen offset:2048 nt lds
  buffer_load_dwordx4 v13, s[16:19], s40 offen offset:3072 nt lds
  s_waitcnt vmcnt(24)
  s_mov_b32 m0, 118784
  s_add_u32 s40, s33, 249856
  s_and_b32 s40, s40, 262143
  buffer_load_dwordx4 v14, s[16:19], s40 offen nt lds
  buffer_load_dwordx4 v15, s[16:19], s40 offen offset:1024 nt lds
  buffer_load_dwordx4 v16, s[16:19], s40 offen offset:2048 nt lds
  buffer_load_dwordx4 v17, s[16:19], s40 offen offset:3072 nt lds
  s_waitcnt vmcnt(24)
  v_mov_b32 v7, 14
  ds_max_u32 v8, v7 offset:4
  s_mov_b32 m0, 122880
  s_add_u32 s40, s33, 253952
  s_and_b32 s40, s40, 262143
  buffer_load_dwordx4 v10, s[16:19], s40 offen nt lds
  buffer_load_dwordx4 v11, s[16:19], s40 offen offset:1024 nt lds
  buffer_load_dwordx4 v12, s[16:19], s40 offen offset:2048 nt lds
  buffer_load_dwordx4 v13, s[16:19], s40 offen offset:3072 nt lds
  s_waitcnt vmcnt(24)
  s_mov_b32 m0, 126976
  s_add_u32 s40, s33, 258048
  s_and_b32 s40, s40, 262143
  buffer_load_dwordx4 v14, s[16:19], s40 offen nt lds
  buffer_load_dwordx4 v15, s[16:19], s40 offen offset:1024 nt lds
  buffer_load_dwordx4 v16, s[16:19], s40 offen offset:2048 nt lds
  buffer_load_dwordx4 v17, s[16:19], s40 offen offset:3072 nt lds
  s_waitcnt vmcnt(24)
  s_cmp_ge_u32 s38, 36
  s_cbranch_scc1 L_fr_31
  ds_read_b32 v52, v8 offset:8
  s_waitcnt lgkmcnt(0)
  v_readlane_b32 s38, v52, 0
  v_readlane_b32 s37, v52, 1
  v_readlane_b32 s41, v52, 2
  s_nop 0
  s_min_u32 s38, s38, s37
  s_min_u32 s38, s38, s41
  s_cmp_ge_u32 s38, 36
  s_cbranch_scc1 L_fr_31
  s_waitcnt vmcnt(16)
  v_mov_b32 v7, 15
  ds_max_u32 v8, v7 offset:4
L_sp_31:
  ds_read_b32 v52, v8 offset:8
  s_waitcnt lgkmcnt(0)
  v_readlane_b32 s38, v52, 0
  v_readlane_b32 s37, v52, 1
  v_readlane_b32 s41, v52, 2
  s_nop 0
  s_min_u32 s38, s38, s37
  s_min_u32 s38, s38, s41
  s_cmp_ge_u32 s38, 36
  s_cbranch_scc0 L_sp_31
L_fr_31:
  s_mov_b32 m0, 131072
  s_add_u32 s40, s33, 0
  s_and_b32 s40, s40, 262143
  buffer_load_dwordx4 v24, s[20:23], s40 offen nt lds
  buffer_load_dwordx4 v25, s[20:23], s40 offen offset:1024 nt lds
  buffer_load_dwordx4 v26, s[20:23], s40 offen offset:2048 nt lds
  buffer_load_dwordx4 v27, s[20:23], s40 offen offset:3072 nt lds
  s_waitcnt vmcnt(32)
  s_mov_b32 m0, 135168
  s_add_u32 s40, s33, 8192
  s_and_b32 s40, s40, 262143
  buffer_load_dwordx4 v24, s[20:23], s40 offen nt lds
  buffer_load_dwordx4 v25, s[20:23], s40 offen offset:1024 nt lds
  buffer_load_dwordx4 v26, s[20:23], s40 offen offset:2048 nt lds
  buffer_load_dwordx4 v27, s[20:23], s40 offen offset:3072 nt lds
  s_waitcnt vmcnt(32)
  s_mov_b32 m0, 139264
  s_add_u32 s40, s33, 16384
  s_and_b32 s40, s40, 262143
  buffer_load_dwordx4 v24, s[20:23], s40 offen nt lds
  buffer_load_dwordx4 v25, s[20:23], s40 offen offset:1024 nt lds
  buffer_load_dwordx4 v26, s[20:23], s40 offen offset:2048 nt lds
  buffer_load_dwordx4 v27, s[20:23], s40 offen offset:3072 nt lds
  s_waitcnt vmcnt(32)
  s_mov_b32 m0, 143360
  s_add_u32 s40, s33, 24576
  s_and_b32 s40, s40, 262143
  buffer_load_dwordx4 v24, s[20:23], s40 offen nt lds
  buffer_load_dwordx4 v25, s[20:23], s40 offen offset:1024 nt lds
  buffer_load_dwordx4 v26, s[20:23], s40 offen offset:2048 nt lds
  buffer_load_dwordx4 v27, s[20:23], s40 offen offset:3072 nt lds
  s_waitcnt vmcnt(32)
  v_mov_b32 v7, 15
  ds_max_u32 v8, v7 offset:4
  s_cmp_ge_u32 s38, 37
  s_cbranch_scc1 L_fr_32
  ds_read_b32 v52, v8 offset:8
  s_waitcnt lgkmcnt(0)
  v_readlane_b32 s38, v52, 0
  v_readlane_b32 s37, v52, 1
  v_readlane_b32 s41, v52, 2
  s_nop 0
  s_min_u32 s38, s38, s37
  s_min_u32 s38, s38, s41
  s_cmp_ge_u32 s38, 37
  s_cbranch_scc1 L_fr_32
  s_waitcnt vmcnt(16)
  v_mov_b32 v7, 16
  ds_max_u32 v8, v7 offset:4
L_sp_32:
  ds_read_b32 v52, v8 offset:8
  s_waitcnt lgkmcnt(0)
  v_readlane_b32 s38, v52, 0
  v_readlane_b32 s37, v52, 1
  v_readlane_b32 s41, v52, 2
  s_nop 0
  s_min_u32 s38, s38, s37
  s_min_u32 s38, s38, s41
  s_cmp_ge_u32 s38, 37
  s_cbranch_scc0 L_sp_32
L_fr_32:
  s_mov_b32 m0, 81920
  s_add_u32 s40, s33, 32768
  s_and_b32 s40, s40, 262143
  buffer_load_dwordx4 v24, s[20:23], s40 offen nt lds
  buffer_load_dwordx4 v25, s[20:23], s40 offen offset:1024 nt lds
  buffer_load_dwordx4 v26, s[20:23], s40 offen offset:2048 nt lds
  buffer_load_dwordx4 v27, s[20:23], s40 offen offset:3072 nt lds
  s_waitcnt vmcnt(32)
  s_mov_b32 m0, 86016
  s_add_u32 s40, s33, 40960
  s_and_b32 s40, s40, 262143
  buffer_load_dwordx4 v24, s[20:23], s40 offen nt lds
  buffer_load_dwordx4 v25, s[20:23], s40 offen offset:1024 nt lds
  buffer_load_dwordx4 v26, s[20:23], s40 offen offset:2048 nt lds
  buffer_load_dwordx4 v27, s[20:23], s40 offen offset:3072 nt lds
  s_waitcnt vmcnt(32)
  s_mov_b32 m0, 90112
  s_add_u32 s40, s33, 49152
  s_and_b32 s40, s40, 262143
  buffer_load_dwordx4 v24, s[20:23], s40 offen nt lds
  buffer_load_dwordx4 v25, s[20:23], s40 offen offset:1024 nt lds
  buffer_load_dwordx4 v26, s[20:23], s40 offen offset:2048 nt lds
  buffer_load_dwordx4 v27, s[20:23], s40 offen offset:3072 nt lds
  s_waitcnt vmcnt(32)
  s_mov_b32 m0, 94208
  s_add_u32 s40, s33, 57344
  s_and_b32 s40, s40, 262143
  buffer_load_dwordx4 v24, s[20:23], s40 offen nt lds
  buffer_load_dwordx4 v25, s[20:23], s40 offen offset:1024 nt lds
  buffer_load_dwordx4 v26, s[20:23], s40 offen offset:2048 nt lds
  buffer_load_dwordx4 v27, s[20:23], s40 offen offset:3072 nt lds
  s_waitcnt vmcnt(32)
  v_mov_b32 v7, 16
  ds_max_u32 v8, v7 offset:4
  s_cmp_ge_u32 s38, 38
  s_cbranch_scc1 L_fr_33
  ds_read_b32 v52, v8 offset:8
  s_waitcnt lgkmcnt(0)
  v_readlane_b32 s38, v52, 0
  v_readlane_b32 s37, v52, 1
  v_readlane_b32 s41, v52, 2
  s_nop 0
  s_min_u32 s38, s38, s37
  s_min_u32 s38, s38, s41
  s_cmp_ge_u32 s38, 38
  s_cbranch_scc1 L_fr_33
  s_waitcnt vmcnt(16)
  v_mov_b32 v7, 17
  ds_max_u32 v8, v7 offset:4
L_sp_33:
  ds_read_b32 v52, v8 offset:8
  s_waitcnt lgkmcnt(0)
  v_readlane_b32 s38, v52, 0
  v_readlane_b32 s37, v52, 1
  v_readlane_b32 s41, v52, 2
  s_nop 0
  s_min_u32 s38, s38, s37
  s_min_u32 s38, s38, s41
  s_cmp_ge_u32 s38, 38
  s_cbranch_scc0 L_sp_33
L_fr_33:
  s_mov_b32 m0, 49152
  s_add_u32 s40, s33, 65536
  s_and_b32 s40, s40, 262143
  buffer_load_dwordx4 v24, s[20:23], s40 offen nt lds
  buffer_load_dwordx4 v25, s[20:23], s40 offen offset:1024 nt lds
  buffer_load_dwordx4 v26, s[20:23], s40 offen offset:2048 nt lds
  buffer_load_dwordx4 v27, s[20:23], s40 offen offset:3072 nt lds
  s_waitcnt vmcnt(32)
  s_mov_b32 m0, 53248
  s_add_u32 s40, s33, 73728
  s_and_b32 s40, s40, 262143
  buffer_load_dwordx4 v24, s[20:23], s40 offen nt lds
  buffer_load_dwordx4 v25, s[20:23], s40 offen offset:1024 nt lds
  buffer_load_dwordx4 v26, s[20:23], s40 offen offset:2048 nt lds
  buffer_load_dwordx4 v27, s[20:23], s40 offen offset:3072 nt lds
  s_waitcnt vmcnt(32)
  s_mov_b32 m0, 57344
  s_add_u32 s40, s33, 81920
  s_and_b32 s40, s40, 262143
  buffer_load_dwordx4 v24, s[20:23], s40 offen nt lds
  buffer_load_dwordx4 v25, s[20:23], s40 offen offset:1024 nt lds
  buffer_load_dwordx4 v26, s[20:23], s40 offen offset:2048 nt lds
  buffer_load_dwordx4 v27, s[20:23], s40 offen offset:3072 nt lds
  s_waitcnt vmcnt(32)
  s_mov_b32 m0, 61440
  s_add_u32 s40, s33, 90112
  s_and_b32 s40, s40, 262143
  buffer_load_dwordx4 v24, s[20:23], s40 offen nt lds
  buffer_load_dwordx4 v25, s[20:23], s40 offen offset:1024 nt lds
  buffer_load_dwordx4 v26, s[20:23], s40 offen offset:2048 nt lds
  buffer_load_dwordx4 v27, s[20:23], s40 offen offset:3072 nt lds
  s_waitcnt vmcnt(32)
  v_mov_b32 v7, 17
  ds_max_u32 v8, v7 offset:4
  s_cmp_ge_u32 s38, 39
  s_cbranch_scc1 L_fr_34
  ds_read_b32 v52, v8 offset:8
  s_waitcnt lgkmcnt(0)
  v_readlane_b32 s38, v52, 0
  v_readlane_b32 s37, v52, 1
  v_readlane_b32 s41, v52, 2
  s_nop 0
  s_min_u32 s38, s38, s37
  s_min_u32 s38, s38, s41
  s_cmp_ge_u32 s38, 39
  s_cbranch_scc1 L_fr_34
  s_waitcnt vmcnt(16)
  v_mov_b32 v7, 18
  ds_max_u32 v8, v7 offset:4
L_sp_34:
  ds_read_b32 v52, v8 offset:8
  s_waitcnt lgkmcnt(0)
  v_readlane_b32 s38, v52, 0
  v_readlane_b32 s37, v52, 1
  v_readlane_b32 s41, v52, 2
  s_nop 0
  s_min_u32 s38, s38, s37
  s_min_u32 s38, s38, s41
  s_cmp_ge_u32 s38, 39
  s_cbranch_scc0 L_sp_34
L_fr_34:
  s_mov_b32 m0, 65536
  s_add_u32 s40, s33, 98304
  s_and_b32 s40, s40, 262143
  buffer_load_dwordx4 v24, s[20:23], s40 offen nt lds
  buffer_load_dwordx4 v25, s[20:23], s40 offen offset:1024 nt lds
  buffer_load_dwordx4 v26, s[20:23], s40 offen offset:2048 nt lds
  buffer_load_dwordx4 v27, s[20:23], s40 offen offset:3072 nt lds
  s_waitcnt vmcnt(32)
  s_mov_b32 m0, 69632
  s_add_u32 s40, s33, 106496
  s_and_b32 s40, s40, 262143
  buffer_load_dwordx4 v24, s[20:23], s40 offen nt lds
  buffer_load_dwordx4 v25, s[20:23], s40 offen offset:1024 nt lds
  buffer_load_dwordx4 v26, s[20:23], s40 offen offset:2048 nt lds
  buffer_load_dwordx4 v27, s[20:23], s40 offen offset:3072 nt lds
  s_waitcnt vmcnt(32)
  s_mov_b32 m0, 73728
  s_add_u32 s40, s33, 114688
  s_and_b32 s40, s40, 262143
  buffer_load_dwordx4 v24, s[20:23], s40 offen nt lds
  buffer_load_dwordx4 v25, s[20:23], s40 offen offset:1024 nt lds
  buffer_load_dwordx4 v26, s[20:23], s40 offen offset:2048 nt lds
  buffer_load_dwordx4 v27, s[20:23], s40 offen offset:3072 nt lds
  s_waitcnt vmcnt(32)
  s_mov_b32 m0, 77824
  s_add_u32 s40, s33, 122880
  s_and_b32 s40, s40, 262143
  buffer_load_dwordx4 v24, s[20:23], s40 offen nt lds
  buffer_load_dwordx4 v25, s[20:23], s40 offen offset:1024 nt lds
  buffer_load_dwordx4 v26, s[20:23], s40 offen offset:2048 nt lds
  buffer_load_dwordx4 v27, s[20:23], s40 offen offset:3072 nt lds
  s_waitcnt vmcnt(32)
  v_mov_b32 v7, 18
  ds_max_u32 v8, v7 offset:4
  s_cmp_ge_u32 s38, 40
  s_cbranch_scc1 L_fr_35
  ds_read_b32 v52, v8 offset:8
  s_waitcnt lgkmcnt(0)
  v_readlane_b32 s38, v52, 0
  v_readlane_b32 s37, v52, 1
  v_readlane_b32 s41, v52, 2
  s_nop 0
  s_min_u32 s38, s38, s37
  s_min_u32 s38, s38, s41
  s_cmp_ge_u32 s38, 40
  s_cbranch_scc1 L_fr_35
  s_waitcnt vmcnt(16)
  v_mov_b32 v7, 19
  ds_max_u32 v8, v7 offset:4
L_sp_35:
  ds_read_b32 v52, v8 offset:8
  s_waitcnt lgkmcnt(0)
  v_readlane_b32 s38, v52, 0
  v_readlane_b32 s37, v52, 1
  v_readlane_b32 s41, v52, 2
  s_nop 0
  s_min_u32 s38, s38, s37
  s_min_u32 s38, s38, s41
  s_cmp_ge_u32 s38, 40
  s_cbranch_scc0 L_sp_35
L_fr_35:
  s_mov_b32 m0, 0
  s_add_u32 s40, s33, 131072
  s_and_b32 s40, s40, 262143
  buffer_load_dwordx4 v24, s[20:23], s40 offen nt lds
  buffer_load_dwordx4 v25, s[20:23], s40 offen offset:1024 nt lds
  buffer_load_dwordx4 v26, s[20:23], s40 offen offset:2048 nt lds
  buffer_load_dwordx4 v27, s[20:23], s40 offen offset:3072 nt lds
  s_waitcnt vmcnt(32)
  s_mov_b32 m0, 4096
  s_add_u32 s40, s33, 139264
  s_and_b32 s40, s40, 262143
  buffer_load_dwordx4 v24, s[20:23], s40 offen nt lds
  buffer_load_dwordx4 v25, s[20:23], s40 offen offset:1024 nt lds
  buffer_load_dwordx4 v26, s[20:23], s40 offen offset:2048 nt lds
  buffer_load_dwordx4 v27, s[20:23], s40 offen offset:3072 nt lds
  s_waitcnt vmcnt(32)
  s_mov_b32 m0, 8192
  s_add_u32 s40, s33, 147456
  s_and_b32 s40, s40, 262143
  buffer_load_dwordx4 v24, s[20:23], s40 offen nt lds
  buffer_load_dwordx4 v25, s[20:23], s40 offen offset:1024 nt lds
  buffer_load_dwordx4 v26, s[20:23], s40 offen offset:2048 nt lds
  buffer_load_dwordx4 v27, s[20:23], s40 offen offset:3072 nt lds
  s_waitcnt vmcnt(32)
  s_mov_b32 m0, 12288
  s_add_u32 s40, s33, 155648
  s_and_b32 s40, s40, 262143
  buffer_load_dwordx4 v24, s[20:23], s40 offen nt lds
  buffer_load_dwordx4 v25, s[20:23], s40 offen offset:1024 nt lds
  buffer_load_dwordx4 v26, s[20:23], s40 offen offset:2048 nt lds
  buffer_load_dwordx4 v27, s[20:23], s40 offen offset:3072 nt lds
  s_waitcnt vmcnt(32)
  v_mov_b32 v7, 19
  ds_max_u32 v8, v7 offset:4
  s_cmp_ge_u32 s38, 41
  s_cbranch_scc1 L_fr_36
  ds_read_b32 v52, v8 offset:8
  s_waitcnt lgkmcnt(0)
  v_readlane_b32 s38, v52, 0
  v_readlane_b32 s37, v52, 1
  v_readlane_b32 s41, v52, 2
  s_nop 0
  s_min_u32 s38, s38, s37
  s_min_u32 s38, s38, s41
  s_cmp_ge_u32 s38, 41
  s_cbranch_scc1 L_fr_36
  s_waitcnt vmcnt(16)
  v_mov_b32 v7, 20
  ds_max_u32 v8, v7 offset:4
L_sp_36:
  ds_read_b32 v52, v8 offset:8
  s_waitcnt lgkmcnt(0)
  v_readlane_b32 s38, v52, 0
  v_readlane_b32 s37, v52, 1
  v_readlane_b32 s41, v52, 2
  s_nop 0
  s_min_u32 s38, s38, s37
  s_min_u32 s38, s38, s41
  s_cmp_ge_u32 s38, 41
  s_cbranch_scc0 L_sp_36
L_fr_36:
  s_mov_b32 m0, 16384
  s_add_u32 s40, s33, 163840
  s_and_b32 s40, s40, 262143
  buffer_load_dwordx4 v24, s[20:23], s40 offen nt lds
  buffer_load_dwordx4 v25, s[20:23], s40 offen offset:1024 nt lds
  buffer_load_dwordx4 v26, s[20:23], s40 offen offset:2048 nt lds
  buffer_load_dwordx4 v27, s[20:23], s40 offen offset:3072 nt lds
  s_waitcnt vmcnt(32)
  s_mov_b32 m0, 20480
  s_add_u32 s40, s33, 172032
  s_and_b32 s40, s40, 262143
  buffer_load_dwordx4 v24, s[20:23], s40 offen nt lds
  buffer_load_dwordx4 v25, s[20:23], s40 offen offset:1024 nt lds
  buffer_load_dwordx4 v26, s[20:23], s40 offen offset:2048 nt lds
  buffer_load_dwordx4 v27, s[20:23], s40 offen offset:3072 nt lds
  s_waitcnt vmcnt(32)
  s_mov_b32 m0, 24576
  s_add_u32 s40, s33, 180224
  s_and_b32 s40, s40, 262143
  buffer_load_dwordx4 v24, s[20:23], s40 offen nt lds
  buffer_load_dwordx4 v25, s[20:23], s40 offen offset:1024 nt lds
  buffer_load_dwordx4 v26, s[20:23], s40 offen offset:2048 nt lds
  buffer_load_dwordx4 v27, s[20:23], s40 offen offset:3072 nt lds
  s_waitcnt vmcnt(32)
  s_mov_b32 m0, 28672
  s_add_u32 s40, s33, 188416
  s_and_b32 s40, s40, 262143
  buffer_load_dwordx4 v24, s[20:23], s40 offen nt lds
  buffer_load_dwordx4 v25, s[20:23], s40 offen offset:1024 nt lds
  buffer_load_dwordx4 v26, s[20:23], s40 offen offset:2048 nt lds
  buffer_load_dwordx4 v27, s[20:23], s40 offen offset:3072 nt lds
  s_waitcnt vmcnt(32)
  v_mov_b32 v7, 20
  ds_max_u32 v8, v7 offset:4
  s_cmp_ge_u32 s38, 42
  s_cbranch_scc1 L_fr_37
  ds_read_b32 v52, v8 offset:8
  s_waitcnt lgkmcnt(0)
  v_readlane_b32 s38, v52, 0
  v_readlane_b32 s37, v52, 1
  v_readlane_b32 s41, v52, 2
  s_nop 0
  s_min_u32 s38, s38, s37
  s_min_u32 s38, s38, s41
  s_cmp_ge_u32 s38, 42
  s_cbranch_scc1 L_fr_37
  s_waitcnt vmcnt(16)
  v_mov_b32 v7, 21
  ds_max_u32 v8, v7 offset:4
L_sp_37:
  ds_read_b32 v52, v8 offset:8
  s_waitcnt lgkmcnt(0)
  v_readlane_b32 s38, v52, 0
  v_readlane_b32 s37, v52, 1
  v_readlane_b32 s41, v52, 2
  s_nop 0
  s_min_u32 s38, s38, s37
  s_min_u32 s38, s38, s41
  s_cmp_ge_u32 s38, 42
  s_cbranch_scc0 L_sp_37
L_fr_37:
  s_mov_b32 m0, 32768
  s_add_u32 s40, s33, 196608
  s_and_b32 s40, s40, 262143
  buffer_load_dwordx4 v24, s[20:23], s40 offen nt lds
  buffer_load_dwordx4 v25, s[20:23], s40 offen offset:1024 nt lds
  buffer_load_dwordx4 v26, s[20:23], s40 offen offset:2048 nt lds
  buffer_load_dwordx4 v27, s[20:23], s40 offen offset:3072 nt lds
  s_waitcnt vmcnt(32)
  s_mov_b32 m0, 36864
  s_add_u32 s40, s33, 204800
  s_and_b32 s40, s40, 262143
  buffer_load_dwordx4 v24, s[20:23], s40 offen nt lds
  buffer_load_dwordx4 v25, s[20:23], s40 offen offset:1024 nt lds
  buffer_load_dwordx4 v26, s[20:23], s40 offen offset:2048 nt lds
  buffer_load_dwordx4 v27, s[20:23], s40 offen offset:3072 nt lds
  s_waitcnt vmcnt(32)
  s_mov_b32 m0, 40960
  s_add_u32 s40, s33, 212992
  s_and_b32 s40, s40, 262143
  buffer_load_dwordx4 v24, s[20:23], s40 offen nt lds
  buffer_load_dwordx4 v25, s[20:23], s40 offen offset:1024 nt lds
  buffer_load_dwordx4 v26, s[20:23], s40 offen offset:2048 nt lds
  buffer_load_dwordx4 v27, s[20:23], s40 offen offset:3072 nt lds
  s_waitcnt vmcnt(32)
  s_mov_b32 m0, 45056
  s_add_u32 s40, s33, 221184
  s_and_b32 s40, s40, 262143
  buffer_load_dwordx4 v24, s[20:23], s40 offen nt lds
  buffer_load_dwordx4 v25, s[20:23], s40 offen offset:1024 nt lds
  buffer_load_dwordx4 v26, s[20:23], s40 offen offset:2048 nt lds
  buffer_load_dwordx4 v27, s[20:23], s40 offen offset:3072 nt lds
  s_waitcnt vmcnt(32)
  v_mov_b32 v7, 21
  ds_max_u32 v8, v7 offset:4
  s_cmp_ge_u32 s38, 43
  s_cbranch_scc1 L_fr_38
  ds_read_b32 v52, v8 offset:8
  s_waitcnt lgkmcnt(0)
  v_readlane_b32 s38, v52, 0
  v_readlane_b32 s37, v52, 1
  v_readlane_b32 s41, v52, 2
  s_nop 0
  s_min_u32 s38, s38, s37
  s_min_u32 s38, s38, s41
  s_cmp_ge_u32 s38, 43
  s_cbranch_scc1 L_fr_38
  s_waitcnt vmcnt(16)
  v_mov_b32 v7, 22
  ds_max_u32 v8, v7 offset:4
L_sp_38:
  ds_read_b32 v52, v8 offset:8
  s_waitcnt lgkmcnt(0)
  v_readlane_b32 s38, v52, 0
  v_readlane_b32 s37, v52, 1
  v_readlane_b32 s41, v52, 2
  s_nop 0
  s_min_u32 s38, s38, s37
  s_min_u32 s38, s38, s41
  s_cmp_ge_u32 s38, 43
  s_cbranch_scc0 L_sp_38
L_fr_38:
  s_mov_b32 m0, 98304
  s_add_u32 s40, s33, 229376
  s_and_b32 s40, s40, 262143
  buffer_load_dwordx4 v24, s[20:23], s40 offen nt lds
  buffer_load_dwordx4 v25, s[20:23], s40 offen offset:1024 nt lds
  buffer_load_dwordx4 v26, s[20:23], s40 offen offset:2048 nt lds
  buffer_load_dwordx4 v27, s[20:23], s40 offen offset:3072 nt lds
  s_waitcnt vmcnt(32)
  s_mov_b32 m0, 102400
  s_add_u32 s40, s33, 237568
  s_and_b32 s40, s40, 262143
  buffer_load_dwordx4 v24, s[20:23], s40 offen nt lds
  buffer_load_dwordx4 v25, s[20:23], s40 offen offset:1024 nt lds
  buffer_load_dwordx4 v26, s[20:23], s40 offen offset:2048 nt lds
  buffer_load_dwordx4 v27, s[20:23], s40 offen offset:3072 nt lds
  s_waitcnt vmcnt(32)
  s_mov_b32 m0, 106496
  s_add_u32 s40, s33, 245760
  s_and_b32 s40, s40, 262143
  buffer_load_dwordx4 v24, s[20:23], s40 offen nt lds
  buffer_load_dwordx4 v25, s[20:23], s40 offen offset:1024 nt lds
  buffer_load_dwordx4 v26, s[20:23], s40 offen offset:2048 nt lds
  buffer_load_dwordx4 v27, s[20:23], s40 offen offset:3072 nt lds
  s_waitcnt vmcnt(32)
  s_mov_b32 m0, 110592
  s_add_u32 s40, s33, 253952
  s_and_b32 s40, s40, 262143
  buffer_load_dwordx4 v24, s[20:23], s40 offen nt lds
  buffer_load_dwordx4 v25, s[20:23], s40 offen offset:1024 nt lds
  buffer_load_dwordx4 v26, s[20:23], s40 offen offset:2048 nt lds
  buffer_load_dwordx4 v27, s[20:23], s40 offen offset:3072 nt lds
  s_waitcnt vmcnt(32)
  v_mov_b32 v7, 22
  ds_max_u32 v8, v7 offset:4
  s_cmp_ge_u32 s38, 44
  s_cbranch_scc1 L_fr_39
  ds_read_b32 v52, v8 offset:8
  s_waitcnt lgkmcnt(0)
  v_readlane_b32 s38, v52, 0
  v_readlane_b32 s37, v52, 1
  v_readlane_b32 s41, v52, 2
  s_nop 0
  s_min_u32 s38, s38, s37
  s_min_u32 s38, s38, s41
  s_cmp_ge_u32 s38, 44
  s_cbranch_scc1 L_fr_39
  s_waitcnt vmcnt(16)
  v_mov_b32 v7, 23
  ds_max_u32 v8, v7 offset:4
L_sp_39:
  ds_read_b32 v52, v8 offset:8
  s_waitcnt lgkmcnt(0)
  v_readlane_b32 s38, v52, 0
  v_readlane_b32 s37, v52, 1
  v_readlane_b32 s41, v52, 2
  s_nop 0
  s_min_u32 s38, s38, s37
  s_min_u32 s38, s38, s41
  s_cmp_ge_u32 s38, 44
  s_cbranch_scc0 L_sp_39
L_fr_39:
  s_mov_b32 m0, 114688
  s_mov_b32 s40, 0
  buffer_load_dwordx4 v30, s[28:31], s40 offen lds
  buffer_load_dwordx4 v31, s[28:31], s40 offen offset:1024 lds
  buffer_load_dwordx4 v32, s[28:31], s40 offen offset:2048 lds
  buffer_load_dwordx4 v33, s[28:31], s40 offen offset:3072 lds
  s_waitcnt vmcnt(32)
  s_mov_b32 m0, 118784
  s_mov_b32 s40, 28672
  buffer_load_dwordx4 v30, s[28:31], s40 offen lds
  buffer_load_dwordx4 v31, s[28:31], s40 offen offset:1024 lds
  buffer_load_dwordx4 v32, s[28:31], s40 offen offset:2048 lds
  buffer_load_dwordx4 v33, s[28:31], s40 offen offset:3072 lds
  s_waitcnt vmcnt(32)
  s_mov_b32 m0, 122880
  s_mov_b32 s40, 57344
  buffer_load_dwordx4 v30, s[28:31], s40 offen lds
  buffer_load_dwordx4 v31, s[28:31], s40 offen offset:1024 lds
  buffer_load_dwordx4 v32, s[28:31], s40 offen offset:2048 lds
  buffer_load_dwordx4 v33, s[28:31], s40 offen offset:3072 lds
  s_waitcnt vmcnt(32)
  s_mov_b32 m0, 126976
  s_mov_b32 s40, 86016
  buffer_load_dwordx4 v30, s[28:31], s40 offen lds
  buffer_load_dwordx4 v31, s[28:31], s40 offen offset:1024 lds
  buffer_load_dwordx4 v32, s[28:31], s40 offen offset:2048 lds
  buffer_load_dwordx4 v33, s[28:31], s40 offen offset:3072 lds
  s_waitcnt vmcnt(32)
  v_mov_b32 v7, 23
  ds_max_u32 v8, v7 offset:4
  s_cmp_ge_u32 s38, 45
  s_cbranch_scc1 L_fr_40
  ds_read_b32 v52, v8 offset:8
  s_waitcnt lgkmcnt(0)
  v_readlane_b32 s38, v52, 0
  v_readlane_b32 s37, v52, 1
  v_readlane_b32 s41, v52, 2
  s_nop 0
  s_min_u32 s38, s38, s37
  s_min_u32 s38, s38, s41
  s_cmp_ge_u32 s38, 45
  s_cbranch_scc1 L_fr_40
  s_waitcnt vmcnt(16)
  v_mov_b32 v7, 24
  ds_max_u32 v8, v7 offset:4
L_sp_40:
  ds_read_b32 v52, v8 offset:8
  s_waitcnt lgkmcnt(0)
  v_readlane_b32 s38, v52, 0
  v_readlane_b32 s37, v52, 1
  v_readlane_b32 s41, v52, 2
  s_nop 0
  s_min_u32 s38, s38, s37
  s_min_u32 s38, s38, s41
  s_cmp_ge_u32 s38, 45
  s_cbranch_scc0 L_sp_40
L_fr_40:
  s_mov_b32 m0, 131072
  s_mov_b32 s40, 128
  buffer_load_dwordx4 v30, s[28:31], s40 offen lds
  buffer_load_dwordx4 v31, s[28:31], s40 offen offset:1024 lds
  buffer_load_dwordx4 v32, s[28:31], s40 offen offset:2048 lds
  buffer_load_dwordx4 v33, s[28:31], s40 offen offset:3072 lds
  s_waitcnt vmcnt(32)
  s_mov_b32 m0, 135168
  s_mov_b32 s40, 28800
  buffer_load_dwordx4 v30, s[28:31], s40 offen lds
  buffer_load_dwordx4 v31, s[28:31], s40 offen offset:1024 lds
  buffer_load_dwordx4 v32, s[28:31], s40 offen offset:2048 lds
  buffer_load_dwordx4 v33, s[28:31], s40 offen offset:3072 lds
  s_waitcnt vmcnt(32)
  s_mov_b32 m0, 139264
  s_mov_b32 s40, 57472
  buffer_load_dwordx4 v30, s[28:31], s40 offen lds
  buffer_load_dwordx4 v31, s[28:31], s40 offen offset:1024 lds
  buffer_load_dwordx4 v32, s[28:31], s40 offen offset:2048 lds
  buffer_load_dwordx4 v33, s[28:31], s40 offen offset:3072 lds
  s_waitcnt vmcnt(32)
  s_mov_b32 m0, 143360
  s_mov_b32 s40, 86144
  buffer_load_dwordx4 v30, s[28:31], s40 offen lds
  buffer_load_dwordx4 v31, s[28:31], s40 offen offset:1024 lds
  buffer_load_dwordx4 v32, s[28:31], s40 offen offset:2048 lds
  buffer_load_dwordx4 v33, s[28:31], s40 offen offset:3072 lds
  s_waitcnt vmcnt(32)
  v_mov_b32 v7, 24
  ds_max_u32 v8, v7 offset:4
  s_cmp_ge_u32 s38, 46
  s_cbranch_scc1 L_fr_41
  ds_read_b32 v52, v8 offset:8
  s_waitcnt lgkmcnt(0)
  v_readlane_b32 s38, v52, 0
  v_readlane_b32 s37, v52, 1
  v_readlane_b32 s41, v52, 2
  s_nop 0
  s_min_u32 s38, s38, s37
  s_min_u32 s38, s38, s41
  s_cmp_ge_u32 s38, 46
  s_cbranch_scc1 L_fr_41
  s_waitcnt vmcnt(16)
  v_mov_b32 v7, 25
  ds_max_u32 v8, v7 offset:4
L_sp_41:
  ds_read_b32 v52, v8 offset:8
  s_waitcnt lgkmcnt(0)
  v_readlane_b32 s38, v52, 0
  v_readlane_b32 s37, v52, 1
  v_readlane_b32 s41, v52, 2
  s_nop 0
  s_min_u32 s38, s38, s37
  s_min_u32 s38, s38, s41
  s_cmp_ge_u32 s38, 46
  s_cbranch_scc0 L_sp_41
L_fr_41:
  s_mov_b32 m0, 81920
  s_mov_b32 s40, 256
  buffer_load_dwordx4 v30, s[28:31], s40 offen lds
  buffer_load_dwordx4 v31, s[28:31], s40 offen offset:1024 lds
  buffer_load_dwordx4 v32, s[28:31], s40 offen offset:2048 lds
  buffer_load_dwordx4 v33, s[28:31], s40 offen offset:3072 lds
  s_waitcnt vmcnt(32)
  s_mov_b32 m0, 86016
  s_mov_b32 s40, 28928
  buffer_load_dwordx4 v30, s[28:31], s40 offen lds
  buffer_load_dwordx4 v31, s[28:31], s40 offen offset:1024 lds
  buffer_load_dwordx4 v32, s[28:31], s40 offen offset:2048 lds
  buffer_load_dwordx4 v33, s[28:31], s40 offen offset:3072 lds
  s_waitcnt vmcnt(32)
  s_mov_b32 m0, 90112
  s_mov_b32 s40, 57600
  buffer_load_dwordx4 v30, s[28:31], s40 offen lds
  buffer_load_dwordx4 v31, s[28:31], s40 offen offset:1024 lds
  buffer_load_dwordx4 v32, s[28:31], s40 offen offset:2048 lds
  buffer_load_dwordx4 v33, s[28:31], s40 offen offset:3072 lds
  s_waitcnt vmcnt(32)
  s_mov_b32 m0, 94208
  s_mov_b32 s40, 86272
  buffer_load_dwordx4 v30, s[28:31], s40 offen lds
  buffer_load_dwordx4 v31, s[28:31], s40 offen offset:1024 lds
  buffer_load_dwordx4 v32, s[28:31], s40 offen offset:2048 lds
  buffer_load_dwordx4 v33, s[28:31], s40 offen offset:3072 lds
  s_waitcnt vmcnt(32)
  v_mov_b32 v7, 25
  ds_max_u32 v8, v7 offset:4
  s_cmp_ge_u32 s38, 47
  s_cbranch_scc1 L_fr_42
  ds_read_b32 v52, v8 offset:8
  s_waitcnt lgkmcnt(0)
  v_readlane_b32 s38, v52, 0
  v_readlane_b32 s37, v52, 1
  v_readlane_b32 s41, v52, 2
  s_nop 0
  s_min_u32 s38, s38, s37
  s_min_u32 s38, s38, s41
  s_cmp_ge_u32 s38, 47
  s_cbranch_scc1 L_fr_42
  s_waitcnt vmcnt(16)
  v_mov_b32 v7, 26
  ds_max_u32 v8, v7 offset:4
L_sp_42:
  ds_read_b32 v52, v8 offset:8
  s_waitcnt lgkmcnt(0)
  v_readlane_b32 s38, v52, 0
  v_readlane_b32 s37, v52, 1
  v_readlane_b32 s41, v52, 2
  s_nop 0
  s_min_u32 s38, s38, s37
  s_min_u32 s38, s38, s41
  s_cmp_ge_u32 s38, 47
  s_cbranch_scc0 L_sp_42
L_fr_42:
  s_mov_b32 m0, 49152
  s_mov_b32 s40, 384
  buffer_load_dwordx4 v30, s[28:31], s40 offen lds
  buffer_load_dwordx4 v31, s[28:31], s40 offen offset:1024 lds
  buffer_load_dwordx4 v32, s[28:31], s40 offen offset:2048 lds
  buffer_load_dwordx4 v33, s[28:31], s40 offen offset:3072 lds
  s_waitcnt vmcnt(32)
  s_mov_b32 m0, 53248
  s_mov_b32 s40, 29056
  buffer_load_dwordx4 v30, s[28:31], s40 offen lds
  buffer_load_dwordx4 v31, s[28:31], s40 offen offset:1024 lds
  buffer_load_dwordx4 v32, s[28:31], s40 offen offset:2048 lds
  buffer_load_dwordx4 v33, s[28:31], s40 offen offset:3072 lds
  s_waitcnt vmcnt(32)
  s_mov_b32 m0, 57344
  s_mov_b32 s40, 57728
  buffer_load_dwordx4 v30, s[28:31], s40 offen lds
  buffer_load_dwordx4 v31, s[28:31], s40 offen offset:1024 lds
  buffer_load_dwordx4 v32, s[28:31], s40 offen offset:2048 lds
  buffer_load_dwordx4 v33, s[28:31], s40 offen offset:3072 lds
  s_waitcnt vmcnt(32)
  s_mov_b32 m0, 61440
  s_mov_b32 s40, 86400
  buffer_load_dwordx4 v30, s[28:31], s40 offen lds
  buffer_load_dwordx4 v31, s[28:31], s40 offen offset:1024 lds
  buffer_load_dwordx4 v32, s[28:31], s40 offen offset:2048 lds
  buffer_load_dwordx4 v33, s[28:31], s40 offen offset:3072 lds
  s_waitcnt vmcnt(32)
  v_mov_b32 v7, 26
  ds_max_u32 v8, v7 offset:4
  s_cmp_ge_u32 s38, 48
  s_cbranch_scc1 L_fr_43
  ds_read_b32 v52, v8 offset:8
  s_waitcnt lgkmcnt(0)
  v_readlane_b32 s38, v52, 0
  v_readlane_b32 s37, v52, 1
  v_readlane_b32 s41, v52, 2
  s_nop 0
  s_min_u32 s38, s38, s37
  s_min_u32 s38, s38, s41
  s_cmp_ge_u32 s38, 48
  s_cbranch_scc1 L_fr_43
  s_waitcnt vmcnt(16)
  v_mov_b32 v7, 27
  ds_max_u32 v8, v7 offset:4
L_sp_43:
  ds_read_b32 v52, v8 offset:8
  s_waitcnt lgkmcnt(0)
  v_readlane_b32 s38, v52, 0
  v_readlane_b32 s37, v52, 1
  v_readlane_b32 s41, v52, 2
  s_nop 0
  s_min_u32 s38, s38, s37
  s_min_u32 s38, s38, s41
  s_cmp_ge_u32 s38, 48
  s_cbranch_scc0 L_sp_43
L_fr_43:
  s_mov_b32 m0, 65536
  s_mov_b32 s40, 512
  buffer_load_dwordx4 v30, s[28:31], s40 offen lds
  buffer_load_dwordx4 v31, s[28:31], s40 offen offset:1024 lds
  buffer_load_dwordx4 v32, s[28:31], s40 offen offset:2048 lds
  buffer_load_dwordx4 v33, s[28:31], s40 offen offset:3072 lds
  s_waitcnt vmcnt(32)
  s_mov_b32 m0, 69632
  s_mov_b32 s40, 29184
  buffer_load_dwordx4 v30, s[28:31], s40 offen lds
  buffer_load_dwordx4 v31, s[28:31], s40 offen offset:1024 lds
  buffer_load_dwordx4 v32, s[28:31], s40 offen offset:2048 lds
  buffer_load_dwordx4 v33, s[28:31], s40 offen offset:3072 lds
  s_waitcnt vmcnt(32)
  s_mov_b32 m0, 73728
  s_mov_b32 s40, 57856
  buffer_load_dwordx4 v30, s[28:31], s40 offen lds
  buffer_load_dwordx4 v31, s[28:31], s40 offen offset:1024 lds
  buffer_load_dwordx4 v32, s[28:31], s40 offen offset:2048 lds
  buffer_load_dwordx4 v33, s[28:31], s40 offen offset:3072 lds
  s_waitcnt vmcnt(32)
  s_mov_b32 m0, 77824
  s_mov_b32 s40, 86528
  buffer_load_dwordx4 v30, s[28:31], s40 offen lds
  buffer_load_dwordx4 v31, s[28:31], s40 offen offset:1024 lds
  buffer_load_dwordx4 v32, s[28:31], s40 offen offset:2048 lds
  buffer_load_dwordx4 v33, s[28:31], s40 offen offset:3072 lds
  s_waitcnt vmcnt(32)
  v_mov_b32 v7, 27
  ds_max_u32 v8, v7 offset:4
  s_cmp_ge_u32 s38, 49
  s_cbranch_scc1 L_fr_44
  ds_read_b32 v52, v8 offset:8
  s_waitcnt lgkmcnt(0)
  v_readlane_b32 s38, v52, 0
  v_readlane_b32 s37, v52, 1
  v_readlane_b32 s41, v52, 2
  s_nop 0
  s_min_u32 s38, s38, s37
  s_min_u32 s38, s38, s41
  s_cmp_ge_u32 s38, 49
  s_cbranch_scc1 L_fr_44
  s_waitcnt vmcnt(16)
  v_mov_b32 v7, 28
  ds_max_u32 v8, v7 offset:4
L_sp_44:
  ds_read_b32 v52, v8 offset:8
  s_waitcnt lgkmcnt(0)
  v_readlane_b32 s38, v52, 0
  v_readlane_b32 s37, v52, 1
  v_readlane_b32 s41, v52, 2
  s_nop 0
  s_min_u32 s38, s38, s37
  s_min_u32 s38, s38, s41
  s_cmp_ge_u32 s38, 49
  s_cbranch_scc0 L_sp_44
L_fr_44:
  s_mov_b32 m0, 0
  s_mov_b32 s40, 640
  buffer_load_dwordx4 v30, s[28:31], s40 offen lds
  buffer_load_dwordx4 v31, s[28:31], s40 offen offset:1024 lds
  buffer_load_dwordx4 v32, s[28:31], s40 offen offset:2048 lds
  buffer_load_dwordx4 v33, s[28:31], s40 offen offset:3072 lds
  s_waitcnt vmcnt(32)
  s_mov_b32 m0, 4096
  s_mov_b32 s40, 29312
  buffer_load_dwordx4 v30, s[28:31], s40 offen lds
  buffer_load_dwordx4 v31, s[28:31], s40 offen offset:1024 lds
  buffer_load_dwordx4 v32, s[28:31], s40 offen offset:2048 lds
  buffer_load_dwordx4 v33, s[28:31], s40 offen offset:3072 lds
  s_waitcnt vmcnt(32)
  s_mov_b32 m0, 8192
  s_mov_b32 s40, 57984
  buffer_load_dwordx4 v30, s[28:31], s40 offen lds
  buffer_load_dwordx4 v31, s[28:31], s40 offen offset:1024 lds
  buffer_load_dwordx4 v32, s[28:31], s40 offen offset:2048 lds
  buffer_load_dwordx4 v33, s[28:31], s40 offen offset:3072 lds
  s_waitcnt vmcnt(32)
  s_mov_b32 m0, 12288
  s_mov_b32 s40, 86656
  buffer_load_dwordx4 v30, s[28:31], s40 offen lds
  buffer_load_dwordx4 v31, s[28:31], s40 offen offset:1024 lds
  buffer_load_dwordx4 v32, s[28:31], s40 offen offset:2048 lds
  buffer_load_dwordx4 v33, s[28:31], s40 offen offset:3072 lds
  s_waitcnt vmcnt(32)
  v_mov_b32 v7, 28
  ds_max_u32 v8, v7 offset:4
  s_cmp_ge_u32 s38, 50
  s_cbranch_scc1 L_fr_45
  ds_read_b32 v52, v8 offset:8
  s_waitcnt lgkmcnt(0)
  v_readlane_b32 s38, v52, 0
  v_readlane_b32 s37, v52, 1
  v_readlane_b32 s41, v52, 2
  s_nop 0
  s_min_u32 s38, s38, s37
  s_min_u32 s38, s38, s41
  s_cmp_ge_u32 s38, 50
  s_cbranch_scc1 L_fr_45
  s_waitcnt vmcnt(16)
  v_mov_b32 v7, 29
  ds_max_u32 v8, v7 offset:4
L_sp_45:
  ds_read_b32 v52, v8 offset:8
  s_waitcnt lgkmcnt(0)
  v_readlane_b32 s38, v52, 0
  v_readlane_b32 s37, v52, 1
  v_readlane_b32 s41, v52, 2
  s_nop 0
  s_min_u32 s38, s38, s37
  s_min_u32 s38, s38, s41
  s_cmp_ge_u32 s38, 50
  s_cbranch_scc0 L_sp_45
L_fr_45:
  s_mov_b32 m0, 16384
  s_mov_b32 s40, 768
  buffer_load_dwordx4 v30, s[28:31], s40 offen lds
  buffer_load_dwordx4 v31, s[28:31], s40 offen offset:1024 lds
  buffer_load_dwordx4 v32, s[28:31], s40 offen offset:2048 lds
  buffer_load_dwordx4 v33, s[28:31], s40 offen offset:3072 lds
  s_waitcnt vmcnt(32)
  s_mov_b32 m0, 20480
  s_mov_b32 s40, 29440
  buffer_load_dwordx4 v30, s[28:31], s40 offen lds
  buffer_load_dwordx4 v31, s[28:31], s40 offen offset:1024 lds
  buffer_load_dwordx4 v32, s[28:31], s40 offen offset:2048 lds
  buffer_load_dwordx4 v33, s[28:31], s40 offen offset:3072 lds
  s_waitcnt vmcnt(32)
  s_mov_b32 m0, 24576
  s_mov_b32 s40, 58112
  buffer_load_dwordx4 v30, s[28:31], s40 offen lds
  buffer_load_dwordx4 v31, s[28:31], s40 offen offset:1024 lds
  buffer_load_dwordx4 v32, s[28:31], s40 offen offset:2048 lds
  buffer_load_dwordx4 v33, s[28:31], s40 offen offset:3072 lds
  s_waitcnt vmcnt(32)
  s_mov_b32 m0, 28672
  s_mov_b32 s40, 86784
  buffer_load_dwordx4 v30, s[28:31], s40 offen lds
  buffer_load_dwordx4 v31, s[28:31], s40 offen offset:1024 lds
  buffer_load_dwordx4 v32, s[28:31], s40 offen offset:2048 lds
  buffer_load_dwordx4 v33, s[28:31], s40 offen offset:3072 lds
  s_waitcnt vmcnt(32)
  v_mov_b32 v7, 29
  ds_max_u32 v8, v7 offset:4
  s_add_u32 s37, s36, 114688
  buffer_load_dwordx4 v[192:195], v44, s[28:31], s37 offen
  s_add_u32 s37, s36, 115712
  buffer_load_dwordx4 v[196:199], v44, s[28:31], s37 offen
  s_add_u32 s37, s36, 116736
  buffer_load_dwordx4 v[200:203], v44, s[28:31], s37 offen
  s_add_u32 s37, s36, 117760
  buffer_load_dwordx4 v[204:207], v44, s[28:31], s37 offen
  s_add_u32 s37, s36, 118784
  buffer_load_dwordx4 v[208:211], v44, s[28:31], s37 offen
  s_add_u32 s37, s36, 119808
  buffer_load_dwordx4 v[212:215], v44, s[28:31], s37 offen
  s_add_u32 s37, s36, 120832
  buffer_load_dwordx4 v[216:219], v44, s[28:31], s37 offen
  s_waitcnt vmcnt(32)
  s_cmp_ge_u32 s38, 51
  s_cbranch_scc1 L_fr_46
  ds_read_b32 v52, v8 offset:8
  s_waitcnt lgkmcnt(0)
  v_readlane_b32 s38, v52, 0
  v_readlane_b32 s37, v52, 1
  v_readlane_b32 s41, v52, 2
  s_nop 0
  s_min_u32 s38, s38, s37
  s_min_u32 s38, s38, s41
  s_cmp_ge_u32 s38, 51
  s_cbranch_scc1 L_fr_46
  s_waitcnt vmcnt(7)
  v_mov_b32 v7, 31
  ds_max_u32 v8, v7 offset:4
L_sp_46:
  ds_read_b32 v52, v8 offset:8
  s_waitcnt lgkmcnt(0)
  v_readlane_b32 s38, v52, 0
  v_readlane_b32 s37, v52, 1
  v_readlane_b32 s41, v52, 2
  s_nop 0
  s_min_u32 s38, s38, s37
  s_min_u32 s38, s38, s41
  s_cmp_ge_u32 s38, 51
  s_cbranch_scc0 L_sp_46
L_fr_46:
  s_mov_b32 m0, 32768
  s_add_u32 s40, s33, 256
  s_and_b32 s40, s40, 262143
  buffer_load_dwordx4 v24, s[20:23], s40 offen nt lds
  buffer_load_dwordx4 v25, s[20:23], s40 offen offset:1024 nt lds
  buffer_load_dwordx4 v26, s[20:23], s40 offen offset:2048 nt lds
  buffer_load_dwordx4 v27, s[20:23], s40 offen offset:3072 nt lds
  s_waitcnt vmcnt(32)
  s_mov_b32 m0, 36864
  s_add_u32 s40, s33, 8448
  s_and_b32 s40, s40, 262143
  buffer_load_dwordx4 v24, s[20:23], s40 offen nt lds
  buffer_load_dwordx4 v25, s[20:23], s40 offen offset:1024 nt lds
  buffer_load_dwordx4 v26, s[20:23], s40 offen offset:2048 nt lds
  buffer_load_dwordx4 v27, s[20:23], s40 offen offset:3072 nt lds
  s_waitcnt vmcnt(32)
  s_mov_b32 m0, 40960
  s_add_u32 s40, s33, 16640
  s_and_b32 s40, s40, 262143
  buffer_load_dwordx4 v24, s[20:23], s40 offen nt lds
  buffer_load_dwordx4 v25, s[20:23], s40 offen offset:1024 nt lds
  buffer_load_dwordx4 v26, s[20:23], s40 offen offset:2048 nt lds
  buffer_load_dwordx4 v27, s[20:23], s40 offen offset:3072 nt lds
  s_waitcnt vmcnt(32)
  v_mov_b32 v7, 30
  ds_max_u32 v8, v7 offset:4
  s_mov_b32 m0, 45056
  s_add_u32 s40, s33, 24832
  s_and_b32 s40, s40, 262143
  buffer_load_dwordx4 v24, s[20:23], s40 offen nt lds
  buffer_load_dwordx4 v25, s[20:23], s40 offen offset:1024 nt lds
  buffer_load_dwordx4 v26, s[20:23], s40 offen offset:2048 nt lds
  buffer_load_dwordx4 v27, s[20:23], s40 offen offset:3072 nt lds
  s_waitcnt vmcnt(32)
  s_cmp_ge_u32 s38, 52
  s_cbranch_scc1 L_fr_47
  ds_read_b32 v52, v8 offset:8
  s_waitcnt lgkmcnt(0)
  v_readlane_b32 s38, v52, 0
  v_readlane_b32 s37, v52, 1
  v_readlane_b32 s41, v52, 2
  s_nop 0
  s_min_u32 s38, s38, s37
  s_min_u32 s38, s38, s41
  s_cmp_ge_u32 s38, 52
  s_cbranch_scc1 L_fr_47
  s_waitcnt vmcnt(16)
  v_mov_b32 v7, 31
  ds_max_u32 v8, v7 offset:4
L_sp_47:
  ds_read_b32 v52, v8 offset:8
  s_waitcnt lgkmcnt(0)
  v_readlane_b32 s38, v52, 0
  v_readlane_b32 s37, v52, 1
  v_readlane_b32 s41, v52, 2
  s_nop 0
  s_min_u32 s38, s38, s37
  s_min_u32 s38, s38, s41
  s_cmp_ge_u32 s38, 52
  s_cbranch_scc0 L_sp_47
L_fr_47:
  s_mov_b32 m0, 98304
  s_add_u32 s40, s33, 33024
  s_and_b32 s40, s40, 262143
  buffer_load_dwordx4 v24, s[20:23], s40 offen nt lds
  buffer_load_dwordx4 v25, s[20:23], s40 offen offset:1024 nt lds
  buffer_load_dwordx4 v26, s[20:23], s40 offen offset:2048 nt lds
  buffer_load_dwordx4 v27, s[20:23], s40 offen offset:3072 nt lds
  s_waitcnt vmcnt(32)
  s_mov_b32 m0, 102400
  s_add_u32 s40, s33, 41216
  s_and_b32 s40, s40, 262143
  buffer_load_dwordx4 v24, s[20:23], s40 offen nt lds
  buffer_load_dwordx4 v25, s[20:23], s40 offen offset:1024 nt lds
  buffer_load_dwordx4 v26, s[20:23], s40 offen offset:2048 nt lds
  buffer_load_dwordx4 v27, s[20:23], s40 offen offset:3072 nt lds
  s_waitcnt vmcnt(32)
  s_mov_b32 m0, 106496
  s_add_u32 s40, s33, 49408
  s_and_b32 s40, s40, 262143
  buffer_load_dwordx4 v24, s[20:23], s40 offen nt lds
  buffer_load_dwordx4 v25, s[20:23], s40 offen offset:1024 nt lds
  buffer_load_dwordx4 v26, s[20:23], s40 offen offset:2048 nt lds
  buffer_load_dwordx4 v27, s[20:23], s40 offen offset:3072 nt lds
  s_waitcnt vmcnt(32)
  v_mov_b32 v7, 31
  ds_max_u32 v8, v7 offset:4
  s_mov_b32 m0, 110592
  s_add_u32 s40, s33, 57600
  s_and_b32 s40, s40, 262143
  buffer_load_dwordx4 v24, s[20:23], s40 offen nt lds
  buffer_load_dwordx4 v25, s[20:23], s40 offen offset:1024 nt lds
  buffer_load_dwordx4 v26, s[20:23], s40 offen offset:2048 nt lds
  buffer_load_dwordx4 v27, s[20:23], s40 offen offset:3072 nt lds
  s_waitcnt vmcnt(32)
  s_add_u32 s37, s36, 121856
  buffer_load_dwordx4 v[220:223], v44, s[28:31], s37 offen
  s_add_u32 s37, s36, 122880
  buffer_load_dwordx4 v[224:227], v44, s[28:31], s37 offen
  s_add_u32 s37, s36, 123904
  buffer_load_dwordx4 v[228:231], v44, s[28:31], s37 offen
  s_add_u32 s37, s36, 124928
  buffer_load_dwordx4 v[232:235], v44, s[28:31], s37 offen
  s_add_u32 s37, s36, 125952
  buffer_load_dwordx4 v[236:239], v44, s[28:31], s37 offen
  s_add_u32 s37, s36, 126976
  buffer_load_dwordx4 v[240:243], v44, s[28:31], s37 offen
  s_add_u32 s37, s36, 128000
  buffer_load_dwordx4 v[244:247], v44, s[28:31], s37 offen
  s_waitcnt vmcnt(32)
  s_cmp_ge_u32 s38, 53
  s_cbranch_scc1 L_fr_48
  ds_read_b32 v52, v8 offset:8
  s_waitcnt lgkmcnt(0)
  v_readlane_b32 s38, v52, 0
  v_readlane_b32 s37, v52, 1
  v_readlane_b32 s41, v52, 2
  s_nop 0
  s_min_u32 s38, s38, s37
  s_min_u32 s38, s38, s41
  s_cmp_ge_u32 s38, 53
  s_cbranch_scc1 L_fr_48
  s_waitcnt vmcnt(7)
  v_mov_b32 v7, 33
  ds_max_u32 v8, v7 offset:4
L_sp_48:
  ds_read_b32 v52, v8 offset:8
  s_waitcnt lgkmcnt(0)
  v_readlane_b32 s38, v52, 0
  v_readlane_b32 s37, v52, 1
  v_readlane_b32 s41, v52, 2
  s_nop 0
  s_min_u32 s38, s38, s37
  s_min_u32 s38, s38, s41
  s_cmp_ge_u32 s38, 53
  s_cbranch_scc0 L_sp_48
L_fr_48:
  s_mov_b32 m0, 114688
  s_add_u32 s40, s33, 65792
  s_and_b32 s40, s40, 262143
  buffer_load_dwordx4 v24, s[20:23], s40 offen nt lds
  buffer_load_dwordx4 v25, s[20:23], s40 offen offset:1024 nt lds
  buffer_load_dwordx4 v26, s[20:23], s40 offen offset:2048 nt lds
  buffer_load_dwordx4 v27, s[20:23], s40 offen offset:3072 nt lds
  s_waitcnt vmcnt(32)
  s_mov_b32 m0, 118784
  s_add_u32 s40, s33, 73984
  s_and_b32 s40, s40, 262143
  buffer_load_dwordx4 v24, s[20:23], s40 offen nt lds
  buffer_load_dwordx4 v25, s[20:23], s40 offen offset:1024 nt lds
  buffer_load_dwordx4 v26, s[20:23], s40 offen offset:2048 nt lds
  buffer_load_dwordx4 v27, s[20:23], s40 offen offset:3072 nt lds
  s_waitcnt vmcnt(32)
  s_mov_b32 m0, 122880
  s_add_u32 s40, s33, 82176
  s_and_b32 s40, s40, 262143
  buffer_load_dwordx4 v24, s[20:23], s40 offen nt lds
  buffer_load_dwordx4 v25, s[20:23], s40 offen offset:1024 nt lds
  buffer_load_dwordx4 v26, s[20:23], s40 offen offset:2048 nt lds
  buffer_load_dwordx4 v27, s[20:23], s40 offen offset:3072 nt lds
  s_waitcnt vmcnt(32)
  v_mov_b32 v7, 32
  ds_max_u32 v8, v7 offset:4
  s_mov_b32 m0, 126976
  s_add_u32 s40, s33, 90368
  s_and_b32 s40, s40, 262143
  buffer_load_dwordx4 v24, s[20:23], s40 offen nt lds
  buffer_load_dwordx4 v25, s[20:23], s40 offen offset:1024 nt lds
  buffer_load_dwordx4 v26, s[20:23], s40 offen offset:2048 nt lds
  buffer_load_dwordx4 v27, s[20:23], s40 offen offset:3072 nt lds
  s_waitcnt vmcnt(32)
  s_cmp_ge_u32 s38, 54
  s_cbranch_scc1 L_fr_49
  ds_read_b32 v52, v8 offset:8
  s_waitcnt lgkmcnt(0)
  v_readlane_b32 s38, v52, 0
  v_readlane_b32 s37, v52, 1
  v_readlane_b32 s41, v52, 2
  s_nop 0
  s_min_u32 s38, s38, s37
  s_min_u32 s38, s38, s41
  s_cmp_ge_u32 s38, 54
  s_cbranch_scc1 L_fr_49
  s_waitcnt vmcnt(16)
  v_mov_b32 v7, 33
  ds_max_u32 v8, v7 offset:4
L_sp_49:
  ds_read_b32 v52, v8 offset:8
  s_waitcnt lgkmcnt(0)
  v_readlane_b32 s38, v52, 0
  v_readlane_b32 s37, v52, 1
  v_readlane_b32 s41, v52, 2
  s_nop 0
  s_min_u32 s38, s38, s37
  s_min_u32 s38, s38, s41
  s_cmp_ge_u32 s38, 54
  s_cbranch_scc0 L_sp_49
L_fr_49:
  s_mov_b32 m0, 131072
  s_add_u32 s40, s33, 98560
  s_and_b32 s40, s40, 262143
  buffer_load_dwordx4 v24, s[20:23], s40 offen nt lds
  buffer_load_dwordx4 v25, s[20:23], s40 offen offset:1024 nt lds
  buffer_load_dwordx4 v26, s[20:23], s40 offen offset:2048 nt lds
  buffer_load_dwordx4 v27, s[20:23], s40 offen offset:3072 nt lds
  s_waitcnt vmcnt(32)
  s_mov_b32 m0, 135168
  s_add_u32 s40, s33, 106752
  s_and_b32 s40, s40, 262143
  buffer_load_dwordx4 v24, s[20:23], s40 offen nt lds
  buffer_load_dwordx4 v25, s[20:23], s40 offen offset:1024 nt lds
  buffer_load_dwordx4 v26, s[20:23], s40 offen offset:2048 nt lds
  buffer_load_dwordx4 v27, s[20:23], s40 offen offset:3072 nt lds
  s_waitcnt vmcnt(32)
  s_mov_b32 m0, 139264
  s_add_u32 s40, s33, 114944
  s_and_b32 s40, s40, 262143
  buffer_load_dwordx4 v24, s[20:23], s40 offen nt lds
  buffer_load_dwordx4 v25, s[20:23], s40 offen offset:1024 nt lds
  buffer_load_dwordx4 v26, s[20:23], s40 offen offset:2048 nt lds
  buffer_load_dwordx4 v27, s[20:23], s40 offen offset:3072 nt lds
  s_waitcnt vmcnt(32)
  v_mov_b32 v7, 33
  ds_max_u32 v8, v7 offset:4
  s_mov_b32 m0, 143360
  s_add_u32 s40, s33, 123136
  s_and_b32 s40, s40, 262143
  buffer_load_dwordx4 v24, s[20:23], s40 offen nt lds
  buffer_load_dwordx4 v25, s[20:23], s40 offen offset:1024 nt lds
  buffer_load_dwordx4 v26, s[20:23], s40 offen offset:2048 nt lds
  buffer_load_dwordx4 v27, s[20:23], s40 offen offset:3072 nt lds
  s_waitcnt vmcnt(32)
  s_cmp_ge_u32 s38, 55
  s_cbranch_scc1 L_fr_50
  ds_read_b32 v52, v8 offset:8
  s_waitcnt lgkmcnt(0)
  v_readlane_b32 s38, v52, 0
  v_readlane_b32 s37, v52, 1
  v_readlane_b32 s41, v52, 2
  s_nop 0
  s_min_u32 s38, s38, s37
  s_min_u32 s38, s38, s41
  s_cmp_ge_u32 s38, 55
  s_cbranch_scc1 L_fr_50
  s_waitcnt vmcnt(16)
  v_mov_b32 v7, 34
  ds_max_u32 v8, v7 offset:4
L_sp_50:
  ds_read_b32 v52, v8 offset:8
  s_waitcnt lgkmcnt(0)
  v_readlane_b32 s38, v52, 0
  v_readlane_b32 s37, v52, 1
  v_readlane_b32 s41, v52, 2
  s_nop 0
  s_min_u32 s38, s38, s37
  s_min_u32 s38, s38, s41
  s_cmp_ge_u32 s38, 55
  s_cbranch_scc0 L_sp_50
L_fr_50:
  s_mov_b32 m0, 81920
  s_add_u32 s40, s33, 131328
  s_and_b32 s40, s40, 262143
  buffer_load_dwordx4 v24, s[20:23], s40 offen nt lds
  buffer_load_dwordx4 v25, s[20:23], s40 offen offset:1024 nt lds
  buffer_load_dwordx4 v26, s[20:23], s40 offen offset:2048 nt lds
  buffer_load_dwordx4 v27, s[20:23], s40 offen offset:3072 nt lds
  s_waitcnt vmcnt(32)
  s_mov_b32 m0, 86016
  s_add_u32 s40, s33, 139520
  s_and_b32 s40, s40, 262143
  buffer_load_dwordx4 v24, s[20:23], s40 offen nt lds
  buffer_load_dwordx4 v25, s[20:23], s40 offen offset:1024 nt lds
  buffer_load_dwordx4 v26, s[20:23], s40 offen offset:2048 nt lds
  buffer_load_dwordx4 v27, s[20:23], s40 offen offset:3072 nt lds
  s_waitcnt vmcnt(32)
  s_mov_b32 m0, 90112
  s_add_u32 s40, s33, 147712
  s_and_b32 s40, s40, 262143
  buffer_load_dwordx4 v24, s[20:23], s40 offen nt lds
  buffer_load_dwordx4 v25, s[20:23], s40 offen offset:1024 nt lds
  buffer_load_dwordx4 v26, s[20:23], s40 offen offset:2048 nt lds
  buffer_load_dwordx4 v27, s[20:23], s40 offen offset:3072 nt lds
  s_waitcnt vmcnt(32)
  s_mov_b32 m0, 94208
  s_add_u32 s40, s33, 155904
  s_and_b32 s40, s40, 262143
  buffer_load_dwordx4 v24, s[20:23], s40 offen nt lds
  buffer_load_dwordx4 v25, s[20:23], s40 offen offset:1024 nt lds
  buffer_load_dwordx4 v26, s[20:23], s40 offen offset:2048 nt lds
  buffer_load_dwordx4 v27, s[20:23], s40 offen offset:3072 nt lds
  s_waitcnt vmcnt(32)
  v_mov_b32 v7, 34
  ds_max_u32 v8, v7 offset:4
  s_cmp_ge_u32 s38, 56
  s_cbranch_scc1 L_fr_51
  ds_read_b32 v52, v8 offset:8
  s_waitcnt lgkmcnt(0)
  v_readlane_b32 s38, v52, 0
  v_readlane_b32 s37, v52, 1
  v_readlane_b32 s41, v52, 2
  s_nop 0
  s_min_u32 s38, s38, s37
  s_min_u32 s38, s38, s41
  s_cmp_ge_u32 s38, 56
  s_cbranch_scc1 L_fr_51
  s_waitcnt vmcnt(16)
  v_mov_b32 v7, 35
  ds_max_u32 v8, v7 offset:4
L_sp_51:
  ds_read_b32 v52, v8 offset:8
  s_waitcnt lgkmcnt(0)
  v_readlane_b32 s38, v52, 0
  v_readlane_b32 s37, v52, 1
  v_readlane_b32 s41, v52, 2
  s_nop 0
  s_min_u32 s38, s38, s37
  s_min_u32 s38, s38, s41
  s_cmp_ge_u32 s38, 56
  s_cbranch_scc0 L_sp_51
L_fr_51:
  s_mov_b32 m0, 49152
  s_add_u32 s40, s33, 164096
  s_and_b32 s40, s40, 262143
  buffer_load_dwordx4 v24, s[20:23], s40 offen nt lds
  buffer_load_dwordx4 v25, s[20:23], s40 offen offset:1024 nt lds
  buffer_load_dwordx4 v26, s[20:23], s40 offen offset:2048 nt lds
  buffer_load_dwordx4 v27, s[20:23], s40 offen offset:3072 nt lds
  s_waitcnt vmcnt(32)
  s_mov_b32 m0, 53248
  s_add_u32 s40, s33, 172288
  s_and_b32 s40, s40, 262143
  buffer_load_dwordx4 v24, s[20:23], s40 offen nt lds
  buffer_load_dwordx4 v25, s[20:23], s40 offen offset:1024 nt lds
  buffer_load_dwordx4 v26, s[20:23], s40 offen offset:2048 nt lds
  buffer_load_dwordx4 v27, s[20:23], s40 offen offset:3072 nt lds
  s_waitcnt vmcnt(32)
  s_mov_b32 m0, 57344
  s_add_u32 s40, s33, 180480
  s_and_b32 s40, s40, 262143
  buffer_load_dwordx4 v24, s[20:23], s40 offen nt lds
  buffer_load_dwordx4 v25, s[20:23], s40 offen offset:1024 nt lds
  buffer_load_dwordx4 v26, s[20:23], s40 offen offset:2048 nt lds
  buffer_load_dwordx4 v27, s[20:23], s40 offen offset:3072 nt lds
  s_waitcnt vmcnt(32)
  s_mov_b32 m0, 61440
  s_add_u32 s40, s33, 188672
  s_and_b32 s40, s40, 262143
  buffer_load_dwordx4 v24, s[20:23], s40 offen nt lds
  buffer_load_dwordx4 v25, s[20:23], s40 offen offset:1024 nt lds
  buffer_load_dwordx4 v26, s[20:23], s40 offen offset:2048 nt lds
  buffer_load_dwordx4 v27, s[20:23], s40 offen offset:3072 nt lds
  s_waitcnt vmcnt(32)
  v_mov_b32 v7, 35
  ds_max_u32 v8, v7 offset:4
  s_cmp_ge_u32 s38, 57
  s_cbranch_scc1 L_fr_52
  ds_read_b32 v52, v8 offset:8
  s_waitcnt lgkmcnt(0)
  v_readlane_b32 s38, v52, 0
  v_readlane_b32 s37, v52, 1
  v_readlane_b32 s41, v52, 2
  s_nop 0
  s_min_u32 s38, s38, s37
  s_min_u32 s38, s38, s41
  s_cmp_ge_u32 s38, 57
  s_cbranch_scc1 L_fr_52
  s_waitcnt vmcnt(16)
  v_mov_b32 v7, 36
  ds_max_u32 v8, v7 offset:4
L_sp_52:
  ds_read_b32 v52, v8 offset:8
  s_waitcnt lgkmcnt(0)
  v_readlane_b32 s38, v52, 0
  v_readlane_b32 s37, v52, 1
  v_readlane_b32 s41, v52, 2
  s_nop 0
  s_min_u32 s38, s38, s37
  s_min_u32 s38, s38, s41
  s_cmp_ge_u32 s38, 57
  s_cbranch_scc0 L_sp_52
L_fr_52:
  s_mov_b32 m0, 65536
  s_add_u32 s40, s33, 196864
  s_and_b32 s40, s40, 262143
  buffer_load_dwordx4 v24, s[20:23], s40 offen nt lds
  buffer_load_dwordx4 v25, s[20:23], s40 offen offset:1024 nt lds
  buffer_load_dwordx4 v26, s[20:23], s40 offen offset:2048 nt lds
  buffer_load_dwordx4 v27, s[20:23], s40 offen offset:3072 nt lds
  s_waitcnt vmcnt(32)
  s_mov_b32 m0, 69632
  s_add_u32 s40, s33, 205056
  s_and_b32 s40, s40, 262143
  buffer_load_dwordx4 v24, s[20:23], s40 offen nt lds
  buffer_load_dwordx4 v25, s[20:23], s40 offen offset:1024 nt lds
  buffer_load_dwordx4 v26, s[20:23], s40 offen offset:2048 nt lds
  buffer_load_dwordx4 v27, s[20:23], s40 offen offset:3072 nt lds
  s_waitcnt vmcnt(32)
  s_mov_b32 m0, 73728
  s_add_u32 s40, s33, 213248
  s_and_b32 s40, s40, 262143
  buffer_load_dwordx4 v24, s[20:23], s40 offen nt lds
  buffer_load_dwordx4 v25, s[20:23], s40 offen offset:1024 nt lds
  buffer_load_dwordx4 v26, s[20:23], s40 offen offset:2048 nt lds
  buffer_load_dwordx4 v27, s[20:23], s40 offen offset:3072 nt lds
  s_waitcnt vmcnt(32)
  s_mov_b32 m0, 77824
  s_add_u32 s40, s33, 221440
  s_and_b32 s40, s40, 262143
  buffer_load_dwordx4 v24, s[20:23], s40 offen nt lds
  buffer_load_dwordx4 v25, s[20:23], s40 offen offset:1024 nt lds
  buffer_load_dwordx4 v26, s[20:23], s40 offen offset:2048 nt lds
  buffer_load_dwordx4 v27, s[20:23], s40 offen offset:3072 nt lds
  s_waitcnt vmcnt(32)
  v_mov_b32 v7, 36
  ds_max_u32 v8, v7 offset:4
  s_cmp_ge_u32 s38, 58
  s_cbranch_scc1 L_fr_53
  ds_read_b32 v52, v8 offset:8
  s_waitcnt lgkmcnt(0)
  v_readlane_b32 s38, v52, 0
  v_readlane_b32 s37, v52, 1
  v_readlane_b32 s41, v52, 2
  s_nop 0
  s_min_u32 s38, s38, s37
  s_min_u32 s38, s38, s41
  s_cmp_ge_u32 s38, 58
  s_cbranch_scc1 L_fr_53
  s_waitcnt vmcnt(16)
  v_mov_b32 v7, 37
  ds_max_u32 v8, v7 offset:4
L_sp_53:
  ds_read_b32 v52, v8 offset:8
  s_waitcnt lgkmcnt(0)
  v_readlane_b32 s38, v52, 0
  v_readlane_b32 s37, v52, 1
  v_readlane_b32 s41, v52, 2
  s_nop 0
  s_min_u32 s38, s38, s37
  s_min_u32 s38, s38, s41
  s_cmp_ge_u32 s38, 58
  s_cbranch_scc0 L_sp_53
L_fr_53:
  s_mov_b32 m0, 0
  s_add_u32 s40, s33, 229632
  s_and_b32 s40, s40, 262143
  buffer_load_dwordx4 v24, s[20:23], s40 offen nt lds
  buffer_load_dwordx4 v25, s[20:23], s40 offen offset:1024 nt lds
  buffer_load_dwordx4 v26, s[20:23], s40 offen offset:2048 nt lds
  buffer_load_dwordx4 v27, s[20:23], s40 offen offset:3072 nt lds
  s_waitcnt vmcnt(32)
  s_mov_b32 m0, 4096
  s_add_u32 s40, s33, 237824
  s_and_b32 s40, s40, 262143
  buffer_load_dwordx4 v24, s[20:23], s40 offen nt lds
  buffer_load_dwordx4 v25, s[20:23], s40 offen offset:1024 nt lds
  buffer_load_dwordx4 v26, s[20:23], s40 offen offset:2048 nt lds
  buffer_load_dwordx4 v27, s[20:23], s40 offen offset:3072 nt lds
  s_waitcnt vmcnt(32)
  s_mov_b32 m0, 8192
  s_add_u32 s40, s33, 246016
  s_and_b32 s40, s40, 262143
  buffer_load_dwordx4 v24, s[20:23], s40 offen nt lds
  buffer_load_dwordx4 v25, s[20:23], s40 offen offset:1024 nt lds
  buffer_load_dwordx4 v26, s[20:23], s40 offen offset:2048 nt lds
  buffer_load_dwordx4 v27, s[20:23], s40 offen offset:3072 nt lds
  s_waitcnt vmcnt(32)
  s_mov_b32 m0, 12288
  s_add_u32 s40, s33, 254208
  s_and_b32 s40, s40, 262143
  buffer_load_dwordx4 v24, s[20:23], s40 offen nt lds
  buffer_load_dwordx4 v25, s[20:23], s40 offen offset:1024 nt lds
  buffer_load_dwordx4 v26, s[20:23], s40 offen offset:2048 nt lds
  buffer_load_dwordx4 v27, s[20:23], s40 offen offset:3072 nt lds
  s_waitcnt vmcnt(32)
  v_mov_b32 v7, 37
  ds_max_u32 v8, v7 offset:4
  s_cmp_ge_u32 s38, 59
  s_cbranch_scc1 L_fr_54
  ds_read_b32 v52, v8 offset:8
  s_waitcnt lgkmcnt(0)
  v_readlane_b32 s38, v52, 0
  v_readlane_b32 s37, v52, 1
  v_readlane_b32 s41, v52, 2
  s_nop 0
  s_min_u32 s38, s38, s37
  s_min_u32 s38, s38, s41
  s_cmp_ge_u32 s38, 59
  s_cbranch_scc1 L_fr_54
  s_waitcnt vmcnt(16)
  v_mov_b32 v7, 38
  ds_max_u32 v8, v7 offset:4
L_sp_54:
  ds_read_b32 v52, v8 offset:8
  s_waitcnt lgkmcnt(0)
  v_readlane_b32 s38, v52, 0
  v_readlane_b32 s37, v52, 1
  v_readlane_b32 s41, v52, 2
  s_nop 0
  s_min_u32 s38, s38, s37
  s_min_u32 s38, s38, s41
  s_cmp_ge_u32 s38, 59
  s_cbranch_scc0 L_sp_54
L_fr_54:
  s_mov_b32 m0, 16384
  s_mov_b32 s40, 114688
  buffer_load_dwordx4 v30, s[28:31], s40 offen lds
  buffer_load_dwordx4 v31, s[28:31], s40 offen offset:1024 lds
  buffer_load_dwordx4 v32, s[28:31], s40 offen offset:2048 lds
  buffer_load_dwordx4 v33, s[28:31], s40 offen offset:3072 lds
  s_waitcnt vmcnt(32)
  s_mov_b32 m0, 20480
  s_mov_b32 s40, 143360
  buffer_load_dwordx4 v30, s[28:31], s40 offen lds
  buffer_load_dwordx4 v31, s[28:31], s40 offen offset:1024 lds
  buffer_load_dwordx4 v32, s[28:31], s40 offen offset:2048 lds
  buffer_load_dwordx4 v33, s[28:31], s40 offen offset:3072 lds
  s_waitcnt vmcnt(32)
  s_mov_b32 m0, 24576
  s_mov_b32 s40, 172032
  buffer_load_dwordx4 v30, s[28:31], s40 offen lds
  buffer_load_dwordx4 v31, s[28:31], s40 offen offset:1024 lds
  buffer_load_dwordx4 v32, s[28:31], s40 offen offset:2048 lds
  buffer_load_dwordx4 v33, s[28:31], s40 offen offset:3072 lds
  s_waitcnt vmcnt(32)
  s_mov_b32 m0, 28672
  s_mov_b32 s40, 200704
  buffer_load_dwordx4 v30, s[28:31], s40 offen lds
  buffer_load_dwordx4 v31, s[28:31], s40 offen offset:1024 lds
  buffer_load_dwordx4 v32, s[28:31], s40 offen offset:2048 lds
  buffer_load_dwordx4 v33, s[28:31], s40 offen offset:3072 lds
  s_waitcnt vmcnt(32)
  v_mov_b32 v7, 38
  ds_max_u32 v8, v7 offset:4
  s_cmp_ge_u32 s38, 60
  s_cbranch_scc1 L_fr_55
  ds_read_b32 v52, v8 offset:8
  s_waitcnt lgkmcnt(0)
  v_readlane_b32 s38, v52, 0
  v_readlane_b32 s37, v52, 1
  v_readlane_b32 s41, v52, 2
  s_nop 0
  s_min_u32 s38, s38, s37
  s_min_u32 s38, s38, s41
  s_cmp_ge_u32 s38, 60
  s_cbranch_scc1 L_fr_55
  s_waitcnt vmcnt(16)
  v_mov_b32 v7, 39
  ds_max_u32 v8, v7 offset:4
L_sp_55:
  ds_read_b32 v52, v8 offset:8
  s_waitcnt lgkmcnt(0)
  v_readlane_b32 s38, v52, 0
  v_readlane_b32 s37, v52, 1
  v_readlane_b32 s41, v52, 2
  s_nop 0
  s_min_u32 s38, s38, s37
  s_min_u32 s38, s38, s41
  s_cmp_ge_u32 s38, 60
  s_cbranch_scc0 L_sp_55
L_fr_55:
  s_mov_b32 m0, 32768
  s_mov_b32 s40, 114816
  buffer_load_dwordx4 v30, s[28:31], s40 offen lds
  buffer_load_dwordx4 v31, s[28:31], s40 offen offset:1024 lds
  buffer_load_dwordx4 v32, s[28:31], s40 offen offset:2048 lds
  buffer_load_dwordx4 v33, s[28:31], s40 offen offset:3072 lds
  s_waitcnt vmcnt(32)
  s_mov_b32 m0, 36864
  s_mov_b32 s40, 143488
  buffer_load_dwordx4 v30, s[28:31], s40 offen lds
  buffer_load_dwordx4 v31, s[28:31], s40 offen offset:1024 lds
  buffer_load_dwordx4 v32, s[28:31], s40 offen offset:2048 lds
  buffer_load_dwordx4 v33, s[28:31], s40 offen offset:3072 lds
  s_waitcnt vmcnt(32)
  s_mov_b32 m0, 40960
  s_mov_b32 s40, 172160
  buffer_load_dwordx4 v30, s[28:31], s40 offen lds
  buffer_load_dwordx4 v31, s[28:31], s40 offen offset:1024 lds
  buffer_load_dwordx4 v32, s[28:31], s40 offen offset:2048 lds
  buffer_load_dwordx4 v33, s[28:31], s40 offen offset:3072 lds
  s_waitcnt vmcnt(32)
  s_mov_b32 m0, 45056
  s_mov_b32 s40, 200832
  buffer_load_dwordx4 v30, s[28:31], s40 offen lds
  buffer_load_dwordx4 v31, s[28:31], s40 offen offset:1024 lds
  buffer_load_dwordx4 v32, s[28:31], s40 offen offset:2048 lds
  buffer_load_dwordx4 v33, s[28:31], s40 offen offset:3072 lds
  s_waitcnt vmcnt(32)
  v_mov_b32 v7, 39
  ds_max_u32 v8, v7 offset:4
  s_cmp_ge_u32 s38, 61
  s_cbranch_scc1 L_fr_56
  ds_read_b32 v52, v8 offset:8
  s_waitcnt lgkmcnt(0)
  v_readlane_b32 s38, v52, 0
  v_readlane_b32 s37, v52, 1
  v_readlane_b32 s41, v52, 2
  s_nop 0
  s_min_u32 s38, s38, s37
  s_min_u32 s38, s38, s41
  s_cmp_ge_u32 s38, 61
  s_cbranch_scc1 L_fr_56
  s_waitcnt vmcnt(16)
  v_mov_b32 v7, 40
  ds_max_u32 v8, v7 offset:4
L_sp_56:
  ds_read_b32 v52, v8 offset:8
  s_waitcnt lgkmcnt(0)
  v_readlane_b32 s38, v52, 0
  v_readlane_b32 s37, v52, 1
  v_readlane_b32 s41, v52, 2
  s_nop 0
  s_min_u32 s38, s38, s37
  s_min_u32 s38, s38, s41
  s_cmp_ge_u32 s38, 61
  s_cbranch_scc0 L_sp_56
L_fr_56:
  s_mov_b32 m0, 98304
  s_mov_b32 s40, 114944
  buffer_load_dwordx4 v30, s[28:31], s40 offen lds
  buffer_load_dwordx4 v31, s[28:31], s40 offen offset:1024 lds
  buffer_load_dwordx4 v32, s[28:31], s40 offen offset:2048 lds
  buffer_load_dwordx4 v33, s[28:31], s40 offen offset:3072 lds
  s_waitcnt vmcnt(32)
  s_mov_b32 m0, 102400
  s_mov_b32 s40, 143616
  buffer_load_dwordx4 v30, s[28:31], s40 offen lds
  buffer_load_dwordx4 v31, s[28:31], s40 offen offset:1024 lds
  buffer_load_dwordx4 v32, s[28:31], s40 offen offset:2048 lds
  buffer_load_dwordx4 v33, s[28:31], s40 offen offset:3072 lds
  s_waitcnt vmcnt(32)
  s_mov_b32 m0, 106496
  s_mov_b32 s40, 172288
  buffer_load_dwordx4 v30, s[28:31], s40 offen lds
  buffer_load_dwordx4 v31, s[28:31], s40 offen offset:1024 lds
  buffer_load_dwordx4 v32, s[28:31], s40 offen offset:2048 lds
  buffer_load_dwordx4 v33, s[28:31], s40 offen offset:3072 lds
  s_waitcnt vmcnt(32)
  s_mov_b32 m0, 110592
  s_mov_b32 s40, 200960
  buffer_load_dwordx4 v30, s[28:31], s40 offen lds
  buffer_load_dwordx4 v31, s[28:31], s40 offen offset:1024 lds
  buffer_load_dwordx4 v32, s[28:31], s40 offen offset:2048 lds
  buffer_load_dwordx4 v33, s[28:31], s40 offen offset:3072 lds
  s_waitcnt vmcnt(32)
  v_mov_b32 v7, 40
  ds_max_u32 v8, v7 offset:4
  s_cmp_ge_u32 s38, 62
  s_cbranch_scc1 L_fr_57
  ds_read_b32 v52, v8 offset:8
  s_waitcnt lgkmcnt(0)
  v_readlane_b32 s38, v52, 0
  v_readlane_b32 s37, v52, 1
  v_readlane_b32 s41, v52, 2
  s_nop 0
  s_min_u32 s38, s38, s37
  s_min_u32 s38, s38, s41
  s_cmp_ge_u32 s38, 62
  s_cbranch_scc1 L_fr_57
  s_waitcnt vmcnt(16)
  v_mov_b32 v7, 41
  ds_max_u32 v8, v7 offset:4
L_sp_57:
  ds_read_b32 v52, v8 offset:8
  s_waitcnt lgkmcnt(0)
  v_readlane_b32 s38, v52, 0
  v_readlane_b32 s37, v52, 1
  v_readlane_b32 s41, v52, 2
  s_nop 0
  s_min_u32 s38, s38, s37
  s_min_u32 s38, s38, s41
  s_cmp_ge_u32 s38, 62
  s_cbranch_scc0 L_sp_57
L_fr_57:
  s_mov_b32 m0, 114688
  s_mov_b32 s40, 115072
  buffer_load_dwordx4 v30, s[28:31], s40 offen lds
  buffer_load_dwordx4 v31, s[28:31], s40 offen offset:1024 lds
  buffer_load_dwordx4 v32, s[28:31], s40 offen offset:2048 lds
  buffer_load_dwordx4 v33, s[28:31], s40 offen offset:3072 lds
  s_waitcnt vmcnt(32)
  s_mov_b32 m0, 118784
  s_mov_b32 s40, 143744
  buffer_load_dwordx4 v30, s[28:31], s40 offen lds
  buffer_load_dwordx4 v31, s[28:31], s40 offen offset:1024 lds
  buffer_load_dwordx4 v32, s[28:31], s40 offen offset:2048 lds
  buffer_load_dwordx4 v33, s[28:31], s40 offen offset:3072 lds
  s_waitcnt vmcnt(32)
  s_mov_b32 m0, 122880
  s_mov_b32 s40, 172416
  buffer_load_dwordx4 v30, s[28:31], s40 offen lds
  buffer_load_dwordx4 v31, s[28:31], s40 offen offset:1024 lds
  buffer_load_dwordx4 v32, s[28:31], s40 offen offset:2048 lds
  buffer_load_dwordx4 v33, s[28:31], s40 offen offset:3072 lds
  s_waitcnt vmcnt(32)
  s_mov_b32 m0, 126976
  s_mov_b32 s40, 201088
  buffer_load_dwordx4 v30, s[28:31], s40 offen lds
  buffer_load_dwordx4 v31, s[28:31], s40 offen offset:1024 lds
  buffer_load_dwordx4 v32, s[28:31], s40 offen offset:2048 lds
  buffer_load_dwordx4 v33, s[28:31], s40 offen offset:3072 lds
  s_waitcnt vmcnt(32)
  v_mov_b32 v7, 41
  ds_max_u32 v8, v7 offset:4
  s_cmp_ge_u32 s38, 63
  s_cbranch_scc1 L_fr_58
  ds_read_b32 v52, v8 offset:8
  s_waitcnt lgkmcnt(0)
  v_readlane_b32 s38, v52, 0
  v_readlane_b32 s37, v52, 1
  v_readlane_b32 s41, v52, 2
  s_nop 0
  s_min_u32 s38, s38, s37
  s_min_u32 s38, s38, s41
  s_cmp_ge_u32 s38, 63
  s_cbranch_scc1 L_fr_58
  s_waitcnt vmcnt(16)
  v_mov_b32 v7, 42
  ds_max_u32 v8, v7 offset:4
L_sp_58:
  ds_read_b32 v52, v8 offset:8
  s_waitcnt lgkmcnt(0)
  v_readlane_b32 s38, v52, 0
  v_readlane_b32 s37, v52, 1
  v_readlane_b32 s41, v52, 2
  s_nop 0
  s_min_u32 s38, s38, s37
  s_min_u32 s38, s38, s41
  s_cmp_ge_u32 s38, 63
  s_cbranch_scc0 L_sp_58
L_fr_58:
  s_mov_b32 m0, 131072
  s_mov_b32 s40, 115200
  buffer_load_dwordx4 v30, s[28:31], s40 offen lds
  buffer_load_dwordx4 v31, s[28:31], s40 offen offset:1024 lds
  buffer_load_dwordx4 v32, s[28:31], s40 offen offset:2048 lds
  buffer_load_dwordx4 v33, s[28:31], s40 offen offset:3072 lds
  s_waitcnt vmcnt(32)
  s_mov_b32 m0, 135168
  s_mov_b32 s40, 143872
  buffer_load_dwordx4 v30, s[28:31], s40 offen lds
  buffer_load_dwordx4 v31, s[28:31], s40 offen offset:1024 lds
  buffer_load_dwordx4 v32, s[28:31], s40 offen offset:2048 lds
  buffer_load_dwordx4 v33, s[28:31], s40 offen offset:3072 lds
  s_waitcnt vmcnt(32)
  s_mov_b32 m0, 139264
  s_mov_b32 s40, 172544
  buffer_load_dwordx4 v30, s[28:31], s40 offen lds
  buffer_load_dwordx4 v31, s[28:31], s40 offen offset:1024 lds
  buffer_load_dwordx4 v32, s[28:31], s40 offen offset:2048 lds
  buffer_load_dwordx4 v33, s[28:31], s40 offen offset:3072 lds
  s_waitcnt vmcnt(32)
  s_mov_b32 m0, 143360
  s_mov_b32 s40, 201216
  buffer_load_dwordx4 v30, s[28:31], s40 offen lds
  buffer_load_dwordx4 v31, s[28:31], s40 offen offset:1024 lds
  buffer_load_dwordx4 v32, s[28:31], s40 offen offset:2048 lds
  buffer_load_dwordx4 v33, s[28:31], s40 offen offset:3072 lds
  s_waitcnt vmcnt(32)
  v_mov_b32 v7, 42
  ds_max_u32 v8, v7 offset:4
  s_cmp_ge_u32 s38, 64
  s_cbranch_scc1 L_fr_59
  ds_read_b32 v52, v8 offset:8
  s_waitcnt lgkmcnt(0)
  v_readlane_b32 s38, v52, 0
  v_readlane_b32 s37, v52, 1
  v_readlane_b32 s41, v52, 2
  s_nop 0
  s_min_u32 s38, s38, s37
  s_min_u32 s38, s38, s41
  s_cmp_ge_u32 s38, 64
  s_cbranch_scc1 L_fr_59
  s_waitcnt vmcnt(16)
  v_mov_b32 v7, 43
  ds_max_u32 v8, v7 offset:4
L_sp_59:
  ds_read_b32 v52, v8 offset:8
  s_waitcnt lgkmcnt(0)
  v_readlane_b32 s38, v52, 0
  v_readlane_b32 s37, v52, 1
  v_readlane_b32 s41, v52, 2
  s_nop 0
  s_min_u32 s38, s38, s37
  s_min_u32 s38, s38, s41
  s_cmp_ge_u32 s38, 64
  s_cbranch_scc0 L_sp_59
L_fr_59:
  s_mov_b32 m0, 81920
  s_mov_b32 s40, 115328
  buffer_load_dwordx4 v30, s[28:31], s40 offen lds
  buffer_load_dwordx4 v31, s[28:31], s40 offen offset:1024 lds
  buffer_load_dwordx4 v32, s[28:31], s40 offen offset:2048 lds
  buffer_load_dwordx4 v33, s[28:31], s40 offen offset:3072 lds
  s_waitcnt vmcnt(32)
  s_mov_b32 m0, 86016
  s_mov_b32 s40, 144000
  buffer_load_dwordx4 v30, s[28:31], s40 offen lds
  buffer_load_dwordx4 v31, s[28:31], s40 offen offset:1024 lds
  buffer_load_dwordx4 v32, s[28:31], s40 offen offset:2048 lds
  buffer_load_dwordx4 v33, s[28:31], s40 offen offset:3072 lds
  s_waitcnt vmcnt(32)
  s_mov_b32 m0, 90112
  s_mov_b32 s40, 172672
  buffer_load_dwordx4 v30, s[28:31], s40 offen lds
  buffer_load_dwordx4 v31, s[28:31], s40 offen offset:1024 lds
  buffer_load_dwordx4 v32, s[28:31], s40 offen offset:2048 lds
  buffer_load_dwordx4 v33, s[28:31], s40 offen offset:3072 lds
  s_waitcnt vmcnt(32)
  s_mov_b32 m0, 94208
  s_mov_b32 s40, 201344
  buffer_load_dwordx4 v30, s[28:31], s40 offen lds
  buffer_load_dwordx4 v31, s[28:31], s40 offen offset:1024 lds
  buffer_load_dwordx4 v32, s[28:31], s40 offen offset:2048 lds
  buffer_load_dwordx4 v33, s[28:31], s40 offen offset:3072 lds
  s_waitcnt vmcnt(32)
  v_mov_b32 v7, 43
  ds_max_u32 v8, v7 offset:4
  s_cmp_ge_u32 s38, 65
  s_cbranch_scc1 L_fr_60
  ds_read_b32 v52, v8 offset:8
  s_waitcnt lgkmcnt(0)
  v_readlane_b32 s38, v52, 0
  v_readlane_b32 s37, v52, 1
  v_readlane_b32 s41, v52, 2
  s_nop 0
  s_min_u32 s38, s38, s37
  s_min_u32 s38, s38, s41
  s_cmp_ge_u32 s38, 65
  s_cbranch_scc1 L_fr_60
  s_waitcnt vmcnt(16)
  v_mov_b32 v7, 44
  ds_max_u32 v8, v7 offset:4
L_sp_60:
  ds_read_b32 v52, v8 offset:8
  s_waitcnt lgkmcnt(0)
  v_readlane_b32 s38, v52, 0
  v_readlane_b32 s37, v52, 1
  v_readlane_b32 s41, v52, 2
  s_nop 0
  s_min_u32 s38, s38, s37
  s_min_u32 s38, s38, s41
  s_cmp_ge_u32 s38, 65
  s_cbranch_scc0 L_sp_60
L_fr_60:
  s_mov_b32 m0, 49152
  s_mov_b32 s40, 115456
  buffer_load_dwordx4 v30, s[28:31], s40 offen lds
  buffer_load_dwordx4 v31, s[28:31], s40 offen offset:1024 lds
  buffer_load_dwordx4 v32, s[28:31], s40 offen offset:2048 lds
  buffer_load_dwordx4 v33, s[28:31], s40 offen offset:3072 lds
  s_waitcnt vmcnt(32)
  s_mov_b32 m0, 53248
  s_mov_b32 s40, 144128
  buffer_load_dwordx4 v30, s[28:31], s40 offen lds
  buffer_load_dwordx4 v31, s[28:31], s40 offen offset:1024 lds
  buffer_load_dwordx4 v32, s[28:31], s40 offen offset:2048 lds
  buffer_load_dwordx4 v33, s[28:31], s40 offen offset:3072 lds
  s_waitcnt vmcnt(32)
  s_mov_b32 m0, 57344
  s_mov_b32 s40, 172800
  buffer_load_dwordx4 v30, s[28:31], s40 offen lds
  buffer_load_dwordx4 v31, s[28:31], s40 offen offset:1024 lds
  buffer_load_dwordx4 v32, s[28:31], s40 offen offset:2048 lds
  buffer_load_dwordx4 v33, s[28:31], s40 offen offset:3072 lds
  s_waitcnt vmcnt(32)
  s_mov_b32 m0, 61440
  s_mov_b32 s40, 201472
  buffer_load_dwordx4 v30, s[28:31], s40 offen lds
  buffer_load_dwordx4 v31, s[28:31], s40 offen offset:1024 lds
  buffer_load_dwordx4 v32, s[28:31], s40 offen offset:2048 lds
  buffer_load_dwordx4 v33, s[28:31], s40 offen offset:3072 lds
  s_waitcnt vmcnt(32)
  v_mov_b32 v7, 44
  ds_max_u32 v8, v7 offset:4
  s_waitcnt vmcnt(16)
  v_mov_b32 v7, 45
  ds_max_u32 v8, v7 offset:4
  s_waitcnt vmcnt(0)
  v_mov_b32 v7, 46
  ds_max_u32 v8, v7 offset:4
  s_waitcnt lgkmcnt(0)
  v_mbcnt_lo_u32_b32 v0, -1, 0
  v_mbcnt_hi_u32_b32 v0, -1, v0
  s_lshr_b32 s36, s11, 4
  s_and_b32 s37, s11, 15
  s_mul_i32 s38, s36, 1376256
  s_add_u32 s16, s86, s38
  s_addc_u32 s17, s87, 0
  s_and_b32 s17, s17, 0xffff
  s_mov_b32 s18, 1376256
  s_mov_b32 s19, 0x20000
  s_mov_b32 s20, s80
  s_and_b32 s21, s81, 0xffff
  s_mov_b32 s22, 1376256
  s_mov_b32 s23, 0x20000
  s_lshl_b32 s38, s36, 8
  s_add_u32 s38, s38, 33554432
  s_add_u32 s74, s86, s38
  s_addc_u32 s75, s87, 0
  v_and_b32 v2, 7, v0
  v_lshrrev_b32 v3, 3, v0
  s_mul_i32 s41, s37, 3
  s_add_u32 s41, s41, 0
  s_lshr_b32 s39, s41, 2
  s_and_b32 s40, s41, 3
  s_lshl_b32 s39, s39, 3
  s_lshl_b32 s40, s40, 3
  v_add_u32 v4, s39, v2
  v_add_u32 v5, s40, v3
  v_lshrrev_b32 v6, 5, v4
  v_mul_u32_u24 v6, 28672, v6
  v_lshrrev_b32 v7, 1, v5
  v_lshl_add_u32 v6, v7, 10, v6
  v_and_b32 v7, 1, v5
  v_lshlrev_b32 v7, 5, v7
  v_and_b32 v9, 31, v4
  v_add_u32 v7, v7, v9
  v_lshl_add_u32 v10, v7, 4, v6
  s_and_b32 s39, s36, 7
  s_mul_i32 s39, s39, 96
  v_add_u32 v6, s39, v4
  v_mul_u32_u24 v6, 1792, v6
  s_lshr_b32 s39, s36, 3
  s_mul_i32 s39, s39, 896
  v_lshl_add_u32 v6, v5, 4, v6
  v_add_u32 v11, s39, v6
  s_mul_i32 s41, s37, 3
  s_add_u32 s41, s41, 1
  s_lshr_b32 s39, s41, 2
  s_and_b32 s40, s41, 3
  s_lshl_b32 s39, s39, 3
  s_lshl_b32 s40, s40, 3
  v_add_u32 v4, s39, v2
  v_add_u32 v5, s40, v3
  v_lshrrev_b32 v6, 5, v4
  v_mul_u32_u24 v6, 28672, v6
  v_lshrrev_b32 v7, 1, v5
  v_lshl_add_u32 v6, v7, 10, v6
  v_and_b32 v7, 1, v5
  v_lshlrev_b32 v7, 5, v7
  v_and_b32 v9, 31, v4
  v_add_u32 v7, v7, v9
  v_lshl_add_u32 v12, v7, 4, v6
  s_and_b32 s39, s36, 7
  s_mul_i32 s39, s39, 96
  v_add_u32 v6, s39, v4
  v_mul_u32_u24 v6, 1792, v6
  s_lshr_b32 s39, s36, 3
  s_mul_i32 s39, s39, 896
  v_lshl_add_u32 v6, v5, 4, v6
  v_add_u32 v13, s39, v6
  s_mul_i32 s41, s37, 3
  s_add_u32 s41, s41, 2
  s_lshr_b32 s39, s41, 2
  s_and_b32 s40, s41, 3
  s_lshl_b32 s39, s39, 3
  s_lshl_b32 s40, s40, 3
  v_add_u32 v4, s39, v2
  v_add_u32 v5, s40, v3
  v_lshrrev_b32 v6, 5, v4
  v_mul_u32_u24 v6, 28672, v6
  v_lshrrev_b32 v7, 1, v5
  v_lshl_add_u32 v6, v7, 10, v6
  v_and_b32 v7, 1, v5
  v_lshlrev_b32 v7, 5, v7
  v_and_b32 v9, 31, v4
  v_add_u32 v7, v7, v9
  v_lshl_add_u32 v14, v7, 4, v6
  s_and_b32 s39, s36, 7
  s_mul_i32 s39, s39, 96
  v_add_u32 v6, s39, v4
  v_mul_u32_u24 v6, 1792, v6
  s_lshr_b32 s39, s36, 3
  s_mul_i32 s39, s39, 896
  v_lshl_add_u32 v6, v5, 4, v6
  v_add_u32 v15, s39, v6
  v_and_b32 v28, 15, v0
  v_lshlrev_b32 v28, 2, v28
  s_lshl_b32 s45, s37, 2
  v_mov_b32 v29, s45
L_wh1:
  ds_read_b32 v1, v8 offset:8
  s_waitcnt lgkmcnt(0)
  v_readlane_b32 s38, v1, 0
  v_readlane_b32 s12, v1, 1
  v_readlane_b32 s13, v1, 2
  s_nop 0
  s_min_u32 s38, s38, s12
  s_min_u32 s38, s38, s13
  s_cmp_ge_u32 s38, 66
  s_cbranch_scc0 L_wh1
  v_mov_b32 v30, 147468
  ds_read_b32 v30, v30
  s_waitcnt lgkmcnt(0)
  v_readfirstlane_b32 s44, v30
  s_nop 3
  s_cmp_lg_u32 s44, 0
  s_cbranch_scc1 L_havenonce
L_getnonce:
  v_mov_b32 v30, 0
  global_load_dword v30, v30, s[82:83] sc0 sc1
  s_waitcnt vmcnt(0)
  v_readfirstlane_b32 s44, v30
  s_nop 3
  s_cmp_eq_u32 s44, 0
  s_cbranch_scc1 L_getnonce
L_havenonce:
  v_mov_b32 v30, s44
  s_mov_b64 exec, 1
  global_store_dword v29, v30, s[74:75] sc0 sc1
  s_mov_b64 exec, -1
L_poll:
  global_load_dword v31, v28, s[74:75] sc0 sc1
  s_waitcnt vmcnt(0)
  v_cmp_ne_u32 vcc, s44, v31
  s_cbranch_vccz L_polled
  s_sleep 1
  s_branch L_poll
L_polled:
  s_mov_b32 s24, 0x00003f80
  s_mov_b32 s25, 0x3f800000
  s_mov_b32 s42, 0
  buffer_load_dwordx4 v[32:35], v10, s[16:19], s42 offen sc1
  s_mov_b32 s42, 86016
  buffer_load_dwordx4 v[36:39], v10, s[16:19], s42 offen sc1
  s_mov_b32 s42, 172032
  buffer_load_dwordx4 v[40:43], v10, s[16:19], s42 offen sc1
  s_mov_b32 s42, 258048
  buffer_load_dwordx4 v[44:47], v10, s[16:19], s42 offen sc1
  s_mov_b32 s42, 344064
  buffer_load_dwordx4 v[48:51], v10, s[16:19], s42 offen sc1
  s_mov_b32 s42, 430080
  buffer_load_dwordx4 v[52:55], v10, s[16:19], s42 offen sc1
  s_mov_b32 s42, 516096
  buffer_load_dwordx4 v[56:59], v10, s[16:19], s42 offen sc1
  s_mov_b32 s42, 602112
  buffer_load_dwordx4 v[60:63], v10, s[16:19], s42 offen sc1
  s_mov_b32 s42, 688128
  buffer_load_dwordx4 v[64:67], v10, s[16:19], s42 offen sc1
  s_mov_b32 s42, 774144
  buffer_load_dwordx4 v[68:71], v10, s[16:19], s42 offen sc1
  s_mov_b32 s42, 860160
  buffer_load_dwordx4 v[72:75], v10, s[16:19], s42 offen sc1
  s_mov_b32 s42, 946176
  buffer_load_dwordx4 v[76:79], v10, s[16:19], s42 offen sc1
  s_mov_b32 s42, 1032192
  buffer_load_dwordx4 v[80:83], v10, s[16:19], s42 offen sc1
  s_mov_b32 s42, 1118208
  buffer_load_dwordx4 v[84:87], v10, s[16:19], s42 offen sc1
  s_mov_b32 s42, 1204224
  buffer_load_dwordx4 v[88:91], v10, s[16:19], s42 offen sc1
  s_mov_b32 s42, 1290240
  buffer_load_dwordx4 v[92:95], v10, s[16:19], s42 offen sc1
  s_mov_b32 s24, 0x00003f80
  s_mov_b32 s25, 0x3f800000
  s_mov_b32 s42, 0
  buffer_load_dwordx4 v[96:99], v12, s[16:19], s42 offen sc1
  s_mov_b32 s42, 86016
  buffer_load_dwordx4 v[100:103], v12, s[16:19], s42 offen sc1
  s_mov_b32 s42, 172032
  buffer_load_dwordx4 v[104:107], v12, s[16:19], s42 offen sc1
  s_mov_b32 s42, 258048
  buffer_load_dwordx4 v[108:111], v12, s[16:19], s42 offen sc1
  s_mov_b32 s42, 344064
  buffer_load_dwordx4 v[112:115], v12, s[16:19], s42 offen sc1
  s_mov_b32 s42, 430080
  buffer_load_dwordx4 v[116:119], v12, s[16:19], s42 offen sc1
  s_mov_b32 s42, 516096
  buffer_load_dwordx4 v[120:123], v12, s[16:19], s42 offen sc1
  s_mov_b32 s42, 602112
  buffer_load_dwordx4 v[124:127], v12, s[16:19], s42 offen sc1
  s_mov_b32 s42, 688128
  buffer_load_dwordx4 v[128:131], v12, s[16:19], s42 offen sc1
  s_mov_b32 s42, 774144
  buffer_load_dwordx4 v[132:135], v12, s[16:19], s42 offen sc1
  s_mov_b32 s42, 860160
  buffer_load_dwordx4 v[136:139], v12, s[16:19], s42 offen sc1
  s_mov_b32 s42, 946176
  buffer_load_dwordx4 v[140:143], v12, s[16:19], s42 offen sc1
  s_mov_b32 s42, 1032192
  buffer_load_dwordx4 v[144:147], v12, s[16:19], s42 offen sc1
  s_mov_b32 s42, 1118208
  buffer_load_dwordx4 v[148:151], v12, s[16:19], s42 offen sc1
  s_mov_b32 s42, 1204224
  buffer_load_dwordx4 v[152:155], v12, s[16:19], s42 offen sc1
  s_mov_b32 s42, 1290240
  buffer_load_dwordx4 v[156:159], v12, s[16:19], s42 offen sc1
  s_mov_b32 s24, 0x00003f80
  s_mov_b32 s25, 0x3f800000
  s_mov_b32 s42, 0
  buffer_load_dwordx4 v[160:163], v14, s[16:19], s42 offen sc1
  s_mov_b32 s42, 86016
  buffer_load_dwordx4 v[164:167], v14, s[16:19], s42 offen sc1
  s_mov_b32 s42, 172032
  buffer_load_dwordx4 v[168:171], v14, s[16:19], s42 offen sc1
  s_mov_b32 s42, 258048
  buffer_load_dwordx4 v[172:175], v14, s[16:19], s42 offen sc1
  s_mov_b32 s42, 344064
  buffer_load_dwordx4 v[176:179], v14, s[16:19], s42 offen sc1
  s_mov_b32 s42, 430080
  buffer_load_dwordx4 v[180:183], v14, s[16:19], s42 offen sc1
  s_mov_b32 s42, 516096
  buffer_load_dwordx4 v[184:187], v14, s[16:19], s42 offen sc1
  s_mov_b32 s42, 602112
  buffer_load_dwordx4 v[188:191], v14, s[16:19], s42 offen sc1
  s_mov_b32 s42, 688128
  buffer_load_dwordx4 v[192:195], v14, s[16:19], s42 offen sc1
  s_mov_b32 s42, 774144
  buffer_load_dwordx4 v[196:199], v14, s[16:19], s42 offen sc1
  s_mov_b32 s42, 860160
  buffer_load_dwordx4 v[200:203], v14, s[16:19], s42 offen sc1
  s_mov_b32 s42, 946176
  buffer_load_dwordx4 v[204:207], v14, s[16:19], s42 offen sc1
  s_mov_b32 s42, 1032192
  buffer_load_dwordx4 v[208:211], v14, s[16:19], s42 offen sc1
  s_mov_b32 s42, 1118208
  buffer_load_dwordx4 v[212:215], v14, s[16:19], s42 offen sc1
  s_mov_b32 s42, 1204224
  buffer_load_dwordx4 v[216:219], v14, s[16:19], s42 offen sc1
  s_mov_b32 s42, 1290240
  buffer_load_dwordx4 v[220:223], v14, s[16:19], s42 offen sc1
  s_waitcnt vmcnt(47)
  v_lshlrev_b32 v16, 16, v32
  v_and_b32 v17, 0xffff0000, v32
  v_lshlrev_b32 v18, 16, v33
  v_and_b32 v19, 0xffff0000, v33
  v_lshlrev_b32 v20, 16, v34
  v_and_b32 v21, 0xffff0000, v34
  v_lshlrev_b32 v22, 16, v35
  v_and_b32 v23, 0xffff0000, v35
  s_waitcnt vmcnt(46)
  v_dot2c_f32_bf16 v16, s24, v36
  v_dot2c_f32_bf16 v17, s25, v36
  v_dot2c_f32_bf16 v18, s24, v37
  v_dot2c_f32_bf16 v19, s25, v37
  v_dot2c_f32_bf16 v20, s24, v38
  v_dot2c_f32_bf16 v21, s25, v38
  v_dot2c_f32_bf16 v22, s24, v39
  v_dot2c_f32_bf16 v23, s25, v39
  s_waitcnt vmcnt(45)
  v_dot2c_f32_bf16 v16, s24, v40
  v_dot2c_f32_bf16 v17, s25, v40
  v_dot2c_f32_bf16 v18, s24, v41
  v_dot2c_f32_bf16 v19, s25, v41
  v_dot2c_f32_bf16 v20, s24, v42
  v_dot2c_f32_bf16 v21, s25, v42
  v_dot2c_f32_bf16 v22, s24, v43
  v_dot2c_f32_bf16 v23, s25, v43
  s_waitcnt vmcnt(44)
  v_dot2c_f32_bf16 v16, s24, v44
  v_dot2c_f32_bf16 v17, s25, v44
  v_dot2c_f32_bf16 v18, s24, v45
  v_dot2c_f32_bf16 v19, s25, v45
  v_dot2c_f32_bf16 v20, s24, v46
  v_dot2c_f32_bf16 v21, s25, v46
  v_dot2c_f32_bf16 v22, s24, v47
  v_dot2c_f32_bf16 v23, s25, v47
  s_waitcnt vmcnt(43)
  v_dot2c_f32_bf16 v16, s24, v48
  v_dot2c_f32_bf16 v17, s25, v48
  v_dot2c_f32_bf16 v18, s24, v49
  v_dot2c_f32_bf16 v19, s25, v49
  v_dot2c_f32_bf16 v20, s24, v50
  v_dot2c_f32_bf16 v21, s25, v50
  v_dot2c_f32_bf16 v22, s24, v51
  v_dot2c_f32_bf16 v23, s25, v51
  s_waitcnt vmcnt(42)
  v_dot2c_f32_bf16 v16, s24, v52
  v_dot2c_f32_bf16 v17, s25, v52
  v_dot2c_f32_bf16 v18, s24, v53
  v_dot2c_f32_bf16 v19, s25, v53
  v_dot2c_f32_bf16 v20, s24, v54
  v_dot2c_f32_bf16 v21, s25, v54
  v_dot2c_f32_bf16 v22, s24, v55
  v_dot2c_f32_bf16 v23, s25, v55
  s_waitcnt vmcnt(41)
  v_dot2c_f32_bf16 v16, s24, v56
  v_dot2c_f32_bf16 v17, s25, v56
  v_dot2c_f32_bf16 v18, s24, v57
  v_dot2c_f32_bf16 v19, s25, v57
  v_dot2c_f32_bf16 v20, s24, v58
  v_dot2c_f32_bf16 v21, s25, v58
  v_dot2c_f32_bf16 v22, s24, v59
  v_dot2c_f32_bf16 v23, s25, v59
  s_waitcnt vmcnt(40)
  v_dot2c_f32_bf16 v16, s24, v60
  v_dot2c_f32_bf16 v17, s25, v60
  v_dot2c_f32_bf16 v18, s24, v61
  v_dot2c_f32_bf16 v19, s25, v61
  v_dot2c_f32_bf16 v20, s24, v62
  v_dot2c_f32_bf16 v21, s25, v62
  v_dot2c_f32_bf16 v22, s24, v63
  v_dot2c_f32_bf16 v23, s25, v63
  s_waitcnt vmcnt(39)
  v_dot2c_f32_bf16 v16, s24, v64
  v_dot2c_f32_bf16 v17, s25, v64
  v_dot2c_f32_bf16 v18, s24, v65
  v_dot2c_f32_bf16 v19, s25, v65
  v_dot2c_f32_bf16 v20, s24, v66
  v_dot2c_f32_bf16 v21, s25, v66
  v_dot2c_f32_bf16 v22, s24, v67
  v_dot2c_f32_bf16 v23, s25, v67
  s_waitcnt vmcnt(38)
  v_dot2c_f32_bf16 v16, s24, v68
  v_dot2c_f32_bf16 v17, s25, v68
  v_dot2c_f32_bf16 v18, s24, v69
  v_dot2c_f32_bf16 v19, s25, v69
  v_dot2c_f32_bf16 v20, s24, v70
  v_dot2c_f32_bf16 v21, s25, v70
  v_dot2c_f32_bf16 v22, s24, v71
  v_dot2c_f32_bf16 v23, s25, v71
  s_waitcnt vmcnt(37)
  v_dot2c_f32_bf16 v16, s24, v72
  v_dot2c_f32_bf16 v17, s25, v72
  v_dot2c_f32_bf16 v18, s24, v73
  v_dot2c_f32_bf16 v19, s25, v73
  v_dot2c_f32_bf16 v20, s24, v74
  v_dot2c_f32_bf16 v21, s25, v74
  v_dot2c_f32_bf16 v22, s24, v75
  v_dot2c_f32_bf16 v23, s25, v75
  s_waitcnt vmcnt(36)
  v_dot2c_f32_bf16 v16, s24, v76
  v_dot2c_f32_bf16 v17, s25, v76
  v_dot2c_f32_bf16 v18, s24, v77
  v_dot2c_f32_bf16 v19, s25, v77
  v_dot2c_f32_bf16 v20, s24, v78
  v_dot2c_f32_bf16 v21, s25, v78
  v_dot2c_f32_bf16 v22, s24, v79
  v_dot2c_f32_bf16 v23, s25, v79
  s_waitcnt vmcnt(35)
  v_dot2c_f32_bf16 v16, s24, v80
  v_dot2c_f32_bf16 v17, s25, v80
  v_dot2c_f32_bf16 v18, s24, v81
  v_dot2c_f32_bf16 v19, s25, v81
  v_dot2c_f32_bf16 v20, s24, v82
  v_dot2c_f32_bf16 v21, s25, v82
  v_dot2c_f32_bf16 v22, s24, v83
  v_dot2c_f32_bf16 v23, s25, v83
  s_waitcnt vmcnt(34)
  v_dot2c_f32_bf16 v16, s24, v84
  v_dot2c_f32_bf16 v17, s25, v84
  v_dot2c_f32_bf16 v18, s24, v85
  v_dot2c_f32_bf16 v19, s25, v85
  v_dot2c_f32_bf16 v20, s24, v86
  v_dot2c_f32_bf16 v21, s25, v86
  v_dot2c_f32_bf16 v22, s24, v87
  v_dot2c_f32_bf16 v23, s25, v87
  s_waitcnt vmcnt(33)
  v_dot2c_f32_bf16 v16, s24, v88
  v_dot2c_f32_bf16 v17, s25, v88
  v_dot2c_f32_bf16 v18, s24, v89
  v_dot2c_f32_bf16 v19, s25, v89
  v_dot2c_f32_bf16 v20, s24, v90
  v_dot2c_f32_bf16 v21, s25, v90
  v_dot2c_f32_bf16 v22, s24, v91
  v_dot2c_f32_bf16 v23, s25, v91
  s_waitcnt vmcnt(32)
  v_dot2c_f32_bf16 v16, s24, v92
  v_dot2c_f32_bf16 v17, s25, v92
  v_dot2c_f32_bf16 v18, s24, v93
  v_dot2c_f32_bf16 v19, s25, v93
  v_dot2c_f32_bf16 v20, s24, v94
  v_dot2c_f32_bf16 v21, s25, v94
  v_dot2c_f32_bf16 v22, s24, v95
  v_dot2c_f32_bf16 v23, s25, v95
  s_nop 3
  v_cvt_pk_bf16_f32 v24, v16, v17
  v_cvt_pk_bf16_f32 v25, v18, v19
  v_cvt_pk_bf16_f32 v26, v20, v21
  v_cvt_pk_bf16_f32 v27, v22, v23
  buffer_store_dwordx4 v[24:27], v11, s[20:23], 0 offen
  s_nop 1
  s_waitcnt vmcnt(32)
  v_lshlrev_b32 v16, 16, v96
  v_and_b32 v17, 0xffff0000, v96
  v_lshlrev_b32 v18, 16, v97
  v_and_b32 v19, 0xffff0000, v97
  v_lshlrev_b32 v20, 16, v98
  v_and_b32 v21, 0xffff0000, v98
  v_lshlrev_b32 v22, 16, v99
  v_and_b32 v23, 0xffff0000, v99
  s_waitcnt vmcnt(31)
  v_dot2c_f32_bf16 v16, s24, v100
  v_dot2c_f32_bf16 v17, s25, v100
  v_dot2c_f32_bf16 v18, s24, v101
  v_dot2c_f32_bf16 v19, s25, v101
  v_dot2c_f32_bf16 v20, s24, v102
  v_dot2c_f32_bf16 v21, s25, v102
  v_dot2c_f32_bf16 v22, s24, v103
  v_dot2c_f32_bf16 v23, s25, v103
  s_waitcnt vmcnt(30)
  v_dot2c_f32_bf16 v16, s24, v104
  v_dot2c_f32_bf16 v17, s25, v104
  v_dot2c_f32_bf16 v18, s24, v105
  v_dot2c_f32_bf16 v19, s25, v105
  v_dot2c_f32_bf16 v20, s24, v106
  v_dot2c_f32_bf16 v21, s25, v106
  v_dot2c_f32_bf16 v22, s24, v107
  v_dot2c_f32_bf16 v23, s25, v107
  s_waitcnt vmcnt(29)
  v_dot2c_f32_bf16 v16, s24, v108
  v_dot2c_f32_bf16 v17, s25, v108
  v_dot2c_f32_bf16 v18, s24, v109
  v_dot2c_f32_bf16 v19, s25, v109
  v_dot2c_f32_bf16 v20, s24, v110
  v_dot2c_f32_bf16 v21, s25, v110
  v_dot2c_f32_bf16 v22, s24, v111
  v_dot2c_f32_bf16 v23, s25, v111
  s_waitcnt vmcnt(28)
  v_dot2c_f32_bf16 v16, s24, v112
  v_dot2c_f32_bf16 v17, s25, v112
  v_dot2c_f32_bf16 v18, s24, v113
  v_dot2c_f32_bf16 v19, s25, v113
  v_dot2c_f32_bf16 v20, s24, v114
  v_dot2c_f32_bf16 v21, s25, v114
  v_dot2c_f32_bf16 v22, s24, v115
  v_dot2c_f32_bf16 v23, s25, v115
  s_waitcnt vmcnt(27)
  v_dot2c_f32_bf16 v16, s24, v116
  v_dot2c_f32_bf16 v17, s25, v116
  v_dot2c_f32_bf16 v18, s24, v117
  v_dot2c_f32_bf16 v19, s25, v117
  v_dot2c_f32_bf16 v20, s24, v118
  v_dot2c_f32_bf16 v21, s25, v118
  v_dot2c_f32_bf16 v22, s24, v119
  v_dot2c_f32_bf16 v23, s25, v119
  s_waitcnt vmcnt(26)
  v_dot2c_f32_bf16 v16, s24, v120
  v_dot2c_f32_bf16 v17, s25, v120
  v_dot2c_f32_bf16 v18, s24, v121
  v_dot2c_f32_bf16 v19, s25, v121
  v_dot2c_f32_bf16 v20, s24, v122
  v_dot2c_f32_bf16 v21, s25, v122
  v_dot2c_f32_bf16 v22, s24, v123
  v_dot2c_f32_bf16 v23, s25, v123
  s_waitcnt vmcnt(25)
  v_dot2c_f32_bf16 v16, s24, v124
  v_dot2c_f32_bf16 v17, s25, v124
  v_dot2c_f32_bf16 v18, s24, v125
  v_dot2c_f32_bf16 v19, s25, v125
  v_dot2c_f32_bf16 v20, s24, v126
  v_dot2c_f32_bf16 v21, s25, v126
  v_dot2c_f32_bf16 v22, s24, v127
  v_dot2c_f32_bf16 v23, s25, v127
  s_waitcnt vmcnt(24)
  v_dot2c_f32_bf16 v16, s24, v128
  v_dot2c_f32_bf16 v17, s25, v128
  v_dot2c_f32_bf16 v18, s24, v129
  v_dot2c_f32_bf16 v19, s25, v129
  v_dot2c_f32_bf16 v20, s24, v130
  v_dot2c_f32_bf16 v21, s25, v130
  v_dot2c_f32_bf16 v22, s24, v131
  v_dot2c_f32_bf16 v23, s25, v131
  s_waitcnt vmcnt(23)
  v_dot2c_f32_bf16 v16, s24, v132
  v_dot2c_f32_bf16 v17, s25, v132
  v_dot2c_f32_bf16 v18, s24, v133
  v_dot2c_f32_bf16 v19, s25, v133
  v_dot2c_f32_bf16 v20, s24, v134
  v_dot2c_f32_bf16 v21, s25, v134
  v_dot2c_f32_bf16 v22, s24, v135
  v_dot2c_f32_bf16 v23, s25, v135
  s_waitcnt vmcnt(22)
  v_dot2c_f32_bf16 v16, s24, v136
  v_dot2c_f32_bf16 v17, s25, v136
  v_dot2c_f32_bf16 v18, s24, v137
  v_dot2c_f32_bf16 v19, s25, v137
  v_dot2c_f32_bf16 v20, s24, v138
  v_dot2c_f32_bf16 v21, s25, v138
  v_dot2c_f32_bf16 v22, s24, v139
  v_dot2c_f32_bf16 v23, s25, v139
  s_waitcnt vmcnt(21)
  v_dot2c_f32_bf16 v16, s24, v140
  v_dot2c_f32_bf16 v17, s25, v140
  v_dot2c_f32_bf16 v18, s24, v141
  v_dot2c_f32_bf16 v19, s25, v141
  v_dot2c_f32_bf16 v20, s24, v142
  v_dot2c_f32_bf16 v21, s25, v142
  v_dot2c_f32_bf16 v22, s24, v143
  v_dot2c_f32_bf16 v23, s25, v143
  s_waitcnt vmcnt(20)
  v_dot2c_f32_bf16 v16, s24, v144
  v_dot2c_f32_bf16 v17, s25, v144
  v_dot2c_f32_bf16 v18, s24, v145
  v_dot2c_f32_bf16 v19, s25, v145
  v_dot2c_f32_bf16 v20, s24, v146
  v_dot2c_f32_bf16 v21, s25, v146
  v_dot2c_f32_bf16 v22, s24, v147
  v_dot2c_f32_bf16 v23, s25, v147
  s_waitcnt vmcnt(19)
  v_dot2c_f32_bf16 v16, s24, v148
  v_dot2c_f32_bf16 v17, s25, v148
  v_dot2c_f32_bf16 v18, s24, v149
  v_dot2c_f32_bf16 v19, s25, v149
  v_dot2c_f32_bf16 v20, s24, v150
  v_dot2c_f32_bf16 v21, s25, v150
  v_dot2c_f32_bf16 v22, s24, v151
  v_dot2c_f32_bf16 v23, s25, v151
  s_waitcnt vmcnt(18)
  v_dot2c_f32_bf16 v16, s24, v152
  v_dot2c_f32_bf16 v17, s25, v152
  v_dot2c_f32_bf16 v18, s24, v153
  v_dot2c_f32_bf16 v19, s25, v153
  v_dot2c_f32_bf16 v20, s24, v154
  v_dot2c_f32_bf16 v21, s25, v154
  v_dot2c_f32_bf16 v22, s24, v155
  v_dot2c_f32_bf16 v23, s25, v155
  s_waitcnt vmcnt(17)
  v_dot2c_f32_bf16 v16, s24, v156
  v_dot2c_f32_bf16 v17, s25, v156
  v_dot2c_f32_bf16 v18, s24, v157
  v_dot2c_f32_bf16 v19, s25, v157
  v_dot2c_f32_bf16 v20, s24, v158
  v_dot2c_f32_bf16 v21, s25, v158
  v_dot2c_f32_bf16 v22, s24, v159
  v_dot2c_f32_bf16 v23, s25, v159
  s_nop 3
  v_cvt_pk_bf16_f32 v24, v16, v17
  v_cvt_pk_bf16_f32 v25, v18, v19
  v_cvt_pk_bf16_f32 v26, v20, v21
  v_cvt_pk_bf16_f32 v27, v22, v23
  buffer_store_dwordx4 v[24:27], v13, s[20:23], 0 offen
  s_nop 1
  s_waitcnt vmcnt(17)
  v_lshlrev_b32 v16, 16, v160
  v_and_b32 v17, 0xffff0000, v160
  v_lshlrev_b32 v18, 16, v161
  v_and_b32 v19, 0xffff0000, v161
  v_lshlrev_b32 v20, 16, v162
  v_and_b32 v21, 0xffff0000, v162
  v_lshlrev_b32 v22, 16, v163
  v_and_b32 v23, 0xffff0000, v163
  s_waitcnt vmcnt(16)
  v_dot2c_f32_bf16 v16, s24, v164
  v_dot2c_f32_bf16 v17, s25, v164
  v_dot2c_f32_bf16 v18, s24, v165
  v_dot2c_f32_bf16 v19, s25, v165
  v_dot2c_f32_bf16 v20, s24, v166
  v_dot2c_f32_bf16 v21, s25, v166
  v_dot2c_f32_bf16 v22, s24, v167
  v_dot2c_f32_bf16 v23, s25, v167
  s_waitcnt vmcnt(15)
  v_dot2c_f32_bf16 v16, s24, v168
  v_dot2c_f32_bf16 v17, s25, v168
  v_dot2c_f32_bf16 v18, s24, v169
  v_dot2c_f32_bf16 v19, s25, v169
  v_dot2c_f32_bf16 v20, s24, v170
  v_dot2c_f32_bf16 v21, s25, v170
  v_dot2c_f32_bf16 v22, s24, v171
  v_dot2c_f32_bf16 v23, s25, v171
  s_waitcnt vmcnt(14)
  v_dot2c_f32_bf16 v16, s24, v172
  v_dot2c_f32_bf16 v17, s25, v172
  v_dot2c_f32_bf16 v18, s24, v173
  v_dot2c_f32_bf16 v19, s25, v173
  v_dot2c_f32_bf16 v20, s24, v174
  v_dot2c_f32_bf16 v21, s25, v174
  v_dot2c_f32_bf16 v22, s24, v175
  v_dot2c_f32_bf16 v23, s25, v175
  s_waitcnt vmcnt(13)
  v_dot2c_f32_bf16 v16, s24, v176
  v_dot2c_f32_bf16 v17, s25, v176
  v_dot2c_f32_bf16 v18, s24, v177
  v_dot2c_f32_bf16 v19, s25, v177
  v_dot2c_f32_bf16 v20, s24, v178
  v_dot2c_f32_bf16 v21, s25, v178
  v_dot2c_f32_bf16 v22, s24, v179
  v_dot2c_f32_bf16 v23, s25, v179
  s_waitcnt vmcnt(12)
  v_dot2c_f32_bf16 v16, s24, v180
  v_dot2c_f32_bf16 v17, s25, v180
  v_dot2c_f32_bf16 v18, s24, v181
  v_dot2c_f32_bf16 v19, s25, v181
  v_dot2c_f32_bf16 v20, s24, v182
  v_dot2c_f32_bf16 v21, s25, v182
  v_dot2c_f32_bf16 v22, s24, v183
  v_dot2c_f32_bf16 v23, s25, v183
  s_waitcnt vmcnt(11)
  v_dot2c_f32_bf16 v16, s24, v184
  v_dot2c_f32_bf16 v17, s25, v184
  v_dot2c_f32_bf16 v18, s24, v185
  v_dot2c_f32_bf16 v19, s25, v185
  v_dot2c_f32_bf16 v20, s24, v186
  v_dot2c_f32_bf16 v21, s25, v186
  v_dot2c_f32_bf16 v22, s24, v187
  v_dot2c_f32_bf16 v23, s25, v187
  s_waitcnt vmcnt(10)
  v_dot2c_f32_bf16 v16, s24, v188
  v_dot2c_f32_bf16 v17, s25, v188
  v_dot2c_f32_bf16 v18, s24, v189
  v_dot2c_f32_bf16 v19, s25, v189
  v_dot2c_f32_bf16 v20, s24, v190
  v_dot2c_f32_bf16 v21, s25, v190
  v_dot2c_f32_bf16 v22, s24, v191
  v_dot2c_f32_bf16 v23, s25, v191
  s_waitcnt vmcnt(9)
  v_dot2c_f32_bf16 v16, s24, v192
  v_dot2c_f32_bf16 v17, s25, v192
  v_dot2c_f32_bf16 v18, s24, v193
  v_dot2c_f32_bf16 v19, s25, v193
  v_dot2c_f32_bf16 v20, s24, v194
  v_dot2c_f32_bf16 v21, s25, v194
  v_dot2c_f32_bf16 v22, s24, v195
  v_dot2c_f32_bf16 v23, s25, v195
  s_waitcnt vmcnt(8)
  v_dot2c_f32_bf16 v16, s24, v196
  v_dot2c_f32_bf16 v17, s25, v196
  v_dot2c_f32_bf16 v18, s24, v197
  v_dot2c_f32_bf16 v19, s25, v197
  v_dot2c_f32_bf16 v20, s24, v198
  v_dot2c_f32_bf16 v21, s25, v198
  v_dot2c_f32_bf16 v22, s24, v199
  v_dot2c_f32_bf16 v23, s25, v199
  s_waitcnt vmcnt(7)
  v_dot2c_f32_bf16 v16, s24, v200
  v_dot2c_f32_bf16 v17, s25, v200
  v_dot2c_f32_bf16 v18, s24, v201
  v_dot2c_f32_bf16 v19, s25, v201
  v_dot2c_f32_bf16 v20, s24, v202
  v_dot2c_f32_bf16 v21, s25, v202
  v_dot2c_f32_bf16 v22, s24, v203
  v_dot2c_f32_bf16 v23, s25, v203
  s_waitcnt vmcnt(6)
  v_dot2c_f32_bf16 v16, s24, v204
  v_dot2c_f32_bf16 v17, s25, v204
  v_dot2c_f32_bf16 v18, s24, v205
  v_dot2c_f32_bf16 v19, s25, v205
  v_dot2c_f32_bf16 v20, s24, v206
  v_dot2c_f32_bf16 v21, s25, v206
  v_dot2c_f32_bf16 v22, s24, v207
  v_dot2c_f32_bf16 v23, s25, v207
  s_waitcnt vmcnt(5)
  v_dot2c_f32_bf16 v16, s24, v208
  v_dot2c_f32_bf16 v17, s25, v208
  v_dot2c_f32_bf16 v18, s24, v209
  v_dot2c_f32_bf16 v19, s25, v209
  v_dot2c_f32_bf16 v20, s24, v210
  v_dot2c_f32_bf16 v21, s25, v210
  v_dot2c_f32_bf16 v22, s24, v211
  v_dot2c_f32_bf16 v23, s25, v211
  s_waitcnt vmcnt(4)
  v_dot2c_f32_bf16 v16, s24, v212
  v_dot2c_f32_bf16 v17, s25, v212
  v_dot2c_f32_bf16 v18, s24, v213
  v_dot2c_f32_bf16 v19, s25, v213
  v_dot2c_f32_bf16 v20, s24, v214
  v_dot2c_f32_bf16 v21, s25, v214
  v_dot2c_f32_bf16 v22, s24, v215
  v_dot2c_f32_bf16 v23, s25, v215
  s_waitcnt vmcnt(3)
  v_dot2c_f32_bf16 v16, s24, v216
  v_dot2c_f32_bf16 v17, s25, v216
  v_dot2c_f32_bf16 v18, s24, v217
  v_dot2c_f32_bf16 v19, s25, v217
  v_dot2c_f32_bf16 v20, s24, v218
  v_dot2c_f32_bf16 v21, s25, v218
  v_dot2c_f32_bf16 v22, s24, v219
  v_dot2c_f32_bf16 v23, s25, v219
  s_waitcnt vmcnt(2)
  v_dot2c_f32_bf16 v16, s24, v220
  v_dot2c_f32_bf16 v17, s25, v220
  v_dot2c_f32_bf16 v18, s24, v221
  v_dot2c_f32_bf16 v19, s25, v221
  v_dot2c_f32_bf16 v20, s24, v222
  v_dot2c_f32_bf16 v21, s25, v222
  v_dot2c_f32_bf16 v22, s24, v223
  v_dot2c_f32_bf16 v23, s25, v223
  s_nop 3
  v_cvt_pk_bf16_f32 v24, v16, v17
  v_cvt_pk_bf16_f32 v25, v18, v19
  v_cvt_pk_bf16_f32 v26, v20, v21
  v_cvt_pk_bf16_f32 v27, v22, v23
  buffer_store_dwordx4 v[24:27], v15, s[20:23], 0 offen
  s_nop 1
  s_branch L_h1done
L_h1two:
  s_waitcnt vmcnt(31)
  v_lshlrev_b32 v16, 16, v32
  v_and_b32 v17, 0xffff0000, v32
  v_lshlrev_b32 v18, 16, v33
  v_and_b32 v19, 0xffff0000, v33
  v_lshlrev_b32 v20, 16, v34
  v_and_b32 v21, 0xffff0000, v34
  v_lshlrev_b32 v22, 16, v35
  v_and_b32 v23, 0xffff0000, v35
  s_waitcnt vmcnt(30)
  v_dot2c_f32_bf16 v16, s24, v36
  v_dot2c_f32_bf16 v17, s25, v36
  v_dot2c_f32_bf16 v18, s24, v37
  v_dot2c_f32_bf16 v19, s25, v37
  v_dot2c_f32_bf16 v20, s24, v38
  v_dot2c_f32_bf16 v21, s25, v38
  v_dot2c_f32_bf16 v22, s24, v39
  v_dot2c_f32_bf16 v23, s25, v39
  s_waitcnt vmcnt(29)
  v_dot2c_f32_bf16 v16, s24, v40
  v_dot2c_f32_bf16 v17, s25, v40
  v_dot2c_f32_bf16 v18, s24, v41
  v_dot2c_f32_bf16 v19, s25, v41
  v_dot2c_f32_bf16 v20, s24, v42
  v_dot2c_f32_bf16 v21, s25, v42
  v_dot2c_f32_bf16 v22, s24, v43
  v_dot2c_f32_bf16 v23, s25, v43
  s_waitcnt vmcnt(28)
  v_dot2c_f32_bf16 v16, s24, v44
  v_dot2c_f32_bf16 v17, s25, v44
  v_dot2c_f32_bf16 v18, s24, v45
  v_dot2c_f32_bf16 v19, s25, v45
  v_dot2c_f32_bf16 v20, s24, v46
  v_dot2c_f32_bf16 v21, s25, v46
  v_dot2c_f32_bf16 v22, s24, v47
  v_dot2c_f32_bf16 v23, s25, v47
  s_waitcnt vmcnt(27)
  v_dot2c_f32_bf16 v16, s24, v48
  v_dot2c_f32_bf16 v17, s25, v48
  v_dot2c_f32_bf16 v18, s24, v49
  v_dot2c_f32_bf16 v19, s25, v49
  v_dot2c_f32_bf16 v20, s24, v50
  v_dot2c_f32_bf16 v21, s25, v50
  v_dot2c_f32_bf16 v22, s24, v51
  v_dot2c_f32_bf16 v23, s25, v51
  s_waitcnt vmcnt(26)
  v_dot2c_f32_bf16 v16, s24, v52
  v_dot2c_f32_bf16 v17, s25, v52
  v_dot2c_f32_bf16 v18, s24, v53
  v_dot2c_f32_bf16 v19, s25, v53
  v_dot2c_f32_bf16 v20, s24, v54
  v_dot2c_f32_bf16 v21, s25, v54
  v_dot2c_f32_bf16 v22, s24, v55
  v_dot2c_f32_bf16 v23, s25, v55
  s_waitcnt vmcnt(25)
  v_dot2c_f32_bf16 v16, s24, v56
  v_dot2c_f32_bf16 v17, s25, v56
  v_dot2c_f32_bf16 v18, s24, v57
  v_dot2c_f32_bf16 v19, s25, v57
  v_dot2c_f32_bf16 v20, s24, v58
  v_dot2c_f32_bf16 v21, s25, v58
  v_dot2c_f32_bf16 v22, s24, v59
  v_dot2c_f32_bf16 v23, s25, v59
  s_waitcnt vmcnt(24)
  v_dot2c_f32_bf16 v16, s24, v60
  v_dot2c_f32_bf16 v17, s25, v60
  v_dot2c_f32_bf16 v18, s24, v61
  v_dot2c_f32_bf16 v19, s25, v61
  v_dot2c_f32_bf16 v20, s24, v62
  v_dot2c_f32_bf16 v21, s25, v62
  v_dot2c_f32_bf16 v22, s24, v63
  v_dot2c_f32_bf16 v23, s25, v63
  s_waitcnt vmcnt(23)
  v_dot2c_f32_bf16 v16, s24, v64
  v_dot2c_f32_bf16 v17, s25, v64
  v_dot2c_f32_bf16 v18, s24, v65
  v_dot2c_f32_bf16 v19, s25, v65
  v_dot2c_f32_bf16 v20, s24, v66
  v_dot2c_f32_bf16 v21, s25, v66
  v_dot2c_f32_bf16 v22, s24, v67
  v_dot2c_f32_bf16 v23, s25, v67
  s_waitcnt vmcnt(22)
  v_dot2c_f32_bf16 v16, s24, v68
  v_dot2c_f32_bf16 v17, s25, v68
  v_dot2c_f32_bf16 v18, s24, v69
  v_dot2c_f32_bf16 v19, s25, v69
  v_dot2c_f32_bf16 v20, s24, v70
  v_dot2c_f32_bf16 v21, s25, v70
  v_dot2c_f32_bf16 v22, s24, v71
  v_dot2c_f32_bf16 v23, s25, v71
  s_waitcnt vmcnt(21)
  v_dot2c_f32_bf16 v16, s24, v72
  v_dot2c_f32_bf16 v17, s25, v72
  v_dot2c_f32_bf16 v18, s24, v73
  v_dot2c_f32_bf16 v19, s25, v73
  v_dot2c_f32_bf16 v20, s24, v74
  v_dot2c_f32_bf16 v21, s25, v74
  v_dot2c_f32_bf16 v22, s24, v75
  v_dot2c_f32_bf16 v23, s25, v75
  s_waitcnt vmcnt(20)
  v_dot2c_f32_bf16 v16, s24, v76
  v_dot2c_f32_bf16 v17, s25, v76
  v_dot2c_f32_bf16 v18, s24, v77
  v_dot2c_f32_bf16 v19, s25, v77
  v_dot2c_f32_bf16 v20, s24, v78
  v_dot2c_f32_bf16 v21, s25, v78
  v_dot2c_f32_bf16 v22, s24, v79
  v_dot2c_f32_bf16 v23, s25, v79
  s_waitcnt vmcnt(19)
  v_dot2c_f32_bf16 v16, s24, v80
  v_dot2c_f32_bf16 v17, s25, v80
  v_dot2c_f32_bf16 v18, s24, v81
  v_dot2c_f32_bf16 v19, s25, v81
  v_dot2c_f32_bf16 v20, s24, v82
  v_dot2c_f32_bf16 v21, s25, v82
  v_dot2c_f32_bf16 v22, s24, v83
  v_dot2c_f32_bf16 v23, s25, v83
  s_waitcnt vmcnt(18)
  v_dot2c_f32_bf16 v16, s24, v84
  v_dot2c_f32_bf16 v17, s25, v84
  v_dot2c_f32_bf16 v18, s24, v85
  v_dot2c_f32_bf16 v19, s25, v85
  v_dot2c_f32_bf16 v20, s24, v86
  v_dot2c_f32_bf16 v21, s25, v86
  v_dot2c_f32_bf16 v22, s24, v87
  v_dot2c_f32_bf16 v23, s25, v87
  s_waitcnt vmcnt(17)
  v_dot2c_f32_bf16 v16, s24, v88
  v_dot2c_f32_bf16 v17, s25, v88
  v_dot2c_f32_bf16 v18, s24, v89
  v_dot2c_f32_bf16 v19, s25, v89
  v_dot2c_f32_bf16 v20, s24, v90
  v_dot2c_f32_bf16 v21, s25, v90
  v_dot2c_f32_bf16 v22, s24, v91
  v_dot2c_f32_bf16 v23, s25, v91
  s_waitcnt vmcnt(16)
  v_dot2c_f32_bf16 v16, s24, v92
  v_dot2c_f32_bf16 v17, s25, v92
  v_dot2c_f32_bf16 v18, s24, v93
  v_dot2c_f32_bf16 v19, s25, v93
  v_dot2c_f32_bf16 v20, s24, v94
  v_dot2c_f32_bf16 v21, s25, v94
  v_dot2c_f32_bf16 v22, s24, v95
  v_dot2c_f32_bf16 v23, s25, v95
  s_nop 3
  v_cvt_pk_bf16_f32 v24, v16, v17
  v_cvt_pk_bf16_f32 v25, v18, v19
  v_cvt_pk_bf16_f32 v26, v20, v21
  v_cvt_pk_bf16_f32 v27, v22, v23
  buffer_store_dwordx4 v[24:27], v11, s[20:23], 0 offen
  s_nop 1
  s_waitcnt vmcnt(16)
  v_lshlrev_b32 v16, 16, v96
  v_and_b32 v17, 0xffff0000, v96
  v_lshlrev_b32 v18, 16, v97
  v_and_b32 v19, 0xffff0000, v97
  v_lshlrev_b32 v20, 16, v98
  v_and_b32 v21, 0xffff0000, v98
  v_lshlrev_b32 v22, 16, v99
  v_and_b32 v23, 0xffff0000, v99
  s_waitcnt vmcnt(15)
  v_dot2c_f32_bf16 v16, s24, v100
  v_dot2c_f32_bf16 v17, s25, v100
  v_dot2c_f32_bf16 v18, s24, v101
  v_dot2c_f32_bf16 v19, s25, v101
  v_dot2c_f32_bf16 v20, s24, v102
  v_dot2c_f32_bf16 v21, s25, v102
  v_dot2c_f32_bf16 v22, s24, v103
  v_dot2c_f32_bf16 v23, s25, v103
  s_waitcnt vmcnt(14)
  v_dot2c_f32_bf16 v16, s24, v104
  v_dot2c_f32_bf16 v17, s25, v104
  v_dot2c_f32_bf16 v18, s24, v105
  v_dot2c_f32_bf16 v19, s25, v105
  v_dot2c_f32_bf16 v20, s24, v106
  v_dot2c_f32_bf16 v21, s25, v106
  v_dot2c_f32_bf16 v22, s24, v107
  v_dot2c_f32_bf16 v23, s25, v107
  s_waitcnt vmcnt(13)
  v_dot2c_f32_bf16 v16, s24, v108
  v_dot2c_f32_bf16 v17, s25, v108
  v_dot2c_f32_bf16 v18, s24, v109
  v_dot2c_f32_bf16 v19, s25, v109
  v_dot2c_f32_bf16 v20, s24, v110
  v_dot2c_f32_bf16 v21, s25, v110
  v_dot2c_f32_bf16 v22, s24, v111
  v_dot2c_f32_bf16 v23, s25, v111
  s_waitcnt vmcnt(12)
  v_dot2c_f32_bf16 v16, s24, v112
  v_dot2c_f32_bf16 v17, s25, v112
  v_dot2c_f32_bf16 v18, s24, v113
  v_dot2c_f32_bf16 v19, s25, v113
  v_dot2c_f32_bf16 v20, s24, v114
  v_dot2c_f32_bf16 v21, s25, v114
  v_dot2c_f32_bf16 v22, s24, v115
  v_dot2c_f32_bf16 v23, s25, v115
  s_waitcnt vmcnt(11)
  v_dot2c_f32_bf16 v16, s24, v116
  v_dot2c_f32_bf16 v17, s25, v116
  v_dot2c_f32_bf16 v18, s24, v117
  v_dot2c_f32_bf16 v19, s25, v117
  v_dot2c_f32_bf16 v20, s24, v118
  v_dot2c_f32_bf16 v21, s25, v118
  v_dot2c_f32_bf16 v22, s24, v119
  v_dot2c_f32_bf16 v23, s25, v119
  s_waitcnt vmcnt(10)
  v_dot2c_f32_bf16 v16, s24, v120
  v_dot2c_f32_bf16 v17, s25, v120
  v_dot2c_f32_bf16 v18, s24, v121
  v_dot2c_f32_bf16 v19, s25, v121
  v_dot2c_f32_bf16 v20, s24, v122
  v_dot2c_f32_bf16 v21, s25, v122
  v_dot2c_f32_bf16 v22, s24, v123
  v_dot2c_f32_bf16 v23, s25, v123
  s_waitcnt vmcnt(9)
  v_dot2c_f32_bf16 v16, s24, v124
  v_dot2c_f32_bf16 v17, s25, v124
  v_dot2c_f32_bf16 v18, s24, v125
  v_dot2c_f32_bf16 v19, s25, v125
  v_dot2c_f32_bf16 v20, s24, v126
  v_dot2c_f32_bf16 v21, s25, v126
  v_dot2c_f32_bf16 v22, s24, v127
  v_dot2c_f32_bf16 v23, s25, v127
  s_waitcnt vmcnt(8)
  v_dot2c_f32_bf16 v16, s24, v128
  v_dot2c_f32_bf16 v17, s25, v128
  v_dot2c_f32_bf16 v18, s24, v129
  v_dot2c_f32_bf16 v19, s25, v129
  v_dot2c_f32_bf16 v20, s24, v130
  v_dot2c_f32_bf16 v21, s25, v130
  v_dot2c_f32_bf16 v22, s24, v131
  v_dot2c_f32_bf16 v23, s25, v131
  s_waitcnt vmcnt(7)
  v_dot2c_f32_bf16 v16, s24, v132
  v_dot2c_f32_bf16 v17, s25, v132
  v_dot2c_f32_bf16 v18, s24, v133
  v_dot2c_f32_bf16 v19, s25, v133
  v_dot2c_f32_bf16 v20, s24, v134
  v_dot2c_f32_bf16 v21, s25, v134
  v_dot2c_f32_bf16 v22, s24, v135
  v_dot2c_f32_bf16 v23, s25, v135
  s_waitcnt vmcnt(6)
  v_dot2c_f32_bf16 v16, s24, v136
  v_dot2c_f32_bf16 v17, s25, v136
  v_dot2c_f32_bf16 v18, s24, v137
  v_dot2c_f32_bf16 v19, s25, v137
  v_dot2c_f32_bf16 v20, s24, v138
  v_dot2c_f32_bf16 v21, s25, v138
  v_dot2c_f32_bf16 v22, s24, v139
  v_dot2c_f32_bf16 v23, s25, v139
  s_waitcnt vmcnt(5)
  v_dot2c_f32_bf16 v16, s24, v140
  v_dot2c_f32_bf16 v17, s25, v140
  v_dot2c_f32_bf16 v18, s24, v141
  v_dot2c_f32_bf16 v19, s25, v141
  v_dot2c_f32_bf16 v20, s24, v142
  v_dot2c_f32_bf16 v21, s25, v142
  v_dot2c_f32_bf16 v22, s24, v143
  v_dot2c_f32_bf16 v23, s25, v143
  s_waitcnt vmcnt(4)
  v_dot2c_f32_bf16 v16, s24, v144
  v_dot2c_f32_bf16 v17, s25, v144
  v_dot2c_f32_bf16 v18, s24, v145
  v_dot2c_f32_bf16 v19, s25, v145
  v_dot2c_f32_bf16 v20, s24, v146
  v_dot2c_f32_bf16 v21, s25, v146
  v_dot2c_f32_bf16 v22, s24, v147
  v_dot2c_f32_bf16 v23, s25, v147
  s_waitcnt vmcnt(3)
  v_dot2c_f32_bf16 v16, s24, v148
  v_dot2c_f32_bf16 v17, s25, v148
  v_dot2c_f32_bf16 v18, s24, v149
  v_dot2c_f32_bf16 v19, s25, v149
  v_dot2c_f32_bf16 v20, s24, v150
  v_dot2c_f32_bf16 v21, s25, v150
  v_dot2c_f32_bf16 v22, s24, v151
  v_dot2c_f32_bf16 v23, s25, v151
  s_waitcnt vmcnt(2)
  v_dot2c_f32_bf16 v16, s24, v152
  v_dot2c_f32_bf16 v17, s25, v152
  v_dot2c_f32_bf16 v18, s24, v153
  v_dot2c_f32_bf16 v19, s25, v153
  v_dot2c_f32_bf16 v20, s24, v154
  v_dot2c_f32_bf16 v21, s25, v154
  v_dot2c_f32_bf16 v22, s24, v155
  v_dot2c_f32_bf16 v23, s25, v155
  s_waitcnt vmcnt(1)
  v_dot2c_f32_bf16 v16, s24, v156
  v_dot2c_f32_bf16 v17, s25, v156
  v_dot2c_f32_bf16 v18, s24, v157
  v_dot2c_f32_bf16 v19, s25, v157
  v_dot2c_f32_bf16 v20, s24, v158
  v_dot2c_f32_bf16 v21, s25, v158
  v_dot2c_f32_bf16 v22, s24, v159
  v_dot2c_f32_bf16 v23, s25, v159
  s_nop 3
  v_cvt_pk_bf16_f32 v24, v16, v17
  v_cvt_pk_bf16_f32 v25, v18, v19
  v_cvt_pk_bf16_f32 v26, v20, v21
  v_cvt_pk_bf16_f32 v27, v22, v23
  buffer_store_dwordx4 v[24:27], v13, s[20:23], 0 offen
  s_nop 1
L_h1done:
L_end:
  s_endpgm
L_spin0:
  ds_read_b32 v254, v251 offset:0
  s_waitcnt lgkmcnt(0)
  v_readfirstlane_b32 s39, v254
  s_nop 1
  s_setpc_b64 s[30:31]
L_spin4:
  ds_read_b32 v254, v251 offset:4
  s_waitcnt lgkmcnt(0)
  v_readfirstlane_b32 s39, v254
  s_nop 1
  s_setpc_b64 s[30:31]
L_cons:
  v_lshrrev_b32 v2, 3, v0
  v_mul_u32_u24 v2, 896, v2
  v_and_b32 v3, 7, v0
  v_lshrrev_b32 v4, 4, v0
  v_add_u32 v5, 0, v4
  v_xor_b32 v5, v5, v3
  v_lshlrev_b32 v5, 4, v5
  v_add_u32 v252, v5, v2
  v_add_u32 v5, 4, v4
  v_xor_b32 v5, v5, v3
  v_lshlrev_b32 v5, 4, v5
  v_add_u32 v253, v5, v2
  s_lshl_b32 s43, s3, 14
  s_lshl_b32 s37, s3, 9
  s_add_u32 s37, s37, 148480
  v_lshl_add_u32 v251, v0, 2, s37
  s_lshl_b32 s37, s3, 4
  s_add_u32 s37, s37, 147456
  v_writelane_b32 v251, s37, 0
  v_mov_b32 v255, 0
  ds_write_b32 v251, v255 offset:8
  v_mov_b32 v255, 1
  s_waitcnt lgkmcnt(0)
  s_cmp_eq_u32 s5, 0
  s_cselect_b64 s[64:65], s[64:65], s[76:77]
  s_mul_i32 s36, s6, 86016
  s_add_u32 s12, s64, s36
  s_addc_u32 s13, s65, 0
  s_and_b32 s13, s13, 0xffff
  s_mov_b32 s14, 86016
  s_mov_b32 s15, 0x20000
  s_mul_i32 s36, s3, 28672
  s_lshl_b32 s8, s9, 7
  s_add_u32 s36, s36, s8
  s_mul_i32 s45, s11, 86016
  s_add_u32 s32, s86, s45
  s_addc_u32 s33, s87, 0
  s_and_b32 s33, s33, 0xffff
  s_mov_b32 s34, 86016
  s_mov_b32 s35, 0x20000
  s_load_dwordx4 s[80:83], s[0:1], 80
  s_waitcnt lgkmcnt(0)
  s_barrier
  v_lshrrev_b32 v2, 5, v0
  v_lshrrev_b32 v3, 4, v0
  v_and_b32 v3, 1, v3
  v_lshrrev_b32 v4, 2, v0
  v_and_b32 v4, 3, v4
  v_and_b32 v5, 3, v0
  v_and_b32 v6, 1, v5
  v_lshlrev_b32 v6, 1, v6
  v_lshrrev_b32 v7, 1, v5
  v_or_b32 v6, v6, v7
  v_lshrrev_b32 v8, 1, v6
  v_lshl_add_u32 v8, v3, 1, v8
  v_lshlrev_b32 v8, 4, v8
  v_and_b32 v10, 1, v6
  v_lshl_add_u32 v8, v10, 3, v8
  v_lshrrev_b32 v9, 1, v5
  v_lshl_add_u32 v9, v3, 1, v9
  v_lshlrev_b32 v9, 4, v9
  v_and_b32 v10, 1, v5
  v_lshl_add_u32 v9, v10, 3, v9
  v_lshl_add_u32 v11, v2, 3, v4
  v_lshlrev_b32 v11, 9, v11
  v_add_u32 v11, v11, v8
  v_add_u32 v11, 114688, v11
  v_xor_b32 v12, 0, v4
  v_lshl_add_u32 v228, v12, 6, v11
  v_subrev_u32 v160, 65536, v228
  v_xor_b32 v12, 1, v4
  v_lshl_add_u32 v229, v12, 6, v11
  v_subrev_u32 v161, 65536, v229
  v_xor_b32 v12, 2, v4
  v_lshl_add_u32 v230, v12, 6, v11
  v_subrev_u32 v162, 65536, v230
  v_xor_b32 v12, 3, v4
  v_lshl_add_u32 v231, v12, 6, v11
  v_subrev_u32 v163, 65536, v231
  v_and_b32 v11, 31, v0
  v_lshrrev_b32 v12, 1, v11
  v_and_b32 v12, 7, v12
  v_xor_b32 v12, v12, v2
  v_lshlrev_b32 v11, 7, v11
  v_add_u32 v11, s43, v11
  v_xor_b32 v10, 0, v12
  v_lshl_add_u32 v224, v10, 4, v11
  v_xor_b32 v10, 2, v12
  v_lshl_add_u32 v225, v10, 4, v11
  v_xor_b32 v10, 4, v12
  v_lshl_add_u32 v226, v10, 4, v11
  v_xor_b32 v10, 6, v12
  v_lshl_add_u32 v227, v10, 4, v11
  v_lshl_add_u32 v11, v2, 2, v4
  v_lshlrev_b32 v11, 8, v11
  v_add_u32 v11, v11, v9
  v_xor_b32 v12, 0, v4
  v_lshl_add_u32 v240, v12, 6, v11
  v_xor_b32 v12, 1, v4
  v_lshl_add_u32 v241, v12, 6, v11
  v_xor_b32 v12, 2, v4
  v_lshl_add_u32 v242, v12, 6, v11
  v_xor_b32 v12, 3, v4
  v_lshl_add_u32 v243, v12, 6, v11
  v_lshl_add_u32 v11, v2, 2, v4
  v_lshlrev_b32 v11, 7, v11
  v_add_u32 v11, v11, v8
  v_lshrrev_b32 v10, 1, v4
  v_xor_b32 v12, 0, v10
  v_lshl_add_u32 v244, v12, 6, v11
  v_xor_b32 v12, 1, v10
  v_lshl_add_u32 v245, v12, 6, v11
  v_and_b32 v11, 31, v0
  v_and_b32 v12, 15, v0
  v_xor_b32 v12, v12, v2
  v_lshlrev_b32 v11, 9, v11
  v_xor_b32 v10, 0, v12
  v_lshl_add_u32 v232, v10, 4, v11
  v_xor_b32 v10, 2, v12
  v_lshl_add_u32 v233, v10, 4, v11
  v_xor_b32 v10, 4, v12
  v_lshl_add_u32 v234, v10, 4, v11
  v_xor_b32 v10, 6, v12
  v_lshl_add_u32 v235, v10, 4, v11
  v_xor_b32 v10, 8, v12
  v_lshl_add_u32 v236, v10, 4, v11
  v_xor_b32 v10, 10, v12
  v_lshl_add_u32 v237, v10, 4, v11
  v_xor_b32 v10, 12, v12
  v_lshl_add_u32 v238, v10, 4, v11
  v_xor_b32 v10, 14, v12
  v_lshl_add_u32 v239, v10, 4, v11
  s_mul_i32 s44, s3, 28672
  s_mov_b32 s45, 0x3f803f80
  s_mov_b32 s42, 0x3db8aa3b
  ds_read_b32 v254, v251 offset:0
  s_waitcnt lgkmcnt(0)
  v_readfirstlane_b32 s39, v254
  s_getpc_b64 s[30:31]
  s_cmp_ge_u32 s39, 1
  s_cbranch_scc0 L_spin0
  ds_read_b128 a[0:3], v224 offset:0
  ds_read_b128 a[4:7], v225 offset:0
  ds_read_b128 a[8:11], v226 offset:0
  ds_read_b128 a[12:15], v227 offset:0
  ds_read_b64_tr_b16 a[224:225], v228 offset:0
  ds_read_b64_tr_b16 a[226:227], v228 offset:2048
  ds_read_b64_tr_b16 a[228:229], v229 offset:0
  ds_read_b64_tr_b16 a[230:231], v229 offset:2048
  ds_read_b64_tr_b16 a[232:233], v230 offset:0
  ds_read_b64_tr_b16 a[234:235], v230 offset:2048
  ds_read_b32 v254, v251 offset:0
  ds_read_b64_tr_b16 a[236:237], v231 offset:0
  ds_read_b64_tr_b16 a[238:239], v231 offset:2048
  s_waitcnt lgkmcnt(5)
  v_mfma_f32_32x32x16_bf16 v[0:15], a[224:227], a[0:3], 0
  ds_read_b64_tr_b16 a[240:241], v228 offset:256
  ds_read_b64_tr_b16 a[242:243], v228 offset:2304
  v_mfma_f32_32x32x16_bf16 v[16:31], a[228:231], a[0:3], 0
  ds_read_b64_tr_b16 a[244:245], v229 offset:256
  ds_read_b64_tr_b16 a[246:247], v229 offset:2304
  s_waitcnt lgkmcnt(4)
  v_mfma_f32_32x32x16_bf16 v[32:47], a[232:235], a[0:3], 0
  v_readfirstlane_b32 s39, v254
  ds_read_b64_tr_b16 a[248:249], v230 offset:256
  ds_read_b64_tr_b16 a[250:251], v230 offset:2304
  v_mfma_f32_32x32x16_bf16 v[48:63], a[236:239], a[0:3], 0
  ds_read_b64_tr_b16 a[252:253], v231 offset:256
  ds_read_b64_tr_b16 a[254:255], v231 offset:2304
  s_waitcnt lgkmcnt(4)
  v_mfma_f32_32x32x16_bf16 v[64:79], a[240:243], a[0:3], 0
  s_getpc_b64 s[30:31]
  s_cmp_ge_u32 s39, 2
  s_cbranch_scc0 L_spin0
  ds_read_b64_tr_b16 a[224:225], v228 offset:8192
  ds_read_b64_tr_b16 a[226:227], v228 offset:10240
  v_mfma_f32_32x32x16_bf16 v[80:95], a[244:247], a[0:3], 0
  ds_read_b64_tr_b16 a[228:229], v229 offset:8192
  ds_read_b64_tr_b16 a[230:231], v229 offset:10240
  s_waitcnt lgkmcnt(4)
  v_mfma_f32_32x32x16_bf16 v[96:111], a[248:251], a[0:3], 0
  ds_read_b64_tr_b16 a[232:233], v230 offset:8192
  ds_read_b64_tr_b16 a[234:235], v230 offset:10240
  v_mfma_f32_32x32x16_bf16 v[112:127], a[252:255], a[0:3], 0
  ds_add_u32 v251, v255 offset:8
  ds_read_b32 v254, v251 offset:0
  ds_read_b64_tr_b16 a[236:237], v231 offset:8192
  ds_read_b64_tr_b16 a[238:239], v231 offset:10240
  s_waitcnt lgkmcnt(6)
  v_mfma_f32_32x32x16_bf16 v[0:15], a[224:227], a[4:7], v[0:15]
  ds_read_b64_tr_b16 a[240:241], v228 offset:8448
  ds_read_b64_tr_b16 a[242:243], v228 offset:10496
  v_mfma_f32_32x32x16_bf16 v[16:31], a[228:231], a[4:7], v[16:31]
  ds_read_b64_tr_b16 a[244:245], v229 offset:8448
  ds_read_b64_tr_b16 a[246:247], v229 offset:10496
  s_waitcnt lgkmcnt(4)
  v_mfma_f32_32x32x16_bf16 v[32:47], a[232:235], a[4:7], v[32:47]
  v_readfirstlane_b32 s39, v254
  ds_read_b64_tr_b16 a[248:249], v230 offset:8448
  ds_read_b64_tr_b16 a[250:251], v230 offset:10496
  v_mfma_f32_32x32x16_bf16 v[48:63], a[236:239], a[4:7], v[48:63]
  ds_read_b64_tr_b16 a[252:253], v231 offset:8448
  ds_read_b64_tr_b16 a[254:255], v231 offset:10496
  s_waitcnt lgkmcnt(4)
  v_mfma_f32_32x32x16_bf16 v[64:79], a[240:243], a[4:7], v[64:79]
  s_getpc_b64 s[30:31]
  s_cmp_ge_u32 s39, 3
  s_cbranch_scc0 L_spin0
  ds_read_b64_tr_b16 a[224:225], v228 offset:16384
  ds_read_b64_tr_b16 a[226:227], v228 offset:18432
  v_mfma_f32_32x32x16_bf16 v[80:95], a[244:247], a[4:7], v[80:95]
  ds_read_b64_tr_b16 a[228:229], v229 offset:16384
  ds_read_b64_tr_b16 a[230:231], v229 offset:18432
  s_waitcnt lgkmcnt(4)
  v_mfma_f32_32x32x16_bf16 v[96:111], a[248:251], a[4:7], v[96:111]
  ds_read_b64_tr_b16 a[232:233], v230 offset:16384
  ds_read_b64_tr_b16 a[234:235], v230 offset:18432
  v_mfma_f32_32x32x16_bf16 v[112:127], a[252:255], a[4:7], v[112:127]
  ds_add_u32 v251, v255 offset:8
  ds_read_b32 v254, v251 offset:0
  ds_read_b64_tr_b16 a[236:237], v231 offset:16384
  ds_read_b64_tr_b16 a[238:239], v231 offset:18432
  s_waitcnt lgkmcnt(6)
  v_mfma_f32_32x32x16_bf16 v[0:15], a[224:227], a[8:11], v[0:15]
  ds_read_b64_tr_b16 a[240:241], v228 offset:16640
  ds_read_b64_tr_b16 a[242:243], v228 offset:18688
  v_mfma_f32_32x32x16_bf16 v[16:31], a[228:231], a[8:11], v[16:31]
  ds_read_b64_tr_b16 a[244:245], v229 offset:16640
  ds_read_b64_tr_b16 a[246:247], v229 offset:18688
  s_waitcnt lgkmcnt(4)
  v_mfma_f32_32x32x16_bf16 v[32:47], a[232:235], a[8:11], v[32:47]
  v_readfirstlane_b32 s39, v254
  ds_read_b64_tr_b16 a[248:249], v230 offset:16640
  ds_read_b64_tr_b16 a[250:251], v230 offset:18688
  v_mfma_f32_32x32x16_bf16 v[48:63], a[236:239], a[8:11], v[48:63]
  ds_read_b64_tr_b16 a[252:253], v231 offset:16640
  ds_read_b64_tr_b16 a[254:255], v231 offset:18688
  s_waitcnt lgkmcnt(4)
  v_mfma_f32_32x32x16_bf16 v[64:79], a[240:243], a[8:11], v[64:79]
  s_getpc_b64 s[30:31]
  s_cmp_ge_u32 s39, 4
  s_cbranch_scc0 L_spin0
  ds_read_b64_tr_b16 a[224:225], v228 offset:24576
  ds_read_b64_tr_b16 a[226:227], v228 offset:26624
  v_mfma_f32_32x32x16_bf16 v[80:95], a[244:247], a[8:11], v[80:95]
  ds_read_b64_tr_b16 a[228:229], v229 offset:24576
  ds_read_b64_tr_b16 a[230:231], v229 offset:26624
  s_waitcnt lgkmcnt(4)
  v_mfma_f32_32x32x16_bf16 v[96:111], a[248:251], a[8:11], v[96:111]
  ds_read_b64_tr_b16 a[232:233], v230 offset:24576
  ds_read_b64_tr_b16 a[234:235], v230 offset:26624
  v_mfma_f32_32x32x16_bf16 v[112:127], a[252:255], a[8:11], v[112:127]
  ds_add_u32 v251, v255 offset:8
  ds_read_b32 v254, v251 offset:0
  ds_read_b64_tr_b16 a[236:237], v231 offset:24576
  ds_read_b64_tr_b16 a[238:239], v231 offset:26624
  s_waitcnt lgkmcnt(6)
  v_mfma_f32_32x32x16_bf16 v[0:15], a[224:227], a[12:15], v[0:15]
  ds_read_b64_tr_b16 a[240:241], v228 offset:24832
  ds_read_b64_tr_b16 a[242:243], v228 offset:26880
  v_mfma_f32_32x32x16_bf16 v[16:31], a[228:231], a[12:15], v[16:31]
  ds_read_b64_tr_b16 a[244:245], v229 offset:24832
  ds_read_b64_tr_b16 a[246:247], v229 offset:26880
  s_waitcnt lgkmcnt(4)
  v_mfma_f32_32x32x16_bf16 v[32:47], a[232:235], a[12:15], v[32:47]
  v_readfirstlane_b32 s39, v254
  ds_read_b64_tr_b16 a[248:249], v230 offset:24832
  ds_read_b64_tr_b16 a[250:251], v230 offset:26880
  v_mfma_f32_32x32x16_bf16 v[48:63], a[236:239], a[12:15], v[48:63]
  ds_read_b64_tr_b16 a[252:253], v231 offset:24832
  ds_read_b64_tr_b16 a[254:255], v231 offset:26880
  s_waitcnt lgkmcnt(4)
  v_mfma_f32_32x32x16_bf16 v[64:79], a[240:243], a[12:15], v[64:79]
  s_getpc_b64 s[30:31]
  s_cmp_ge_u32 s39, 5
  s_cbranch_scc0 L_spin0
  ds_read_b128 a[16:19], v224 offset:4096
  ds_read_b128 a[20:23], v225 offset:4096
  ds_read_b128 a[24:27], v226 offset:4096
  ds_read_b128 a[28:31], v227 offset:4096
  ds_read_b64_tr_b16 a[224:225], v228 offset:40960
  ds_read_b64_tr_b16 a[226:227], v228 offset:43008
  v_mfma_f32_32x32x16_bf16 v[80:95], a[244:247], a[12:15], v[80:95]
  ds_read_b64_tr_b16 a[228:229], v229 offset:40960
  ds_read_b64_tr_b16 a[230:231], v229 offset:43008
  s_waitcnt lgkmcnt(8)
  v_mfma_f32_32x32x16_bf16 v[96:111], a[248:251], a[12:15], v[96:111]
  ds_read_b64_tr_b16 a[232:233], v230 offset:40960
  ds_read_b64_tr_b16 a[234:235], v230 offset:43008
  v_mfma_f32_32x32x16_bf16 v[112:127], a[252:255], a[12:15], v[112:127]
  ds_add_u32 v251, v255 offset:8
  ds_read_b32 v254, v251 offset:0
  ds_read_b64_tr_b16 a[236:237], v231 offset:40960
  ds_read_b64_tr_b16 a[238:239], v231 offset:43008
  s_waitcnt lgkmcnt(6)
  v_mfma_f32_32x32x16_bf16 v[0:15], a[224:227], a[16:19], v[0:15]
  ds_read_b64_tr_b16 a[240:241], v228 offset:41216
  ds_read_b64_tr_b16 a[242:243], v228 offset:43264
  v_mfma_f32_32x32x16_bf16 v[16:31], a[228:231], a[16:19], v[16:31]
  ds_read_b64_tr_b16 a[244:245], v229 offset:41216
  ds_read_b64_tr_b16 a[246:247], v229 offset:43264
  s_waitcnt lgkmcnt(4)
  v_mfma_f32_32x32x16_bf16 v[32:47], a[232:235], a[16:19], v[32:47]
  v_readfirstlane_b32 s39, v254
  ds_read_b64_tr_b16 a[248:249], v230 offset:41216
  ds_read_b64_tr_b16 a[250:251], v230 offset:43264
  v_mfma_f32_32x32x16_bf16 v[48:63], a[236:239], a[16:19], v[48:63]
  ds_read_b64_tr_b16 a[252:253], v231 offset:41216
  ds_read_b64_tr_b16 a[254:255], v231 offset:43264
  s_waitcnt lgkmcnt(4)
  v_mfma_f32_32x32x16_bf16 v[64:79], a[240:243], a[16:19], v[64:79]
  s_getpc_b64 s[30:31]
  s_cmp_ge_u32 s39, 6
  s_cbranch_scc0 L_spin0
  ds_read_b64_tr_b16 a[224:225], v160 offset:0
  ds_read_b64_tr_b16 a[226:227], v160 offset:2048
  v_mfma_f32_32x32x16_bf16 v[80:95], a[244:247], a[16:19], v[80:95]
  ds_read_b64_tr_b16 a[228:229], v161 offset:0
  ds_read_b64_tr_b16 a[230:231], v161 offset:2048
  s_waitcnt lgkmcnt(4)
  v_mfma_f32_32x32x16_bf16 v[96:111], a[248:251], a[16:19], v[96:111]
  ds_read_b64_tr_b16 a[232:233], v162 offset:0
  ds_read_b64_tr_b16 a[234:235], v162 offset:2048
  v_mfma_f32_32x32x16_bf16 v[112:127], a[252:255], a[16:19], v[112:127]
  ds_add_u32 v251, v255 offset:8
  ds_read_b32 v254, v251 offset:0
  ds_read_b64_tr_b16 a[236:237], v163 offset:0
  ds_read_b64_tr_b16 a[238:239], v163 offset:2048
  s_waitcnt lgkmcnt(6)
  v_mfma_f32_32x32x16_bf16 v[0:15], a[224:227], a[20:23], v[0:15]
  ds_read_b64_tr_b16 a[240:241], v160 offset:256
  ds_read_b64_tr_b16 a[242:243], v160 offset:2304
  v_mfma_f32_32x32x16_bf16 v[16:31], a[228:231], a[20:23], v[16:31]
  ds_read_b64_tr_b16 a[244:245], v161 offset:256
  ds_read_b64_tr_b16 a[246:247], v161 offset:2304
  s_waitcnt lgkmcnt(4)
  v_mfma_f32_32x32x16_bf16 v[32:47], a[232:235], a[20:23], v[32:47]
  v_readfirstlane_b32 s39, v254
  ds_read_b64_tr_b16 a[248:249], v162 offset:256
  ds_read_b64_tr_b16 a[250:251], v162 offset:2304
  v_mfma_f32_32x32x16_bf16 v[48:63], a[236:239], a[20:23], v[48:63]
  ds_read_b64_tr_b16 a[252:253], v163 offset:256
  ds_read_b64_tr_b16 a[254:255], v163 offset:2304
  s_waitcnt lgkmcnt(4)
  v_mfma_f32_32x32x16_bf16 v[64:79], a[240:243], a[20:23], v[64:79]
  s_getpc_b64 s[30:31]
  s_cmp_ge_u32 s39, 7
  s_cbranch_scc0 L_spin0
  ds_read_b64_tr_b16 a[224:225], v160 offset:8192
  ds_read_b64_tr_b16 a[226:227], v160 offset:10240
  v_mfma_f32_32x32x16_bf16 v[80:95], a[244:247], a[20:23], v[80:95]
  ds_read_b64_tr_b16 a[228:229], v161 offset:8192
  ds_read_b64_tr_b16 a[230:231], v161 offset:10240
  s_waitcnt lgkmcnt(4)
  v_mfma_f32_32x32x16_bf16 v[96:111], a[248:251], a[20:23], v[96:111]
  ds_read_b64_tr_b16 a[232:233], v162 offset:8192
  ds_read_b64_tr_b16 a[234:235], v162 offset:10240
  v_mfma_f32_32x32x16_bf16 v[112:127], a[252:255], a[20:23], v[112:127]
  ds_add_u32 v251, v255 offset:8
  ds_read_b32 v254, v251 offset:0
  ds_read_b64_tr_b16 a[236:237], v163 offset:8192
  ds_read_b64_tr_b16 a[238:239], v163 offset:10240
  s_waitcnt lgkmcnt(6)
  v_mfma_f32_32x32x16_bf16 v[0:15], a[224:227], a[24:27], v[0:15]
  ds_read_b64_tr_b16 a[240:241], v160 offset:8448
  ds_read_b64_tr_b16 a[242:243], v160 offset:10496
  v_mfma_f32_32x32x16_bf16 v[16:31], a[228:231], a[24:27], v[16:31]
  ds_read_b64_tr_b16 a[244:245], v161 offset:8448
  ds_read_b64_tr_b16 a[246:247], v161 offset:10496
  s_waitcnt lgkmcnt(4)
  v_mfma_f32_32x32x16_bf16 v[32:47], a[232:235], a[24:27], v[32:47]
  v_readfirstlane_b32 s39, v254
  ds_read_b64_tr_b16 a[248:249], v162 offset:8448
  ds_read_b64_tr_b16 a[250:251], v162 offset:10496
  v_mfma_f32_32x32x16_bf16 v[48:63], a[236:239], a[24:27], v[48:63]
  ds_read_b64_tr_b16 a[252:253], v163 offset:8448
  ds_read_b64_tr_b16 a[254:255], v163 offset:10496
  s_waitcnt lgkmcnt(4)
  v_mfma_f32_32x32x16_bf16 v[64:79], a[240:243], a[24:27], v[64:79]
  s_getpc_b64 s[30:31]
  s_cmp_ge_u32 s39, 8
  s_cbranch_scc0 L_spin0
  ds_read_b64_tr_b16 a[224:225], v160 offset:16384
  ds_read_b64_tr_b16 a[226:227], v160 offset:18432
  v_mfma_f32_32x32x16_bf16 v[80:95], a[244:247], a[24:27], v[80:95]
  ds_read_b64_tr_b16 a[228:229], v161 offset:16384
  ds_read_b64_tr_b16 a[230:231], v161 offset:18432
  s_waitcnt lgkmcnt(4)
  v_mfma_f32_32x32x16_bf16 v[96:111], a[248:251], a[24:27], v[96:111]
  ds_read_b64_tr_b16 a[232:233], v162 offset:16384
  ds_read_b64_tr_b16 a[234:235], v162 offset:18432
  v_mfma_f32_32x32x16_bf16 v[112:127], a[252:255], a[24:27], v[112:127]
  ds_add_u32 v251, v255 offset:8
  ds_read_b32 v254, v251 offset:0
  ds_read_b64_tr_b16 a[236:237], v163 offset:16384
  ds_read_b64_tr_b16 a[238:239], v163 offset:18432
  s_waitcnt lgkmcnt(6)
  v_mfma_f32_32x32x16_bf16 v[0:15], a[224:227], a[28:31], v[0:15]
  ds_read_b64_tr_b16 a[240:241], v160 offset:16640
  ds_read_b64_tr_b16 a[242:243], v160 offset:18688
  v_mfma_f32_32x32x16_bf16 v[16:31], a[228:231], a[28:31], v[16:31]
  ds_read_b64_tr_b16 a[244:245], v161 offset:16640
  ds_read_b64_tr_b16 a[246:247], v161 offset:18688
  s_waitcnt lgkmcnt(4)
  v_mfma_f32_32x32x16_bf16 v[32:47], a[232:235], a[28:31], v[32:47]
  v_readfirstlane_b32 s39, v254
  ds_read_b64_tr_b16 a[248:249], v162 offset:16640
  ds_read_b64_tr_b16 a[250:251], v162 offset:18688
  v_mfma_f32_32x32x16_bf16 v[48:63], a[236:239], a[28:31], v[48:63]
  ds_read_b64_tr_b16 a[252:253], v163 offset:16640
  ds_read_b64_tr_b16 a[254:255], v163 offset:18688
  s_waitcnt lgkmcnt(4)
  v_mfma_f32_32x32x16_bf16 v[64:79], a[240:243], a[28:31], v[64:79]
  s_getpc_b64 s[30:31]
  s_cmp_ge_u32 s39, 9
  s_cbranch_scc0 L_spin0
  ds_read_b128 a[32:35], v224 offset:8192
  ds_read_b128 a[36:39], v225 offset:8192
  ds_read_b128 a[40:43], v226 offset:8192
  ds_read_b128 a[44:47], v227 offset:8192
  ds_read_b64_tr_b16 a[224:225], v160 offset:24576
  ds_read_b64_tr_b16 a[226:227], v160 offset:26624
  v_mfma_f32_32x32x16_bf16 v[80:95], a[244:247], a[28:31], v[80:95]
  ds_read_b64_tr_b16 a[228:229], v161 offset:24576
  ds_read_b64_tr_b16 a[230:231], v161 offset:26624
  s_waitcnt lgkmcnt(8)
  v_mfma_f32_32x32x16_bf16 v[96:111], a[248:251], a[28:31], v[96:111]
  ds_read_b64_tr_b16 a[232:233], v162 offset:24576
  ds_read_b64_tr_b16 a[234:235], v162 offset:26624
  v_mfma_f32_32x32x16_bf16 v[112:127], a[252:255], a[28:31], v[112:127]
  ds_add_u32 v251, v255 offset:8
  ds_read_b32 v254, v251 offset:0
  ds_read_b64_tr_b16 a[236:237], v163 offset:24576
  ds_read_b64_tr_b16 a[238:239], v163 offset:26624
  s_waitcnt lgkmcnt(6)
  v_mfma_f32_32x32x16_bf16 v[0:15], a[224:227], a[32:35], v[0:15]
  ds_read_b64_tr_b16 a[240:241], v160 offset:24832
  ds_read_b64_tr_b16 a[242:243], v160 offset:26880
  v_mfma_f32_32x32x16_bf16 v[16:31], a[228:231], a[32:35], v[16:31]
  ds_read_b64_tr_b16 a[244:245], v161 offset:24832
  ds_read_b64_tr_b16 a[246:247], v161 offset:26880
  s_waitcnt lgkmcnt(4)
  v_mfma_f32_32x32x16_bf16 v[32:47], a[232:235], a[32:35], v[32:47]
  v_readfirstlane_b32 s39, v254
  ds_read_b64_tr_b16 a[248:249], v162 offset:24832
  ds_read_b64_tr_b16 a[250:251], v162 offset:26880
  v_mfma_f32_32x32x16_bf16 v[48:63], a[236:239], a[32:35], v[48:63]
  ds_read_b64_tr_b16 a[252:253], v163 offset:24832
  ds_read_b64_tr_b16 a[254:255], v163 offset:26880
  s_waitcnt lgkmcnt(4)
  v_mfma_f32_32x32x16_bf16 v[64:79], a[240:243], a[32:35], v[64:79]
  s_getpc_b64 s[30:31]
  s_cmp_ge_u32 s39, 10
  s_cbranch_scc0 L_spin0
  ds_read_b64_tr_b16 a[224:225], v160 offset:32768
  ds_read_b64_tr_b16 a[226:227], v160 offset:34816
  v_mfma_f32_32x32x16_bf16 v[80:95], a[244:247], a[32:35], v[80:95]
  ds_read_b64_tr_b16 a[228:229], v161 offset:32768
  ds_read_b64_tr_b16 a[230:231], v161 offset:34816
  s_waitcnt lgkmcnt(4)
  v_mfma_f32_32x32x16_bf16 v[96:111], a[248:251], a[32:35], v[96:111]
  ds_read_b64_tr_b16 a[232:233], v162 offset:32768
  ds_read_b64_tr_b16 a[234:235], v162 offset:34816
  v_mfma_f32_32x32x16_bf16 v[112:127], a[252:255], a[32:35], v[112:127]
  ds_add_u32 v251, v255 offset:8
  ds_read_b32 v254, v251 offset:0
  ds_read_b64_tr_b16 a[236:237], v163 offset:32768
  ds_read_b64_tr_b16 a[238:239], v163 offset:34816
  s_waitcnt lgkmcnt(6)
  v_mfma_f32_32x32x16_bf16 v[0:15], a[224:227], a[36:39], v[0:15]
  ds_read_b64_tr_b16 a[240:241], v160 offset:33024
  ds_read_b64_tr_b16 a[242:243], v160 offset:35072
  v_mfma_f32_32x32x16_bf16 v[16:31], a[228:231], a[36:39], v[16:31]
  ds_read_b64_tr_b16 a[244:245], v161 offset:33024
  ds_read_b64_tr_b16 a[246:247], v161 offset:35072
  s_waitcnt lgkmcnt(4)
  v_mfma_f32_32x32x16_bf16 v[32:47], a[232:235], a[36:39], v[32:47]
  v_readfirstlane_b32 s39, v254
  ds_read_b64_tr_b16 a[248:249], v162 offset:33024
  ds_read_b64_tr_b16 a[250:251], v162 offset:35072
  v_mfma_f32_32x32x16_bf16 v[48:63], a[236:239], a[36:39], v[48:63]
  ds_read_b64_tr_b16 a[252:253], v163 offset:33024
  ds_read_b64_tr_b16 a[254:255], v163 offset:35072
  s_waitcnt lgkmcnt(4)
  v_mfma_f32_32x32x16_bf16 v[64:79], a[240:243], a[36:39], v[64:79]
  s_getpc_b64 s[30:31]
  s_cmp_ge_u32 s39, 11
  s_cbranch_scc0 L_spin0
  ds_read_b64_tr_b16 a[224:225], v160 offset:40960
  ds_read_b64_tr_b16 a[226:227], v160 offset:43008
  v_mfma_f32_32x32x16_bf16 v[80:95], a[244:247], a[36:39], v[80:95]
  ds_read_b64_tr_b16 a[228:229], v161 offset:40960
  ds_read_b64_tr_b16 a[230:231], v161 offset:43008
  s_waitcnt lgkmcnt(4)
  v_mfma_f32_32x32x16_bf16 v[96:111], a[248:251], a[36:39], v[96:111]
  ds_read_b64_tr_b16 a[232:233], v162 offset:40960
  ds_read_b64_tr_b16 a[234:235], v162 offset:43008
  v_mfma_f32_32x32x16_bf16 v[112:127], a[252:255], a[36:39], v[112:127]
  ds_add_u32 v251, v255 offset:8
  ds_read_b32 v254, v251 offset:0
  ds_read_b64_tr_b16 a[236:237], v163 offset:40960
  ds_read_b64_tr_b16 a[238:239], v163 offset:43008
  s_waitcnt lgkmcnt(6)
  v_mfma_f32_32x32x16_bf16 v[0:15], a[224:227], a[40:43], v[0:15]
  ds_read_b64_tr_b16 a[240:241], v160 offset:41216
  ds_read_b64_tr_b16 a[242:243], v160 offset:43264
  v_mfma_f32_32x32x16_bf16 v[16:31], a[228:231], a[40:43], v[16:31]
  ds_read_b64_tr_b16 a[244:245], v161 offset:41216
  ds_read_b64_tr_b16 a[246:247], v161 offset:43264
  s_waitcnt lgkmcnt(4)
  v_mfma_f32_32x32x16_bf16 v[32:47], a[232:235], a[40:43], v[32:47]
  v_readfirstlane_b32 s39, v254
  ds_read_b64_tr_b16 a[248:249], v162 offset:41216
  ds_read_b64_tr_b16 a[250:251], v162 offset:43264
  v_mfma_f32_32x32x16_bf16 v[48:63], a[236:239], a[40:43], v[48:63]
  ds_read_b64_tr_b16 a[252:253], v163 offset:41216
  ds_read_b64_tr_b16 a[254:255], v163 offset:43264
  s_waitcnt lgkmcnt(4)
  v_mfma_f32_32x32x16_bf16 v[64:79], a[240:243], a[40:43], v[64:79]
  s_getpc_b64 s[30:31]
  s_cmp_ge_u32 s39, 12
  s_cbranch_scc0 L_spin0
  ds_read_b64_tr_b16 a[224:225], v160 offset:49152
  ds_read_b64_tr_b16 a[226:227], v160 offset:51200
  v_mfma_f32_32x32x16_bf16 v[80:95], a[244:247], a[40:43], v[80:95]
  ds_read_b64_tr_b16 a[228:229], v161 offset:49152
  ds_read_b64_tr_b16 a[230:231], v161 offset:51200
  s_waitcnt lgkmcnt(4)
  v_mfma_f32_32x32x16_bf16 v[96:111], a[248:251], a[40:43], v[96:111]
  ds_read_b64_tr_b16 a[232:233], v162 offset:49152
  ds_read_b64_tr_b16 a[234:235], v162 offset:51200
  v_mfma_f32_32x32x16_bf16 v[112:127], a[252:255], a[40:43], v[112:127]
  ds_add_u32 v251, v255 offset:8
  ds_read_b32 v254, v251 offset:0
  ds_read_b64_tr_b16 a[236:237], v163 offset:49152
  ds_read_b64_tr_b16 a[238:239], v163 offset:51200
  s_waitcnt lgkmcnt(6)
  v_mfma_f32_32x32x16_bf16 v[0:15], a[224:227], a[44:47], v[0:15]
  ds_read_b64_tr_b16 a[240:241], v160 offset:49408
  ds_read_b64_tr_b16 a[242:243], v160 offset:51456
  v_mfma_f32_32x32x16_bf16 v[16:31], a[228:231], a[44:47], v[16:31]
  ds_read_b64_tr_b16 a[244:245], v161 offset:49408
  ds_read_b64_tr_b16 a[246:247], v161 offset:51456
  s_waitcnt lgkmcnt(4)
  v_mfma_f32_32x32x16_bf16 v[32:47], a[232:235], a[44:47], v[32:47]
  v_readfirstlane_b32 s39, v254
  ds_read_b64_tr_b16 a[248:249], v162 offset:49408
  ds_read_b64_tr_b16 a[250:251], v162 offset:51456
  v_mfma_f32_32x32x16_bf16 v[48:63], a[236:239], a[44:47], v[48:63]
  ds_read_b64_tr_b16 a[252:253], v163 offset:49408
  ds_read_b64_tr_b16 a[254:255], v163 offset:51456
  s_waitcnt lgkmcnt(4)
  v_mfma_f32_32x32x16_bf16 v[64:79], a[240:243], a[44:47], v[64:79]
  s_getpc_b64 s[30:31]
  s_cmp_ge_u32 s39, 13
  s_cbranch_scc0 L_spin0
  ds_read_b128 a[48:51], v224 offset:12288
  ds_read_b128 a[52:55], v225 offset:12288
  ds_read_b128 a[56:59], v226 offset:12288
  ds_read_b128 a[60:63], v227 offset:12288
  ds_read_b64_tr_b16 a[224:225], v160 offset:57344
  ds_read_b64_tr_b16 a[226:227], v160 offset:59392
  v_mfma_f32_32x32x16_bf16 v[80:95], a[244:247], a[44:47], v[80:95]
  ds_read_b64_tr_b16 a[228:229], v161 offset:57344
  ds_read_b64_tr_b16 a[230:231], v161 offset:59392
  s_waitcnt lgkmcnt(8)
  v_mfma_f32_32x32x16_bf16 v[96:111], a[248:251], a[44:47], v[96:111]
  ds_read_b64_tr_b16 a[232:233], v162 offset:57344
  ds_read_b64_tr_b16 a[234:235], v162 offset:59392
  v_mfma_f32_32x32x16_bf16 v[112:127], a[252:255], a[44:47], v[112:127]
  ds_add_u32 v251, v255 offset:8
  ds_read_b32 v254, v251 offset:0
  ds_read_b64_tr_b16 a[236:237], v163 offset:57344
  ds_read_b64_tr_b16 a[238:239], v163 offset:59392
  s_waitcnt lgkmcnt(6)
  v_mfma_f32_32x32x16_bf16 v[0:15], a[224:227], a[48:51], v[0:15]
  ds_read_b64_tr_b16 a[240:241], v160 offset:57600
  ds_read_b64_tr_b16 a[242:243], v160 offset:59648
  v_mfma_f32_32x32x16_bf16 v[16:31], a[228:231], a[48:51], v[16:31]
  ds_read_b64_tr_b16 a[244:245], v161 offset:57600
  ds_read_b64_tr_b16 a[246:247], v161 offset:59648
  s_waitcnt lgkmcnt(4)
  v_mfma_f32_32x32x16_bf16 v[32:47], a[232:235], a[48:51], v[32:47]
  v_readfirstlane_b32 s39, v254
  ds_read_b64_tr_b16 a[248:249], v162 offset:57600
  ds_read_b64_tr_b16 a[250:251], v162 offset:59648
  v_mfma_f32_32x32x16_bf16 v[48:63], a[236:239], a[48:51], v[48:63]
  ds_read_b64_tr_b16 a[252:253], v163 offset:57600
  ds_read_b64_tr_b16 a[254:255], v163 offset:59648
  s_waitcnt lgkmcnt(4)
  v_mfma_f32_32x32x16_bf16 v[64:79], a[240:243], a[48:51], v[64:79]
  s_getpc_b64 s[30:31]
  s_cmp_ge_u32 s39, 14
  s_cbranch_scc0 L_spin0
  ds_read_b64_tr_b16 a[224:225], v228 offset:0
  ds_read_b64_tr_b16 a[226:227], v228 offset:2048
  v_mfma_f32_32x32x16_bf16 v[80:95], a[244:247], a[48:51], v[80:95]
  ds_read_b64_tr_b16 a[228:229], v229 offset:0
  ds_read_b64_tr_b16 a[230:231], v229 offset:2048
  s_waitcnt lgkmcnt(4)
  v_mfma_f32_32x32x16_bf16 v[96:111], a[248:251], a[48:51], v[96:111]
  ds_read_b64_tr_b16 a[232:233], v230 offset:0
  ds_read_b64_tr_b16 a[234:235], v230 offset:2048
  v_mfma_f32_32x32x16_bf16 v[112:127], a[252:255], a[48:51], v[112:127]
  ds_add_u32 v251, v255 offset:8
  ds_read_b32 v254, v251 offset:0
  ds_read_b64_tr_b16 a[236:237], v231 offset:0
  ds_read_b64_tr_b16 a[238:239], v231 offset:2048
  s_waitcnt lgkmcnt(6)
  v_mfma_f32_32x32x16_bf16 v[0:15], a[224:227], a[52:55], v[0:15]
  ds_read_b64_tr_b16 a[240:241], v228 offset:256
  ds_read_b64_tr_b16 a[242:243], v228 offset:2304
  v_mfma_f32_32x32x16_bf16 v[16:31], a[228:231], a[52:55], v[16:31]
  ds_read_b64_tr_b16 a[244:245], v229 offset:256
  ds_read_b64_tr_b16 a[246:247], v229 offset:2304
  s_waitcnt lgkmcnt(4)
  v_mfma_f32_32x32x16_bf16 v[32:47], a[232:235], a[52:55], v[32:47]
  v_readfirstlane_b32 s39, v254
  ds_read_b64_tr_b16 a[248:249], v230 offset:256
  ds_read_b64_tr_b16 a[250:251], v230 offset:2304
  v_mfma_f32_32x32x16_bf16 v[48:63], a[236:239], a[52:55], v[48:63]
  ds_read_b64_tr_b16 a[252:253], v231 offset:256
  ds_read_b64_tr_b16 a[254:255], v231 offset:2304
  s_waitcnt lgkmcnt(4)
  v_mfma_f32_32x32x16_bf16 v[64:79], a[240:243], a[52:55], v[64:79]
  s_getpc_b64 s[30:31]
  s_cmp_ge_u32 s39, 15
  s_cbranch_scc0 L_spin0
  ds_read_b64_tr_b16 a[224:225], v228 offset:8192
  ds_read_b64_tr_b16 a[226:227], v228 offset:10240
  v_mfma_f32_32x32x16_bf16 v[80:95], a[244:247], a[52:55], v[80:95]
  ds_read_b64_tr_b16 a[228:229], v229 offset:8192
  ds_read_b64_tr_b16 a[230:231], v229 offset:10240
  s_waitcnt lgkmcnt(4)
  v_mfma_f32_32x32x16_bf16 v[96:111], a[248:251], a[52:55], v[96:111]
  ds_read_b64_tr_b16 a[232:233], v230 offset:8192
  ds_read_b64_tr_b16 a[234:235], v230 offset:10240
  v_mfma_f32_32x32x16_bf16 v[112:127], a[252:255], a[52:55], v[112:127]
  ds_add_u32 v251, v255 offset:8
  ds_read_b32 v254, v251 offset:0
  ds_read_b64_tr_b16 a[236:237], v231 offset:8192
  ds_read_b64_tr_b16 a[238:239], v231 offset:10240
  s_waitcnt lgkmcnt(6)
  v_mfma_f32_32x32x16_bf16 v[0:15], a[224:227], a[56:59], v[0:15]
  ds_read_b64_tr_b16 a[240:241], v228 offset:8448
  ds_read_b64_tr_b16 a[242:243], v228 offset:10496
  v_mfma_f32_32x32x16_bf16 v[16:31], a[228:231], a[56:59], v[16:31]
  ds_read_b64_tr_b16 a[244:245], v229 offset:8448
  ds_read_b64_tr_b16 a[246:247], v229 offset:10496
  s_waitcnt lgkmcnt(4)
  v_mfma_f32_32x32x16_bf16 v[32:47], a[232:235], a[56:59], v[32:47]
  v_readfirstlane_b32 s39, v254
  ds_read_b64_tr_b16 a[248:249], v230 offset:8448
  ds_read_b64_tr_b16 a[250:251], v230 offset:10496
  v_mfma_f32_32x32x16_bf16 v[48:63], a[236:239], a[56:59], v[48:63]
  ds_read_b64_tr_b16 a[252:253], v231 offset:8448
  ds_read_b64_tr_b16 a[254:255], v231 offset:10496
  s_waitcnt lgkmcnt(4)
  v_mfma_f32_32x32x16_bf16 v[64:79], a[240:243], a[56:59], v[64:79]
  s_getpc_b64 s[30:31]
  s_cmp_ge_u32 s39, 16
  s_cbranch_scc0 L_spin0
  ds_read_b64_tr_b16 a[224:225], v228 offset:16384
  ds_read_b64_tr_b16 a[226:227], v228 offset:18432
  v_mfma_f32_32x32x16_bf16 v[80:95], a[244:247], a[56:59], v[80:95]
  ds_read_b64_tr_b16 a[228:229], v229 offset:16384
  ds_read_b64_tr_b16 a[230:231], v229 offset:18432
  s_waitcnt lgkmcnt(4)
  v_mfma_f32_32x32x16_bf16 v[96:111], a[248:251], a[56:59], v[96:111]
  ds_read_b64_tr_b16 a[232:233], v230 offset:16384
  ds_read_b64_tr_b16 a[234:235], v230 offset:18432
  v_mfma_f32_32x32x16_bf16 v[112:127], a[252:255], a[56:59], v[112:127]
  ds_add_u32 v251, v255 offset:8
  ds_read_b32 v254, v251 offset:0
  ds_read_b64_tr_b16 a[236:237], v231 offset:16384
  ds_read_b64_tr_b16 a[238:239], v231 offset:18432
  s_waitcnt lgkmcnt(6)
  v_mfma_f32_32x32x16_bf16 v[0:15], a[224:227], a[60:63], v[0:15]
  ds_read_b64_tr_b16 a[240:241], v228 offset:16640
  ds_read_b64_tr_b16 a[242:243], v228 offset:18688
  v_mfma_f32_32x32x16_bf16 v[16:31], a[228:231], a[60:63], v[16:31]
  ds_read_b64_tr_b16 a[244:245], v229 offset:16640
  ds_read_b64_tr_b16 a[246:247], v229 offset:18688
  s_waitcnt lgkmcnt(4)
  v_mfma_f32_32x32x16_bf16 v[32:47], a[232:235], a[60:63], v[32:47]
  v_readfirstlane_b32 s39, v254
  ds_read_b64_tr_b16 a[248:249], v230 offset:16640
  ds_read_b64_tr_b16 a[250:251], v230 offset:18688
  v_mfma_f32_32x32x16_bf16 v[48:63], a[236:239], a[60:63], v[48:63]
  ds_read_b64_tr_b16 a[252:253], v231 offset:16640
  ds_read_b64_tr_b16 a[254:255], v231 offset:18688
  s_waitcnt lgkmcnt(4)
  v_mfma_f32_32x32x16_bf16 v[64:79], a[240:243], a[60:63], v[64:79]
  s_getpc_b64 s[30:31]
  s_cmp_ge_u32 s39, 17
  s_cbranch_scc0 L_spin0
  ds_read_b128 a[64:67], v224 offset:0
  ds_read_b128 a[68:71], v225 offset:0
  ds_read_b128 a[72:75], v226 offset:0
  ds_read_b128 a[76:79], v227 offset:0
  ds_read_b64_tr_b16 a[224:225], v228 offset:24576
  ds_read_b64_tr_b16 a[226:227], v228 offset:26624
  v_mfma_f32_32x32x16_bf16 v[80:95], a[244:247], a[60:63], v[80:95]
  ds_read_b64_tr_b16 a[228:229], v229 offset:24576
  ds_read_b64_tr_b16 a[230:231], v229 offset:26624
  s_waitcnt lgkmcnt(8)
  v_mfma_f32_32x32x16_bf16 v[96:111], a[248:251], a[60:63], v[96:111]
  ds_read_b64_tr_b16 a[232:233], v230 offset:24576
  ds_read_b64_tr_b16 a[234:235], v230 offset:26624
  v_mfma_f32_32x32x16_bf16 v[112:127], a[252:255], a[60:63], v[112:127]
  ds_add_u32 v251, v255 offset:8
  ds_read_b32 v254, v251 offset:0
  ds_read_b64_tr_b16 a[236:237], v231 offset:24576
  ds_read_b64_tr_b16 a[238:239], v231 offset:26624
  s_waitcnt lgkmcnt(6)
  v_mfma_f32_32x32x16_bf16 v[0:15], a[224:227], a[64:67], v[0:15]
  ds_read_b64_tr_b16 a[240:241], v228 offset:24832
  ds_read_b64_tr_b16 a[242:243], v228 offset:26880
  v_mfma_f32_32x32x16_bf16 v[16:31], a[228:231], a[64:67], v[16:31]
  ds_read_b64_tr_b16 a[244:245], v229 offset:24832
  ds_read_b64_tr_b16 a[246:247], v229 offset:26880
  s_waitcnt lgkmcnt(4)
  v_mfma_f32_32x32x16_bf16 v[32:47], a[232:235], a[64:67], v[32:47]
  v_readfirstlane_b32 s39, v254
  ds_read_b64_tr_b16 a[248:249], v230 offset:24832
  ds_read_b64_tr_b16 a[250:251], v230 offset:26880
  v_mfma_f32_32x32x16_bf16 v[48:63], a[236:239], a[64:67], v[48:63]
  ds_read_b64_tr_b16 a[252:253], v231 offset:24832
  ds_read_b64_tr_b16 a[254:255], v231 offset:26880
  s_waitcnt lgkmcnt(4)
  v_mfma_f32_32x32x16_bf16 v[64:79], a[240:243], a[64:67], v[64:79]
  s_getpc_b64 s[30:31]
  s_cmp_ge_u32 s39, 18
  s_cbranch_scc0 L_spin0
  ds_read_b64_tr_b16 a[224:225], v228 offset:40960
  ds_read_b64_tr_b16 a[226:227], v228 offset:43008
  v_mfma_f32_32x32x16_bf16 v[80:95], a[244:247], a[64:67], v[80:95]
  ds_read_b64_tr_b16 a[228:229], v229 offset:40960
  ds_read_b64_tr_b16 a[230:231], v229 offset:43008
  s_waitcnt lgkmcnt(4)
  v_mfma_f32_32x32x16_bf16 v[96:111], a[248:251], a[64:67], v[96:111]
  ds_read_b64_tr_b16 a[232:233], v230 offset:40960
  ds_read_b64_tr_b16 a[234:235], v230 offset:43008
  v_mfma_f32_32x32x16_bf16 v[112:127], a[252:255], a[64:67], v[112:127]
  ds_add_u32 v251, v255 offset:8
  ds_read_b32 v254, v251 offset:0
  ds_read_b64_tr_b16 a[236:237], v231 offset:40960
  ds_read_b64_tr_b16 a[238:239], v231 offset:43008
  s_waitcnt lgkmcnt(6)
  v_mfma_f32_32x32x16_bf16 v[0:15], a[224:227], a[68:71], v[0:15]
  ds_read_b64_tr_b16 a[240:241], v228 offset:41216
  ds_read_b64_tr_b16 a[242:243], v228 offset:43264
  v_mfma_f32_32x32x16_bf16 v[16:31], a[228:231], a[68:71], v[16:31]
  ds_read_b64_tr_b16 a[244:245], v229 offset:41216
  ds_read_b64_tr_b16 a[246:247], v229 offset:43264
  s_waitcnt lgkmcnt(4)
  v_mfma_f32_32x32x16_bf16 v[32:47], a[232:235], a[68:71], v[32:47]
  v_readfirstlane_b32 s39, v254
  ds_read_b64_tr_b16 a[248:249], v230 offset:41216
  ds_read_b64_tr_b16 a[250:251], v230 offset:43264
  v_mfma_f32_32x32x16_bf16 v[48:63], a[236:239], a[68:71], v[48:63]
  ds_read_b64_tr_b16 a[252:253], v231 offset:41216
  ds_read_b64_tr_b16 a[254:255], v231 offset:43264
  s_waitcnt lgkmcnt(4)
  v_mfma_f32_32x32x16_bf16 v[64:79], a[240:243], a[68:71], v[64:79]
  s_getpc_b64 s[30:31]
  s_cmp_ge_u32 s39, 19
  s_cbranch_scc0 L_spin0
  ds_read_b64_tr_b16 a[224:225], v160 offset:32768
  ds_read_b64_tr_b16 a[226:227], v160 offset:34816
  v_mfma_f32_32x32x16_bf16 v[80:95], a[244:247], a[68:71], v[80:95]
  ds_read_b64_tr_b16 a[228:229], v161 offset:32768
  ds_read_b64_tr_b16 a[230:231], v161 offset:34816
  s_waitcnt lgkmcnt(4)
  v_mfma_f32_32x32x16_bf16 v[96:111], a[248:251], a[68:71], v[96:111]
  ds_read_b64_tr_b16 a[232:233], v162 offset:32768
  ds_read_b64_tr_b16 a[234:235], v162 offset:34816
  v_mfma_f32_32x32x16_bf16 v[112:127], a[252:255], a[68:71], v[112:127]
  ds_add_u32 v251, v255 offset:8
  ds_read_b32 v254, v251 offset:0
  ds_read_b64_tr_b16 a[236:237], v163 offset:32768
  ds_read_b64_tr_b16 a[238:239], v163 offset:34816
  s_waitcnt lgkmcnt(6)
  v_mfma_f32_32x32x16_bf16 v[0:15], a[224:227], a[72:75], v[0:15]
  ds_read_b64_tr_b16 a[240:241], v160 offset:33024
  ds_read_b64_tr_b16 a[242:243], v160 offset:35072
  v_mfma_f32_32x32x16_bf16 v[16:31], a[228:231], a[72:75], v[16:31]
  ds_read_b64_tr_b16 a[244:245], v161 offset:33024
  ds_read_b64_tr_b16 a[246:247], v161 offset:35072
  s_waitcnt lgkmcnt(4)
  v_mfma_f32_32x32x16_bf16 v[32:47], a[232:235], a[72:75], v[32:47]
  v_readfirstlane_b32 s39, v254
  ds_read_b64_tr_b16 a[248:249], v162 offset:33024
  ds_read_b64_tr_b16 a[250:251], v162 offset:35072
  v_mfma_f32_32x32x16_bf16 v[48:63], a[236:239], a[72:75], v[48:63]
  ds_read_b64_tr_b16 a[252:253], v163 offset:33024
  ds_read_b64_tr_b16 a[254:255], v163 offset:35072
  s_waitcnt lgkmcnt(4)
  v_mfma_f32_32x32x16_bf16 v[64:79], a[240:243], a[72:75], v[64:79]
  s_getpc_b64 s[30:31]
  s_cmp_ge_u32 s39, 20
  s_cbranch_scc0 L_spin0
  ds_read_b64_tr_b16 a[224:225], v160 offset:40960
  ds_read_b64_tr_b16 a[226:227], v160 offset:43008
  v_mfma_f32_32x32x16_bf16 v[80:95], a[244:247], a[72:75], v[80:95]
  ds_read_b64_tr_b16 a[228:229], v161 offset:40960
  ds_read_b64_tr_b16 a[230:231], v161 offset:43008
  s_waitcnt lgkmcnt(4)
  v_mfma_f32_32x32x16_bf16 v[96:111], a[248:251], a[72:75], v[96:111]
  ds_read_b64_tr_b16 a[232:233], v162 offset:40960
  ds_read_b64_tr_b16 a[234:235], v162 offset:43008
  v_mfma_f32_32x32x16_bf16 v[112:127], a[252:255], a[72:75], v[112:127]
  ds_add_u32 v251, v255 offset:8
  ds_read_b32 v254, v251 offset:0
  ds_read_b64_tr_b16 a[236:237], v163 offset:40960
  ds_read_b64_tr_b16 a[238:239], v163 offset:43008
  s_waitcnt lgkmcnt(6)
  v_mfma_f32_32x32x16_bf16 v[0:15], a[224:227], a[76:79], v[0:15]
  ds_read_b64_tr_b16 a[240:241], v160 offset:41216
  ds_read_b64_tr_b16 a[242:243], v160 offset:43264
  v_mfma_f32_32x32x16_bf16 v[16:31], a[228:231], a[76:79], v[16:31]
  ds_read_b64_tr_b16 a[244:245], v161 offset:41216
  ds_read_b64_tr_b16 a[246:247], v161 offset:43264
  s_waitcnt lgkmcnt(4)
  v_mfma_f32_32x32x16_bf16 v[32:47], a[232:235], a[76:79], v[32:47]
  v_readfirstlane_b32 s39, v254
  ds_read_b64_tr_b16 a[248:249], v162 offset:41216
  ds_read_b64_tr_b16 a[250:251], v162 offset:43264
  v_mfma_f32_32x32x16_bf16 v[48:63], a[236:239], a[76:79], v[48:63]
  ds_read_b64_tr_b16 a[252:253], v163 offset:41216
  ds_read_b64_tr_b16 a[254:255], v163 offset:43264
  s_waitcnt lgkmcnt(4)
  v_mfma_f32_32x32x16_bf16 v[64:79], a[240:243], a[76:79], v[64:79]
  s_getpc_b64 s[30:31]
  s_cmp_ge_u32 s39, 21
  s_cbranch_scc0 L_spin0
  ds_read_b128 a[80:83], v224 offset:4096
  ds_read_b128 a[84:87], v225 offset:4096
  ds_read_b128 a[88:91], v226 offset:4096
  ds_read_b128 a[92:95], v227 offset:4096
  ds_read_b64_tr_b16 a[224:225], v160 offset:49152
  ds_read_b64_tr_b16 a[226:227], v160 offset:51200
  v_mfma_f32_32x32x16_bf16 v[80:95], a[244:247], a[76:79], v[80:95]
  ds_read_b64_tr_b16 a[228:229], v161 offset:49152
  ds_read_b64_tr_b16 a[230:231], v161 offset:51200
  s_waitcnt lgkmcnt(8)
  v_mfma_f32_32x32x16_bf16 v[96:111], a[248:251], a[76:79], v[96:111]
  ds_read_b64_tr_b16 a[232:233], v162 offset:49152
  ds_read_b64_tr_b16 a[234:235], v162 offset:51200
  v_mfma_f32_32x32x16_bf16 v[112:127], a[252:255], a[76:79], v[112:127]
  ds_add_u32 v251, v255 offset:8
  ds_read_b32 v254, v251 offset:0
  ds_read_b64_tr_b16 a[236:237], v163 offset:49152
  ds_read_b64_tr_b16 a[238:239], v163 offset:51200
  s_waitcnt lgkmcnt(6)
  v_mfma_f32_32x32x16_bf16 v[0:15], a[224:227], a[80:83], v[0:15]
  ds_read_b64_tr_b16 a[240:241], v160 offset:49408
  ds_read_b64_tr_b16 a[242:243], v160 offset:51456
  v_mfma_f32_32x32x16_bf16 v[16:31], a[228:231], a[80:83], v[16:31]
  ds_read_b64_tr_b16 a[244:245], v161 offset:49408
  ds_read_b64_tr_b16 a[246:247], v161 offset:51456
  s_waitcnt lgkmcnt(4)
  v_mfma_f32_32x32x16_bf16 v[32:47], a[232:235], a[80:83], v[32:47]
  v_readfirstlane_b32 s39, v254
  ds_read_b64_tr_b16 a[248:249], v162 offset:49408
  ds_read_b64_tr_b16 a[250:251], v162 offset:51456
  v_mfma_f32_32x32x16_bf16 v[48:63], a[236:239], a[80:83], v[48:63]
  ds_read_b64_tr_b16 a[252:253], v163 offset:49408
  ds_read_b64_tr_b16 a[254:255], v163 offset:51456
  s_waitcnt lgkmcnt(4)
  v_mfma_f32_32x32x16_bf16 v[64:79], a[240:243], a[80:83], v[64:79]
  s_getpc_b64 s[30:31]
  s_cmp_ge_u32 s39, 22
  s_cbranch_scc0 L_spin0
  ds_read_b64_tr_b16 a[224:225], v160 offset:57344
  ds_read_b64_tr_b16 a[226:227], v160 offset:59392
  v_mfma_f32_32x32x16_bf16 v[80:95], a[244:247], a[80:83], v[80:95]
  ds_read_b64_tr_b16 a[228:229], v161 offset:57344
  ds_read_b64_tr_b16 a[230:231], v161 offset:59392
  s_waitcnt lgkmcnt(4)
  v_mfma_f32_32x32x16_bf16 v[96:111], a[248:251], a[80:83], v[96:111]
  ds_read_b64_tr_b16 a[232:233], v162 offset:57344
  ds_read_b64_tr_b16 a[234:235], v162 offset:59392
  v_mfma_f32_32x32x16_bf16 v[112:127], a[252:255], a[80:83], v[112:127]
  ds_add_u32 v251, v255 offset:8
  ds_read_b32 v254, v251 offset:0
  ds_read_b64_tr_b16 a[236:237], v163 offset:57344
  ds_read_b64_tr_b16 a[238:239], v163 offset:59392
  s_waitcnt lgkmcnt(6)
  v_mfma_f32_32x32x16_bf16 v[0:15], a[224:227], a[84:87], v[0:15]
  ds_read_b64_tr_b16 a[240:241], v160 offset:57600
  ds_read_b64_tr_b16 a[242:243], v160 offset:59648
  v_mfma_f32_32x32x16_bf16 v[16:31], a[228:231], a[84:87], v[16:31]
  ds_read_b64_tr_b16 a[244:245], v161 offset:57600
  ds_read_b64_tr_b16 a[246:247], v161 offset:59648
  s_waitcnt lgkmcnt(4)
  v_mfma_f32_32x32x16_bf16 v[32:47], a[232:235], a[84:87], v[32:47]
  v_readfirstlane_b32 s39, v254
  ds_read_b64_tr_b16 a[248:249], v162 offset:57600
  ds_read_b64_tr_b16 a[250:251], v162 offset:59648
  v_mfma_f32_32x32x16_bf16 v[48:63], a[236:239], a[84:87], v[48:63]
  ds_read_b64_tr_b16 a[252:253], v163 offset:57600
  ds_read_b64_tr_b16 a[254:255], v163 offset:59648
  s_waitcnt lgkmcnt(4)
  v_mfma_f32_32x32x16_bf16 v[64:79], a[240:243], a[84:87], v[64:79]
  s_getpc_b64 s[30:31]
  s_cmp_ge_u32 s39, 23
  s_cbranch_scc0 L_spin0
  ds_read_b64_tr_b16 a[224:225], v228 offset:0
  ds_read_b64_tr_b16 a[226:227], v228 offset:2048
  v_mfma_f32_32x32x16_bf16 v[80:95], a[244:247], a[84:87], v[80:95]
  ds_read_b64_tr_b16 a[228:229], v229 offset:0
  ds_read_b64_tr_b16 a[230:231], v229 offset:2048
  s_waitcnt lgkmcnt(4)
  v_mfma_f32_32x32x16_bf16 v[96:111], a[248:251], a[84:87], v[96:111]
  ds_read_b64_tr_b16 a[232:233], v230 offset:0
  ds_read_b64_tr_b16 a[234:235], v230 offset:2048
  v_mfma_f32_32x32x16_bf16 v[112:127], a[252:255], a[84:87], v[112:127]
  ds_add_u32 v251, v255 offset:8
  ds_read_b32 v254, v251 offset:0
  ds_read_b64_tr_b16 a[236:237], v231 offset:0
  ds_read_b64_tr_b16 a[238:239], v231 offset:2048
  s_waitcnt lgkmcnt(6)
  v_mfma_f32_32x32x16_bf16 v[0:15], a[224:227], a[88:91], v[0:15]
  ds_read_b64_tr_b16 a[240:241], v228 offset:256
  ds_read_b64_tr_b16 a[242:243], v228 offset:2304
  v_mfma_f32_32x32x16_bf16 v[16:31], a[228:231], a[88:91], v[16:31]
  ds_read_b64_tr_b16 a[244:245], v229 offset:256
  ds_read_b64_tr_b16 a[246:247], v229 offset:2304
  s_waitcnt lgkmcnt(4)
  v_mfma_f32_32x32x16_bf16 v[32:47], a[232:235], a[88:91], v[32:47]
  v_readfirstlane_b32 s39, v254
  ds_read_b64_tr_b16 a[248:249], v230 offset:256
  ds_read_b64_tr_b16 a[250:251], v230 offset:2304
  v_mfma_f32_32x32x16_bf16 v[48:63], a[236:239], a[88:91], v[48:63]
  ds_read_b64_tr_b16 a[252:253], v231 offset:256
  ds_read_b64_tr_b16 a[254:255], v231 offset:2304
  s_waitcnt lgkmcnt(4)
  v_mfma_f32_32x32x16_bf16 v[64:79], a[240:243], a[88:91], v[64:79]
  s_getpc_b64 s[30:31]
  s_cmp_ge_u32 s39, 24
  s_cbranch_scc0 L_spin0
  ds_read_b64_tr_b16 a[224:225], v228 offset:8192
  ds_read_b64_tr_b16 a[226:227], v228 offset:10240
  v_mfma_f32_32x32x16_bf16 v[80:95], a[244:247], a[88:91], v[80:95]
  ds_read_b64_tr_b16 a[228:229], v229 offset:8192
  ds_read_b64_tr_b16 a[230:231], v229 offset:10240
  s_waitcnt lgkmcnt(4)
  v_mfma_f32_32x32x16_bf16 v[96:111], a[248:251], a[88:91], v[96:111]
  ds_read_b64_tr_b16 a[232:233], v230 offset:8192
  ds_read_b64_tr_b16 a[234:235], v230 offset:10240
  v_mfma_f32_32x32x16_bf16 v[112:127], a[252:255], a[88:91], v[112:127]
  ds_add_u32 v251, v255 offset:8
  ds_read_b32 v254, v251 offset:0
  ds_read_b64_tr_b16 a[236:237], v231 offset:8192
  ds_read_b64_tr_b16 a[238:239], v231 offset:10240
  s_waitcnt lgkmcnt(6)
  v_mfma_f32_32x32x16_bf16 v[0:15], a[224:227], a[92:95], v[0:15]
  ds_read_b64_tr_b16 a[240:241], v228 offset:8448
  ds_read_b64_tr_b16 a[242:243], v228 offset:10496
  v_add_u32 v144, 65536, v232
  v_add_u32 v145, 65536, v233
  v_add_u32 v146, 65536, v234
  v_mfma_f32_32x32x16_bf16 v[16:31], a[228:231], a[92:95], v[16:31]
  ds_read_b64_tr_b16 a[244:245], v229 offset:8448
  ds_read_b64_tr_b16 a[246:247], v229 offset:10496
  v_add_u32 v147, 65536, v235
  v_add_u32 v148, 65536, v236
  v_add_u32 v149, 65536, v237
  s_waitcnt lgkmcnt(4)
  v_mfma_f32_32x32x16_bf16 v[32:47], a[232:235], a[92:95], v[32:47]
  v_readfirstlane_b32 s39, v254
  ds_read_b64_tr_b16 a[248:249], v230 offset:8448
  ds_read_b64_tr_b16 a[250:251], v230 offset:10496
  v_add_u32 v150, 65536, v238
  v_add_u32 v151, 65536, v239
  v_mfma_f32_32x32x16_bf16 v[48:63], a[236:239], a[92:95], v[48:63]
  ds_read_b64_tr_b16 a[252:253], v231 offset:8448
  ds_read_b64_tr_b16 a[254:255], v231 offset:10496
  v_add_u32 v152, 131072, v232
  v_add_u32 v153, 131072, v233
  v_add_u32 v154, 131072, v234
  s_waitcnt lgkmcnt(4)
  v_mfma_f32_32x32x16_bf16 v[64:79], a[240:243], a[92:95], v[64:79]
  s_getpc_b64 s[30:31]
  s_cmp_ge_u32 s39, 25
  s_cbranch_scc0 L_spin0
  ds_read_b128 a[96:99], v224 offset:8192
  ds_read_b128 a[100:103], v225 offset:8192
  ds_read_b128 a[104:107], v226 offset:8192
  ds_read_b128 a[108:111], v227 offset:8192
  ds_read_b64_tr_b16 a[224:225], v228 offset:16384
  ds_read_b64_tr_b16 a[226:227], v228 offset:18432
  v_mfma_f32_32x32x16_bf16 v[80:95], a[244:247], a[92:95], v[80:95]
  ds_read_b64_tr_b16 a[228:229], v229 offset:16384
  ds_read_b64_tr_b16 a[230:231], v229 offset:18432
  v_add_u32 v155, 131072, v235
  v_add_u32 v156, 131072, v236
  v_add_u32 v157, 131072, v237
  s_waitcnt lgkmcnt(8)
  v_mfma_f32_32x32x16_bf16 v[96:111], a[248:251], a[92:95], v[96:111]
  ds_read_b64_tr_b16 a[232:233], v230 offset:16384
  ds_read_b64_tr_b16 a[234:235], v230 offset:18432
  v_add_u32 v158, 131072, v238
  v_add_u32 v159, 131072, v239
  s_cmp_eq_u32 s3, 0
  s_cbranch_scc0 L_nonc
  v_mov_b32 v253, 0
  global_load_dword v253, v253, s[82:83] sc0 sc1
L_nonc:
  v_mfma_f32_32x32x16_bf16 v[112:127], a[252:255], a[92:95], v[112:127]
  ds_add_u32 v251, v255 offset:8
  ds_read_b32 v254, v251 offset:0
  ds_read_b64_tr_b16 a[236:237], v231 offset:16384
  ds_read_b64_tr_b16 a[238:239], v231 offset:18432
  s_waitcnt lgkmcnt(6)
  v_mfma_f32_32x32x16_bf16 v[0:15], a[224:227], a[96:99], v[0:15]
  ds_read_b64_tr_b16 a[240:241], v228 offset:16640
  ds_read_b64_tr_b16 a[242:243], v228 offset:18688
  v_mfma_f32_32x32x16_bf16 v[16:31], a[228:231], a[96:99], v[16:31]
  ds_read_b64_tr_b16 a[244:245], v229 offset:16640
  ds_read_b64_tr_b16 a[246:247], v229 offset:18688
  s_waitcnt lgkmcnt(4)
  v_mfma_f32_32x32x16_bf16 v[32:47], a[232:235], a[96:99], v[32:47]
  v_readfirstlane_b32 s39, v254
  ds_read_b64_tr_b16 a[248:249], v230 offset:16640
  ds_read_b64_tr_b16 a[250:251], v230 offset:18688
  v_mfma_f32_32x32x16_bf16 v[48:63], a[236:239], a[96:99], v[48:63]
  ds_read_b64_tr_b16 a[252:253], v231 offset:16640
  ds_read_b64_tr_b16 a[254:255], v231 offset:18688
  s_waitcnt lgkmcnt(4)
  v_mfma_f32_32x32x16_bf16 v[64:79], a[240:243], a[96:99], v[64:79]
  s_getpc_b64 s[30:31]
  s_cmp_ge_u32 s39, 26
  s_cbranch_scc0 L_spin0
  ds_read_b64_tr_b16 a[224:225], v228 offset:24576
  ds_read_b64_tr_b16 a[226:227], v228 offset:26624
  v_mfma_f32_32x32x16_bf16 v[80:95], a[244:247], a[96:99], v[80:95]
  ds_read_b64_tr_b16 a[228:229], v229 offset:24576
  ds_read_b64_tr_b16 a[230:231], v229 offset:26624
  s_waitcnt lgkmcnt(4)
  v_mfma_f32_32x32x16_bf16 v[96:111], a[248:251], a[96:99], v[96:111]
  ds_read_b64_tr_b16 a[232:233], v230 offset:24576
  ds_read_b64_tr_b16 a[234:235], v230 offset:26624
  v_mfma_f32_32x32x16_bf16 v[112:127], a[252:255], a[96:99], v[112:127]
  ds_add_u32 v251, v255 offset:8
  ds_read_b32 v254, v251 offset:0
  ds_read_b64_tr_b16 a[236:237], v231 offset:24576
  ds_read_b64_tr_b16 a[238:239], v231 offset:26624
  s_waitcnt lgkmcnt(6)
  v_mfma_f32_32x32x16_bf16 v[0:15], a[224:227], a[100:103], v[0:15]
  ds_read_b64_tr_b16 a[240:241], v228 offset:24832
  ds_read_b64_tr_b16 a[242:243], v228 offset:26880
  v_mfma_f32_32x32x16_bf16 v[16:31], a[228:231], a[100:103], v[16:31]
  ds_read_b64_tr_b16 a[244:245], v229 offset:24832
  ds_read_b64_tr_b16 a[246:247], v229 offset:26880
  s_waitcnt lgkmcnt(4)
  v_mfma_f32_32x32x16_bf16 v[32:47], a[232:235], a[100:103], v[32:47]
  v_readfirstlane_b32 s39, v254
  ds_read_b64_tr_b16 a[248:249], v230 offset:24832
  ds_read_b64_tr_b16 a[250:251], v230 offset:26880
  v_mfma_f32_32x32x16_bf16 v[48:63], a[236:239], a[100:103], v[48:63]
  ds_read_b64_tr_b16 a[252:253], v231 offset:24832
  ds_read_b64_tr_b16 a[254:255], v231 offset:26880
  s_waitcnt lgkmcnt(4)
  v_mfma_f32_32x32x16_bf16 v[64:79], a[240:243], a[100:103], v[64:79]
  s_getpc_b64 s[30:31]
  s_cmp_ge_u32 s39, 27
  s_cbranch_scc0 L_spin0
  ds_read_b64_tr_b16 a[224:225], v228 offset:40960
  ds_read_b64_tr_b16 a[226:227], v228 offset:43008
  v_mfma_f32_32x32x16_bf16 v[80:95], a[244:247], a[100:103], v[80:95]
  ds_read_b64_tr_b16 a[228:229], v229 offset:40960
  ds_read_b64_tr_b16 a[230:231], v229 offset:43008
  s_waitcnt lgkmcnt(4)
  v_mfma_f32_32x32x16_bf16 v[96:111], a[248:251], a[100:103], v[96:111]
  ds_read_b64_tr_b16 a[232:233], v230 offset:40960
  ds_read_b64_tr_b16 a[234:235], v230 offset:43008
  v_mfma_f32_32x32x16_bf16 v[112:127], a[252:255], a[100:103], v[112:127]
  ds_add_u32 v251, v255 offset:8
  ds_read_b32 v254, v251 offset:0
  ds_read_b64_tr_b16 a[236:237], v231 offset:40960
  ds_read_b64_tr_b16 a[238:239], v231 offset:43008
  s_waitcnt lgkmcnt(6)
  v_mfma_f32_32x32x16_bf16 v[0:15], a[224:227], a[104:107], v[0:15]
  ds_read_b64_tr_b16 a[240:241], v228 offset:41216
  ds_read_b64_tr_b16 a[242:243], v228 offset:43264
  v_mfma_f32_32x32x16_bf16 v[16:31], a[228:231], a[104:107], v[16:31]
  ds_read_b64_tr_b16 a[244:245], v229 offset:41216
  ds_read_b64_tr_b16 a[246:247], v229 offset:43264
  s_waitcnt lgkmcnt(4)
  v_mfma_f32_32x32x16_bf16 v[32:47], a[232:235], a[104:107], v[32:47]
  v_readfirstlane_b32 s39, v254
  ds_read_b64_tr_b16 a[248:249], v230 offset:41216
  ds_read_b64_tr_b16 a[250:251], v230 offset:43264
  v_mfma_f32_32x32x16_bf16 v[48:63], a[236:239], a[104:107], v[48:63]
  ds_read_b64_tr_b16 a[252:253], v231 offset:41216
  ds_read_b64_tr_b16 a[254:255], v231 offset:43264
  s_waitcnt lgkmcnt(4)
  v_mfma_f32_32x32x16_bf16 v[64:79], a[240:243], a[104:107], v[64:79]
  s_getpc_b64 s[30:31]
  s_cmp_ge_u32 s39, 28
  s_cbranch_scc0 L_spin0
  ds_read_b64_tr_b16 a[224:225], v160 offset:32768
  ds_read_b64_tr_b16 a[226:227], v160 offset:34816
  v_mfma_f32_32x32x16_bf16 v[80:95], a[244:247], a[104:107], v[80:95]
  ds_read_b64_tr_b16 a[228:229], v161 offset:32768
  ds_read_b64_tr_b16 a[230:231], v161 offset:34816
  s_waitcnt lgkmcnt(4)
  v_mfma_f32_32x32x16_bf16 v[96:111], a[248:251], a[104:107], v[96:111]
  ds_read_b64_tr_b16 a[232:233], v162 offset:32768
  ds_read_b64_tr_b16 a[234:235], v162 offset:34816
  v_mfma_f32_32x32x16_bf16 v[112:127], a[252:255], a[104:107], v[112:127]
  ds_add_u32 v251, v255 offset:8
  ds_read_b32 v254, v251 offset:4
  ds_read_b64_tr_b16 a[236:237], v163 offset:32768
  ds_read_b64_tr_b16 a[238:239], v163 offset:34816
  s_waitcnt lgkmcnt(6)
  v_mfma_f32_32x32x16_bf16 v[0:15], a[224:227], a[108:111], v[0:15]
  ds_read_b64_tr_b16 a[240:241], v160 offset:33024
  ds_read_b64_tr_b16 a[242:243], v160 offset:35072
  v_mfma_f32_32x32x16_bf16 v[16:31], a[228:231], a[108:111], v[16:31]
  ds_read_b64_tr_b16 a[244:245], v161 offset:33024
  ds_read_b64_tr_b16 a[246:247], v161 offset:35072
  s_waitcnt lgkmcnt(4)
  v_mfma_f32_32x32x16_bf16 v[32:47], a[232:235], a[108:111], v[32:47]
  v_readfirstlane_b32 s39, v254
  ds_read_b64_tr_b16 a[248:249], v162 offset:33024
  ds_read_b64_tr_b16 a[250:251], v162 offset:35072
  v_mfma_f32_32x32x16_bf16 v[48:63], a[236:239], a[108:111], v[48:63]
  ds_read_b64_tr_b16 a[252:253], v163 offset:33024
  ds_read_b64_tr_b16 a[254:255], v163 offset:35072
  v_mul_f32 v0, s42, v0
  v_mul_f32 v1, s42, v1
  v_cvt_pk_bf16_f32 v0, v0, v1
  s_waitcnt lgkmcnt(4)
  v_mfma_f32_32x32x16_bf16 v[64:79], a[240:243], a[108:111], v[64:79]
  s_getpc_b64 s[30:31]
  s_cmp_ge_u32 s39, 1
  s_cbranch_scc0 L_spin4
  ds_read_b128 a[224:227], v232 offset:49152
  v_mul_f32 v2, s42, v2
  v_mfma_f32_32x32x16_bf16 v[80:95], a[244:247], a[108:111], v[80:95]
  ds_read_b128 a[228:231], v233 offset:49152
  v_mul_f32 v3, s42, v3
  v_cvt_pk_bf16_f32 v2, v2, v3
  v_mul_f32 v4, s42, v4
  v_mul_f32 v5, s42, v5
  s_waitcnt lgkmcnt(2)
  v_mfma_f32_32x32x16_bf16 v[96:111], a[248:251], a[108:111], v[96:111]
  ds_read_b128 a[232:235], v234 offset:49152
  v_cvt_pk_bf16_f32 v4, v4, v5
  v_mul_f32 v6, s42, v6
  v_mul_f32 v7, s42, v7
  v_cvt_pk_bf16_f32 v6, v6, v7
  v_mfma_f32_32x32x16_bf16 v[112:127], a[252:255], a[108:111], v[112:127]
  ds_add_u32 v251, v255 offset:8
  ds_read_b128 a[236:239], v235 offset:49152
  v_accvgpr_write_b32 a128, v0
  v_accvgpr_write_b32 a129, v2
  v_accvgpr_write_b32 a130, v4
  v_accvgpr_write_b32 a131, v6
  s_waitcnt lgkmcnt(3)
  s_nop 0
  v_mfma_f32_32x32x16_bf16 v[192:207], a[224:227], a[128:131], 0
  ds_read_b128 a[240:243], v236 offset:49152
  v_mul_f32 v8, s42, v8
  v_mul_f32 v9, s42, v9
  v_cvt_pk_bf16_f32 v8, v8, v9
  v_mul_f32 v10, s42, v10
  v_mul_f32 v11, s42, v11
  v_cvt_pk_bf16_f32 v10, v10, v11
  v_mul_f32 v12, s42, v12
  v_mul_f32 v13, s42, v13
  v_cvt_pk_bf16_f32 v12, v12, v13
  v_mul_f32 v14, s42, v14
  v_mul_f32 v15, s42, v15
  v_cvt_pk_bf16_f32 v14, v14, v15
  v_accvgpr_write_b32 a132, v8
  v_accvgpr_write_b32 a133, v10
  v_accvgpr_write_b32 a134, v12
  v_accvgpr_write_b32 a135, v14
  s_nop 1
  v_mfma_f32_32x32x16_bf16 v[192:207], a[228:231], a[132:135], v[192:207]
  ds_read_b128 a[244:247], v237 offset:49152
  v_mul_f32 v16, s42, v16
  v_mul_f32 v17, s42, v17
  v_cvt_pk_bf16_f32 v16, v16, v17
  v_mul_f32 v18, s42, v18
  v_mul_f32 v19, s42, v19
  v_cvt_pk_bf16_f32 v18, v18, v19
  v_mul_f32 v20, s42, v20
  v_mul_f32 v21, s42, v21
  v_cvt_pk_bf16_f32 v20, v20, v21
  v_mul_f32 v22, s42, v22
  v_mul_f32 v23, s42, v23
  v_cvt_pk_bf16_f32 v22, v22, v23
  v_accvgpr_write_b32 a136, v16
  v_accvgpr_write_b32 a137, v18
  v_accvgpr_write_b32 a138, v20
  v_accvgpr_write_b32 a139, v22
  s_waitcnt lgkmcnt(2)
  s_nop 0
  v_mfma_f32_32x32x16_bf16 v[192:207], a[232:235], a[136:139], v[192:207]
  ds_read_b128 a[248:251], v238 offset:49152
  v_mul_f32 v24, s42, v24
  v_mul_f32 v25, s42, v25
  v_cvt_pk_bf16_f32 v24, v24, v25
  v_mul_f32 v26, s42, v26
  v_mul_f32 v27, s42, v27
  v_cvt_pk_bf16_f32 v26, v26, v27
  v_mul_f32 v28, s42, v28
  v_mul_f32 v29, s42, v29
  v_cvt_pk_bf16_f32 v28, v28, v29
  v_mul_f32 v30, s42, v30
  v_mul_f32 v31, s42, v31
  v_cvt_pk_bf16_f32 v30, v30, v31
  v_accvgpr_write_b32 a140, v24
  v_accvgpr_write_b32 a141, v26
  v_accvgpr_write_b32 a142, v28
  v_accvgpr_write_b32 a143, v30
  s_nop 1
  v_mfma_f32_32x32x16_bf16 v[192:207], a[236:239], a[140:143], v[192:207]
  ds_read_b128 a[252:255], v239 offset:49152
  v_mul_f32 v32, s42, v32
  v_mul_f32 v33, s42, v33
  v_cvt_pk_bf16_f32 v32, v32, v33
  v_mul_f32 v34, s42, v34
  v_mul_f32 v35, s42, v35
  v_cvt_pk_bf16_f32 v34, v34, v35
  v_mul_f32 v36, s42, v36
  v_mul_f32 v37, s42, v37
  v_cvt_pk_bf16_f32 v36, v36, v37
  v_mul_f32 v38, s42, v38
  v_mul_f32 v39, s42, v39
  v_cvt_pk_bf16_f32 v38, v38, v39
  v_accvgpr_write_b32 a144, v32
  v_accvgpr_write_b32 a145, v34
  v_accvgpr_write_b32 a146, v36
  v_accvgpr_write_b32 a147, v38
  s_waitcnt lgkmcnt(2)
  s_nop 0
  v_mfma_f32_32x32x16_bf16 v[192:207], a[240:243], a[144:147], v[192:207]
  ds_read_b128 a[224:227], v232 offset:49408
  v_mul_f32 v40, s42, v40
  v_mul_f32 v41, s42, v41
  v_cvt_pk_bf16_f32 v40, v40, v41
  v_mul_f32 v42, s42, v42
  v_mul_f32 v43, s42, v43
  v_cvt_pk_bf16_f32 v42, v42, v43
  v_mul_f32 v44, s42, v44
  v_mul_f32 v45, s42, v45
  v_cvt_pk_bf16_f32 v44, v44, v45
  v_mul_f32 v46, s42, v46
  v_mul_f32 v47, s42, v47
  v_cvt_pk_bf16_f32 v46, v46, v47
  v_accvgpr_write_b32 a148, v40
  v_accvgpr_write_b32 a149, v42
  v_accvgpr_write_b32 a150, v44
  v_accvgpr_write_b32 a151, v46
  s_nop 1
  v_mfma_f32_32x32x16_bf16 v[192:207], a[244:247], a[148:151], v[192:207]
  ds_read_b128 a[228:231], v233 offset:49408
  v_mul_f32 v48, s42, v48
  v_mul_f32 v49, s42, v49
  v_cvt_pk_bf16_f32 v48, v48, v49
  v_mul_f32 v50, s42, v50
  v_mul_f32 v51, s42, v51
  v_cvt_pk_bf16_f32 v50, v50, v51
  v_mul_f32 v52, s42, v52
  v_mul_f32 v53, s42, v53
  v_cvt_pk_bf16_f32 v52, v52, v53
  v_mul_f32 v54, s42, v54
  v_mul_f32 v55, s42, v55
  v_cvt_pk_bf16_f32 v54, v54, v55
  v_accvgpr_write_b32 a152, v48
  v_accvgpr_write_b32 a153, v50
  v_accvgpr_write_b32 a154, v52
  v_accvgpr_write_b32 a155, v54
  s_waitcnt lgkmcnt(2)
  s_nop 0
  v_mfma_f32_32x32x16_bf16 v[192:207], a[248:251], a[152:155], v[192:207]
  ds_read_b128 a[232:235], v234 offset:49408
  v_mul_f32 v56, s42, v56
  v_mul_f32 v57, s42, v57
  v_cvt_pk_bf16_f32 v56, v56, v57
  v_mul_f32 v58, s42, v58
  v_mul_f32 v59, s42, v59
  v_cvt_pk_bf16_f32 v58, v58, v59
  v_mul_f32 v60, s42, v60
  v_mul_f32 v61, s42, v61
  v_cvt_pk_bf16_f32 v60, v60, v61
  v_mul_f32 v62, s42, v62
  v_mul_f32 v63, s42, v63
  v_cvt_pk_bf16_f32 v62, v62, v63
  v_accvgpr_write_b32 a156, v56
  v_accvgpr_write_b32 a157, v58
  v_accvgpr_write_b32 a158, v60
  v_accvgpr_write_b32 a159, v62
  s_nop 1
  v_mfma_f32_32x32x16_bf16 v[192:207], a[252:255], a[156:159], v[192:207]
  ds_read_b32 v254, v251 offset:4
  ds_read_b128 a[236:239], v235 offset:49408
  v_mul_f32 v64, s42, v64
  v_mul_f32 v65, s42, v65
  v_cvt_pk_bf16_f32 v64, v64, v65
  v_mul_f32 v66, s42, v66
  v_mul_f32 v67, s42, v67
  v_cvt_pk_bf16_f32 v66, v66, v67
  v_mul_f32 v68, s42, v68
  v_mul_f32 v69, s42, v69
  v_cvt_pk_bf16_f32 v68, v68, v69
  v_mul_f32 v70, s42, v70
  v_mul_f32 v71, s42, v71
  v_cvt_pk_bf16_f32 v70, v70, v71
  v_accvgpr_write_b32 a160, v64
  v_accvgpr_write_b32 a161, v66
  v_accvgpr_write_b32 a162, v68
  v_accvgpr_write_b32 a163, v70
  s_waitcnt lgkmcnt(3)
  s_nop 0
  v_mfma_f32_32x32x16_bf16 v[192:207], a[224:227], a[160:163], v[192:207]
  ds_read_b128 a[240:243], v236 offset:49408
  v_mul_f32 v72, s42, v72
  v_mul_f32 v73, s42, v73
  v_cvt_pk_bf16_f32 v72, v72, v73
  v_mul_f32 v74, s42, v74
  v_mul_f32 v75, s42, v75
  v_cvt_pk_bf16_f32 v74, v74, v75
  v_mul_f32 v76, s42, v76
  v_mul_f32 v77, s42, v77
  v_cvt_pk_bf16_f32 v76, v76, v77
  v_mul_f32 v78, s42, v78
  v_mul_f32 v79, s42, v79
  v_cvt_pk_bf16_f32 v78, v78, v79
  v_accvgpr_write_b32 a164, v72
  v_accvgpr_write_b32 a165, v74
  v_accvgpr_write_b32 a166, v76
  v_accvgpr_write_b32 a167, v78
  s_nop 1
  v_mfma_f32_32x32x16_bf16 v[192:207], a[228:231], a[164:167], v[192:207]
  ds_read_b128 a[244:247], v237 offset:49408
  v_mul_f32 v80, s42, v80
  v_mul_f32 v81, s42, v81
  v_cvt_pk_bf16_f32 v80, v80, v81
  v_mul_f32 v82, s42, v82
  v_mul_f32 v83, s42, v83
  v_cvt_pk_bf16_f32 v82, v82, v83
  v_mul_f32 v84, s42, v84
  v_mul_f32 v85, s42, v85
  v_cvt_pk_bf16_f32 v84, v84, v85
  v_mul_f32 v86, s42, v86
  v_mul_f32 v87, s42, v87
  v_cvt_pk_bf16_f32 v86, v86, v87
  v_accvgpr_write_b32 a168, v80
  v_accvgpr_write_b32 a169, v82
  v_accvgpr_write_b32 a170, v84
  v_accvgpr_write_b32 a171, v86
  s_waitcnt lgkmcnt(2)
  s_nop 0
  v_mfma_f32_32x32x16_bf16 v[192:207], a[232:235], a[168:171], v[192:207]
  v_readfirstlane_b32 s39, v254
  ds_read_b128 a[248:251], v238 offset:49408
  v_mul_f32 v88, s42, v88
  v_mul_f32 v89, s42, v89
  v_cvt_pk_bf16_f32 v88, v88, v89
  v_mul_f32 v90, s42, v90
  v_mul_f32 v91, s42, v91
  v_cvt_pk_bf16_f32 v90, v90, v91
  v_mul_f32 v92, s42, v92
  v_mul_f32 v93, s42, v93
  v_cvt_pk_bf16_f32 v92, v92, v93
  v_mul_f32 v94, s42, v94
  v_mul_f32 v95, s42, v95
  v_cvt_pk_bf16_f32 v94, v94, v95
  v_accvgpr_write_b32 a172, v88
  v_accvgpr_write_b32 a173, v90
  v_accvgpr_write_b32 a174, v92
  v_accvgpr_write_b32 a175, v94
  s_nop 1
  v_mfma_f32_32x32x16_bf16 v[192:207], a[236:239], a[172:175], v[192:207]
  ds_read_b128 a[252:255], v239 offset:49408
  v_mul_f32 v96, s42, v96
  v_mul_f32 v97, s42, v97
  v_cvt_pk_bf16_f32 v96, v96, v97
  v_mul_f32 v98, s42, v98
  v_mul_f32 v99, s42, v99
  v_cvt_pk_bf16_f32 v98, v98, v99
  v_mul_f32 v100, s42, v100
  v_mul_f32 v101, s42, v101
  v_cvt_pk_bf16_f32 v100, v100, v101
  v_mul_f32 v102, s42, v102
  v_mul_f32 v103, s42, v103
  v_cvt_pk_bf16_f32 v102, v102, v103
  v_accvgpr_write_b32 a176, v96
  v_accvgpr_write_b32 a177, v98
  v_accvgpr_write_b32 a178, v100
  v_accvgpr_write_b32 a179, v102
  s_waitcnt lgkmcnt(2)
  s_nop 0
  v_mfma_f32_32x32x16_bf16 v[192:207], a[240:243], a[176:179], v[192:207]
  s_getpc_b64 s[30:31]
  s_cmp_ge_u32 s39, 2
  s_cbranch_scc0 L_spin4
  ds_read_b128 a[224:227], v144 offset:0
  v_mul_f32 v104, s42, v104
  v_mul_f32 v105, s42, v105
  v_cvt_pk_bf16_f32 v104, v104, v105
  v_mul_f32 v106, s42, v106
  v_mul_f32 v107, s42, v107
  v_cvt_pk_bf16_f32 v106, v106, v107
  v_mul_f32 v108, s42, v108
  v_mul_f32 v109, s42, v109
  v_cvt_pk_bf16_f32 v108, v108, v109
  v_mul_f32 v110, s42, v110
  v_mul_f32 v111, s42, v111
  v_cvt_pk_bf16_f32 v110, v110, v111
  v_accvgpr_write_b32 a180, v104
  v_accvgpr_write_b32 a181, v106
  v_accvgpr_write_b32 a182, v108
  v_accvgpr_write_b32 a183, v110
  s_nop 1
  v_mfma_f32_32x32x16_bf16 v[192:207], a[244:247], a[180:183], v[192:207]
  ds_read_b128 a[228:231], v145 offset:0
  v_mul_f32 v112, s42, v112
  v_mul_f32 v113, s42, v113
  v_cvt_pk_bf16_f32 v112, v112, v113
  v_mul_f32 v114, s42, v114
  v_mul_f32 v115, s42, v115
  v_cvt_pk_bf16_f32 v114, v114, v115
  v_mul_f32 v116, s42, v116
  v_mul_f32 v117, s42, v117
  v_cvt_pk_bf16_f32 v116, v116, v117
  v_mul_f32 v118, s42, v118
  v_mul_f32 v119, s42, v119
  v_cvt_pk_bf16_f32 v118, v118, v119
  v_accvgpr_write_b32 a184, v112
  v_accvgpr_write_b32 a185, v114
  v_accvgpr_write_b32 a186, v116
  v_accvgpr_write_b32 a187, v118
  s_waitcnt lgkmcnt(2)
  s_nop 0
  v_mfma_f32_32x32x16_bf16 v[192:207], a[248:251], a[184:187], v[192:207]
  ds_read_b128 a[232:235], v146 offset:0
  v_mul_f32 v120, s42, v120
  v_mul_f32 v121, s42, v121
  v_cvt_pk_bf16_f32 v120, v120, v121
  v_mul_f32 v122, s42, v122
  v_mul_f32 v123, s42, v123
  v_cvt_pk_bf16_f32 v122, v122, v123
  v_mul_f32 v124, s42, v124
  v_mul_f32 v125, s42, v125
  v_cvt_pk_bf16_f32 v124, v124, v125
  v_mul_f32 v126, s42, v126
  v_mul_f32 v127, s42, v127
  v_cvt_pk_bf16_f32 v126, v126, v127
  v_accvgpr_write_b32 a188, v120
  v_accvgpr_write_b32 a189, v122
  v_accvgpr_write_b32 a190, v124
  v_accvgpr_write_b32 a191, v126
  s_nop 1
  v_mfma_f32_32x32x16_bf16 v[192:207], a[252:255], a[188:191], v[192:207]
  ds_add_u32 v251, v255 offset:8
  ds_read_b128 a[236:239], v147 offset:0
  s_waitcnt lgkmcnt(3)
  v_mfma_f32_32x32x16_bf16 v[208:223], a[224:227], a[128:131], 0
  ds_read_b128 a[240:243], v148 offset:0
  v_mfma_f32_32x32x16_bf16 v[208:223], a[228:231], a[132:135], v[208:223]
  ds_read_b128 a[244:247], v149 offset:0
  s_waitcnt lgkmcnt(2)
  v_mfma_f32_32x32x16_bf16 v[208:223], a[232:235], a[136:139], v[208:223]
  ds_read_b128 a[248:251], v150 offset:0
  v_mfma_f32_32x32x16_bf16 v[208:223], a[236:239], a[140:143], v[208:223]
  ds_read_b128 a[252:255], v151 offset:0
  v_max3_f32 v249, v192, v193, v194
  v_max3_f32 v249, v249, v195, v196
  v_max3_f32 v249, v249, v197, v198
  v_max3_f32 v249, v249, v199, v200
  v_max3_f32 v249, v249, v201, v202
  s_waitcnt lgkmcnt(2)
  v_mfma_f32_32x32x16_bf16 v[208:223], a[240:243], a[144:147], v[208:223]
  ds_read_b128 a[224:227], v144 offset:256
  v_max3_f32 v249, v249, v203, v204
  v_max3_f32 v249, v249, v205, v206
  v_max_f32 v249, v249, v207
  v_mov_b32 v250, v249
  v_mfma_f32_32x32x16_bf16 v[208:223], a[244:247], a[148:151], v[208:223]
  ds_read_b128 a[228:231], v145 offset:256
  v_permlane32_swap_b32 v249, v250
  v_max_f32 v248, v249, v250
  v_mov_b32 v246, 0
  v_sub_f32 v192, v192, v248
  v_sub_f32 v193, v193, v248
  s_waitcnt lgkmcnt(2)
  v_mfma_f32_32x32x16_bf16 v[208:223], a[248:251], a[152:155], v[208:223]
  ds_read_b128 a[232:235], v146 offset:256
  v_sub_f32 v194, v194, v248
  v_sub_f32 v195, v195, v248
  v_sub_f32 v196, v196, v248
  v_sub_f32 v197, v197, v248
  v_sub_f32 v198, v198, v248
  v_mfma_f32_32x32x16_bf16 v[208:223], a[252:255], a[156:159], v[208:223]
  ds_read_b32 v254, v251 offset:4
  ds_read_b128 a[236:239], v147 offset:256
  v_sub_f32 v199, v199, v248
  v_sub_f32 v200, v200, v248
  v_sub_f32 v201, v201, v248
  v_sub_f32 v202, v202, v248
  s_waitcnt lgkmcnt(3)
  v_mfma_f32_32x32x16_bf16 v[208:223], a[224:227], a[160:163], v[208:223]
  ds_read_b128 a[240:243], v148 offset:256
  v_sub_f32 v203, v203, v248
  v_sub_f32 v204, v204, v248
  v_sub_f32 v205, v205, v248
  v_sub_f32 v206, v206, v248
  v_sub_f32 v207, v207, v248
  v_mfma_f32_32x32x16_bf16 v[208:223], a[228:231], a[164:167], v[208:223]
  ds_read_b128 a[244:247], v149 offset:256
  v_sub_f32 v128, 0, v248
  v_sub_f32 v129, 0, v248
  v_sub_f32 v130, 0, v248
  v_sub_f32 v131, 0, v248
  v_sub_f32 v132, 0, v248
  s_waitcnt lgkmcnt(2)
  v_mfma_f32_32x32x16_bf16 v[208:223], a[232:235], a[168:171], v[208:223]
  v_readfirstlane_b32 s39, v254
  ds_read_b128 a[248:251], v150 offset:256
  v_sub_f32 v133, 0, v248
  v_sub_f32 v134, 0, v248
  v_sub_f32 v135, 0, v248
  v_sub_f32 v136, 0, v248
  v_mfma_f32_32x32x16_bf16 v[208:223], a[236:239], a[172:175], v[208:223]
  ds_read_b128 a[252:255], v151 offset:256
  v_sub_f32 v137, 0, v248
  v_sub_f32 v138, 0, v248
  v_sub_f32 v139, 0, v248
  v_sub_f32 v140, 0, v248
  v_sub_f32 v141, 0, v248
  s_waitcnt lgkmcnt(2)
  v_mfma_f32_32x32x16_bf16 v[208:223], a[240:243], a[176:179], v[208:223]
  s_getpc_b64 s[30:31]
  s_cmp_ge_u32 s39, 3
  s_cbranch_scc0 L_spin4
  ds_read_b128 a[224:227], v232 offset:0
  v_sub_f32 v142, 0, v248
  v_sub_f32 v143, 0, v248
  v_mfma_f32_32x32x16_bf16 v[208:223], a[244:247], a[180:183], v[208:223]
  ds_read_b128 a[228:231], v233 offset:0
  v_exp_f32 v192, v192
  v_exp_f32 v193, v193
  s_waitcnt lgkmcnt(2)
  v_mfma_f32_32x32x16_bf16 v[208:223], a[248:251], a[184:187], v[208:223]
  ds_read_b128 a[232:235], v234 offset:0
  v_exp_f32 v194, v194
  v_exp_f32 v195, v195
  v_cvt_pk_bf16_f32 v0, v192, v193
  v_mfma_f32_32x32x16_bf16 v[208:223], a[252:255], a[188:191], v[208:223]
  ds_add_u32 v251, v255 offset:8
  ds_read_b128 a[236:239], v235 offset:0
  v_cvt_pk_bf16_f32 v1, v194, v195
  v_dot2c_f32_bf16 v246, s45, v0
  v_dot2c_f32_bf16 v246, s45, v1
  v_exp_f32 v196, v196
  v_exp_f32 v197, v197
  v_exp_f32 v198, v198
  v_exp_f32 v199, v199
  v_cvt_pk_bf16_f32 v2, v196, v197
  v_cvt_pk_bf16_f32 v3, v198, v199
  v_dot2c_f32_bf16 v246, s45, v2
  v_dot2c_f32_bf16 v246, s45, v3
  v_exp_f32 v200, v200
  v_exp_f32 v201, v201
  v_exp_f32 v202, v202
  v_exp_f32 v203, v203
  v_cvt_pk_bf16_f32 v4, v200, v201
  v_cvt_pk_bf16_f32 v5, v202, v203
  v_dot2c_f32_bf16 v246, s45, v4
  v_dot2c_f32_bf16 v246, s45, v5
  v_exp_f32 v204, v204
  v_exp_f32 v205, v205
  v_exp_f32 v206, v206
  v_exp_f32 v207, v207
  v_cvt_pk_bf16_f32 v6, v204, v205
  v_cvt_pk_bf16_f32 v7, v206, v207
  s_waitcnt lgkmcnt(3)
  v_mfma_f32_32x32x16_bf16 v[192:207], a[224:227], a[128:131], v[128:143]
  ds_read_b128 a[240:243], v236 offset:0
  v_dot2c_f32_bf16 v246, s45, v6
  v_dot2c_f32_bf16 v246, s45, v7
  v_mfma_f32_32x32x16_bf16 v[192:207], a[228:231], a[132:135], v[192:207]
  ds_read_b128 a[244:247], v237 offset:0
  v_sub_f32 v208, v208, v248
  v_sub_f32 v209, v209, v248
  v_sub_f32 v210, v210, v248
  v_sub_f32 v211, v211, v248
  v_sub_f32 v212, v212, v248
  s_waitcnt lgkmcnt(2)
  v_mfma_f32_32x32x16_bf16 v[192:207], a[232:235], a[136:139], v[192:207]
  ds_read_b128 a[248:251], v238 offset:0
  v_sub_f32 v213, v213, v248
  v_sub_f32 v214, v214, v248
  v_sub_f32 v215, v215, v248
  v_sub_f32 v216, v216, v248
  v_sub_f32 v217, v217, v248
  v_mfma_f32_32x32x16_bf16 v[192:207], a[236:239], a[140:143], v[192:207]
  ds_read_b128 a[252:255], v239 offset:0
  v_sub_f32 v218, v218, v248
  v_sub_f32 v219, v219, v248
  v_sub_f32 v220, v220, v248
  v_sub_f32 v221, v221, v248
  v_sub_f32 v222, v222, v248
  s_waitcnt lgkmcnt(2)
  v_mfma_f32_32x32x16_bf16 v[192:207], a[240:243], a[144:147], v[192:207]
  ds_read_b128 a[224:227], v232 offset:256
  v_sub_f32 v223, v223, v248
  v_max3_f32 v249, v208, v209, v210
  v_max3_f32 v249, v249, v211, v212
  v_max3_f32 v249, v249, v213, v214
  v_max3_f32 v249, v249, v215, v216
  v_mfma_f32_32x32x16_bf16 v[192:207], a[244:247], a[148:151], v[192:207]
  ds_read_b128 a[228:231], v233 offset:256
  v_max3_f32 v249, v249, v217, v218
  v_max3_f32 v249, v249, v219, v220
  v_max3_f32 v249, v249, v221, v222
  v_max_f32 v249, v249, v223
  v_cmp_lt_f32 vcc, 0x41000000, v249
  s_waitcnt lgkmcnt(2)
  v_mfma_f32_32x32x16_bf16 v[192:207], a[248:251], a[152:155], v[192:207]
  ds_read_b128 a[232:235], v234 offset:256
  s_cbranch_vccnz L_rare_1
L_ret_1:
  v_exp_f32 v208, v208
  v_exp_f32 v209, v209
  v_mfma_f32_32x32x16_bf16 v[192:207], a[252:255], a[156:159], v[192:207]
  ds_read_b32 v254, v251 offset:4
  ds_read_b128 a[236:239], v235 offset:256
  v_exp_f32 v210, v210
  v_exp_f32 v211, v211
  s_waitcnt lgkmcnt(3)
  v_mfma_f32_32x32x16_bf16 v[192:207], a[224:227], a[160:163], v[192:207]
  ds_read_b128 a[240:243], v236 offset:256
  v_cvt_pk_bf16_f32 v8, v208, v209
  v_cvt_pk_bf16_f32 v9, v210, v211
  v_dot2c_f32_bf16 v246, s45, v8
  v_dot2c_f32_bf16 v246, s45, v9
  v_mfma_f32_32x32x16_bf16 v[192:207], a[228:231], a[164:167], v[192:207]
  ds_read_b128 a[244:247], v237 offset:256
  v_exp_f32 v212, v212
  v_exp_f32 v213, v213
  s_waitcnt lgkmcnt(2)
  v_mfma_f32_32x32x16_bf16 v[192:207], a[232:235], a[168:171], v[192:207]
  v_readfirstlane_b32 s39, v254
  ds_read_b128 a[248:251], v238 offset:256
  v_exp_f32 v214, v214
  v_exp_f32 v215, v215
  v_mfma_f32_32x32x16_bf16 v[192:207], a[236:239], a[172:175], v[192:207]
  ds_read_b128 a[252:255], v239 offset:256
  v_cvt_pk_bf16_f32 v10, v212, v213
  v_cvt_pk_bf16_f32 v11, v214, v215
  v_dot2c_f32_bf16 v246, s45, v10
  v_dot2c_f32_bf16 v246, s45, v11
  s_waitcnt lgkmcnt(2)
  v_mfma_f32_32x32x16_bf16 v[192:207], a[240:243], a[176:179], v[192:207]
  s_getpc_b64 s[30:31]
  s_cmp_ge_u32 s39, 4
  s_cbranch_scc0 L_spin4
  ds_read_b128 a[224:227], v232 offset:16384
  v_exp_f32 v216, v216
  v_mfma_f32_32x32x16_bf16 v[192:207], a[244:247], a[180:183], v[192:207]
  ds_read_b128 a[228:231], v233 offset:16384
  v_exp_f32 v217, v217
  v_exp_f32 v218, v218
  s_waitcnt lgkmcnt(2)
  v_mfma_f32_32x32x16_bf16 v[192:207], a[248:251], a[184:187], v[192:207]
  ds_read_b128 a[232:235], v234 offset:16384
  v_exp_f32 v219, v219
  v_cvt_pk_bf16_f32 v12, v216, v217
  v_cvt_pk_bf16_f32 v13, v218, v219
  v_dot2c_f32_bf16 v246, s45, v12
  v_mfma_f32_32x32x16_bf16 v[192:207], a[252:255], a[188:191], v[192:207]
  ds_add_u32 v251, v255 offset:8
  ds_read_b128 a[236:239], v235 offset:16384
  v_dot2c_f32_bf16 v246, s45, v13
  v_exp_f32 v220, v220
  v_exp_f32 v221, v221
  v_exp_f32 v222, v222
  v_exp_f32 v223, v223
  v_cvt_pk_bf16_f32 v14, v220, v221
  v_cvt_pk_bf16_f32 v15, v222, v223
  s_waitcnt lgkmcnt(3)
  v_mfma_f32_32x32x16_bf16 v[208:223], a[224:227], a[128:131], v[128:143]
  ds_read_b128 a[240:243], v236 offset:16384
  v_dot2c_f32_bf16 v246, s45, v14
  v_dot2c_f32_bf16 v246, s45, v15
  v_mfma_f32_32x32x16_bf16 v[208:223], a[228:231], a[132:135], v[208:223]
  ds_read_b128 a[244:247], v237 offset:16384
  v_max3_f32 v249, v192, v193, v194
  v_max3_f32 v249, v249, v195, v196
  v_max3_f32 v249, v249, v197, v198
  v_max3_f32 v249, v249, v199, v200
  v_max3_f32 v249, v249, v201, v202
  s_waitcnt lgkmcnt(2)
  v_mfma_f32_32x32x16_bf16 v[208:223], a[232:235], a[136:139], v[208:223]
  ds_read_b128 a[248:251], v238 offset:16384
  v_max3_f32 v249, v249, v203, v204
  v_max3_f32 v249, v249, v205, v206
  v_max_f32 v249, v249, v207
  v_cmp_lt_f32 vcc, 0x41000000, v249
  s_cbranch_vccnz L_rare_2
L_ret_2:
  v_mfma_f32_32x32x16_bf16 v[208:223], a[236:239], a[140:143], v[208:223]
  ds_read_b128 a[252:255], v239 offset:16384
  v_exp_f32 v192, v192
  v_exp_f32 v193, v193
  s_waitcnt lgkmcnt(2)
  v_mfma_f32_32x32x16_bf16 v[208:223], a[240:243], a[144:147], v[208:223]
  ds_read_b128 a[224:227], v232 offset:16640
  v_exp_f32 v194, v194
  v_exp_f32 v195, v195
  v_cvt_pk_bf16_f32 v16, v192, v193
  v_mfma_f32_32x32x16_bf16 v[208:223], a[244:247], a[148:151], v[208:223]
  ds_read_b128 a[228:231], v233 offset:16640
  v_cvt_pk_bf16_f32 v17, v194, v195
  v_dot2c_f32_bf16 v246, s45, v16
  v_dot2c_f32_bf16 v246, s45, v17
  v_exp_f32 v196, v196
  s_waitcnt lgkmcnt(2)
  v_mfma_f32_32x32x16_bf16 v[208:223], a[248:251], a[152:155], v[208:223]
  ds_read_b128 a[232:235], v234 offset:16640
  v_exp_f32 v197, v197
  v_exp_f32 v198, v198
  v_mfma_f32_32x32x16_bf16 v[208:223], a[252:255], a[156:159], v[208:223]
  ds_read_b32 v254, v251 offset:4
  ds_read_b128 a[236:239], v235 offset:16640
  v_exp_f32 v199, v199
  v_cvt_pk_bf16_f32 v18, v196, v197
  v_cvt_pk_bf16_f32 v19, v198, v199
  s_waitcnt lgkmcnt(3)
  v_mfma_f32_32x32x16_bf16 v[208:223], a[224:227], a[160:163], v[208:223]
  ds_read_b128 a[240:243], v236 offset:16640
  v_dot2c_f32_bf16 v246, s45, v18
  v_dot2c_f32_bf16 v246, s45, v19
  v_exp_f32 v200, v200
  v_mfma_f32_32x32x16_bf16 v[208:223], a[228:231], a[164:167], v[208:223]
  ds_read_b128 a[244:247], v237 offset:16640
  v_exp_f32 v201, v201
  v_exp_f32 v202, v202
  s_waitcnt lgkmcnt(2)
  v_mfma_f32_32x32x16_bf16 v[208:223], a[232:235], a[168:171], v[208:223]
  v_readfirstlane_b32 s39, v254
  ds_read_b128 a[248:251], v238 offset:16640
  v_exp_f32 v203, v203
  v_cvt_pk_bf16_f32 v20, v200, v201
  v_cvt_pk_bf16_f32 v21, v202, v203
  v_mfma_f32_32x32x16_bf16 v[208:223], a[236:239], a[172:175], v[208:223]
  ds_read_b128 a[252:255], v239 offset:16640
  v_dot2c_f32_bf16 v246, s45, v20
  v_dot2c_f32_bf16 v246, s45, v21
  v_exp_f32 v204, v204
  s_waitcnt lgkmcnt(2)
  v_mfma_f32_32x32x16_bf16 v[208:223], a[240:243], a[176:179], v[208:223]
  s_getpc_b64 s[30:31]
  s_cmp_ge_u32 s39, 5
  s_cbranch_scc0 L_spin4
  ds_read_b128 a[224:227], v232 offset:32768
  v_exp_f32 v205, v205
  v_mfma_f32_32x32x16_bf16 v[208:223], a[244:247], a[180:183], v[208:223]
  ds_read_b128 a[228:231], v233 offset:32768
  v_exp_f32 v206, v206
  v_exp_f32 v207, v207
  v_cvt_pk_bf16_f32 v22, v204, v205
  s_waitcnt lgkmcnt(2)
  v_mfma_f32_32x32x16_bf16 v[208:223], a[248:251], a[184:187], v[208:223]
  ds_read_b128 a[232:235], v234 offset:32768
  v_cvt_pk_bf16_f32 v23, v206, v207
  v_dot2c_f32_bf16 v246, s45, v22
  v_dot2c_f32_bf16 v246, s45, v23
  v_mfma_f32_32x32x16_bf16 v[208:223], a[252:255], a[188:191], v[208:223]
  ds_add_u32 v251, v255 offset:8
  ds_read_b128 a[236:239], v235 offset:32768
  s_waitcnt lgkmcnt(3)
  v_mfma_f32_32x32x16_bf16 v[192:207], a[224:227], a[128:131], v[128:143]
  ds_read_b128 a[240:243], v236 offset:32768
  v_mfma_f32_32x32x16_bf16 v[192:207], a[228:231], a[132:135], v[192:207]
  ds_read_b128 a[244:247], v237 offset:32768
  s_waitcnt lgkmcnt(2)
  v_mfma_f32_32x32x16_bf16 v[192:207], a[232:235], a[136:139], v[192:207]
  ds_read_b128 a[248:251], v238 offset:32768
  v_mfma_f32_32x32x16_bf16 v[192:207], a[236:239], a[140:143], v[192:207]
  ds_read_b128 a[252:255], v239 offset:32768
  v_max3_f32 v249, v208, v209, v210
  v_max3_f32 v249, v249, v211, v212
  v_max3_f32 v249, v249, v213, v214
  v_max3_f32 v249, v249, v215, v216
  v_max3_f32 v249, v249, v217, v218
  s_waitcnt lgkmcnt(2)
  v_mfma_f32_32x32x16_bf16 v[192:207], a[240:243], a[144:147], v[192:207]
  ds_read_b128 a[224:227], v232 offset:33024
  v_max3_f32 v249, v249, v219, v220
  v_max3_f32 v249, v249, v221, v222
  v_max_f32 v249, v249, v223
  v_cmp_lt_f32 vcc, 0x41000000, v249
  s_cbranch_vccnz L_rare_3
L_ret_3:
  v_mfma_f32_32x32x16_bf16 v[192:207], a[244:247], a[148:151], v[192:207]
  ds_read_b128 a[228:231], v233 offset:33024
  v_exp_f32 v208, v208
  v_exp_f32 v209, v209
  s_waitcnt lgkmcnt(2)
  v_mfma_f32_32x32x16_bf16 v[192:207], a[248:251], a[152:155], v[192:207]
  ds_read_b128 a[232:235], v234 offset:33024
  v_exp_f32 v210, v210
  v_exp_f32 v211, v211
  v_cvt_pk_bf16_f32 v24, v208, v209
  v_mfma_f32_32x32x16_bf16 v[192:207], a[252:255], a[156:159], v[192:207]
  ds_read_b32 v254, v251 offset:4
  ds_read_b128 a[236:239], v235 offset:33024
  v_cvt_pk_bf16_f32 v25, v210, v211
  v_dot2c_f32_bf16 v246, s45, v24
  v_dot2c_f32_bf16 v246, s45, v25
  s_waitcnt lgkmcnt(3)
  v_mfma_f32_32x32x16_bf16 v[192:207], a[224:227], a[160:163], v[192:207]
  ds_read_b128 a[240:243], v236 offset:33024
  v_exp_f32 v212, v212
  v_exp_f32 v213, v213
  v_mfma_f32_32x32x16_bf16 v[192:207], a[228:231], a[164:167], v[192:207]
  ds_read_b128 a[244:247], v237 offset:33024
  v_exp_f32 v214, v214
  v_exp_f32 v215, v215
  v_cvt_pk_bf16_f32 v26, v212, v213
  s_waitcnt lgkmcnt(2)
  v_mfma_f32_32x32x16_bf16 v[192:207], a[232:235], a[168:171], v[192:207]
  v_readfirstlane_b32 s39, v254
  ds_read_b128 a[248:251], v238 offset:33024
  v_cvt_pk_bf16_f32 v27, v214, v215
  v_dot2c_f32_bf16 v246, s45, v26
  v_dot2c_f32_bf16 v246, s45, v27
  v_mfma_f32_32x32x16_bf16 v[192:207], a[236:239], a[172:175], v[192:207]
  ds_read_b128 a[252:255], v239 offset:33024
  v_exp_f32 v216, v216
  v_exp_f32 v217, v217
  s_waitcnt lgkmcnt(2)
  v_mfma_f32_32x32x16_bf16 v[192:207], a[240:243], a[176:179], v[192:207]
  s_getpc_b64 s[30:31]
  s_cmp_ge_u32 s39, 6
  s_cbranch_scc0 L_spin4
  ds_read_b128 a[224:227], v144 offset:32768
  v_exp_f32 v218, v218
  v_mfma_f32_32x32x16_bf16 v[192:207], a[244:247], a[180:183], v[192:207]
  ds_read_b128 a[228:231], v145 offset:32768
  v_exp_f32 v219, v219
  v_cvt_pk_bf16_f32 v28, v216, v217
  v_cvt_pk_bf16_f32 v29, v218, v219
  v_dot2c_f32_bf16 v246, s45, v28
  s_waitcnt lgkmcnt(2)
  v_mfma_f32_32x32x16_bf16 v[192:207], a[248:251], a[184:187], v[192:207]
  ds_read_b128 a[232:235], v146 offset:32768
  v_dot2c_f32_bf16 v246, s45, v29
  v_exp_f32 v220, v220
  v_exp_f32 v221, v221
  v_mfma_f32_32x32x16_bf16 v[192:207], a[252:255], a[188:191], v[192:207]
  ds_add_u32 v251, v255 offset:8
  ds_read_b128 a[236:239], v147 offset:32768
  v_exp_f32 v222, v222
  v_exp_f32 v223, v223
  v_cvt_pk_bf16_f32 v30, v220, v221
  v_cvt_pk_bf16_f32 v31, v222, v223
  s_waitcnt lgkmcnt(3)
  v_mfma_f32_32x32x16_bf16 v[208:223], a[224:227], a[128:131], v[128:143]
  ds_read_b128 a[240:243], v148 offset:32768
  v_dot2c_f32_bf16 v246, s45, v30
  v_dot2c_f32_bf16 v246, s45, v31
  v_mfma_f32_32x32x16_bf16 v[208:223], a[228:231], a[132:135], v[208:223]
  ds_read_b128 a[244:247], v149 offset:32768
  v_max3_f32 v249, v192, v193, v194
  v_max3_f32 v249, v249, v195, v196
  v_max3_f32 v249, v249, v197, v198
  v_max3_f32 v249, v249, v199, v200
  v_max3_f32 v249, v249, v201, v202
  s_waitcnt lgkmcnt(2)
  v_mfma_f32_32x32x16_bf16 v[208:223], a[232:235], a[136:139], v[208:223]
  ds_read_b128 a[248:251], v150 offset:32768
  v_max3_f32 v249, v249, v203, v204
  v_max3_f32 v249, v249, v205, v206
  v_max_f32 v249, v249, v207
  v_cmp_lt_f32 vcc, 0x41000000, v249
  s_cbranch_vccnz L_rare_4
L_ret_4:
  v_mfma_f32_32x32x16_bf16 v[208:223], a[236:239], a[140:143], v[208:223]
  ds_read_b128 a[252:255], v151 offset:32768
  v_exp_f32 v192, v192
  v_exp_f32 v193, v193
  s_waitcnt lgkmcnt(2)
  v_mfma_f32_32x32x16_bf16 v[208:223], a[240:243], a[144:147], v[208:223]
  ds_read_b128 a[224:227], v144 offset:33024
  v_exp_f32 v194, v194
  v_exp_f32 v195, v195
  v_cvt_pk_bf16_f32 v32, v192, v193
  v_mfma_f32_32x32x16_bf16 v[208:223], a[244:247], a[148:151], v[208:223]
  ds_read_b128 a[228:231], v145 offset:33024
  v_cvt_pk_bf16_f32 v33, v194, v195
  v_dot2c_f32_bf16 v246, s45, v32
  v_dot2c_f32_bf16 v246, s45, v33
  v_exp_f32 v196, v196
  s_waitcnt lgkmcnt(2)
  v_mfma_f32_32x32x16_bf16 v[208:223], a[248:251], a[152:155], v[208:223]
  ds_read_b128 a[232:235], v146 offset:33024
  v_exp_f32 v197, v197
  v_exp_f32 v198, v198
  v_mfma_f32_32x32x16_bf16 v[208:223], a[252:255], a[156:159], v[208:223]
  ds_read_b32 v254, v251 offset:4
  ds_read_b128 a[236:239], v147 offset:33024
  v_exp_f32 v199, v199
  v_cvt_pk_bf16_f32 v34, v196, v197
  v_cvt_pk_bf16_f32 v35, v198, v199
  s_waitcnt lgkmcnt(3)
  v_mfma_f32_32x32x16_bf16 v[208:223], a[224:227], a[160:163], v[208:223]
  ds_read_b128 a[240:243], v148 offset:33024
  v_dot2c_f32_bf16 v246, s45, v34
  v_dot2c_f32_bf16 v246, s45, v35
  v_exp_f32 v200, v200
  v_mfma_f32_32x32x16_bf16 v[208:223], a[228:231], a[164:167], v[208:223]
  ds_read_b128 a[244:247], v149 offset:33024
  v_exp_f32 v201, v201
  v_exp_f32 v202, v202
  s_waitcnt lgkmcnt(2)
  v_mfma_f32_32x32x16_bf16 v[208:223], a[232:235], a[168:171], v[208:223]
  v_readfirstlane_b32 s39, v254
  ds_read_b128 a[248:251], v150 offset:33024
  v_exp_f32 v203, v203
  v_cvt_pk_bf16_f32 v36, v200, v201
  v_cvt_pk_bf16_f32 v37, v202, v203
  v_mfma_f32_32x32x16_bf16 v[208:223], a[236:239], a[172:175], v[208:223]
  ds_read_b128 a[252:255], v151 offset:33024
  v_dot2c_f32_bf16 v246, s45, v36
  v_dot2c_f32_bf16 v246, s45, v37
  v_exp_f32 v204, v204
  s_waitcnt lgkmcnt(2)
  v_mfma_f32_32x32x16_bf16 v[208:223], a[240:243], a[176:179], v[208:223]
  s_getpc_b64 s[30:31]
  s_cmp_ge_u32 s39, 7
  s_cbranch_scc0 L_spin4
  ds_read_b128 a[224:227], v144 offset:49152
  v_exp_f32 v205, v205
  v_mfma_f32_32x32x16_bf16 v[208:223], a[244:247], a[180:183], v[208:223]
  ds_read_b128 a[228:231], v145 offset:49152
  v_exp_f32 v206, v206
  v_exp_f32 v207, v207
  v_cvt_pk_bf16_f32 v38, v204, v205
  s_waitcnt lgkmcnt(2)
  v_mfma_f32_32x32x16_bf16 v[208:223], a[248:251], a[184:187], v[208:223]
  ds_read_b128 a[232:235], v146 offset:49152
  v_cvt_pk_bf16_f32 v39, v206, v207
  v_dot2c_f32_bf16 v246, s45, v38
  v_dot2c_f32_bf16 v246, s45, v39
  v_mfma_f32_32x32x16_bf16 v[208:223], a[252:255], a[188:191], v[208:223]
  ds_add_u32 v251, v255 offset:8
  ds_read_b128 a[236:239], v147 offset:49152
  s_waitcnt lgkmcnt(3)
  v_mfma_f32_32x32x16_bf16 v[192:207], a[224:227], a[128:131], v[128:143]
  ds_read_b128 a[240:243], v148 offset:49152
  v_mfma_f32_32x32x16_bf16 v[192:207], a[228:231], a[132:135], v[192:207]
  ds_read_b128 a[244:247], v149 offset:49152
  s_waitcnt lgkmcnt(2)
  v_mfma_f32_32x32x16_bf16 v[192:207], a[232:235], a[136:139], v[192:207]
  ds_read_b128 a[248:251], v150 offset:49152
  v_mfma_f32_32x32x16_bf16 v[192:207], a[236:239], a[140:143], v[192:207]
  ds_read_b128 a[252:255], v151 offset:49152
  v_max3_f32 v249, v208, v209, v210
  v_max3_f32 v249, v249, v211, v212
  v_max3_f32 v249, v249, v213, v214
  v_max3_f32 v249, v249, v215, v216
  v_max3_f32 v249, v249, v217, v218
  s_waitcnt lgkmcnt(2)
  v_mfma_f32_32x32x16_bf16 v[192:207], a[240:243], a[144:147], v[192:207]
  ds_read_b128 a[224:227], v144 offset:49408
  v_max3_f32 v249, v249, v219, v220
  v_max3_f32 v249, v249, v221, v222
  v_max_f32 v249, v249, v223
  v_cmp_lt_f32 vcc, 0x41000000, v249
  s_cbranch_vccnz L_rare_5
L_ret_5:
  v_mfma_f32_32x32x16_bf16 v[192:207], a[244:247], a[148:151], v[192:207]
  ds_read_b128 a[228:231], v145 offset:49408
  v_exp_f32 v208, v208
  v_exp_f32 v209, v209
  s_waitcnt lgkmcnt(2)
  v_mfma_f32_32x32x16_bf16 v[192:207], a[248:251], a[152:155], v[192:207]
  ds_read_b128 a[232:235], v146 offset:49408
  v_exp_f32 v210, v210
  v_exp_f32 v211, v211
  v_cvt_pk_bf16_f32 v40, v208, v209
  v_mfma_f32_32x32x16_bf16 v[192:207], a[252:255], a[156:159], v[192:207]
  ds_read_b32 v254, v251 offset:4
  ds_read_b128 a[236:239], v147 offset:49408
  v_cvt_pk_bf16_f32 v41, v210, v211
  v_dot2c_f32_bf16 v246, s45, v40
  v_dot2c_f32_bf16 v246, s45, v41
  s_waitcnt lgkmcnt(3)
  v_mfma_f32_32x32x16_bf16 v[192:207], a[224:227], a[160:163], v[192:207]
  ds_read_b128 a[240:243], v148 offset:49408
  v_exp_f32 v212, v212
  v_exp_f32 v213, v213
  v_mfma_f32_32x32x16_bf16 v[192:207], a[228:231], a[164:167], v[192:207]
  ds_read_b128 a[244:247], v149 offset:49408
  v_exp_f32 v214, v214
  v_exp_f32 v215, v215
  v_cvt_pk_bf16_f32 v42, v212, v213
  s_waitcnt lgkmcnt(2)
  v_mfma_f32_32x32x16_bf16 v[192:207], a[232:235], a[168:171], v[192:207]
  v_readfirstlane_b32 s39, v254
  ds_read_b128 a[248:251], v150 offset:49408
  v_cvt_pk_bf16_f32 v43, v214, v215
  v_dot2c_f32_bf16 v246, s45, v42
  v_dot2c_f32_bf16 v246, s45, v43
  v_mfma_f32_32x32x16_bf16 v[192:207], a[236:239], a[172:175], v[192:207]
  ds_read_b128 a[252:255], v151 offset:49408
  v_exp_f32 v216, v216
  v_exp_f32 v217, v217
  s_waitcnt lgkmcnt(2)
  v_mfma_f32_32x32x16_bf16 v[192:207], a[240:243], a[176:179], v[192:207]
  s_getpc_b64 s[30:31]
  s_cmp_ge_u32 s39, 8
  s_cbranch_scc0 L_spin4
  ds_read_b128 a[224:227], v152 offset:0
  v_exp_f32 v218, v218
  v_mfma_f32_32x32x16_bf16 v[192:207], a[244:247], a[180:183], v[192:207]
  ds_read_b128 a[228:231], v153 offset:0
  v_exp_f32 v219, v219
  v_cvt_pk_bf16_f32 v44, v216, v217
  v_cvt_pk_bf16_f32 v45, v218, v219
  v_dot2c_f32_bf16 v246, s45, v44
  s_waitcnt lgkmcnt(2)
  v_mfma_f32_32x32x16_bf16 v[192:207], a[248:251], a[184:187], v[192:207]
  ds_read_b128 a[232:235], v154 offset:0
  v_dot2c_f32_bf16 v246, s45, v45
  v_exp_f32 v220, v220
  v_exp_f32 v221, v221
  v_mfma_f32_32x32x16_bf16 v[192:207], a[252:255], a[188:191], v[192:207]
  ds_add_u32 v251, v255 offset:8
  ds_read_b128 a[236:239], v155 offset:0
  v_exp_f32 v222, v222
  v_exp_f32 v223, v223
  v_cvt_pk_bf16_f32 v46, v220, v221
  v_cvt_pk_bf16_f32 v47, v222, v223
  s_waitcnt lgkmcnt(3)
  v_mfma_f32_32x32x16_bf16 v[208:223], a[224:227], a[128:131], v[128:143]
  ds_read_b128 a[240:243], v156 offset:0
  v_dot2c_f32_bf16 v246, s45, v46
  v_dot2c_f32_bf16 v246, s45, v47
  v_mfma_f32_32x32x16_bf16 v[208:223], a[228:231], a[132:135], v[208:223]
  ds_read_b128 a[244:247], v157 offset:0
  v_max3_f32 v249, v192, v193, v194
  v_max3_f32 v249, v249, v195, v196
  v_max3_f32 v249, v249, v197, v198
  v_max3_f32 v249, v249, v199, v200
  v_max3_f32 v249, v249, v201, v202
  s_waitcnt lgkmcnt(2)
  v_mfma_f32_32x32x16_bf16 v[208:223], a[232:235], a[136:139], v[208:223]
  ds_read_b128 a[248:251], v158 offset:0
  v_max3_f32 v249, v249, v203, v204
  v_max3_f32 v249, v249, v205, v206
  v_max_f32 v249, v249, v207
  v_cmp_lt_f32 vcc, 0x41000000, v249
  s_cbranch_vccnz L_rare_6
L_ret_6:
  v_mfma_f32_32x32x16_bf16 v[208:223], a[236:239], a[140:143], v[208:223]
  ds_read_b128 a[252:255], v159 offset:0
  v_exp_f32 v192, v192
  v_exp_f32 v193, v193
  s_waitcnt lgkmcnt(2)
  v_mfma_f32_32x32x16_bf16 v[208:223], a[240:243], a[144:147], v[208:223]
  ds_read_b128 a[224:227], v152 offset:256
  v_exp_f32 v194, v194
  v_exp_f32 v195, v195
  v_cvt_pk_bf16_f32 v48, v192, v193
  v_mfma_f32_32x32x16_bf16 v[208:223], a[244:247], a[148:151], v[208:223]
  ds_read_b128 a[228:231], v153 offset:256
  v_cvt_pk_bf16_f32 v49, v194, v195
  v_dot2c_f32_bf16 v246, s45, v48
  v_dot2c_f32_bf16 v246, s45, v49
  v_exp_f32 v196, v196
  s_waitcnt lgkmcnt(2)
  v_mfma_f32_32x32x16_bf16 v[208:223], a[248:251], a[152:155], v[208:223]
  ds_read_b128 a[232:235], v154 offset:256
  v_exp_f32 v197, v197
  v_exp_f32 v198, v198
  v_mfma_f32_32x32x16_bf16 v[208:223], a[252:255], a[156:159], v[208:223]
  ds_read_b32 v254, v251 offset:4
  ds_read_b128 a[236:239], v155 offset:256
  v_exp_f32 v199, v199
  v_cvt_pk_bf16_f32 v50, v196, v197
  v_cvt_pk_bf16_f32 v51, v198, v199
  s_waitcnt lgkmcnt(3)
  v_mfma_f32_32x32x16_bf16 v[208:223], a[224:227], a[160:163], v[208:223]
  ds_read_b128 a[240:243], v156 offset:256
  v_dot2c_f32_bf16 v246, s45, v50
  v_dot2c_f32_bf16 v246, s45, v51
  v_exp_f32 v200, v200
  v_mfma_f32_32x32x16_bf16 v[208:223], a[228:231], a[164:167], v[208:223]
  ds_read_b128 a[244:247], v157 offset:256
  v_exp_f32 v201, v201
  v_exp_f32 v202, v202
  s_waitcnt lgkmcnt(2)
  v_mfma_f32_32x32x16_bf16 v[208:223], a[232:235], a[168:171], v[208:223]
  v_readfirstlane_b32 s39, v254
  ds_read_b128 a[248:251], v158 offset:256
  v_exp_f32 v203, v203
  v_cvt_pk_bf16_f32 v52, v200, v201
  v_cvt_pk_bf16_f32 v53, v202, v203
  v_mfma_f32_32x32x16_bf16 v[208:223], a[236:239], a[172:175], v[208:223]
  ds_read_b128 a[252:255], v159 offset:256
  v_dot2c_f32_bf16 v246, s45, v52
  v_dot2c_f32_bf16 v246, s45, v53
  v_exp_f32 v204, v204
  s_waitcnt lgkmcnt(2)
  v_mfma_f32_32x32x16_bf16 v[208:223], a[240:243], a[176:179], v[208:223]
  s_getpc_b64 s[30:31]
  s_cmp_ge_u32 s39, 9
  s_cbranch_scc0 L_spin4
  ds_read_b128 a[224:227], v144 offset:16384
  v_exp_f32 v205, v205
  v_mfma_f32_32x32x16_bf16 v[208:223], a[244:247], a[180:183], v[208:223]
  ds_read_b128 a[228:231], v145 offset:16384
  v_exp_f32 v206, v206
  v_exp_f32 v207, v207
  v_cvt_pk_bf16_f32 v54, v204, v205
  s_waitcnt lgkmcnt(2)
  v_mfma_f32_32x32x16_bf16 v[208:223], a[248:251], a[184:187], v[208:223]
  ds_read_b128 a[232:235], v146 offset:16384
  v_cvt_pk_bf16_f32 v55, v206, v207
  v_dot2c_f32_bf16 v246, s45, v54
  v_dot2c_f32_bf16 v246, s45, v55
  v_mfma_f32_32x32x16_bf16 v[208:223], a[252:255], a[188:191], v[208:223]
  ds_add_u32 v251, v255 offset:8
  ds_read_b128 a[236:239], v147 offset:16384
  s_waitcnt lgkmcnt(3)
  v_mfma_f32_32x32x16_bf16 v[192:207], a[224:227], a[128:131], v[128:143]
  ds_read_b128 a[240:243], v148 offset:16384
  v_mfma_f32_32x32x16_bf16 v[192:207], a[228:231], a[132:135], v[192:207]
  ds_read_b128 a[244:247], v149 offset:16384
  s_waitcnt lgkmcnt(2)
  v_mfma_f32_32x32x16_bf16 v[192:207], a[232:235], a[136:139], v[192:207]
  ds_read_b128 a[248:251], v150 offset:16384
  v_mfma_f32_32x32x16_bf16 v[192:207], a[236:239], a[140:143], v[192:207]
  ds_read_b128 a[252:255], v151 offset:16384
  v_max3_f32 v249, v208, v209, v210
  v_max3_f32 v249, v249, v211, v212
  v_max3_f32 v249, v249, v213, v214
  v_max3_f32 v249, v249, v215, v216
  v_max3_f32 v249, v249, v217, v218
  s_waitcnt lgkmcnt(2)
  v_mfma_f32_32x32x16_bf16 v[192:207], a[240:243], a[144:147], v[192:207]
  ds_read_b128 a[224:227], v144 offset:16640
  v_max3_f32 v249, v249, v219, v220
  v_max3_f32 v249, v249, v221, v222
  v_max_f32 v249, v249, v223
  v_cmp_lt_f32 vcc, 0x41000000, v249
  s_cbranch_vccnz L_rare_7
L_ret_7:
  v_mfma_f32_32x32x16_bf16 v[192:207], a[244:247], a[148:151], v[192:207]
  ds_read_b128 a[228:231], v145 offset:16640
  v_exp_f32 v208, v208
  v_exp_f32 v209, v209
  s_waitcnt lgkmcnt(2)
  v_mfma_f32_32x32x16_bf16 v[192:207], a[248:251], a[152:155], v[192:207]
  ds_read_b128 a[232:235], v146 offset:16640
  v_exp_f32 v210, v210
  v_exp_f32 v211, v211
  v_cvt_pk_bf16_f32 v56, v208, v209
  v_mfma_f32_32x32x16_bf16 v[192:207], a[252:255], a[156:159], v[192:207]
  ds_read_b32 v254, v251 offset:4
  ds_read_b128 a[236:239], v147 offset:16640
  v_cvt_pk_bf16_f32 v57, v210, v211
  v_dot2c_f32_bf16 v246, s45, v56
  v_dot2c_f32_bf16 v246, s45, v57
  s_waitcnt lgkmcnt(3)
  v_mfma_f32_32x32x16_bf16 v[192:207], a[224:227], a[160:163], v[192:207]
  ds_read_b128 a[240:243], v148 offset:16640
  v_exp_f32 v212, v212
  v_exp_f32 v213, v213
  v_mfma_f32_32x32x16_bf16 v[192:207], a[228:231], a[164:167], v[192:207]
  ds_read_b128 a[244:247], v149 offset:16640
  v_exp_f32 v214, v214
  v_exp_f32 v215, v215
  v_cvt_pk_bf16_f32 v58, v212, v213
  s_waitcnt lgkmcnt(2)
  v_mfma_f32_32x32x16_bf16 v[192:207], a[232:235], a[168:171], v[192:207]
  v_readfirstlane_b32 s39, v254
  ds_read_b128 a[248:251], v150 offset:16640
  v_cvt_pk_bf16_f32 v59, v214, v215
  v_dot2c_f32_bf16 v246, s45, v58
  v_dot2c_f32_bf16 v246, s45, v59
  v_mfma_f32_32x32x16_bf16 v[192:207], a[236:239], a[172:175], v[192:207]
  ds_read_b128 a[252:255], v151 offset:16640
  v_exp_f32 v216, v216
  v_exp_f32 v217, v217
  s_waitcnt lgkmcnt(2)
  v_mfma_f32_32x32x16_bf16 v[192:207], a[240:243], a[176:179], v[192:207]
  s_getpc_b64 s[30:31]
  s_cmp_ge_u32 s39, 10
  s_cbranch_scc0 L_spin4
  ds_read_b128 a[224:227], v232 offset:49152
  v_exp_f32 v218, v218
  v_mfma_f32_32x32x16_bf16 v[192:207], a[244:247], a[180:183], v[192:207]
  ds_read_b128 a[228:231], v233 offset:49152
  v_exp_f32 v219, v219
  v_cvt_pk_bf16_f32 v60, v216, v217
  v_cvt_pk_bf16_f32 v61, v218, v219
  v_dot2c_f32_bf16 v246, s45, v60
  s_waitcnt lgkmcnt(2)
  v_mfma_f32_32x32x16_bf16 v[192:207], a[248:251], a[184:187], v[192:207]
  ds_read_b128 a[232:235], v234 offset:49152
  v_dot2c_f32_bf16 v246, s45, v61
  v_exp_f32 v220, v220
  v_exp_f32 v221, v221
  v_mfma_f32_32x32x16_bf16 v[192:207], a[252:255], a[188:191], v[192:207]
  ds_add_u32 v251, v255 offset:8
  ds_read_b128 a[236:239], v235 offset:49152
  v_exp_f32 v222, v222
  v_exp_f32 v223, v223
  v_cvt_pk_bf16_f32 v62, v220, v221
  v_cvt_pk_bf16_f32 v63, v222, v223
  s_waitcnt lgkmcnt(3)
  v_mfma_f32_32x32x16_bf16 v[208:223], a[224:227], a[128:131], v[128:143]
  ds_read_b128 a[240:243], v236 offset:49152
  v_dot2c_f32_bf16 v246, s45, v62
  v_dot2c_f32_bf16 v246, s45, v63
  v_mfma_f32_32x32x16_bf16 v[208:223], a[228:231], a[132:135], v[208:223]
  ds_read_b128 a[244:247], v237 offset:49152
  v_max3_f32 v249, v192, v193, v194
  v_max3_f32 v249, v249, v195, v196
  v_max3_f32 v249, v249, v197, v198
  v_max3_f32 v249, v249, v199, v200
  v_max3_f32 v249, v249, v201, v202
  s_waitcnt lgkmcnt(2)
  v_mfma_f32_32x32x16_bf16 v[208:223], a[232:235], a[136:139], v[208:223]
  ds_read_b128 a[248:251], v238 offset:49152
  v_max3_f32 v249, v249, v203, v204
  v_max3_f32 v249, v249, v205, v206
  v_max_f32 v249, v249, v207
  v_cmp_lt_f32 vcc, 0x41000000, v249
  s_cbranch_vccnz L_rare_8
L_ret_8:
  v_mfma_f32_32x32x16_bf16 v[208:223], a[236:239], a[140:143], v[208:223]
  ds_read_b128 a[252:255], v239 offset:49152
  v_exp_f32 v192, v192
  v_exp_f32 v193, v193
  s_waitcnt lgkmcnt(2)
  v_mfma_f32_32x32x16_bf16 v[208:223], a[240:243], a[144:147], v[208:223]
  ds_read_b128 a[224:227], v232 offset:49408
  v_exp_f32 v194, v194
  v_exp_f32 v195, v195
  v_cvt_pk_bf16_f32 v64, v192, v193
  v_mfma_f32_32x32x16_bf16 v[208:223], a[244:247], a[148:151], v[208:223]
  ds_read_b128 a[228:231], v233 offset:49408
  v_cvt_pk_bf16_f32 v65, v194, v195
  v_dot2c_f32_bf16 v246, s45, v64
  v_dot2c_f32_bf16 v246, s45, v65
  v_exp_f32 v196, v196
  s_waitcnt lgkmcnt(2)
  v_mfma_f32_32x32x16_bf16 v[208:223], a[248:251], a[152:155], v[208:223]
  ds_read_b128 a[232:235], v234 offset:49408
  v_exp_f32 v197, v197
  v_exp_f32 v198, v198
  v_mfma_f32_32x32x16_bf16 v[208:223], a[252:255], a[156:159], v[208:223]
  ds_read_b32 v254, v251 offset:4
  ds_read_b128 a[236:239], v235 offset:49408
  v_exp_f32 v199, v199
  v_cvt_pk_bf16_f32 v66, v196, v197
  v_cvt_pk_bf16_f32 v67, v198, v199
  s_waitcnt lgkmcnt(3)
  v_mfma_f32_32x32x16_bf16 v[208:223], a[224:227], a[160:163], v[208:223]
  ds_read_b128 a[240:243], v236 offset:49408
  v_dot2c_f32_bf16 v246, s45, v66
  v_dot2c_f32_bf16 v246, s45, v67
  v_exp_f32 v200, v200
  v_mfma_f32_32x32x16_bf16 v[208:223], a[228:231], a[164:167], v[208:223]
  ds_read_b128 a[244:247], v237 offset:49408
  v_exp_f32 v201, v201
  v_exp_f32 v202, v202
  s_waitcnt lgkmcnt(2)
  v_mfma_f32_32x32x16_bf16 v[208:223], a[232:235], a[168:171], v[208:223]
  v_readfirstlane_b32 s39, v254
  ds_read_b128 a[248:251], v238 offset:49408
  v_exp_f32 v203, v203
  v_cvt_pk_bf16_f32 v68, v200, v201
  v_cvt_pk_bf16_f32 v69, v202, v203
  v_mfma_f32_32x32x16_bf16 v[208:223], a[236:239], a[172:175], v[208:223]
  ds_read_b128 a[252:255], v239 offset:49408
  v_dot2c_f32_bf16 v246, s45, v68
  v_dot2c_f32_bf16 v246, s45, v69
  v_exp_f32 v204, v204
  s_waitcnt lgkmcnt(2)
  v_mfma_f32_32x32x16_bf16 v[208:223], a[240:243], a[176:179], v[208:223]
  s_getpc_b64 s[30:31]
  s_cmp_ge_u32 s39, 11
  s_cbranch_scc0 L_spin4
  ds_read_b128 a[224:227], v144 offset:0
  v_exp_f32 v205, v205
  v_mfma_f32_32x32x16_bf16 v[208:223], a[244:247], a[180:183], v[208:223]
  ds_read_b128 a[228:231], v145 offset:0
  v_exp_f32 v206, v206
  v_exp_f32 v207, v207
  v_cvt_pk_bf16_f32 v70, v204, v205
  s_waitcnt lgkmcnt(2)
  v_mfma_f32_32x32x16_bf16 v[208:223], a[248:251], a[184:187], v[208:223]
  ds_read_b128 a[232:235], v146 offset:0
  v_cvt_pk_bf16_f32 v71, v206, v207
  v_dot2c_f32_bf16 v246, s45, v70
  v_dot2c_f32_bf16 v246, s45, v71
  v_mfma_f32_32x32x16_bf16 v[208:223], a[252:255], a[188:191], v[208:223]
  ds_add_u32 v251, v255 offset:8
  ds_read_b128 a[236:239], v147 offset:0
  s_waitcnt lgkmcnt(3)
  v_mfma_f32_32x32x16_bf16 v[192:207], a[224:227], a[128:131], v[128:143]
  ds_read_b128 a[240:243], v148 offset:0
  v_mfma_f32_32x32x16_bf16 v[192:207], a[228:231], a[132:135], v[192:207]
  ds_read_b128 a[244:247], v149 offset:0
  s_waitcnt lgkmcnt(2)
  v_mfma_f32_32x32x16_bf16 v[192:207], a[232:235], a[136:139], v[192:207]
  ds_read_b128 a[248:251], v150 offset:0
  v_mfma_f32_32x32x16_bf16 v[192:207], a[236:239], a[140:143], v[192:207]
  ds_read_b128 a[252:255], v151 offset:0
  v_max3_f32 v249, v208, v209, v210
  v_max3_f32 v249, v249, v211, v212
  v_max3_f32 v249, v249, v213, v214
  v_max3_f32 v249, v249, v215, v216
  v_max3_f32 v249, v249, v217, v218
  s_waitcnt lgkmcnt(2)
  v_mfma_f32_32x32x16_bf16 v[192:207], a[240:243], a[144:147], v[192:207]
  ds_read_b128 a[224:227], v144 offset:256
  v_max3_f32 v249, v249, v219, v220
  v_max3_f32 v249, v249, v221, v222
  v_max_f32 v249, v249, v223
  v_cmp_lt_f32 vcc, 0x41000000, v249
  s_cbranch_vccnz L_rare_9
L_ret_9:
  v_mfma_f32_32x32x16_bf16 v[192:207], a[244:247], a[148:151], v[192:207]
  ds_read_b128 a[228:231], v145 offset:256
  v_exp_f32 v208, v208
  v_exp_f32 v209, v209
  s_waitcnt lgkmcnt(2)
  v_mfma_f32_32x32x16_bf16 v[192:207], a[248:251], a[152:155], v[192:207]
  ds_read_b128 a[232:235], v146 offset:256
  v_exp_f32 v210, v210
  v_exp_f32 v211, v211
  v_cvt_pk_bf16_f32 v72, v208, v209
  v_mfma_f32_32x32x16_bf16 v[192:207], a[252:255], a[156:159], v[192:207]
  ds_read_b32 v254, v251 offset:4
  ds_read_b128 a[236:239], v147 offset:256
  v_cvt_pk_bf16_f32 v73, v210, v211
  v_dot2c_f32_bf16 v246, s45, v72
  v_dot2c_f32_bf16 v246, s45, v73
  s_waitcnt lgkmcnt(3)
  v_mfma_f32_32x32x16_bf16 v[192:207], a[224:227], a[160:163], v[192:207]
  ds_read_b128 a[240:243], v148 offset:256
  v_exp_f32 v212, v212
  v_exp_f32 v213, v213
  v_mfma_f32_32x32x16_bf16 v[192:207], a[228:231], a[164:167], v[192:207]
  ds_read_b128 a[244:247], v149 offset:256
  v_exp_f32 v214, v214
  v_exp_f32 v215, v215
  v_cvt_pk_bf16_f32 v74, v212, v213
  s_waitcnt lgkmcnt(2)
  v_mfma_f32_32x32x16_bf16 v[192:207], a[232:235], a[168:171], v[192:207]
  v_readfirstlane_b32 s39, v254
  ds_read_b128 a[248:251], v150 offset:256
  v_cvt_pk_bf16_f32 v75, v214, v215
  v_dot2c_f32_bf16 v246, s45, v74
  v_dot2c_f32_bf16 v246, s45, v75
  v_mfma_f32_32x32x16_bf16 v[192:207], a[236:239], a[172:175], v[192:207]
  ds_read_b128 a[252:255], v151 offset:256
  v_exp_f32 v216, v216
  v_exp_f32 v217, v217
  s_waitcnt lgkmcnt(2)
  v_mfma_f32_32x32x16_bf16 v[192:207], a[240:243], a[176:179], v[192:207]
  s_getpc_b64 s[30:31]
  s_cmp_ge_u32 s39, 12
  s_cbranch_scc0 L_spin4
  ds_read_b128 a[224:227], v232 offset:0
  v_exp_f32 v218, v218
  v_mfma_f32_32x32x16_bf16 v[192:207], a[244:247], a[180:183], v[192:207]
  ds_read_b128 a[228:231], v233 offset:0
  v_exp_f32 v219, v219
  v_cvt_pk_bf16_f32 v76, v216, v217
  v_cvt_pk_bf16_f32 v77, v218, v219
  v_dot2c_f32_bf16 v246, s45, v76
  s_waitcnt lgkmcnt(2)
  v_mfma_f32_32x32x16_bf16 v[192:207], a[248:251], a[184:187], v[192:207]
  ds_read_b128 a[232:235], v234 offset:0
  v_dot2c_f32_bf16 v246, s45, v77
  v_exp_f32 v220, v220
  v_exp_f32 v221, v221
  v_mfma_f32_32x32x16_bf16 v[192:207], a[252:255], a[188:191], v[192:207]
  ds_add_u32 v251, v255 offset:8
  ds_read_b128 a[236:239], v235 offset:0
  v_exp_f32 v222, v222
  v_exp_f32 v223, v223
  v_cvt_pk_bf16_f32 v78, v220, v221
  v_cvt_pk_bf16_f32 v79, v222, v223
  s_waitcnt lgkmcnt(3)
  v_mfma_f32_32x32x16_bf16 v[208:223], a[224:227], a[128:131], v[128:143]
  ds_read_b128 a[240:243], v236 offset:0
  v_dot2c_f32_bf16 v246, s45, v78
  v_dot2c_f32_bf16 v246, s45, v79
  v_mfma_f32_32x32x16_bf16 v[208:223], a[228:231], a[132:135], v[208:223]
  ds_read_b128 a[244:247], v237 offset:0
  v_max3_f32 v249, v192, v193, v194
  v_max3_f32 v249, v249, v195, v196
  v_max3_f32 v249, v249, v197, v198
  v_max3_f32 v249, v249, v199, v200
  v_max3_f32 v249, v249, v201, v202
  s_waitcnt lgkmcnt(2)
  v_mfma_f32_32x32x16_bf16 v[208:223], a[232:235], a[136:139], v[208:223]
  ds_read_b128 a[248:251], v238 offset:0
  v_max3_f32 v249, v249, v203, v204
  v_max3_f32 v249, v249, v205, v206
  v_max_f32 v249, v249, v207
  v_cmp_lt_f32 vcc, 0x41000000, v249
  s_cbranch_vccnz L_rare_10
L_ret_10:
  v_mfma_f32_32x32x16_bf16 v[208:223], a[236:239], a[140:143], v[208:223]
  ds_read_b128 a[252:255], v239 offset:0
  v_exp_f32 v192, v192
  v_exp_f32 v193, v193
  s_waitcnt lgkmcnt(2)
  v_mfma_f32_32x32x16_bf16 v[208:223], a[240:243], a[144:147], v[208:223]
  ds_read_b128 a[224:227], v232 offset:256
  v_exp_f32 v194, v194
  v_exp_f32 v195, v195
  v_cvt_pk_bf16_f32 v80, v192, v193
  v_mfma_f32_32x32x16_bf16 v[208:223], a[244:247], a[148:151], v[208:223]
  ds_read_b128 a[228:231], v233 offset:256
  v_cvt_pk_bf16_f32 v81, v194, v195
  v_dot2c_f32_bf16 v246, s45, v80
  v_dot2c_f32_bf16 v246, s45, v81
  v_exp_f32 v196, v196
  s_waitcnt lgkmcnt(2)
  v_mfma_f32_32x32x16_bf16 v[208:223], a[248:251], a[152:155], v[208:223]
  ds_read_b128 a[232:235], v234 offset:256
  v_exp_f32 v197, v197
  v_exp_f32 v198, v198
  v_mfma_f32_32x32x16_bf16 v[208:223], a[252:255], a[156:159], v[208:223]
  ds_read_b32 v254, v251 offset:4
  ds_read_b128 a[236:239], v235 offset:256
  v_exp_f32 v199, v199
  v_cvt_pk_bf16_f32 v82, v196, v197
  v_cvt_pk_bf16_f32 v83, v198, v199
  s_waitcnt lgkmcnt(3)
  v_mfma_f32_32x32x16_bf16 v[208:223], a[224:227], a[160:163], v[208:223]
  ds_read_b128 a[240:243], v236 offset:256
  v_dot2c_f32_bf16 v246, s45, v82
  v_dot2c_f32_bf16 v246, s45, v83
  v_exp_f32 v200, v200
  v_mfma_f32_32x32x16_bf16 v[208:223], a[228:231], a[164:167], v[208:223]
  ds_read_b128 a[244:247], v237 offset:256
  v_exp_f32 v201, v201
  v_exp_f32 v202, v202
  s_waitcnt lgkmcnt(2)
  v_mfma_f32_32x32x16_bf16 v[208:223], a[232:235], a[168:171], v[208:223]
  v_readfirstlane_b32 s39, v254
  ds_read_b128 a[248:251], v238 offset:256
  v_exp_f32 v203, v203
  v_cvt_pk_bf16_f32 v84, v200, v201
  v_cvt_pk_bf16_f32 v85, v202, v203
  v_mfma_f32_32x32x16_bf16 v[208:223], a[236:239], a[172:175], v[208:223]
  ds_read_b128 a[252:255], v239 offset:256
  v_dot2c_f32_bf16 v246, s45, v84
  v_dot2c_f32_bf16 v246, s45, v85
  v_exp_f32 v204, v204
  s_waitcnt lgkmcnt(2)
  v_mfma_f32_32x32x16_bf16 v[208:223], a[240:243], a[176:179], v[208:223]
  s_getpc_b64 s[30:31]
  s_cmp_ge_u32 s39, 13
  s_cbranch_scc0 L_spin4
  ds_read_b128 a[224:227], v232 offset:16384
  v_exp_f32 v205, v205
  v_mfma_f32_32x32x16_bf16 v[208:223], a[244:247], a[180:183], v[208:223]
  ds_read_b128 a[228:231], v233 offset:16384
  v_exp_f32 v206, v206
  v_exp_f32 v207, v207
  v_cvt_pk_bf16_f32 v86, v204, v205
  s_waitcnt lgkmcnt(2)
  v_mfma_f32_32x32x16_bf16 v[208:223], a[248:251], a[184:187], v[208:223]
  ds_read_b128 a[232:235], v234 offset:16384
  v_cvt_pk_bf16_f32 v87, v206, v207
  v_dot2c_f32_bf16 v246, s45, v86
  v_dot2c_f32_bf16 v246, s45, v87
  v_mfma_f32_32x32x16_bf16 v[208:223], a[252:255], a[188:191], v[208:223]
  ds_add_u32 v251, v255 offset:8
  ds_read_b128 a[236:239], v235 offset:16384
  s_waitcnt lgkmcnt(3)
  v_mfma_f32_32x32x16_bf16 v[192:207], a[224:227], a[128:131], v[128:143]
  ds_read_b128 a[240:243], v236 offset:16384
  v_mfma_f32_32x32x16_bf16 v[192:207], a[228:231], a[132:135], v[192:207]
  ds_read_b128 a[244:247], v237 offset:16384
  s_waitcnt lgkmcnt(2)
  v_mfma_f32_32x32x16_bf16 v[192:207], a[232:235], a[136:139], v[192:207]
  ds_read_b128 a[248:251], v238 offset:16384
  v_mfma_f32_32x32x16_bf16 v[192:207], a[236:239], a[140:143], v[192:207]
  ds_read_b128 a[252:255], v239 offset:16384
  v_max3_f32 v249, v208, v209, v210
  v_max3_f32 v249, v249, v211, v212
  v_max3_f32 v249, v249, v213, v214
  v_max3_f32 v249, v249, v215, v216
  v_max3_f32 v249, v249, v217, v218
  s_waitcnt lgkmcnt(2)
  v_mfma_f32_32x32x16_bf16 v[192:207], a[240:243], a[144:147], v[192:207]
  ds_read_b128 a[224:227], v232 offset:16640
  v_max3_f32 v249, v249, v219, v220
  v_max3_f32 v249, v249, v221, v222
  v_max_f32 v249, v249, v223
  v_cmp_lt_f32 vcc, 0x41000000, v249
  s_cbranch_vccnz L_rare_11
L_ret_11:
  v_mfma_f32_32x32x16_bf16 v[192:207], a[244:247], a[148:151], v[192:207]
  ds_read_b128 a[228:231], v233 offset:16640
  v_exp_f32 v208, v208
  v_exp_f32 v209, v209
  s_waitcnt lgkmcnt(2)
  v_mfma_f32_32x32x16_bf16 v[192:207], a[248:251], a[152:155], v[192:207]
  ds_read_b128 a[232:235], v234 offset:16640
  v_exp_f32 v210, v210
  v_exp_f32 v211, v211
  v_cvt_pk_bf16_f32 v88, v208, v209
  v_mfma_f32_32x32x16_bf16 v[192:207], a[252:255], a[156:159], v[192:207]
  ds_read_b32 v254, v251 offset:4
  ds_read_b128 a[236:239], v235 offset:16640
  v_cvt_pk_bf16_f32 v89, v210, v211
  v_dot2c_f32_bf16 v246, s45, v88
  v_dot2c_f32_bf16 v246, s45, v89
  s_waitcnt lgkmcnt(3)
  v_mfma_f32_32x32x16_bf16 v[192:207], a[224:227], a[160:163], v[192:207]
  ds_read_b128 a[240:243], v236 offset:16640
  v_exp_f32 v212, v212
  v_exp_f32 v213, v213
  v_mfma_f32_32x32x16_bf16 v[192:207], a[228:231], a[164:167], v[192:207]
  ds_read_b128 a[244:247], v237 offset:16640
  v_exp_f32 v214, v214
  v_exp_f32 v215, v215
  v_cvt_pk_bf16_f32 v90, v212, v213
  s_waitcnt lgkmcnt(2)
  v_mfma_f32_32x32x16_bf16 v[192:207], a[232:235], a[168:171], v[192:207]
  v_readfirstlane_b32 s39, v254
  ds_read_b128 a[248:251], v238 offset:16640
  v_cvt_pk_bf16_f32 v91, v214, v215
  v_dot2c_f32_bf16 v246, s45, v90
  v_dot2c_f32_bf16 v246, s45, v91
  v_mfma_f32_32x32x16_bf16 v[192:207], a[236:239], a[172:175], v[192:207]
  ds_read_b128 a[252:255], v239 offset:16640
  v_exp_f32 v216, v216
  v_exp_f32 v217, v217
  s_waitcnt lgkmcnt(2)
  v_mfma_f32_32x32x16_bf16 v[192:207], a[240:243], a[176:179], v[192:207]
  s_getpc_b64 s[30:31]
  s_cmp_ge_u32 s39, 14
  s_cbranch_scc0 L_spin4
  ds_read_b128 a[224:227], v232 offset:32768
  v_exp_f32 v218, v218
  v_mfma_f32_32x32x16_bf16 v[192:207], a[244:247], a[180:183], v[192:207]
  ds_read_b128 a[228:231], v233 offset:32768
  v_exp_f32 v219, v219
  v_cvt_pk_bf16_f32 v92, v216, v217
  v_cvt_pk_bf16_f32 v93, v218, v219
  v_dot2c_f32_bf16 v246, s45, v92
  s_waitcnt lgkmcnt(2)
  v_mfma_f32_32x32x16_bf16 v[192:207], a[248:251], a[184:187], v[192:207]
  ds_read_b128 a[232:235], v234 offset:32768
  v_dot2c_f32_bf16 v246, s45, v93
  v_exp_f32 v220, v220
  v_exp_f32 v221, v221
  v_mfma_f32_32x32x16_bf16 v[192:207], a[252:255], a[188:191], v[192:207]
  ds_add_u32 v251, v255 offset:8
  ds_read_b128 a[236:239], v235 offset:32768
  v_exp_f32 v222, v222
  v_exp_f32 v223, v223
  v_cvt_pk_bf16_f32 v94, v220, v221
  v_cvt_pk_bf16_f32 v95, v222, v223
  s_waitcnt lgkmcnt(3)
  v_mfma_f32_32x32x16_bf16 v[208:223], a[224:227], a[128:131], v[128:143]
  ds_read_b128 a[240:243], v236 offset:32768
  v_dot2c_f32_bf16 v246, s45, v94
  v_dot2c_f32_bf16 v246, s45, v95
  v_mfma_f32_32x32x16_bf16 v[208:223], a[228:231], a[132:135], v[208:223]
  ds_read_b128 a[244:247], v237 offset:32768
  v_max3_f32 v249, v192, v193, v194
  v_max3_f32 v249, v249, v195, v196
  v_max3_f32 v249, v249, v197, v198
  v_max3_f32 v249, v249, v199, v200
  v_max3_f32 v249, v249, v201, v202
  s_waitcnt lgkmcnt(2)
  v_mfma_f32_32x32x16_bf16 v[208:223], a[232:235], a[136:139], v[208:223]
  ds_read_b128 a[248:251], v238 offset:32768
  v_max3_f32 v249, v249, v203, v204
  v_max3_f32 v249, v249, v205, v206
  v_max_f32 v249, v249, v207
  v_cmp_lt_f32 vcc, 0x41000000, v249
  s_cbranch_vccnz L_rare_12
L_ret_12:
  v_mfma_f32_32x32x16_bf16 v[208:223], a[236:239], a[140:143], v[208:223]
  ds_read_b128 a[252:255], v239 offset:32768
  v_exp_f32 v192, v192
  v_exp_f32 v193, v193
  s_waitcnt lgkmcnt(2)
  v_mfma_f32_32x32x16_bf16 v[208:223], a[240:243], a[144:147], v[208:223]
  ds_read_b128 a[224:227], v232 offset:33024
  v_exp_f32 v194, v194
  v_exp_f32 v195, v195
  v_cvt_pk_bf16_f32 v96, v192, v193
  v_mfma_f32_32x32x16_bf16 v[208:223], a[244:247], a[148:151], v[208:223]
  ds_read_b128 a[228:231], v233 offset:33024
  v_cvt_pk_bf16_f32 v97, v194, v195
  v_dot2c_f32_bf16 v246, s45, v96
  v_dot2c_f32_bf16 v246, s45, v97
  v_exp_f32 v196, v196
  s_waitcnt lgkmcnt(2)
  v_mfma_f32_32x32x16_bf16 v[208:223], a[248:251], a[152:155], v[208:223]
  ds_read_b128 a[232:235], v234 offset:33024
  v_exp_f32 v197, v197
  v_exp_f32 v198, v198
  v_mfma_f32_32x32x16_bf16 v[208:223], a[252:255], a[156:159], v[208:223]
  ds_read_b32 v254, v251 offset:4
  ds_read_b128 a[236:239], v235 offset:33024
  v_exp_f32 v199, v199
  v_cvt_pk_bf16_f32 v98, v196, v197
  v_cvt_pk_bf16_f32 v99, v198, v199
  s_waitcnt lgkmcnt(3)
  v_mfma_f32_32x32x16_bf16 v[208:223], a[224:227], a[160:163], v[208:223]
  ds_read_b128 a[240:243], v236 offset:33024
  v_dot2c_f32_bf16 v246, s45, v98
  v_dot2c_f32_bf16 v246, s45, v99
  v_exp_f32 v200, v200
  v_mfma_f32_32x32x16_bf16 v[208:223], a[228:231], a[164:167], v[208:223]
  ds_read_b128 a[244:247], v237 offset:33024
  v_exp_f32 v201, v201
  v_exp_f32 v202, v202
  s_waitcnt lgkmcnt(2)
  v_mfma_f32_32x32x16_bf16 v[208:223], a[232:235], a[168:171], v[208:223]
  v_readfirstlane_b32 s39, v254
  ds_read_b128 a[248:251], v238 offset:33024
  v_exp_f32 v203, v203
  v_cvt_pk_bf16_f32 v100, v200, v201
  v_cvt_pk_bf16_f32 v101, v202, v203
  v_mfma_f32_32x32x16_bf16 v[208:223], a[236:239], a[172:175], v[208:223]
  ds_read_b128 a[252:255], v239 offset:33024
  v_dot2c_f32_bf16 v246, s45, v100
  v_dot2c_f32_bf16 v246, s45, v101
  v_exp_f32 v204, v204
  s_waitcnt lgkmcnt(2)
  v_mfma_f32_32x32x16_bf16 v[208:223], a[240:243], a[176:179], v[208:223]
  s_getpc_b64 s[30:31]
  s_cmp_ge_u32 s39, 15
  s_cbranch_scc0 L_spin4
  ds_read_b128 a[224:227], v144 offset:32768
  v_exp_f32 v205, v205
  v_mfma_f32_32x32x16_bf16 v[208:223], a[244:247], a[180:183], v[208:223]
  ds_read_b128 a[228:231], v145 offset:32768
  v_exp_f32 v206, v206
  v_exp_f32 v207, v207
  v_cvt_pk_bf16_f32 v102, v204, v205
  s_waitcnt lgkmcnt(2)
  v_mfma_f32_32x32x16_bf16 v[208:223], a[248:251], a[184:187], v[208:223]
  ds_read_b128 a[232:235], v146 offset:32768
  v_cvt_pk_bf16_f32 v103, v206, v207
  v_dot2c_f32_bf16 v246, s45, v102
  v_dot2c_f32_bf16 v246, s45, v103
  v_add_u32 v224, 65536, v240
  v_add_u32 v225, 65536, v241
  v_mfma_f32_32x32x16_bf16 v[208:223], a[252:255], a[188:191], v[208:223]
  ds_add_u32 v251, v255 offset:8
  ds_read_b128 a[236:239], v147 offset:32768
  v_add_u32 v226, 65536, v242
  v_add_u32 v227, 65536, v243
  v_add_u32 v228, 131072, v240
  v_add_u32 v229, 131072, v241
  s_waitcnt lgkmcnt(3)
  v_mfma_f32_32x32x16_bf16 v[192:207], a[224:227], a[128:131], v[128:143]
  ds_read_b128 a[240:243], v148 offset:32768
  v_add_u32 v230, 131072, v242
  v_add_u32 v231, 131072, v243
  v_mfma_f32_32x32x16_bf16 v[192:207], a[228:231], a[132:135], v[192:207]
  ds_read_b128 a[244:247], v149 offset:32768
  v_max3_f32 v249, v208, v209, v210
  v_max3_f32 v249, v249, v211, v212
  v_max3_f32 v249, v249, v213, v214
  v_max3_f32 v249, v249, v215, v216
  v_max3_f32 v249, v249, v217, v218
  s_waitcnt lgkmcnt(2)
  v_mfma_f32_32x32x16_bf16 v[192:207], a[232:235], a[136:139], v[192:207]
  ds_read_b128 a[248:251], v150 offset:32768
  v_max3_f32 v249, v249, v219, v220
  v_max3_f32 v249, v249, v221, v222
  v_max_f32 v249, v249, v223
  v_cmp_lt_f32 vcc, 0x41000000, v249
  s_cbranch_vccnz L_rare_13
L_ret_13:
  v_mfma_f32_32x32x16_bf16 v[192:207], a[236:239], a[140:143], v[192:207]
  ds_read_b128 a[252:255], v151 offset:32768
  v_exp_f32 v208, v208
  v_exp_f32 v209, v209
  s_waitcnt lgkmcnt(2)
  v_mfma_f32_32x32x16_bf16 v[192:207], a[240:243], a[144:147], v[192:207]
  ds_read_b128 a[224:227], v144 offset:33024
  v_exp_f32 v210, v210
  v_exp_f32 v211, v211
  v_cvt_pk_bf16_f32 v104, v208, v209
  v_mfma_f32_32x32x16_bf16 v[192:207], a[244:247], a[148:151], v[192:207]
  ds_read_b128 a[228:231], v145 offset:33024
  v_cvt_pk_bf16_f32 v105, v210, v211
  v_dot2c_f32_bf16 v246, s45, v104
  v_dot2c_f32_bf16 v246, s45, v105
  v_exp_f32 v212, v212
  s_waitcnt lgkmcnt(2)
  v_mfma_f32_32x32x16_bf16 v[192:207], a[248:251], a[152:155], v[192:207]
  ds_read_b128 a[232:235], v146 offset:33024
  v_exp_f32 v213, v213
  v_exp_f32 v214, v214
  v_mfma_f32_32x32x16_bf16 v[192:207], a[252:255], a[156:159], v[192:207]
  ds_read_b32 v254, v251 offset:4
  ds_read_b128 a[236:239], v147 offset:33024
  v_exp_f32 v215, v215
  v_cvt_pk_bf16_f32 v106, v212, v213
  v_cvt_pk_bf16_f32 v107, v214, v215
  s_waitcnt lgkmcnt(3)
  v_mfma_f32_32x32x16_bf16 v[192:207], a[224:227], a[160:163], v[192:207]
  ds_read_b128 a[240:243], v148 offset:33024
  v_dot2c_f32_bf16 v246, s45, v106
  v_dot2c_f32_bf16 v246, s45, v107
  v_exp_f32 v216, v216
  v_mfma_f32_32x32x16_bf16 v[192:207], a[228:231], a[164:167], v[192:207]
  ds_read_b128 a[244:247], v149 offset:33024
  v_exp_f32 v217, v217
  v_exp_f32 v218, v218
  s_waitcnt lgkmcnt(2)
  v_mfma_f32_32x32x16_bf16 v[192:207], a[232:235], a[168:171], v[192:207]
  v_readfirstlane_b32 s39, v254
  ds_read_b128 a[248:251], v150 offset:33024
  v_exp_f32 v219, v219
  v_cvt_pk_bf16_f32 v108, v216, v217
  v_cvt_pk_bf16_f32 v109, v218, v219
  v_mfma_f32_32x32x16_bf16 v[192:207], a[236:239], a[172:175], v[192:207]
  ds_read_b128 a[252:255], v151 offset:33024
  v_dot2c_f32_bf16 v246, s45, v108
  v_dot2c_f32_bf16 v246, s45, v109
  v_exp_f32 v220, v220
  s_waitcnt lgkmcnt(2)
  v_mfma_f32_32x32x16_bf16 v[192:207], a[240:243], a[176:179], v[192:207]
  s_getpc_b64 s[30:31]
  s_cmp_ge_u32 s39, 16
  s_cbranch_scc0 L_spin4
  ds_read_b128 a[224:227], v144 offset:49152
  v_exp_f32 v221, v221
  v_mfma_f32_32x32x16_bf16 v[192:207], a[244:247], a[180:183], v[192:207]
  ds_read_b128 a[228:231], v145 offset:49152
  v_exp_f32 v222, v222
  v_exp_f32 v223, v223
  v_cvt_pk_bf16_f32 v110, v220, v221
  s_waitcnt lgkmcnt(2)
  v_mfma_f32_32x32x16_bf16 v[192:207], a[248:251], a[184:187], v[192:207]
  ds_read_b128 a[232:235], v146 offset:49152
  v_cvt_pk_bf16_f32 v111, v222, v223
  v_dot2c_f32_bf16 v246, s45, v110
  v_dot2c_f32_bf16 v246, s45, v111
  v_mfma_f32_32x32x16_bf16 v[192:207], a[252:255], a[188:191], v[192:207]
  ds_add_u32 v251, v255 offset:8
  ds_read_b128 a[236:239], v147 offset:49152
  s_waitcnt lgkmcnt(3)
  v_mfma_f32_32x32x16_bf16 v[208:223], a[224:227], a[128:131], v[128:143]
  ds_read_b128 a[240:243], v148 offset:49152
  v_mfma_f32_32x32x16_bf16 v[208:223], a[228:231], a[132:135], v[208:223]
  ds_read_b128 a[244:247], v149 offset:49152
  s_waitcnt lgkmcnt(2)
  v_mfma_f32_32x32x16_bf16 v[208:223], a[232:235], a[136:139], v[208:223]
  ds_read_b128 a[248:251], v150 offset:49152
  v_mfma_f32_32x32x16_bf16 v[208:223], a[236:239], a[140:143], v[208:223]
  ds_read_b128 a[252:255], v151 offset:49152
  v_max3_f32 v249, v192, v193, v194
  v_max3_f32 v249, v249, v195, v196
  v_max3_f32 v249, v249, v197, v198
  v_max3_f32 v249, v249, v199, v200
  v_max3_f32 v249, v249, v201, v202
  s_waitcnt lgkmcnt(2)
  v_mfma_f32_32x32x16_bf16 v[208:223], a[240:243], a[144:147], v[208:223]
  ds_read_b128 a[224:227], v144 offset:49408
  v_max3_f32 v249, v249, v203, v204
  v_max3_f32 v249, v249, v205, v206
  v_max_f32 v249, v249, v207
  v_cmp_lt_f32 vcc, 0x41000000, v249
  s_cbranch_vccnz L_rare_14
L_ret_14:
  v_mfma_f32_32x32x16_bf16 v[208:223], a[244:247], a[148:151], v[208:223]
  ds_read_b128 a[228:231], v145 offset:49408
  v_exp_f32 v192, v192
  v_exp_f32 v193, v193
  s_waitcnt lgkmcnt(2)
  v_mfma_f32_32x32x16_bf16 v[208:223], a[248:251], a[152:155], v[208:223]
  ds_read_b128 a[232:235], v146 offset:49408
  v_exp_f32 v194, v194
  v_exp_f32 v195, v195
  v_cvt_pk_bf16_f32 v112, v192, v193
  v_mfma_f32_32x32x16_bf16 v[208:223], a[252:255], a[156:159], v[208:223]
  ds_read_b32 v254, v251 offset:4
  ds_read_b128 a[236:239], v147 offset:49408
  v_cvt_pk_bf16_f32 v113, v194, v195
  v_dot2c_f32_bf16 v246, s45, v112
  v_dot2c_f32_bf16 v246, s45, v113
  s_waitcnt lgkmcnt(3)
  v_mfma_f32_32x32x16_bf16 v[208:223], a[224:227], a[160:163], v[208:223]
  ds_read_b128 a[240:243], v148 offset:49408
  v_exp_f32 v196, v196
  v_exp_f32 v197, v197
  v_mfma_f32_32x32x16_bf16 v[208:223], a[228:231], a[164:167], v[208:223]
  ds_read_b128 a[244:247], v149 offset:49408
  v_exp_f32 v198, v198
  v_exp_f32 v199, v199
  v_cvt_pk_bf16_f32 v114, v196, v197
  s_waitcnt lgkmcnt(2)
  v_mfma_f32_32x32x16_bf16 v[208:223], a[232:235], a[168:171], v[208:223]
  v_readfirstlane_b32 s39, v254
  ds_read_b128 a[248:251], v150 offset:49408
  v_cvt_pk_bf16_f32 v115, v198, v199
  v_dot2c_f32_bf16 v246, s45, v114
  v_dot2c_f32_bf16 v246, s45, v115
  v_mfma_f32_32x32x16_bf16 v[208:223], a[236:239], a[172:175], v[208:223]
  ds_read_b128 a[252:255], v151 offset:49408
  v_exp_f32 v200, v200
  v_exp_f32 v201, v201
  s_waitcnt lgkmcnt(2)
  v_mfma_f32_32x32x16_bf16 v[208:223], a[240:243], a[176:179], v[208:223]
  s_getpc_b64 s[30:31]
  s_cmp_ge_u32 s39, 17
  s_cbranch_scc0 L_spin4
  ds_read_b64_tr_b16 a[224:225], v228 offset:0
  ds_read_b64_tr_b16 a[226:227], v228 offset:2048
  v_mfma_f32_32x32x16_bf16 v[208:223], a[244:247], a[180:183], v[208:223]
  ds_read_b64_tr_b16 a[228:229], v229 offset:0
  ds_read_b64_tr_b16 a[230:231], v229 offset:2048
  v_exp_f32 v202, v202
  v_exp_f32 v203, v203
  s_waitcnt lgkmcnt(4)
  v_mfma_f32_32x32x16_bf16 v[208:223], a[248:251], a[184:187], v[208:223]
  ds_read_b64_tr_b16 a[232:233], v230 offset:0
  ds_read_b64_tr_b16 a[234:235], v230 offset:2048
  v_cvt_pk_bf16_f32 v116, v200, v201
  v_cvt_pk_bf16_f32 v117, v202, v203
  v_dot2c_f32_bf16 v246, s45, v116
  v_dot2c_f32_bf16 v246, s45, v117
  v_mfma_f32_32x32x16_bf16 v[208:223], a[252:255], a[188:191], v[208:223]
  ds_add_u32 v251, v255 offset:8
  ds_read_b64_tr_b16 a[236:237], v231 offset:0
  ds_read_b64_tr_b16 a[238:239], v231 offset:2048
  v_exp_f32 v204, v204
  s_waitcnt lgkmcnt(5)
  v_mfma_f32_32x32x16_bf16 v[128:143], a[224:227], v[0:3], 0
  ds_read_b64_tr_b16 a[240:241], v228 offset:4096
  ds_read_b64_tr_b16 a[242:243], v228 offset:6144
  v_exp_f32 v205, v205
  v_exp_f32 v206, v206
  v_mfma_f32_32x32x16_bf16 v[144:159], a[228:231], v[0:3], 0
  ds_read_b64_tr_b16 a[244:245], v229 offset:4096
  ds_read_b64_tr_b16 a[246:247], v229 offset:6144
  v_exp_f32 v207, v207
  v_cvt_pk_bf16_f32 v118, v204, v205
  v_cvt_pk_bf16_f32 v119, v206, v207
  s_waitcnt lgkmcnt(4)
  v_mfma_f32_32x32x16_bf16 v[160:175], a[232:235], v[0:3], 0
  ds_read_b64_tr_b16 a[248:249], v230 offset:4096
  ds_read_b64_tr_b16 a[250:251], v230 offset:6144
  v_dot2c_f32_bf16 v246, s45, v118
  v_dot2c_f32_bf16 v246, s45, v119
  v_max3_f32 v249, v208, v209, v210
  v_max3_f32 v249, v249, v211, v212
  v_mfma_f32_32x32x16_bf16 v[176:191], a[236:239], v[0:3], 0
  ds_read_b64_tr_b16 a[252:253], v231 offset:4096
  ds_read_b64_tr_b16 a[254:255], v231 offset:6144
  v_max3_f32 v249, v249, v213, v214
  v_max3_f32 v249, v249, v215, v216
  v_max3_f32 v249, v249, v217, v218
  v_max3_f32 v249, v249, v219, v220
  s_waitcnt lgkmcnt(4)
  v_mfma_f32_32x32x16_bf16 v[128:143], a[240:243], v[4:7], v[128:143]
  ds_read_b64_tr_b16 a[224:225], v228 offset:8192
  ds_read_b64_tr_b16 a[226:227], v228 offset:10240
  v_max3_f32 v249, v249, v221, v222
  v_max_f32 v249, v249, v223
  v_cmp_lt_f32 vcc, 0x41000000, v249
  s_cbranch_vccnz L_rare_15
L_ret_15:
  v_mfma_f32_32x32x16_bf16 v[144:159], a[244:247], v[4:7], v[144:159]
  ds_read_b64_tr_b16 a[228:229], v229 offset:8192
  ds_read_b64_tr_b16 a[230:231], v229 offset:10240
  v_exp_f32 v208, v208
  v_exp_f32 v209, v209
  s_waitcnt lgkmcnt(4)
  v_mfma_f32_32x32x16_bf16 v[160:175], a[248:251], v[4:7], v[160:175]
  ds_read_b64_tr_b16 a[232:233], v230 offset:8192
  ds_read_b64_tr_b16 a[234:235], v230 offset:10240
  v_exp_f32 v210, v210
  v_exp_f32 v211, v211
  v_mfma_f32_32x32x16_bf16 v[176:191], a[252:255], v[4:7], v[176:191]
  ds_read_b32 v254, v251 offset:4
  ds_read_b64_tr_b16 a[236:237], v231 offset:8192
  ds_read_b64_tr_b16 a[238:239], v231 offset:10240
  v_cvt_pk_bf16_f32 v120, v208, v209
  v_cvt_pk_bf16_f32 v121, v210, v211
  v_dot2c_f32_bf16 v246, s45, v120
  s_waitcnt lgkmcnt(5)
  v_mfma_f32_32x32x16_bf16 v[128:143], a[224:227], v[8:11], v[128:143]
  ds_read_b64_tr_b16 a[240:241], v228 offset:12288
  ds_read_b64_tr_b16 a[242:243], v228 offset:14336
  v_dot2c_f32_bf16 v246, s45, v121
  v_exp_f32 v212, v212
  v_mfma_f32_32x32x16_bf16 v[144:159], a[228:231], v[8:11], v[144:159]
  ds_read_b64_tr_b16 a[244:245], v229 offset:12288
  ds_read_b64_tr_b16 a[246:247], v229 offset:14336
  v_exp_f32 v213, v213
  v_exp_f32 v214, v214
  s_waitcnt lgkmcnt(4)
  v_mfma_f32_32x32x16_bf16 v[160:175], a[232:235], v[8:11], v[160:175]
  v_readfirstlane_b32 s39, v254
  ds_read_b64_tr_b16 a[248:249], v230 offset:12288
  ds_read_b64_tr_b16 a[250:251], v230 offset:14336
  v_exp_f32 v215, v215
  v_cvt_pk_bf16_f32 v122, v212, v213
  v_mfma_f32_32x32x16_bf16 v[176:191], a[236:239], v[8:11], v[176:191]
  ds_read_b64_tr_b16 a[252:253], v231 offset:12288
  ds_read_b64_tr_b16 a[254:255], v231 offset:14336
  v_cvt_pk_bf16_f32 v123, v214, v215
  v_dot2c_f32_bf16 v246, s45, v122
  v_dot2c_f32_bf16 v246, s45, v123
  s_waitcnt lgkmcnt(4)
  v_mfma_f32_32x32x16_bf16 v[128:143], a[240:243], v[12:15], v[128:143]
  s_getpc_b64 s[30:31]
  s_cmp_ge_u32 s39, 18
  s_cbranch_scc0 L_spin4
  ds_read_b64_tr_b16 a[224:225], v224 offset:16384
  ds_read_b64_tr_b16 a[226:227], v224 offset:18432
  v_mfma_f32_32x32x16_bf16 v[144:159], a[244:247], v[12:15], v[144:159]
  ds_read_b64_tr_b16 a[228:229], v225 offset:16384
  ds_read_b64_tr_b16 a[230:231], v225 offset:18432
  v_exp_f32 v216, v216
  v_exp_f32 v217, v217
  s_waitcnt lgkmcnt(4)
  v_mfma_f32_32x32x16_bf16 v[160:175], a[248:251], v[12:15], v[160:175]
  ds_read_b64_tr_b16 a[232:233], v226 offset:16384
  ds_read_b64_tr_b16 a[234:235], v226 offset:18432
  v_exp_f32 v218, v218
  v_exp_f32 v219, v219
  v_mfma_f32_32x32x16_bf16 v[176:191], a[252:255], v[12:15], v[176:191]
  ds_add_u32 v251, v255 offset:8
  ds_read_b64_tr_b16 a[236:237], v227 offset:16384
  ds_read_b64_tr_b16 a[238:239], v227 offset:18432
  v_cvt_pk_bf16_f32 v124, v216, v217
  v_cvt_pk_bf16_f32 v125, v218, v219
  v_dot2c_f32_bf16 v246, s45, v124
  s_waitcnt lgkmcnt(5)
  v_mfma_f32_32x32x16_bf16 v[128:143], a[224:227], v[16:19], v[128:143]
  ds_read_b64_tr_b16 a[240:241], v224 offset:20480
  ds_read_b64_tr_b16 a[242:243], v224 offset:22528
  v_dot2c_f32_bf16 v246, s45, v125
  v_exp_f32 v220, v220
  v_mfma_f32_32x32x16_bf16 v[144:159], a[228:231], v[16:19], v[144:159]
  ds_read_b64_tr_b16 a[244:245], v225 offset:20480
  ds_read_b64_tr_b16 a[246:247], v225 offset:22528
  v_exp_f32 v221, v221
  s_waitcnt lgkmcnt(4)
  v_mfma_f32_32x32x16_bf16 v[160:175], a[232:235], v[16:19], v[160:175]
  ds_read_b64_tr_b16 a[248:249], v226 offset:20480
  ds_read_b64_tr_b16 a[250:251], v226 offset:22528
  v_exp_f32 v222, v222
  v_mfma_f32_32x32x16_bf16 v[176:191], a[236:239], v[16:19], v[176:191]
  ds_read_b64_tr_b16 a[252:253], v227 offset:20480
  ds_read_b64_tr_b16 a[254:255], v227 offset:22528
  v_exp_f32 v223, v223
  v_cvt_pk_bf16_f32 v126, v220, v221
  s_waitcnt lgkmcnt(4)
  v_mfma_f32_32x32x16_bf16 v[128:143], a[240:243], v[20:23], v[128:143]
  ds_read_b64_tr_b16 a[224:225], v224 offset:24576
  ds_read_b64_tr_b16 a[226:227], v224 offset:26624
  v_cvt_pk_bf16_f32 v127, v222, v223
  v_dot2c_f32_bf16 v246, s45, v126
  v_dot2c_f32_bf16 v246, s45, v127
  v_mfma_f32_32x32x16_bf16 v[144:159], a[244:247], v[20:23], v[144:159]
  ds_read_b64_tr_b16 a[228:229], v225 offset:24576
  ds_read_b64_tr_b16 a[230:231], v225 offset:26624
  v_mov_b32 v250, v246
  s_waitcnt lgkmcnt(4)
  v_mfma_f32_32x32x16_bf16 v[160:175], a[248:251], v[20:23], v[160:175]
  ds_read_b64_tr_b16 a[232:233], v226 offset:24576
  ds_read_b64_tr_b16 a[234:235], v226 offset:26624
  v_permlane32_swap_b32 v246, v250
  v_add_f32 v246, v246, v250
  v_mfma_f32_32x32x16_bf16 v[176:191], a[252:255], v[20:23], v[176:191]
  ds_read_b32 v254, v251 offset:4
  ds_read_b64_tr_b16 a[236:237], v227 offset:24576
  ds_read_b64_tr_b16 a[238:239], v227 offset:26624
  v_rcp_f32 v247, v246
  s_waitcnt lgkmcnt(5)
  v_mfma_f32_32x32x16_bf16 v[128:143], a[224:227], v[24:27], v[128:143]
  ds_read_b64_tr_b16 a[240:241], v224 offset:28672
  ds_read_b64_tr_b16 a[242:243], v224 offset:30720
  v_add_u32 v232, 65536, v244
  v_add_u32 v233, 65536, v245
  v_add_u32 v234, 131072, v244
  v_mfma_f32_32x32x16_bf16 v[144:159], a[228:231], v[24:27], v[144:159]
  ds_read_b64_tr_b16 a[244:245], v225 offset:28672
  ds_read_b64_tr_b16 a[246:247], v225 offset:30720
  v_add_u32 v235, 131072, v245
  s_waitcnt lgkmcnt(4)
  v_mfma_f32_32x32x16_bf16 v[160:175], a[232:235], v[24:27], v[160:175]
  v_readfirstlane_b32 s39, v254
  ds_read_b64_tr_b16 a[248:249], v226 offset:28672
  ds_read_b64_tr_b16 a[250:251], v226 offset:30720
  v_mfma_f32_32x32x16_bf16 v[176:191], a[236:239], v[24:27], v[176:191]
  ds_read_b64_tr_b16 a[252:253], v227 offset:28672
  ds_read_b64_tr_b16 a[254:255], v227 offset:30720
  s_waitcnt lgkmcnt(4)
  v_mfma_f32_32x32x16_bf16 v[128:143], a[240:243], v[28:31], v[128:143]
  s_getpc_b64 s[30:31]
  s_cmp_ge_u32 s39, 19
  s_cbranch_scc0 L_spin4
  ds_read_b64_tr_b16 a[224:225], v240 offset:49152
  ds_read_b64_tr_b16 a[226:227], v240 offset:51200
  v_mfma_f32_32x32x16_bf16 v[144:159], a[244:247], v[28:31], v[144:159]
  ds_read_b64_tr_b16 a[228:229], v241 offset:49152
  ds_read_b64_tr_b16 a[230:231], v241 offset:51200
  s_waitcnt lgkmcnt(4)
  v_mfma_f32_32x32x16_bf16 v[160:175], a[248:251], v[28:31], v[160:175]
  ds_read_b64_tr_b16 a[232:233], v242 offset:49152
  ds_read_b64_tr_b16 a[234:235], v242 offset:51200
  v_mfma_f32_32x32x16_bf16 v[176:191], a[252:255], v[28:31], v[176:191]
  ds_add_u32 v251, v255 offset:8
  ds_read_b64_tr_b16 a[236:237], v243 offset:49152
  ds_read_b64_tr_b16 a[238:239], v243 offset:51200
  s_waitcnt lgkmcnt(5)
  v_mfma_f32_32x32x16_bf16 v[128:143], a[224:227], v[32:35], v[128:143]
  ds_read_b64_tr_b16 a[240:241], v240 offset:53248
  ds_read_b64_tr_b16 a[242:243], v240 offset:55296
  v_mfma_f32_32x32x16_bf16 v[144:159], a[228:231], v[32:35], v[144:159]
  ds_read_b64_tr_b16 a[244:245], v241 offset:53248
  ds_read_b64_tr_b16 a[246:247], v241 offset:55296
  s_waitcnt lgkmcnt(4)
  v_mfma_f32_32x32x16_bf16 v[160:175], a[232:235], v[32:35], v[160:175]
  ds_read_b64_tr_b16 a[248:249], v242 offset:53248
  ds_read_b64_tr_b16 a[250:251], v242 offset:55296
  v_mfma_f32_32x32x16_bf16 v[176:191], a[236:239], v[32:35], v[176:191]
  ds_read_b64_tr_b16 a[252:253], v243 offset:53248
  ds_read_b64_tr_b16 a[254:255], v243 offset:55296
  s_waitcnt lgkmcnt(4)
  v_mfma_f32_32x32x16_bf16 v[128:143], a[240:243], v[36:39], v[128:143]
  ds_read_b64_tr_b16 a[224:225], v240 offset:57344
  ds_read_b64_tr_b16 a[226:227], v240 offset:59392
  v_mfma_f32_32x32x16_bf16 v[144:159], a[244:247], v[36:39], v[144:159]
  ds_read_b64_tr_b16 a[228:229], v241 offset:57344
  ds_read_b64_tr_b16 a[230:231], v241 offset:59392
  s_waitcnt lgkmcnt(4)
  v_mfma_f32_32x32x16_bf16 v[160:175], a[248:251], v[36:39], v[160:175]
  ds_read_b64_tr_b16 a[232:233], v242 offset:57344
  ds_read_b64_tr_b16 a[234:235], v242 offset:59392
  v_mfma_f32_32x32x16_bf16 v[176:191], a[252:255], v[36:39], v[176:191]
  ds_read_b32 v254, v251 offset:4
  ds_read_b64_tr_b16 a[236:237], v243 offset:57344
  ds_read_b64_tr_b16 a[238:239], v243 offset:59392
  s_waitcnt lgkmcnt(5)
  v_mfma_f32_32x32x16_bf16 v[128:143], a[224:227], v[40:43], v[128:143]
  ds_read_b64_tr_b16 a[240:241], v240 offset:61440
  ds_read_b64_tr_b16 a[242:243], v240 offset:63488
  v_mfma_f32_32x32x16_bf16 v[144:159], a[228:231], v[40:43], v[144:159]
  ds_read_b64_tr_b16 a[244:245], v241 offset:61440
  ds_read_b64_tr_b16 a[246:247], v241 offset:63488
  s_waitcnt lgkmcnt(4)
  v_mfma_f32_32x32x16_bf16 v[160:175], a[232:235], v[40:43], v[160:175]
  v_readfirstlane_b32 s39, v254
  ds_read_b64_tr_b16 a[248:249], v242 offset:61440
  ds_read_b64_tr_b16 a[250:251], v242 offset:63488
  v_mfma_f32_32x32x16_bf16 v[176:191], a[236:239], v[40:43], v[176:191]
  ds_read_b64_tr_b16 a[252:253], v243 offset:61440
  ds_read_b64_tr_b16 a[254:255], v243 offset:63488
  s_waitcnt lgkmcnt(4)
  v_mfma_f32_32x32x16_bf16 v[128:143], a[240:243], v[44:47], v[128:143]
  s_getpc_b64 s[30:31]
  s_cmp_ge_u32 s39, 20
  s_cbranch_scc0 L_spin4
  ds_read_b64_tr_b16 a[224:225], v224 offset:0
  ds_read_b64_tr_b16 a[226:227], v224 offset:2048
  v_mfma_f32_32x32x16_bf16 v[144:159], a[244:247], v[44:47], v[144:159]
  ds_read_b64_tr_b16 a[228:229], v225 offset:0
  ds_read_b64_tr_b16 a[230:231], v225 offset:2048
  s_waitcnt lgkmcnt(4)
  v_mfma_f32_32x32x16_bf16 v[160:175], a[248:251], v[44:47], v[160:175]
  ds_read_b64_tr_b16 a[232:233], v226 offset:0
  ds_read_b64_tr_b16 a[234:235], v226 offset:2048
  v_mfma_f32_32x32x16_bf16 v[176:191], a[252:255], v[44:47], v[176:191]
  ds_add_u32 v251, v255 offset:8
  ds_read_b64_tr_b16 a[236:237], v227 offset:0
  ds_read_b64_tr_b16 a[238:239], v227 offset:2048
  s_waitcnt lgkmcnt(5)
  v_mfma_f32_32x32x16_bf16 v[128:143], a[224:227], v[48:51], v[128:143]
  ds_read_b64_tr_b16 a[240:241], v224 offset:4096
  ds_read_b64_tr_b16 a[242:243], v224 offset:6144
  v_mfma_f32_32x32x16_bf16 v[144:159], a[228:231], v[48:51], v[144:159]
  ds_read_b64_tr_b16 a[244:245], v225 offset:4096
  ds_read_b64_tr_b16 a[246:247], v225 offset:6144
  s_waitcnt lgkmcnt(4)
  v_mfma_f32_32x32x16_bf16 v[160:175], a[232:235], v[48:51], v[160:175]
  ds_read_b64_tr_b16 a[248:249], v226 offset:4096
  ds_read_b64_tr_b16 a[250:251], v226 offset:6144
  v_mfma_f32_32x32x16_bf16 v[176:191], a[236:239], v[48:51], v[176:191]
  ds_read_b64_tr_b16 a[252:253], v227 offset:4096
  ds_read_b64_tr_b16 a[254:255], v227 offset:6144
  s_waitcnt lgkmcnt(4)
  v_mfma_f32_32x32x16_bf16 v[128:143], a[240:243], v[52:55], v[128:143]
  ds_read_b64_tr_b16 a[224:225], v224 offset:8192
  ds_read_b64_tr_b16 a[226:227], v224 offset:10240
  v_mfma_f32_32x32x16_bf16 v[144:159], a[244:247], v[52:55], v[144:159]
  ds_read_b64_tr_b16 a[228:229], v225 offset:8192
  ds_read_b64_tr_b16 a[230:231], v225 offset:10240
  s_waitcnt lgkmcnt(4)
  v_mfma_f32_32x32x16_bf16 v[160:175], a[248:251], v[52:55], v[160:175]
  ds_read_b64_tr_b16 a[232:233], v226 offset:8192
  ds_read_b64_tr_b16 a[234:235], v226 offset:10240
  v_mfma_f32_32x32x16_bf16 v[176:191], a[252:255], v[52:55], v[176:191]
  ds_read_b32 v254, v251 offset:4
  ds_read_b64_tr_b16 a[236:237], v227 offset:8192
  ds_read_b64_tr_b16 a[238:239], v227 offset:10240
  s_waitcnt lgkmcnt(5)
  v_mfma_f32_32x32x16_bf16 v[128:143], a[224:227], v[56:59], v[128:143]
  ds_read_b64_tr_b16 a[240:241], v224 offset:12288
  ds_read_b64_tr_b16 a[242:243], v224 offset:14336
  v_mfma_f32_32x32x16_bf16 v[144:159], a[228:231], v[56:59], v[144:159]
  ds_read_b64_tr_b16 a[244:245], v225 offset:12288
  ds_read_b64_tr_b16 a[246:247], v225 offset:14336
  s_waitcnt lgkmcnt(4)
  v_mfma_f32_32x32x16_bf16 v[160:175], a[232:235], v[56:59], v[160:175]
  v_readfirstlane_b32 s39, v254
  ds_read_b64_tr_b16 a[248:249], v226 offset:12288
  ds_read_b64_tr_b16 a[250:251], v226 offset:14336
  v_mfma_f32_32x32x16_bf16 v[176:191], a[236:239], v[56:59], v[176:191]
  ds_read_b64_tr_b16 a[252:253], v227 offset:12288
  ds_read_b64_tr_b16 a[254:255], v227 offset:14336
  s_waitcnt lgkmcnt(4)
  v_mfma_f32_32x32x16_bf16 v[128:143], a[240:243], v[60:63], v[128:143]
  s_getpc_b64 s[30:31]
  s_cmp_ge_u32 s39, 21
  s_cbranch_scc0 L_spin4
  ds_read_b64_tr_b16 a[224:225], v240 offset:0
  ds_read_b64_tr_b16 a[226:227], v240 offset:2048
  v_mfma_f32_32x32x16_bf16 v[144:159], a[244:247], v[60:63], v[144:159]
  ds_read_b64_tr_b16 a[228:229], v241 offset:0
  ds_read_b64_tr_b16 a[230:231], v241 offset:2048
  s_waitcnt lgkmcnt(4)
  v_mfma_f32_32x32x16_bf16 v[160:175], a[248:251], v[60:63], v[160:175]
  ds_read_b64_tr_b16 a[232:233], v242 offset:0
  ds_read_b64_tr_b16 a[234:235], v242 offset:2048
  v_mfma_f32_32x32x16_bf16 v[176:191], a[252:255], v[60:63], v[176:191]
  ds_add_u32 v251, v255 offset:8
  ds_read_b64_tr_b16 a[236:237], v243 offset:0
  ds_read_b64_tr_b16 a[238:239], v243 offset:2048
  s_waitcnt lgkmcnt(5)
  v_mfma_f32_32x32x16_bf16 v[128:143], a[224:227], v[64:67], v[128:143]
  ds_read_b64_tr_b16 a[240:241], v240 offset:4096
  ds_read_b64_tr_b16 a[242:243], v240 offset:6144
  v_mfma_f32_32x32x16_bf16 v[144:159], a[228:231], v[64:67], v[144:159]
  ds_read_b64_tr_b16 a[244:245], v241 offset:4096
  ds_read_b64_tr_b16 a[246:247], v241 offset:6144
  s_waitcnt lgkmcnt(4)
  v_mfma_f32_32x32x16_bf16 v[160:175], a[232:235], v[64:67], v[160:175]
  ds_read_b64_tr_b16 a[248:249], v242 offset:4096
  ds_read_b64_tr_b16 a[250:251], v242 offset:6144
  v_mfma_f32_32x32x16_bf16 v[176:191], a[236:239], v[64:67], v[176:191]
  ds_read_b64_tr_b16 a[252:253], v243 offset:4096
  ds_read_b64_tr_b16 a[254:255], v243 offset:6144
  s_waitcnt lgkmcnt(4)
  v_mfma_f32_32x32x16_bf16 v[128:143], a[240:243], v[68:71], v[128:143]
  ds_read_b64_tr_b16 a[224:225], v240 offset:8192
  ds_read_b64_tr_b16 a[226:227], v240 offset:10240
  v_mfma_f32_32x32x16_bf16 v[144:159], a[244:247], v[68:71], v[144:159]
  ds_read_b64_tr_b16 a[228:229], v241 offset:8192
  ds_read_b64_tr_b16 a[230:231], v241 offset:10240
  s_waitcnt lgkmcnt(4)
  v_mfma_f32_32x32x16_bf16 v[160:175], a[248:251], v[68:71], v[160:175]
  ds_read_b64_tr_b16 a[232:233], v242 offset:8192
  ds_read_b64_tr_b16 a[234:235], v242 offset:10240
  v_mfma_f32_32x32x16_bf16 v[176:191], a[252:255], v[68:71], v[176:191]
  ds_read_b32 v254, v251 offset:4
  ds_read_b64_tr_b16 a[236:237], v243 offset:8192
  ds_read_b64_tr_b16 a[238:239], v243 offset:10240
  s_waitcnt lgkmcnt(5)
  v_mfma_f32_32x32x16_bf16 v[128:143], a[224:227], v[72:75], v[128:143]
  ds_read_b64_tr_b16 a[240:241], v240 offset:12288
  ds_read_b64_tr_b16 a[242:243], v240 offset:14336
  v_mfma_f32_32x32x16_bf16 v[144:159], a[228:231], v[72:75], v[144:159]
  ds_read_b64_tr_b16 a[244:245], v241 offset:12288
  ds_read_b64_tr_b16 a[246:247], v241 offset:14336
  s_waitcnt lgkmcnt(4)
  v_mfma_f32_32x32x16_bf16 v[160:175], a[232:235], v[72:75], v[160:175]
  v_readfirstlane_b32 s39, v254
  ds_read_b64_tr_b16 a[248:249], v242 offset:12288
  ds_read_b64_tr_b16 a[250:251], v242 offset:14336
  v_mfma_f32_32x32x16_bf16 v[176:191], a[236:239], v[72:75], v[176:191]
  ds_read_b64_tr_b16 a[252:253], v243 offset:12288
  ds_read_b64_tr_b16 a[254:255], v243 offset:14336
  s_waitcnt lgkmcnt(4)
  v_mfma_f32_32x32x16_bf16 v[128:143], a[240:243], v[76:79], v[128:143]
  s_getpc_b64 s[30:31]
  s_cmp_ge_u32 s39, 22
  s_cbranch_scc0 L_spin4
  ds_read_b64_tr_b16 a[224:225], v240 offset:16384
  ds_read_b64_tr_b16 a[226:227], v240 offset:18432
  v_mfma_f32_32x32x16_bf16 v[144:159], a[244:247], v[76:79], v[144:159]
  ds_read_b64_tr_b16 a[228:229], v241 offset:16384
  ds_read_b64_tr_b16 a[230:231], v241 offset:18432
  s_waitcnt lgkmcnt(4)
  v_mfma_f32_32x32x16_bf16 v[160:175], a[248:251], v[76:79], v[160:175]
  ds_read_b64_tr_b16 a[232:233], v242 offset:16384
  ds_read_b64_tr_b16 a[234:235], v242 offset:18432
  v_mfma_f32_32x32x16_bf16 v[176:191], a[252:255], v[76:79], v[176:191]
  ds_add_u32 v251, v255 offset:8
  ds_read_b64_tr_b16 a[236:237], v243 offset:16384
  ds_read_b64_tr_b16 a[238:239], v243 offset:18432
  s_waitcnt lgkmcnt(5)
  v_mfma_f32_32x32x16_bf16 v[128:143], a[224:227], v[80:83], v[128:143]
  ds_read_b64_tr_b16 a[240:241], v240 offset:20480
  ds_read_b64_tr_b16 a[242:243], v240 offset:22528
  v_mfma_f32_32x32x16_bf16 v[144:159], a[228:231], v[80:83], v[144:159]
  ds_read_b64_tr_b16 a[244:245], v241 offset:20480
  ds_read_b64_tr_b16 a[246:247], v241 offset:22528
  s_waitcnt lgkmcnt(4)
  v_mfma_f32_32x32x16_bf16 v[160:175], a[232:235], v[80:83], v[160:175]
  ds_read_b64_tr_b16 a[248:249], v242 offset:20480
  ds_read_b64_tr_b16 a[250:251], v242 offset:22528
  v_mfma_f32_32x32x16_bf16 v[176:191], a[236:239], v[80:83], v[176:191]
  ds_read_b64_tr_b16 a[252:253], v243 offset:20480
  ds_read_b64_tr_b16 a[254:255], v243 offset:22528
  s_waitcnt lgkmcnt(4)
  v_mfma_f32_32x32x16_bf16 v[128:143], a[240:243], v[84:87], v[128:143]
  ds_read_b64_tr_b16 a[224:225], v240 offset:24576
  ds_read_b64_tr_b16 a[226:227], v240 offset:26624
  v_mfma_f32_32x32x16_bf16 v[144:159], a[244:247], v[84:87], v[144:159]
  ds_read_b64_tr_b16 a[228:229], v241 offset:24576
  ds_read_b64_tr_b16 a[230:231], v241 offset:26624
  s_waitcnt lgkmcnt(4)
  v_mfma_f32_32x32x16_bf16 v[160:175], a[248:251], v[84:87], v[160:175]
  ds_read_b64_tr_b16 a[232:233], v242 offset:24576
  ds_read_b64_tr_b16 a[234:235], v242 offset:26624
  v_mfma_f32_32x32x16_bf16 v[176:191], a[252:255], v[84:87], v[176:191]
  ds_read_b32 v254, v251 offset:4
  ds_read_b64_tr_b16 a[236:237], v243 offset:24576
  ds_read_b64_tr_b16 a[238:239], v243 offset:26624
  s_waitcnt lgkmcnt(5)
  v_mfma_f32_32x32x16_bf16 v[128:143], a[224:227], v[88:91], v[128:143]
  ds_read_b64_tr_b16 a[240:241], v240 offset:28672
  ds_read_b64_tr_b16 a[242:243], v240 offset:30720
  v_mfma_f32_32x32x16_bf16 v[144:159], a[228:231], v[88:91], v[144:159]
  ds_read_b64_tr_b16 a[244:245], v241 offset:28672
  ds_read_b64_tr_b16 a[246:247], v241 offset:30720
  s_waitcnt lgkmcnt(4)
  v_mfma_f32_32x32x16_bf16 v[160:175], a[232:235], v[88:91], v[160:175]
  v_readfirstlane_b32 s39, v254
  ds_read_b64_tr_b16 a[248:249], v242 offset:28672
  ds_read_b64_tr_b16 a[250:251], v242 offset:30720
  v_mfma_f32_32x32x16_bf16 v[176:191], a[236:239], v[88:91], v[176:191]
  ds_read_b64_tr_b16 a[252:253], v243 offset:28672
  ds_read_b64_tr_b16 a[254:255], v243 offset:30720
  s_waitcnt lgkmcnt(4)
  v_mfma_f32_32x32x16_bf16 v[128:143], a[240:243], v[92:95], v[128:143]
  s_getpc_b64 s[30:31]
  s_cmp_ge_u32 s39, 23
  s_cbranch_scc0 L_spin4
  ds_read_b64_tr_b16 a[224:225], v240 offset:32768
  ds_read_b64_tr_b16 a[226:227], v240 offset:34816
  v_mfma_f32_32x32x16_bf16 v[144:159], a[244:247], v[92:95], v[144:159]
  ds_read_b64_tr_b16 a[228:229], v241 offset:32768
  ds_read_b64_tr_b16 a[230:231], v241 offset:34816
  s_waitcnt lgkmcnt(4)
  v_mfma_f32_32x32x16_bf16 v[160:175], a[248:251], v[92:95], v[160:175]
  ds_read_b64_tr_b16 a[232:233], v242 offset:32768
  ds_read_b64_tr_b16 a[234:235], v242 offset:34816
  v_mfma_f32_32x32x16_bf16 v[176:191], a[252:255], v[92:95], v[176:191]
  ds_add_u32 v251, v255 offset:8
  ds_read_b64_tr_b16 a[236:237], v243 offset:32768
  ds_read_b64_tr_b16 a[238:239], v243 offset:34816
  s_waitcnt lgkmcnt(5)
  v_mfma_f32_32x32x16_bf16 v[128:143], a[224:227], v[96:99], v[128:143]
  ds_read_b64_tr_b16 a[240:241], v240 offset:36864
  ds_read_b64_tr_b16 a[242:243], v240 offset:38912
  v_mfma_f32_32x32x16_bf16 v[144:159], a[228:231], v[96:99], v[144:159]
  ds_read_b64_tr_b16 a[244:245], v241 offset:36864
  ds_read_b64_tr_b16 a[246:247], v241 offset:38912
  s_waitcnt lgkmcnt(4)
  v_mfma_f32_32x32x16_bf16 v[160:175], a[232:235], v[96:99], v[160:175]
  ds_read_b64_tr_b16 a[248:249], v242 offset:36864
  ds_read_b64_tr_b16 a[250:251], v242 offset:38912
  v_mfma_f32_32x32x16_bf16 v[176:191], a[236:239], v[96:99], v[176:191]
  ds_read_b64_tr_b16 a[252:253], v243 offset:36864
  ds_read_b64_tr_b16 a[254:255], v243 offset:38912
  s_waitcnt lgkmcnt(4)
  v_mfma_f32_32x32x16_bf16 v[128:143], a[240:243], v[100:103], v[128:143]
  ds_read_b64_tr_b16 a[224:225], v240 offset:40960
  ds_read_b64_tr_b16 a[226:227], v240 offset:43008
  v_mfma_f32_32x32x16_bf16 v[144:159], a[244:247], v[100:103], v[144:159]
  ds_read_b64_tr_b16 a[228:229], v241 offset:40960
  ds_read_b64_tr_b16 a[230:231], v241 offset:43008
  s_waitcnt lgkmcnt(4)
  v_mfma_f32_32x32x16_bf16 v[160:175], a[248:251], v[100:103], v[160:175]
  ds_read_b64_tr_b16 a[232:233], v242 offset:40960
  ds_read_b64_tr_b16 a[234:235], v242 offset:43008
  v_mfma_f32_32x32x16_bf16 v[176:191], a[252:255], v[100:103], v[176:191]
  ds_read_b32 v254, v251 offset:4
  ds_read_b64_tr_b16 a[236:237], v243 offset:40960
  ds_read_b64_tr_b16 a[238:239], v243 offset:43008
  s_waitcnt lgkmcnt(5)
  v_mfma_f32_32x32x16_bf16 v[128:143], a[224:227], v[104:107], v[128:143]
  ds_read_b64_tr_b16 a[240:241], v240 offset:45056
  ds_read_b64_tr_b16 a[242:243], v240 offset:47104
  v_mfma_f32_32x32x16_bf16 v[144:159], a[228:231], v[104:107], v[144:159]
  ds_read_b64_tr_b16 a[244:245], v241 offset:45056
  ds_read_b64_tr_b16 a[246:247], v241 offset:47104
  s_waitcnt lgkmcnt(4)
  v_mfma_f32_32x32x16_bf16 v[160:175], a[232:235], v[104:107], v[160:175]
  v_readfirstlane_b32 s39, v254
  ds_read_b64_tr_b16 a[248:249], v242 offset:45056
  ds_read_b64_tr_b16 a[250:251], v242 offset:47104
  v_mfma_f32_32x32x16_bf16 v[176:191], a[236:239], v[104:107], v[176:191]
  ds_read_b64_tr_b16 a[252:253], v243 offset:45056
  ds_read_b64_tr_b16 a[254:255], v243 offset:47104
  s_waitcnt lgkmcnt(4)
  v_mfma_f32_32x32x16_bf16 v[128:143], a[240:243], v[108:111], v[128:143]
  s_getpc_b64 s[30:31]
  s_cmp_ge_u32 s39, 24
  s_cbranch_scc0 L_spin4
  ds_read_b64_tr_b16 a[224:225], v224 offset:32768
  ds_read_b64_tr_b16 a[226:227], v224 offset:34816
  v_mfma_f32_32x32x16_bf16 v[144:159], a[244:247], v[108:111], v[144:159]
  ds_read_b64_tr_b16 a[228:229], v224 offset:36864
  ds_read_b64_tr_b16 a[230:231], v224 offset:38912
  s_waitcnt lgkmcnt(4)
  v_mfma_f32_32x32x16_bf16 v[160:175], a[248:251], v[108:111], v[160:175]
  ds_read_b64_tr_b16 a[232:233], v224 offset:40960
  ds_read_b64_tr_b16 a[234:235], v224 offset:43008
  v_mfma_f32_32x32x16_bf16 v[176:191], a[252:255], v[108:111], v[176:191]
  ds_add_u32 v251, v255 offset:8
  ds_read_b64_tr_b16 a[236:237], v224 offset:45056
  ds_read_b64_tr_b16 a[238:239], v224 offset:47104
  s_waitcnt lgkmcnt(5)
  v_mfma_f32_32x32x16_bf16 v[128:143], a[224:227], v[112:115], v[128:143]
  ds_read_b64_tr_b16 a[240:241], v225 offset:32768
  ds_read_b64_tr_b16 a[242:243], v225 offset:34816
  v_mfma_f32_32x32x16_bf16 v[128:143], a[228:231], v[116:119], v[128:143]
  ds_read_b64_tr_b16 a[244:245], v225 offset:36864
  ds_read_b64_tr_b16 a[246:247], v225 offset:38912
  s_waitcnt lgkmcnt(4)
  v_mfma_f32_32x32x16_bf16 v[128:143], a[232:235], v[120:123], v[128:143]
  ds_read_b64_tr_b16 a[248:249], v225 offset:40960
  ds_read_b64_tr_b16 a[250:251], v225 offset:43008
  v_mfma_f32_32x32x16_bf16 v[128:143], a[236:239], v[124:127], v[128:143]
  ds_read_b64_tr_b16 a[252:253], v225 offset:45056
  ds_read_b64_tr_b16 a[254:255], v225 offset:47104
  s_waitcnt lgkmcnt(4)
  v_mfma_f32_32x32x16_bf16 v[144:159], a[240:243], v[112:115], v[144:159]
  ds_read_b64_tr_b16 a[224:225], v226 offset:32768
  ds_read_b64_tr_b16 a[226:227], v226 offset:34816
  v_mfma_f32_32x32x16_bf16 v[144:159], a[244:247], v[116:119], v[144:159]
  ds_read_b64_tr_b16 a[228:229], v226 offset:36864
  ds_read_b64_tr_b16 a[230:231], v226 offset:38912
  s_waitcnt lgkmcnt(4)
  v_mfma_f32_32x32x16_bf16 v[144:159], a[248:251], v[120:123], v[144:159]
  ds_read_b64_tr_b16 a[232:233], v226 offset:40960
  ds_read_b64_tr_b16 a[234:235], v226 offset:43008
  v_mul_f32 v128, v128, v247
  v_mul_f32 v129, v129, v247
  v_mul_f32 v130, v130, v247
  v_mfma_f32_32x32x16_bf16 v[144:159], a[252:255], v[124:127], v[144:159]
  ds_read_b32 v254, v251 offset:4
  ds_read_b64_tr_b16 a[236:237], v226 offset:45056
  ds_read_b64_tr_b16 a[238:239], v226 offset:47104
  v_mul_f32 v131, v131, v247
  v_mul_f32 v132, v132, v247
  s_waitcnt lgkmcnt(5)
  v_mfma_f32_32x32x16_bf16 v[160:175], a[224:227], v[112:115], v[160:175]
  ds_read_b64_tr_b16 a[240:241], v227 offset:32768
  ds_read_b64_tr_b16 a[242:243], v227 offset:34816
  v_mul_f32 v133, v133, v247
  v_mul_f32 v134, v134, v247
  v_mul_f32 v135, v135, v247
  v_mfma_f32_32x32x16_bf16 v[160:175], a[228:231], v[116:119], v[160:175]
  ds_read_b64_tr_b16 a[244:245], v227 offset:36864
  ds_read_b64_tr_b16 a[246:247], v227 offset:38912
  v_cvt_pk_bf16_f32 v192, v128, v129
  v_cvt_pk_bf16_f32 v193, v130, v131
  v_cvt_pk_bf16_f32 v194, v132, v133
  s_waitcnt lgkmcnt(4)
  v_mfma_f32_32x32x16_bf16 v[160:175], a[232:235], v[120:123], v[160:175]
  v_readfirstlane_b32 s39, v254
  ds_read_b64_tr_b16 a[248:249], v227 offset:40960
  ds_read_b64_tr_b16 a[250:251], v227 offset:43008
  v_cvt_pk_bf16_f32 v195, v134, v135
  v_mul_f32 v136, v136, v247
  v_mfma_f32_32x32x16_bf16 v[160:175], a[236:239], v[124:127], v[160:175]
  ds_read_b64_tr_b16 a[252:253], v227 offset:45056
  ds_read_b64_tr_b16 a[254:255], v227 offset:47104
  v_mul_f32 v137, v137, v247
  v_mul_f32 v138, v138, v247
  v_mul_f32 v139, v139, v247
  s_waitcnt lgkmcnt(4)
  v_mfma_f32_32x32x16_bf16 v[176:191], a[240:243], v[112:115], v[176:191]
  s_getpc_b64 s[30:31]
  s_cmp_ge_u32 s39, 25
  s_cbranch_scc0 L_spin4
  ds_read_b64_tr_b16 a[224:225], v232 offset:49152
  ds_read_b64_tr_b16 a[226:227], v232 offset:50176
  v_mfma_f32_32x32x16_bf16 v[176:191], a[244:247], v[116:119], v[176:191]
  ds_read_b64_tr_b16 a[228:229], v232 offset:51200
  ds_read_b64_tr_b16 a[230:231], v232 offset:52224
  v_mul_f32 v140, v140, v247
  v_mul_f32 v141, v141, v247
  v_mul_f32 v142, v142, v247
  s_waitcnt lgkmcnt(4)
  v_mfma_f32_32x32x16_bf16 v[176:191], a[248:251], v[120:123], v[176:191]
  ds_read_b64_tr_b16 a[232:233], v232 offset:53248
  ds_read_b64_tr_b16 a[234:235], v232 offset:54272
  v_mul_f32 v143, v143, v247
  v_cvt_pk_bf16_f32 v196, v136, v137
  v_cvt_pk_bf16_f32 v197, v138, v139
  v_mfma_f32_32x32x16_bf16 v[176:191], a[252:255], v[124:127], v[176:191]
  ds_add_u32 v251, v255 offset:8
  ds_read_b64_tr_b16 a[236:237], v232 offset:55296
  ds_read_b64_tr_b16 a[238:239], v232 offset:56320
  v_cvt_pk_bf16_f32 v198, v140, v141
  v_cvt_pk_bf16_f32 v199, v142, v143
  s_waitcnt lgkmcnt(5)
  v_mfma_f32_32x32x16_bf16 a[0:15], a[224:227], v[192:195], 0
  ds_read_b64_tr_b16 a[240:241], v232 offset:57344
  ds_read_b64_tr_b16 a[242:243], v232 offset:58368
  v_mul_f32 v144, v144, v247
  v_mul_f32 v145, v145, v247
  v_mul_f32 v146, v146, v247
  v_mul_f32 v147, v147, v247
  v_mfma_f32_32x32x16_bf16 a[0:15], a[228:231], v[196:199], a[0:15]
  ds_read_b64_tr_b16 a[244:245], v232 offset:59392
  ds_read_b64_tr_b16 a[246:247], v232 offset:60416
  v_mul_f32 v148, v148, v247
  v_mul_f32 v149, v149, v247
  v_mul_f32 v150, v150, v247
  v_mul_f32 v151, v151, v247
  v_cvt_pk_bf16_f32 v200, v144, v145
  v_cvt_pk_bf16_f32 v201, v146, v147
  v_cvt_pk_bf16_f32 v202, v148, v149
  v_cvt_pk_bf16_f32 v203, v150, v151
  s_waitcnt lgkmcnt(4)
  s_nop 0
  v_mfma_f32_32x32x16_bf16 a[0:15], a[232:235], v[200:203], a[0:15]
  ds_read_b64_tr_b16 a[248:249], v232 offset:61440
  ds_read_b64_tr_b16 a[250:251], v232 offset:62464
  v_mul_f32 v152, v152, v247
  v_mul_f32 v153, v153, v247
  v_mul_f32 v154, v154, v247
  v_mul_f32 v155, v155, v247
  v_mul_f32 v156, v156, v247
  v_mul_f32 v157, v157, v247
  v_mul_f32 v158, v158, v247
  v_mul_f32 v159, v159, v247
  v_cvt_pk_bf16_f32 v204, v152, v153
  v_cvt_pk_bf16_f32 v205, v154, v155
  v_cvt_pk_bf16_f32 v206, v156, v157
  v_cvt_pk_bf16_f32 v207, v158, v159
  s_nop 1
  v_mfma_f32_32x32x16_bf16 a[0:15], a[236:239], v[204:207], a[0:15]
  ds_read_b64_tr_b16 a[252:253], v232 offset:63488
  ds_read_b64_tr_b16 a[254:255], v232 offset:64512
  v_mul_f32 v160, v160, v247
  v_mul_f32 v161, v161, v247
  v_mul_f32 v162, v162, v247
  v_mul_f32 v163, v163, v247
  v_mul_f32 v164, v164, v247
  v_mul_f32 v165, v165, v247
  v_mul_f32 v166, v166, v247
  v_mul_f32 v167, v167, v247
  v_cvt_pk_bf16_f32 v208, v160, v161
  v_cvt_pk_bf16_f32 v209, v162, v163
  v_cvt_pk_bf16_f32 v210, v164, v165
  v_cvt_pk_bf16_f32 v211, v166, v167
  s_waitcnt lgkmcnt(4)
  s_nop 0
  v_mfma_f32_32x32x16_bf16 a[0:15], a[240:243], v[208:211], a[0:15]
  ds_read_b64_tr_b16 a[224:225], v233 offset:49152
  ds_read_b64_tr_b16 a[226:227], v233 offset:50176
  v_mul_f32 v168, v168, v247
  v_mul_f32 v169, v169, v247
  v_mul_f32 v170, v170, v247
  v_mul_f32 v171, v171, v247
  v_mul_f32 v172, v172, v247
  v_mul_f32 v173, v173, v247
  v_mul_f32 v174, v174, v247
  v_mul_f32 v175, v175, v247
  v_cvt_pk_bf16_f32 v212, v168, v169
  v_cvt_pk_bf16_f32 v213, v170, v171
  v_cvt_pk_bf16_f32 v214, v172, v173
  v_cvt_pk_bf16_f32 v215, v174, v175
  s_nop 1
  v_mfma_f32_32x32x16_bf16 a[0:15], a[244:247], v[212:215], a[0:15]
  ds_read_b64_tr_b16 a[228:229], v233 offset:51200
  ds_read_b64_tr_b16 a[230:231], v233 offset:52224
  v_mul_f32 v176, v176, v247
  v_mul_f32 v177, v177, v247
  v_mul_f32 v178, v178, v247
  v_mul_f32 v179, v179, v247
  v_mul_f32 v180, v180, v247
  v_mul_f32 v181, v181, v247
  v_mul_f32 v182, v182, v247
  v_mul_f32 v183, v183, v247
  v_cvt_pk_bf16_f32 v216, v176, v177
  v_cvt_pk_bf16_f32 v217, v178, v179
  v_cvt_pk_bf16_f32 v218, v180, v181
  v_cvt_pk_bf16_f32 v219, v182, v183
  s_waitcnt lgkmcnt(4)
  s_nop 0
  v_mfma_f32_32x32x16_bf16 a[0:15], a[248:251], v[216:219], a[0:15]
  ds_read_b64_tr_b16 a[232:233], v233 offset:53248
  ds_read_b64_tr_b16 a[234:235], v233 offset:54272
  v_mul_f32 v184, v184, v247
  v_mul_f32 v185, v185, v247
  v_mul_f32 v186, v186, v247
  v_mul_f32 v187, v187, v247
  v_mul_f32 v188, v188, v247
  v_mul_f32 v189, v189, v247
  v_mul_f32 v190, v190, v247
  v_mul_f32 v191, v191, v247
  v_cvt_pk_bf16_f32 v220, v184, v185
  v_cvt_pk_bf16_f32 v221, v186, v187
  v_cvt_pk_bf16_f32 v222, v188, v189
  v_cvt_pk_bf16_f32 v223, v190, v191
  s_nop 1
  v_mfma_f32_32x32x16_bf16 a[0:15], a[252:255], v[220:223], a[0:15]
  ds_read_b32 v254, v251 offset:4
  ds_read_b64_tr_b16 a[236:237], v233 offset:55296
  ds_read_b64_tr_b16 a[238:239], v233 offset:56320
  s_waitcnt lgkmcnt(5)
  v_mfma_f32_32x32x16_bf16 a[16:31], a[224:227], v[192:195], 0
  ds_read_b64_tr_b16 a[240:241], v233 offset:57344
  ds_read_b64_tr_b16 a[242:243], v233 offset:58368
  v_mfma_f32_32x32x16_bf16 a[16:31], a[228:231], v[196:199], a[16:31]
  ds_read_b64_tr_b16 a[244:245], v233 offset:59392
  ds_read_b64_tr_b16 a[246:247], v233 offset:60416
  s_waitcnt lgkmcnt(4)
  v_mfma_f32_32x32x16_bf16 a[16:31], a[232:235], v[200:203], a[16:31]
  v_readfirstlane_b32 s39, v254
  ds_read_b64_tr_b16 a[248:249], v233 offset:61440
  ds_read_b64_tr_b16 a[250:251], v233 offset:62464
  v_mfma_f32_32x32x16_bf16 a[16:31], a[236:239], v[204:207], a[16:31]
  ds_read_b64_tr_b16 a[252:253], v233 offset:63488
  ds_read_b64_tr_b16 a[254:255], v233 offset:64512
  s_waitcnt lgkmcnt(4)
  v_mfma_f32_32x32x16_bf16 a[16:31], a[240:243], v[208:211], a[16:31]
  s_getpc_b64 s[30:31]
  s_cmp_ge_u32 s39, 26
  s_cbranch_scc0 L_spin4
  ds_read_b64_tr_b16 a[224:225], v234 offset:0
  ds_read_b64_tr_b16 a[226:227], v234 offset:1024
  v_mfma_f32_32x32x16_bf16 a[16:31], a[244:247], v[212:215], a[16:31]
  ds_read_b64_tr_b16 a[228:229], v234 offset:2048
  ds_read_b64_tr_b16 a[230:231], v234 offset:3072
  s_waitcnt lgkmcnt(4)
  v_mfma_f32_32x32x16_bf16 a[16:31], a[248:251], v[216:219], a[16:31]
  ds_read_b64_tr_b16 a[232:233], v234 offset:4096
  ds_read_b64_tr_b16 a[234:235], v234 offset:5120
  v_mfma_f32_32x32x16_bf16 a[16:31], a[252:255], v[220:223], a[16:31]
  ds_add_u32 v251, v255 offset:8
  ds_read_b64_tr_b16 a[236:237], v234 offset:6144
  ds_read_b64_tr_b16 a[238:239], v234 offset:7168
  s_waitcnt lgkmcnt(5)
  v_mfma_f32_32x32x16_bf16 a[32:47], a[224:227], v[192:195], 0
  ds_read_b64_tr_b16 a[240:241], v234 offset:8192
  ds_read_b64_tr_b16 a[242:243], v234 offset:9216
  v_mfma_f32_32x32x16_bf16 a[32:47], a[228:231], v[196:199], a[32:47]
  ds_read_b64_tr_b16 a[244:245], v234 offset:10240
  ds_read_b64_tr_b16 a[246:247], v234 offset:11264
  s_waitcnt lgkmcnt(4)
  v_mfma_f32_32x32x16_bf16 a[32:47], a[232:235], v[200:203], a[32:47]
  ds_read_b64_tr_b16 a[248:249], v234 offset:12288
  ds_read_b64_tr_b16 a[250:251], v234 offset:13312
  v_mfma_f32_32x32x16_bf16 a[32:47], a[236:239], v[204:207], a[32:47]
  ds_read_b64_tr_b16 a[252:253], v234 offset:14336
  ds_read_b64_tr_b16 a[254:255], v234 offset:15360
  s_waitcnt lgkmcnt(4)
  v_mfma_f32_32x32x16_bf16 a[32:47], a[240:243], v[208:211], a[32:47]
  ds_read_b64_tr_b16 a[224:225], v235 offset:0
  ds_read_b64_tr_b16 a[226:227], v235 offset:1024
  v_mfma_f32_32x32x16_bf16 a[32:47], a[244:247], v[212:215], a[32:47]
  ds_read_b64_tr_b16 a[228:229], v235 offset:2048
  ds_read_b64_tr_b16 a[230:231], v235 offset:3072
  s_waitcnt lgkmcnt(4)
  v_mfma_f32_32x32x16_bf16 a[32:47], a[248:251], v[216:219], a[32:47]
  ds_read_b64_tr_b16 a[232:233], v235 offset:4096
  ds_read_b64_tr_b16 a[234:235], v235 offset:5120
  v_mfma_f32_32x32x16_bf16 a[32:47], a[252:255], v[220:223], a[32:47]
  ds_read_b32 v254, v251 offset:4
  ds_read_b64_tr_b16 a[236:237], v235 offset:6144
  ds_read_b64_tr_b16 a[238:239], v235 offset:7168
  s_waitcnt lgkmcnt(5)
  v_mfma_f32_32x32x16_bf16 a[48:63], a[224:227], v[192:195], 0
  ds_read_b64_tr_b16 a[240:241], v235 offset:8192
  ds_read_b64_tr_b16 a[242:243], v235 offset:9216
  v_mfma_f32_32x32x16_bf16 a[48:63], a[228:231], v[196:199], a[48:63]
  ds_read_b64_tr_b16 a[244:245], v235 offset:10240
  ds_read_b64_tr_b16 a[246:247], v235 offset:11264
  s_waitcnt lgkmcnt(4)
  v_mfma_f32_32x32x16_bf16 a[48:63], a[232:235], v[200:203], a[48:63]
  v_readfirstlane_b32 s39, v254
  ds_read_b64_tr_b16 a[248:249], v235 offset:12288
  ds_read_b64_tr_b16 a[250:251], v235 offset:13312
  v_mfma_f32_32x32x16_bf16 a[48:63], a[236:239], v[204:207], a[48:63]
  ds_read_b64_tr_b16 a[252:253], v235 offset:14336
  ds_read_b64_tr_b16 a[254:255], v235 offset:15360
  s_waitcnt lgkmcnt(4)
  v_mfma_f32_32x32x16_bf16 a[48:63], a[240:243], v[208:211], a[48:63]
  s_getpc_b64 s[30:31]
  s_cmp_ge_u32 s39, 27
  s_cbranch_scc0 L_spin4
  ds_read_b64_tr_b16 a[224:225], v232 offset:16384
  ds_read_b64_tr_b16 a[226:227], v232 offset:17408
  v_mfma_f32_32x32x16_bf16 a[48:63], a[244:247], v[212:215], a[48:63]
  ds_read_b64_tr_b16 a[228:229], v232 offset:18432
  ds_read_b64_tr_b16 a[230:231], v232 offset:19456
  s_waitcnt lgkmcnt(4)
  v_mfma_f32_32x32x16_bf16 a[48:63], a[248:251], v[216:219], a[48:63]
  ds_read_b64_tr_b16 a[232:233], v232 offset:20480
  ds_read_b64_tr_b16 a[234:235], v232 offset:21504
  v_mfma_f32_32x32x16_bf16 a[48:63], a[252:255], v[220:223], a[48:63]
  ds_add_u32 v251, v255 offset:8
  ds_read_b64_tr_b16 a[236:237], v232 offset:22528
  ds_read_b64_tr_b16 a[238:239], v232 offset:23552
  s_waitcnt lgkmcnt(5)
  v_mfma_f32_32x32x16_bf16 a[64:79], a[224:227], v[192:195], 0
  ds_read_b64_tr_b16 a[240:241], v232 offset:24576
  ds_read_b64_tr_b16 a[242:243], v232 offset:25600
  v_mfma_f32_32x32x16_bf16 a[64:79], a[228:231], v[196:199], a[64:79]
  ds_read_b64_tr_b16 a[244:245], v232 offset:26624
  ds_read_b64_tr_b16 a[246:247], v232 offset:27648
  s_waitcnt lgkmcnt(4)
  v_mfma_f32_32x32x16_bf16 a[64:79], a[232:235], v[200:203], a[64:79]
  ds_read_b64_tr_b16 a[248:249], v232 offset:28672
  ds_read_b64_tr_b16 a[250:251], v232 offset:29696
  v_mfma_f32_32x32x16_bf16 a[64:79], a[236:239], v[204:207], a[64:79]
  ds_read_b64_tr_b16 a[252:253], v232 offset:30720
  ds_read_b64_tr_b16 a[254:255], v232 offset:31744
  s_waitcnt lgkmcnt(4)
  v_mfma_f32_32x32x16_bf16 a[64:79], a[240:243], v[208:211], a[64:79]
  ds_read_b64_tr_b16 a[224:225], v233 offset:16384
  ds_read_b64_tr_b16 a[226:227], v233 offset:17408
  v_mfma_f32_32x32x16_bf16 a[64:79], a[244:247], v[212:215], a[64:79]
  ds_read_b64_tr_b16 a[228:229], v233 offset:18432
  ds_read_b64_tr_b16 a[230:231], v233 offset:19456
  s_waitcnt lgkmcnt(4)
  v_mfma_f32_32x32x16_bf16 a[64:79], a[248:251], v[216:219], a[64:79]
  ds_read_b64_tr_b16 a[232:233], v233 offset:20480
  ds_read_b64_tr_b16 a[234:235], v233 offset:21504
  v_mfma_f32_32x32x16_bf16 a[64:79], a[252:255], v[220:223], a[64:79]
  ds_read_b32 v254, v251 offset:4
  ds_read_b64_tr_b16 a[236:237], v233 offset:22528
  ds_read_b64_tr_b16 a[238:239], v233 offset:23552
  s_waitcnt lgkmcnt(5)
  v_mfma_f32_32x32x16_bf16 a[80:95], a[224:227], v[192:195], 0
  ds_read_b64_tr_b16 a[240:241], v233 offset:24576
  ds_read_b64_tr_b16 a[242:243], v233 offset:25600
  v_mfma_f32_32x32x16_bf16 a[80:95], a[228:231], v[196:199], a[80:95]
  ds_read_b64_tr_b16 a[244:245], v233 offset:26624
  ds_read_b64_tr_b16 a[246:247], v233 offset:27648
  s_waitcnt lgkmcnt(4)
  v_mfma_f32_32x32x16_bf16 a[80:95], a[232:235], v[200:203], a[80:95]
  v_readfirstlane_b32 s39, v254
  ds_read_b64_tr_b16 a[248:249], v233 offset:28672
  ds_read_b64_tr_b16 a[250:251], v233 offset:29696
  v_mfma_f32_32x32x16_bf16 a[80:95], a[236:239], v[204:207], a[80:95]
  ds_read_b64_tr_b16 a[252:253], v233 offset:30720
  ds_read_b64_tr_b16 a[254:255], v233 offset:31744
  s_waitcnt lgkmcnt(4)
  v_mfma_f32_32x32x16_bf16 a[80:95], a[240:243], v[208:211], a[80:95]
  s_getpc_b64 s[30:31]
  s_cmp_ge_u32 s39, 28
  s_cbranch_scc0 L_spin4
  ds_read_b64_tr_b16 a[224:225], v244 offset:49152
  ds_read_b64_tr_b16 a[226:227], v244 offset:50176
  v_mfma_f32_32x32x16_bf16 a[80:95], a[244:247], v[212:215], a[80:95]
  ds_read_b64_tr_b16 a[228:229], v244 offset:51200
  ds_read_b64_tr_b16 a[230:231], v244 offset:52224
  s_waitcnt lgkmcnt(4)
  v_mfma_f32_32x32x16_bf16 a[80:95], a[248:251], v[216:219], a[80:95]
  ds_read_b64_tr_b16 a[232:233], v244 offset:53248
  ds_read_b64_tr_b16 a[234:235], v244 offset:54272
  v_mfma_f32_32x32x16_bf16 a[80:95], a[252:255], v[220:223], a[80:95]
  ds_add_u32 v251, v255 offset:8
  ds_read_b64_tr_b16 a[236:237], v244 offset:55296
  ds_read_b64_tr_b16 a[238:239], v244 offset:56320
  s_waitcnt lgkmcnt(5)
  v_mfma_f32_32x32x16_bf16 a[96:111], a[224:227], v[192:195], 0
  ds_read_b64_tr_b16 a[240:241], v244 offset:57344
  ds_read_b64_tr_b16 a[242:243], v244 offset:58368
  v_mfma_f32_32x32x16_bf16 a[96:111], a[228:231], v[196:199], a[96:111]
  ds_read_b64_tr_b16 a[244:245], v244 offset:59392
  ds_read_b64_tr_b16 a[246:247], v244 offset:60416
  s_waitcnt lgkmcnt(4)
  v_mfma_f32_32x32x16_bf16 a[96:111], a[232:235], v[200:203], a[96:111]
  ds_read_b64_tr_b16 a[248:249], v244 offset:61440
  ds_read_b64_tr_b16 a[250:251], v244 offset:62464
  v_mfma_f32_32x32x16_bf16 a[96:111], a[236:239], v[204:207], a[96:111]
  ds_read_b64_tr_b16 a[252:253], v244 offset:63488
  ds_read_b64_tr_b16 a[254:255], v244 offset:64512
  s_waitcnt lgkmcnt(4)
  v_mfma_f32_32x32x16_bf16 a[96:111], a[240:243], v[208:211], a[96:111]
  ds_read_b64_tr_b16 a[224:225], v245 offset:49152
  ds_read_b64_tr_b16 a[226:227], v245 offset:50176
  v_mfma_f32_32x32x16_bf16 a[96:111], a[244:247], v[212:215], a[96:111]
  ds_read_b64_tr_b16 a[228:229], v245 offset:51200
  ds_read_b64_tr_b16 a[230:231], v245 offset:52224
  s_waitcnt lgkmcnt(4)
  v_mfma_f32_32x32x16_bf16 a[96:111], a[248:251], v[216:219], a[96:111]
  ds_read_b64_tr_b16 a[232:233], v245 offset:53248
  ds_read_b64_tr_b16 a[234:235], v245 offset:54272
  v_mfma_f32_32x32x16_bf16 a[96:111], a[252:255], v[220:223], a[96:111]
  ds_read_b32 v254, v251 offset:4
  ds_read_b64_tr_b16 a[236:237], v245 offset:55296
  ds_read_b64_tr_b16 a[238:239], v245 offset:56320
  s_waitcnt lgkmcnt(5)
  v_mfma_f32_32x32x16_bf16 a[112:127], a[224:227], v[192:195], 0
  ds_read_b64_tr_b16 a[240:241], v245 offset:57344
  ds_read_b64_tr_b16 a[242:243], v245 offset:58368
  v_mfma_f32_32x32x16_bf16 a[112:127], a[228:231], v[196:199], a[112:127]
  ds_read_b64_tr_b16 a[244:245], v245 offset:59392
  ds_read_b64_tr_b16 a[246:247], v245 offset:60416
  s_waitcnt lgkmcnt(4)
  v_mfma_f32_32x32x16_bf16 a[112:127], a[232:235], v[200:203], a[112:127]
  v_readfirstlane_b32 s39, v254
  ds_read_b64_tr_b16 a[248:249], v245 offset:61440
  ds_read_b64_tr_b16 a[250:251], v245 offset:62464
  v_mfma_f32_32x32x16_bf16 a[112:127], a[236:239], v[204:207], a[112:127]
  ds_read_b64_tr_b16 a[252:253], v245 offset:63488
  ds_read_b64_tr_b16 a[254:255], v245 offset:64512
  s_waitcnt lgkmcnt(4)
  v_mfma_f32_32x32x16_bf16 a[112:127], a[240:243], v[208:211], a[112:127]
  s_getpc_b64 s[30:31]
  s_cmp_ge_u32 s39, 29
  s_cbranch_scc0 L_spin4
  ds_read_b64_tr_b16 a[224:225], v232 offset:0
  ds_read_b64_tr_b16 a[226:227], v232 offset:1024
  v_mfma_f32_32x32x16_bf16 a[112:127], a[244:247], v[212:215], a[112:127]
  ds_read_b64_tr_b16 a[228:229], v232 offset:2048
  ds_read_b64_tr_b16 a[230:231], v232 offset:3072
  s_waitcnt lgkmcnt(4)
  v_mfma_f32_32x32x16_bf16 a[112:127], a[248:251], v[216:219], a[112:127]
  ds_read_b64_tr_b16 a[232:233], v232 offset:4096
  ds_read_b64_tr_b16 a[234:235], v232 offset:5120
  v_mfma_f32_32x32x16_bf16 a[112:127], a[252:255], v[220:223], a[112:127]
  ds_add_u32 v251, v255 offset:8
  ds_read_b64_tr_b16 a[236:237], v232 offset:6144
  ds_read_b64_tr_b16 a[238:239], v232 offset:7168
  s_waitcnt lgkmcnt(5)
  v_mfma_f32_32x32x16_bf16 a[128:143], a[224:227], v[192:195], 0
  ds_read_b64_tr_b16 a[240:241], v232 offset:8192
  ds_read_b64_tr_b16 a[242:243], v232 offset:9216
  v_mfma_f32_32x32x16_bf16 a[128:143], a[228:231], v[196:199], a[128:143]
  ds_read_b64_tr_b16 a[244:245], v232 offset:10240
  ds_read_b64_tr_b16 a[246:247], v232 offset:11264
  s_waitcnt lgkmcnt(4)
  v_mfma_f32_32x32x16_bf16 a[128:143], a[232:235], v[200:203], a[128:143]
  ds_read_b64_tr_b16 a[248:249], v232 offset:12288
  ds_read_b64_tr_b16 a[250:251], v232 offset:13312
  v_mfma_f32_32x32x16_bf16 a[128:143], a[236:239], v[204:207], a[128:143]
  ds_read_b64_tr_b16 a[252:253], v232 offset:14336
  ds_read_b64_tr_b16 a[254:255], v232 offset:15360
  s_waitcnt lgkmcnt(4)
  v_mfma_f32_32x32x16_bf16 a[128:143], a[240:243], v[208:211], a[128:143]
  ds_read_b64_tr_b16 a[224:225], v233 offset:0
  ds_read_b64_tr_b16 a[226:227], v233 offset:1024
  v_mfma_f32_32x32x16_bf16 a[128:143], a[244:247], v[212:215], a[128:143]
  ds_read_b64_tr_b16 a[228:229], v233 offset:2048
  ds_read_b64_tr_b16 a[230:231], v233 offset:3072
  s_waitcnt lgkmcnt(4)
  v_mfma_f32_32x32x16_bf16 a[128:143], a[248:251], v[216:219], a[128:143]
  ds_read_b64_tr_b16 a[232:233], v233 offset:4096
  ds_read_b64_tr_b16 a[234:235], v233 offset:5120
  v_mfma_f32_32x32x16_bf16 a[128:143], a[252:255], v[220:223], a[128:143]
  ds_read_b32 v254, v251 offset:4
  ds_read_b64_tr_b16 a[236:237], v233 offset:6144
  ds_read_b64_tr_b16 a[238:239], v233 offset:7168
  s_waitcnt lgkmcnt(5)
  v_mfma_f32_32x32x16_bf16 a[144:159], a[224:227], v[192:195], 0
  ds_read_b64_tr_b16 a[240:241], v233 offset:8192
  ds_read_b64_tr_b16 a[242:243], v233 offset:9216
  v_mfma_f32_32x32x16_bf16 a[144:159], a[228:231], v[196:199], a[144:159]
  ds_read_b64_tr_b16 a[244:245], v233 offset:10240
  ds_read_b64_tr_b16 a[246:247], v233 offset:11264
  s_waitcnt lgkmcnt(4)
  v_mfma_f32_32x32x16_bf16 a[144:159], a[232:235], v[200:203], a[144:159]
  v_readfirstlane_b32 s39, v254
  ds_read_b64_tr_b16 a[248:249], v233 offset:12288
  ds_read_b64_tr_b16 a[250:251], v233 offset:13312
  v_mfma_f32_32x32x16_bf16 a[144:159], a[236:239], v[204:207], a[144:159]
  ds_read_b64_tr_b16 a[252:253], v233 offset:14336
  ds_read_b64_tr_b16 a[254:255], v233 offset:15360
  s_waitcnt lgkmcnt(4)
  v_mfma_f32_32x32x16_bf16 a[144:159], a[240:243], v[208:211], a[144:159]
  s_getpc_b64 s[30:31]
  s_cmp_ge_u32 s39, 30
  s_cbranch_scc0 L_spin4
  ds_read_b64_tr_b16 a[224:225], v244 offset:0
  ds_read_b64_tr_b16 a[226:227], v244 offset:1024
  v_mfma_f32_32x32x16_bf16 a[144:159], a[244:247], v[212:215], a[144:159]
  ds_read_b64_tr_b16 a[228:229], v244 offset:2048
  ds_read_b64_tr_b16 a[230:231], v244 offset:3072
  s_waitcnt lgkmcnt(4)
  v_mfma_f32_32x32x16_bf16 a[144:159], a[248:251], v[216:219], a[144:159]
  ds_read_b64_tr_b16 a[232:233], v244 offset:4096
  ds_read_b64_tr_b16 a[234:235], v244 offset:5120
  v_mfma_f32_32x32x16_bf16 a[144:159], a[252:255], v[220:223], a[144:159]
  ds_add_u32 v251, v255 offset:8
  ds_read_b64_tr_b16 a[236:237], v244 offset:6144
  ds_read_b64_tr_b16 a[238:239], v244 offset:7168
  s_waitcnt lgkmcnt(5)
  v_mfma_f32_32x32x16_bf16 a[160:175], a[224:227], v[192:195], 0
  ds_read_b64_tr_b16 a[240:241], v244 offset:8192
  ds_read_b64_tr_b16 a[242:243], v244 offset:9216
  v_mfma_f32_32x32x16_bf16 a[160:175], a[228:231], v[196:199], a[160:175]
  ds_read_b64_tr_b16 a[244:245], v244 offset:10240
  ds_read_b64_tr_b16 a[246:247], v244 offset:11264
  s_waitcnt lgkmcnt(4)
  v_mfma_f32_32x32x16_bf16 a[160:175], a[232:235], v[200:203], a[160:175]
  ds_read_b64_tr_b16 a[248:249], v244 offset:12288
  ds_read_b64_tr_b16 a[250:251], v244 offset:13312
  v_mfma_f32_32x32x16_bf16 a[160:175], a[236:239], v[204:207], a[160:175]
  ds_read_b64_tr_b16 a[252:253], v244 offset:14336
  ds_read_b64_tr_b16 a[254:255], v244 offset:15360
  s_waitcnt lgkmcnt(4)
  v_mfma_f32_32x32x16_bf16 a[160:175], a[240:243], v[208:211], a[160:175]
  ds_read_b64_tr_b16 a[224:225], v245 offset:0
  ds_read_b64_tr_b16 a[226:227], v245 offset:1024
  v_mfma_f32_32x32x16_bf16 a[160:175], a[244:247], v[212:215], a[160:175]
  ds_read_b64_tr_b16 a[228:229], v245 offset:2048
  ds_read_b64_tr_b16 a[230:231], v245 offset:3072
  s_waitcnt lgkmcnt(4)
  v_mfma_f32_32x32x16_bf16 a[160:175], a[248:251], v[216:219], a[160:175]
  ds_read_b64_tr_b16 a[232:233], v245 offset:4096
  ds_read_b64_tr_b16 a[234:235], v245 offset:5120
  v_mfma_f32_32x32x16_bf16 a[160:175], a[252:255], v[220:223], a[160:175]
  ds_read_b32 v254, v251 offset:4
  ds_read_b64_tr_b16 a[236:237], v245 offset:6144
  ds_read_b64_tr_b16 a[238:239], v245 offset:7168
  s_waitcnt lgkmcnt(5)
  v_mfma_f32_32x32x16_bf16 a[176:191], a[224:227], v[192:195], 0
  ds_read_b64_tr_b16 a[240:241], v245 offset:8192
  ds_read_b64_tr_b16 a[242:243], v245 offset:9216
  v_mfma_f32_32x32x16_bf16 a[176:191], a[228:231], v[196:199], a[176:191]
  ds_read_b64_tr_b16 a[244:245], v245 offset:10240
  ds_read_b64_tr_b16 a[246:247], v245 offset:11264
  s_waitcnt lgkmcnt(4)
  v_mfma_f32_32x32x16_bf16 a[176:191], a[232:235], v[200:203], a[176:191]
  v_readfirstlane_b32 s39, v254
  ds_read_b64_tr_b16 a[248:249], v245 offset:12288
  ds_read_b64_tr_b16 a[250:251], v245 offset:13312
  v_mfma_f32_32x32x16_bf16 a[176:191], a[236:239], v[204:207], a[176:191]
  ds_read_b64_tr_b16 a[252:253], v245 offset:14336
  ds_read_b64_tr_b16 a[254:255], v245 offset:15360
  s_waitcnt lgkmcnt(4)
  v_mfma_f32_32x32x16_bf16 a[176:191], a[240:243], v[208:211], a[176:191]
  s_getpc_b64 s[30:31]
  s_cmp_ge_u32 s39, 31
  s_cbranch_scc0 L_spin4
  ds_read_b64_tr_b16 a[224:225], v244 offset:16384
  ds_read_b64_tr_b16 a[226:227], v244 offset:17408
  v_mfma_f32_32x32x16_bf16 a[176:191], a[244:247], v[212:215], a[176:191]
  ds_read_b64_tr_b16 a[228:229], v244 offset:18432
  ds_read_b64_tr_b16 a[230:231], v244 offset:19456
  s_waitcnt lgkmcnt(4)
  v_mfma_f32_32x32x16_bf16 a[176:191], a[248:251], v[216:219], a[176:191]
  ds_read_b64_tr_b16 a[232:233], v244 offset:20480
  ds_read_b64_tr_b16 a[234:235], v244 offset:21504
  v_mfma_f32_32x32x16_bf16 a[176:191], a[252:255], v[220:223], a[176:191]
  ds_add_u32 v251, v255 offset:8
  ds_read_b64_tr_b16 a[236:237], v244 offset:22528
  ds_read_b64_tr_b16 a[238:239], v244 offset:23552
  s_waitcnt lgkmcnt(5)
  v_mfma_f32_32x32x16_bf16 a[192:207], a[224:227], v[192:195], 0
  ds_read_b64_tr_b16 a[240:241], v244 offset:24576
  ds_read_b64_tr_b16 a[242:243], v244 offset:25600
  v_mfma_f32_32x32x16_bf16 a[192:207], a[228:231], v[196:199], a[192:207]
  ds_read_b64_tr_b16 a[244:245], v244 offset:26624
  ds_read_b64_tr_b16 a[246:247], v244 offset:27648
  s_waitcnt lgkmcnt(4)
  v_mfma_f32_32x32x16_bf16 a[192:207], a[232:235], v[200:203], a[192:207]
  ds_read_b64_tr_b16 a[248:249], v244 offset:28672
  ds_read_b64_tr_b16 a[250:251], v244 offset:29696
  v_mfma_f32_32x32x16_bf16 a[192:207], a[236:239], v[204:207], a[192:207]
  ds_read_b64_tr_b16 a[252:253], v244 offset:30720
  ds_read_b64_tr_b16 a[254:255], v244 offset:31744
  s_waitcnt lgkmcnt(4)
  v_mfma_f32_32x32x16_bf16 a[192:207], a[240:243], v[208:211], a[192:207]
  ds_read_b64_tr_b16 a[224:225], v245 offset:16384
  ds_read_b64_tr_b16 a[226:227], v245 offset:17408
  v_mfma_f32_32x32x16_bf16 a[192:207], a[244:247], v[212:215], a[192:207]
  ds_read_b64_tr_b16 a[228:229], v245 offset:18432
  ds_read_b64_tr_b16 a[230:231], v245 offset:19456
  s_waitcnt lgkmcnt(4)
  v_mfma_f32_32x32x16_bf16 a[192:207], a[248:251], v[216:219], a[192:207]
  ds_read_b64_tr_b16 a[232:233], v245 offset:20480
  ds_read_b64_tr_b16 a[234:235], v245 offset:21504
  v_mfma_f32_32x32x16_bf16 a[192:207], a[252:255], v[220:223], a[192:207]
  ds_read_b32 v254, v251 offset:4
  ds_read_b64_tr_b16 a[236:237], v245 offset:22528
  ds_read_b64_tr_b16 a[238:239], v245 offset:23552
  s_waitcnt lgkmcnt(5)
  v_mfma_f32_32x32x16_bf16 a[208:223], a[224:227], v[192:195], 0
  ds_read_b64_tr_b16 a[240:241], v245 offset:24576
  ds_read_b64_tr_b16 a[242:243], v245 offset:25600
  v_mfma_f32_32x32x16_bf16 a[208:223], a[228:231], v[196:199], a[208:223]
  ds_read_b64_tr_b16 a[244:245], v245 offset:26624
  ds_read_b64_tr_b16 a[246:247], v245 offset:27648
  s_waitcnt lgkmcnt(4)
  v_mfma_f32_32x32x16_bf16 a[208:223], a[232:235], v[200:203], a[208:223]
  v_readfirstlane_b32 s39, v254
  ds_read_b64_tr_b16 a[248:249], v245 offset:28672
  ds_read_b64_tr_b16 a[250:251], v245 offset:29696
  v_mfma_f32_32x32x16_bf16 a[208:223], a[236:239], v[204:207], a[208:223]
  ds_read_b64_tr_b16 a[252:253], v245 offset:30720
  ds_read_b64_tr_b16 a[254:255], v245 offset:31744
  s_waitcnt lgkmcnt(4)
  v_mfma_f32_32x32x16_bf16 a[208:223], a[240:243], v[208:211], a[208:223]
  s_getpc_b64 s[30:31]
  s_cmp_ge_u32 s39, 32
  s_cbranch_scc0 L_spin4
  ds_read_b64_tr_b16 a[224:225], v240 offset:32768
  ds_read_b64_tr_b16 a[226:227], v240 offset:34816
  v_mfma_f32_32x32x16_bf16 a[208:223], a[244:247], v[212:215], a[208:223]
  ds_read_b64_tr_b16 a[228:229], v241 offset:32768
  ds_read_b64_tr_b16 a[230:231], v241 offset:34816
  s_waitcnt lgkmcnt(4)
  v_mfma_f32_32x32x16_bf16 a[208:223], a[248:251], v[216:219], a[208:223]
  ds_read_b64_tr_b16 a[232:233], v242 offset:32768
  ds_read_b64_tr_b16 a[234:235], v242 offset:34816
  v_mfma_f32_32x32x16_bf16 a[208:223], a[252:255], v[220:223], a[208:223]
  ds_add_u32 v251, v255 offset:8
  ds_read_b64_tr_b16 a[236:237], v243 offset:32768
  ds_read_b64_tr_b16 a[238:239], v243 offset:34816
  s_waitcnt lgkmcnt(5)
  v_mfma_f32_32x32x16_bf16 v[128:143], a[224:227], v[0:3], 0
  ds_read_b64_tr_b16 a[240:241], v240 offset:36864
  ds_read_b64_tr_b16 a[242:243], v240 offset:38912
  v_mfma_f32_32x32x16_bf16 v[144:159], a[228:231], v[0:3], 0
  ds_read_b64_tr_b16 a[244:245], v241 offset:36864
  ds_read_b64_tr_b16 a[246:247], v241 offset:38912
  s_waitcnt lgkmcnt(4)
  v_mfma_f32_32x32x16_bf16 v[160:175], a[232:235], v[0:3], 0
  ds_read_b64_tr_b16 a[248:249], v242 offset:36864
  ds_read_b64_tr_b16 a[250:251], v242 offset:38912
  v_mfma_f32_32x32x16_bf16 v[176:191], a[236:239], v[0:3], 0
  ds_read_b64_tr_b16 a[252:253], v243 offset:36864
  ds_read_b64_tr_b16 a[254:255], v243 offset:38912
  s_waitcnt lgkmcnt(4)
  v_mfma_f32_32x32x16_bf16 v[128:143], a[240:243], v[4:7], v[128:143]
  ds_read_b64_tr_b16 a[224:225], v240 offset:40960
  ds_read_b64_tr_b16 a[226:227], v240 offset:43008
  v_mfma_f32_32x32x16_bf16 v[144:159], a[244:247], v[4:7], v[144:159]
  ds_read_b64_tr_b16 a[228:229], v241 offset:40960
  ds_read_b64_tr_b16 a[230:231], v241 offset:43008
  s_waitcnt lgkmcnt(4)
  v_mfma_f32_32x32x16_bf16 v[160:175], a[248:251], v[4:7], v[160:175]
  ds_read_b64_tr_b16 a[232:233], v242 offset:40960
  ds_read_b64_tr_b16 a[234:235], v242 offset:43008
  v_mfma_f32_32x32x16_bf16 v[176:191], a[252:255], v[4:7], v[176:191]
  ds_read_b32 v254, v251 offset:4
  ds_read_b64_tr_b16 a[236:237], v243 offset:40960
  ds_read_b64_tr_b16 a[238:239], v243 offset:43008
  s_waitcnt lgkmcnt(5)
  v_mfma_f32_32x32x16_bf16 v[128:143], a[224:227], v[8:11], v[128:143]
  ds_read_b64_tr_b16 a[240:241], v240 offset:45056
  ds_read_b64_tr_b16 a[242:243], v240 offset:47104
  v_mfma_f32_32x32x16_bf16 v[144:159], a[228:231], v[8:11], v[144:159]
  ds_read_b64_tr_b16 a[244:245], v241 offset:45056
  ds_read_b64_tr_b16 a[246:247], v241 offset:47104
  s_waitcnt lgkmcnt(4)
  v_mfma_f32_32x32x16_bf16 v[160:175], a[232:235], v[8:11], v[160:175]
  v_readfirstlane_b32 s39, v254
  ds_read_b64_tr_b16 a[248:249], v242 offset:45056
  ds_read_b64_tr_b16 a[250:251], v242 offset:47104
  v_mfma_f32_32x32x16_bf16 v[176:191], a[236:239], v[8:11], v[176:191]
  ds_read_b64_tr_b16 a[252:253], v243 offset:45056
  ds_read_b64_tr_b16 a[254:255], v243 offset:47104
  s_waitcnt lgkmcnt(4)
  v_mfma_f32_32x32x16_bf16 v[128:143], a[240:243], v[12:15], v[128:143]
  s_getpc_b64 s[30:31]
  s_cmp_ge_u32 s39, 33
  s_cbranch_scc0 L_spin4
  ds_read_b64_tr_b16 a[224:225], v224 offset:32768
  ds_read_b64_tr_b16 a[226:227], v224 offset:34816
  v_mfma_f32_32x32x16_bf16 v[144:159], a[244:247], v[12:15], v[144:159]
  ds_read_b64_tr_b16 a[228:229], v225 offset:32768
  ds_read_b64_tr_b16 a[230:231], v225 offset:34816
  s_waitcnt lgkmcnt(4)
  v_mfma_f32_32x32x16_bf16 v[160:175], a[248:251], v[12:15], v[160:175]
  ds_read_b64_tr_b16 a[232:233], v226 offset:32768
  ds_read_b64_tr_b16 a[234:235], v226 offset:34816
  v_mfma_f32_32x32x16_bf16 v[176:191], a[252:255], v[12:15], v[176:191]
  ds_add_u32 v251, v255 offset:8
  ds_read_b64_tr_b16 a[236:237], v227 offset:32768
  ds_read_b64_tr_b16 a[238:239], v227 offset:34816
  s_waitcnt lgkmcnt(5)
  v_mfma_f32_32x32x16_bf16 v[128:143], a[224:227], v[16:19], v[128:143]
  ds_read_b64_tr_b16 a[240:241], v224 offset:36864
  ds_read_b64_tr_b16 a[242:243], v224 offset:38912
  v_mfma_f32_32x32x16_bf16 v[144:159], a[228:231], v[16:19], v[144:159]
  ds_read_b64_tr_b16 a[244:245], v225 offset:36864
  ds_read_b64_tr_b16 a[246:247], v225 offset:38912
  s_waitcnt lgkmcnt(4)
  v_mfma_f32_32x32x16_bf16 v[160:175], a[232:235], v[16:19], v[160:175]
  ds_read_b64_tr_b16 a[248:249], v226 offset:36864
  ds_read_b64_tr_b16 a[250:251], v226 offset:38912
  v_mfma_f32_32x32x16_bf16 v[176:191], a[236:239], v[16:19], v[176:191]
  ds_read_b64_tr_b16 a[252:253], v227 offset:36864
  ds_read_b64_tr_b16 a[254:255], v227 offset:38912
  s_waitcnt lgkmcnt(4)
  v_mfma_f32_32x32x16_bf16 v[128:143], a[240:243], v[20:23], v[128:143]
  ds_read_b64_tr_b16 a[224:225], v224 offset:40960
  ds_read_b64_tr_b16 a[226:227], v224 offset:43008
  v_mfma_f32_32x32x16_bf16 v[144:159], a[244:247], v[20:23], v[144:159]
  ds_read_b64_tr_b16 a[228:229], v225 offset:40960
  ds_read_b64_tr_b16 a[230:231], v225 offset:43008
  s_waitcnt lgkmcnt(4)
  v_mfma_f32_32x32x16_bf16 v[160:175], a[248:251], v[20:23], v[160:175]
  ds_read_b64_tr_b16 a[232:233], v226 offset:40960
  ds_read_b64_tr_b16 a[234:235], v226 offset:43008
  v_mfma_f32_32x32x16_bf16 v[176:191], a[252:255], v[20:23], v[176:191]
  ds_read_b32 v254, v251 offset:4
  ds_read_b64_tr_b16 a[236:237], v227 offset:40960
  ds_read_b64_tr_b16 a[238:239], v227 offset:43008
  s_waitcnt lgkmcnt(5)
  v_mfma_f32_32x32x16_bf16 v[128:143], a[224:227], v[24:27], v[128:143]
  ds_read_b64_tr_b16 a[240:241], v224 offset:45056
  ds_read_b64_tr_b16 a[242:243], v224 offset:47104
  v_mfma_f32_32x32x16_bf16 v[144:159], a[228:231], v[24:27], v[144:159]
  ds_read_b64_tr_b16 a[244:245], v225 offset:45056
  ds_read_b64_tr_b16 a[246:247], v225 offset:47104
  s_waitcnt lgkmcnt(4)
  v_mfma_f32_32x32x16_bf16 v[160:175], a[232:235], v[24:27], v[160:175]
  v_readfirstlane_b32 s39, v254
  ds_read_b64_tr_b16 a[248:249], v226 offset:45056
  ds_read_b64_tr_b16 a[250:251], v226 offset:47104
  v_mfma_f32_32x32x16_bf16 v[176:191], a[236:239], v[24:27], v[176:191]
  ds_read_b64_tr_b16 a[252:253], v227 offset:45056
  ds_read_b64_tr_b16 a[254:255], v227 offset:47104
  s_waitcnt lgkmcnt(4)
  v_mfma_f32_32x32x16_bf16 v[128:143], a[240:243], v[28:31], v[128:143]
  s_getpc_b64 s[30:31]
  s_cmp_ge_u32 s39, 34
  s_cbranch_scc0 L_spin4
  ds_read_b64_tr_b16 a[224:225], v224 offset:49152
  ds_read_b64_tr_b16 a[226:227], v224 offset:51200
  v_mfma_f32_32x32x16_bf16 v[144:159], a[244:247], v[28:31], v[144:159]
  ds_read_b64_tr_b16 a[228:229], v225 offset:49152
  ds_read_b64_tr_b16 a[230:231], v225 offset:51200
  s_waitcnt lgkmcnt(4)
  v_mfma_f32_32x32x16_bf16 v[160:175], a[248:251], v[28:31], v[160:175]
  ds_read_b64_tr_b16 a[232:233], v226 offset:49152
  ds_read_b64_tr_b16 a[234:235], v226 offset:51200
  v_mfma_f32_32x32x16_bf16 v[176:191], a[252:255], v[28:31], v[176:191]
  ds_add_u32 v251, v255 offset:8
  ds_read_b64_tr_b16 a[236:237], v227 offset:49152
  ds_read_b64_tr_b16 a[238:239], v227 offset:51200
  s_waitcnt lgkmcnt(5)
  v_mfma_f32_32x32x16_bf16 v[128:143], a[224:227], v[32:35], v[128:143]
  ds_read_b64_tr_b16 a[240:241], v224 offset:53248
  ds_read_b64_tr_b16 a[242:243], v224 offset:55296
  v_mfma_f32_32x32x16_bf16 v[144:159], a[228:231], v[32:35], v[144:159]
  ds_read_b64_tr_b16 a[244:245], v225 offset:53248
  ds_read_b64_tr_b16 a[246:247], v225 offset:55296
  s_waitcnt lgkmcnt(4)
  v_mfma_f32_32x32x16_bf16 v[160:175], a[232:235], v[32:35], v[160:175]
  ds_read_b64_tr_b16 a[248:249], v226 offset:53248
  ds_read_b64_tr_b16 a[250:251], v226 offset:55296
  v_mfma_f32_32x32x16_bf16 v[176:191], a[236:239], v[32:35], v[176:191]
  ds_read_b64_tr_b16 a[252:253], v227 offset:53248
  ds_read_b64_tr_b16 a[254:255], v227 offset:55296
  s_waitcnt lgkmcnt(4)
  v_mfma_f32_32x32x16_bf16 v[128:143], a[240:243], v[36:39], v[128:143]
  ds_read_b64_tr_b16 a[224:225], v224 offset:57344
  ds_read_b64_tr_b16 a[226:227], v224 offset:59392
  v_mfma_f32_32x32x16_bf16 v[144:159], a[244:247], v[36:39], v[144:159]
  ds_read_b64_tr_b16 a[228:229], v225 offset:57344
  ds_read_b64_tr_b16 a[230:231], v225 offset:59392
  s_waitcnt lgkmcnt(4)
  v_mfma_f32_32x32x16_bf16 v[160:175], a[248:251], v[36:39], v[160:175]
  ds_read_b64_tr_b16 a[232:233], v226 offset:57344
  ds_read_b64_tr_b16 a[234:235], v226 offset:59392
  v_mfma_f32_32x32x16_bf16 v[176:191], a[252:255], v[36:39], v[176:191]
  ds_read_b32 v254, v251 offset:4
  ds_read_b64_tr_b16 a[236:237], v227 offset:57344
  ds_read_b64_tr_b16 a[238:239], v227 offset:59392
  s_waitcnt lgkmcnt(5)
  v_mfma_f32_32x32x16_bf16 v[128:143], a[224:227], v[40:43], v[128:143]
  ds_read_b64_tr_b16 a[240:241], v224 offset:61440
  ds_read_b64_tr_b16 a[242:243], v224 offset:63488
  v_mfma_f32_32x32x16_bf16 v[144:159], a[228:231], v[40:43], v[144:159]
  ds_read_b64_tr_b16 a[244:245], v225 offset:61440
  ds_read_b64_tr_b16 a[246:247], v225 offset:63488
  s_waitcnt lgkmcnt(4)
  v_mfma_f32_32x32x16_bf16 v[160:175], a[232:235], v[40:43], v[160:175]
  v_readfirstlane_b32 s39, v254
  ds_read_b64_tr_b16 a[248:249], v226 offset:61440
  ds_read_b64_tr_b16 a[250:251], v226 offset:63488
  v_mfma_f32_32x32x16_bf16 v[176:191], a[236:239], v[40:43], v[176:191]
  ds_read_b64_tr_b16 a[252:253], v227 offset:61440
  ds_read_b64_tr_b16 a[254:255], v227 offset:63488
  s_waitcnt lgkmcnt(4)
  v_mfma_f32_32x32x16_bf16 v[128:143], a[240:243], v[44:47], v[128:143]
  s_getpc_b64 s[30:31]
  s_cmp_ge_u32 s39, 35
  s_cbranch_scc0 L_spin4
  ds_read_b64_tr_b16 a[224:225], v228 offset:0
  ds_read_b64_tr_b16 a[226:227], v228 offset:2048
  v_mfma_f32_32x32x16_bf16 v[144:159], a[244:247], v[44:47], v[144:159]
  ds_read_b64_tr_b16 a[228:229], v229 offset:0
  ds_read_b64_tr_b16 a[230:231], v229 offset:2048
  s_waitcnt lgkmcnt(4)
  v_mfma_f32_32x32x16_bf16 v[160:175], a[248:251], v[44:47], v[160:175]
  ds_read_b64_tr_b16 a[232:233], v230 offset:0
  ds_read_b64_tr_b16 a[234:235], v230 offset:2048
  v_mfma_f32_32x32x16_bf16 v[176:191], a[252:255], v[44:47], v[176:191]
  ds_add_u32 v251, v255 offset:8
  ds_read_b64_tr_b16 a[236:237], v231 offset:0
  ds_read_b64_tr_b16 a[238:239], v231 offset:2048
  s_waitcnt lgkmcnt(5)
  v_mfma_f32_32x32x16_bf16 v[128:143], a[224:227], v[48:51], v[128:143]
  ds_read_b64_tr_b16 a[240:241], v228 offset:4096
  ds_read_b64_tr_b16 a[242:243], v228 offset:6144
  v_mfma_f32_32x32x16_bf16 v[144:159], a[228:231], v[48:51], v[144:159]
  ds_read_b64_tr_b16 a[244:245], v229 offset:4096
  ds_read_b64_tr_b16 a[246:247], v229 offset:6144
  s_waitcnt lgkmcnt(4)
  v_mfma_f32_32x32x16_bf16 v[160:175], a[232:235], v[48:51], v[160:175]
  ds_read_b64_tr_b16 a[248:249], v230 offset:4096
  ds_read_b64_tr_b16 a[250:251], v230 offset:6144
  v_mfma_f32_32x32x16_bf16 v[176:191], a[236:239], v[48:51], v[176:191]
  ds_read_b64_tr_b16 a[252:253], v231 offset:4096
  ds_read_b64_tr_b16 a[254:255], v231 offset:6144
  s_waitcnt lgkmcnt(4)
  v_mfma_f32_32x32x16_bf16 v[128:143], a[240:243], v[52:55], v[128:143]
  ds_read_b64_tr_b16 a[224:225], v228 offset:8192
  ds_read_b64_tr_b16 a[226:227], v228 offset:10240
  v_mfma_f32_32x32x16_bf16 v[144:159], a[244:247], v[52:55], v[144:159]
  ds_read_b64_tr_b16 a[228:229], v229 offset:8192
  ds_read_b64_tr_b16 a[230:231], v229 offset:10240
  s_waitcnt lgkmcnt(4)
  v_mfma_f32_32x32x16_bf16 v[160:175], a[248:251], v[52:55], v[160:175]
  ds_read_b64_tr_b16 a[232:233], v230 offset:8192
  ds_read_b64_tr_b16 a[234:235], v230 offset:10240
  v_mfma_f32_32x32x16_bf16 v[176:191], a[252:255], v[52:55], v[176:191]
  ds_read_b32 v254, v251 offset:4
  ds_read_b64_tr_b16 a[236:237], v231 offset:8192
  ds_read_b64_tr_b16 a[238:239], v231 offset:10240
  s_waitcnt lgkmcnt(5)
  v_mfma_f32_32x32x16_bf16 v[128:143], a[224:227], v[56:59], v[128:143]
  ds_read_b64_tr_b16 a[240:241], v228 offset:12288
  ds_read_b64_tr_b16 a[242:243], v228 offset:14336
  v_mfma_f32_32x32x16_bf16 v[144:159], a[228:231], v[56:59], v[144:159]
  ds_read_b64_tr_b16 a[244:245], v229 offset:12288
  ds_read_b64_tr_b16 a[246:247], v229 offset:14336
  s_waitcnt lgkmcnt(4)
  v_mfma_f32_32x32x16_bf16 v[160:175], a[232:235], v[56:59], v[160:175]
  v_readfirstlane_b32 s39, v254
  ds_read_b64_tr_b16 a[248:249], v230 offset:12288
  ds_read_b64_tr_b16 a[250:251], v230 offset:14336
  v_mfma_f32_32x32x16_bf16 v[176:191], a[236:239], v[56:59], v[176:191]
  ds_read_b64_tr_b16 a[252:253], v231 offset:12288
  ds_read_b64_tr_b16 a[254:255], v231 offset:14336
  s_waitcnt lgkmcnt(4)
  v_mfma_f32_32x32x16_bf16 v[128:143], a[240:243], v[60:63], v[128:143]
  s_getpc_b64 s[30:31]
  s_cmp_ge_u32 s39, 36
  s_cbranch_scc0 L_spin4
  ds_read_b64_tr_b16 a[224:225], v224 offset:16384
  ds_read_b64_tr_b16 a[226:227], v224 offset:18432
  v_mfma_f32_32x32x16_bf16 v[144:159], a[244:247], v[60:63], v[144:159]
  ds_read_b64_tr_b16 a[228:229], v225 offset:16384
  ds_read_b64_tr_b16 a[230:231], v225 offset:18432
  s_waitcnt lgkmcnt(4)
  v_mfma_f32_32x32x16_bf16 v[160:175], a[248:251], v[60:63], v[160:175]
  ds_read_b64_tr_b16 a[232:233], v226 offset:16384
  ds_read_b64_tr_b16 a[234:235], v226 offset:18432
  v_mfma_f32_32x32x16_bf16 v[176:191], a[252:255], v[60:63], v[176:191]
  ds_add_u32 v251, v255 offset:8
  ds_read_b64_tr_b16 a[236:237], v227 offset:16384
  ds_read_b64_tr_b16 a[238:239], v227 offset:18432
  s_waitcnt lgkmcnt(5)
  v_mfma_f32_32x32x16_bf16 v[128:143], a[224:227], v[64:67], v[128:143]
  ds_read_b64_tr_b16 a[240:241], v224 offset:20480
  ds_read_b64_tr_b16 a[242:243], v224 offset:22528
  v_mfma_f32_32x32x16_bf16 v[144:159], a[228:231], v[64:67], v[144:159]
  ds_read_b64_tr_b16 a[244:245], v225 offset:20480
  ds_read_b64_tr_b16 a[246:247], v225 offset:22528
  s_waitcnt lgkmcnt(4)
  v_mfma_f32_32x32x16_bf16 v[160:175], a[232:235], v[64:67], v[160:175]
  ds_read_b64_tr_b16 a[248:249], v226 offset:20480
  ds_read_b64_tr_b16 a[250:251], v226 offset:22528
  v_mfma_f32_32x32x16_bf16 v[176:191], a[236:239], v[64:67], v[176:191]
  ds_read_b64_tr_b16 a[252:253], v227 offset:20480
  ds_read_b64_tr_b16 a[254:255], v227 offset:22528
  s_waitcnt lgkmcnt(4)
  v_mfma_f32_32x32x16_bf16 v[128:143], a[240:243], v[68:71], v[128:143]
  ds_read_b64_tr_b16 a[224:225], v224 offset:24576
  ds_read_b64_tr_b16 a[226:227], v224 offset:26624
  s_waitcnt vmcnt(0)
  ds_write_b32 v251, v253 offset:12
  v_mfma_f32_32x32x16_bf16 v[144:159], a[244:247], v[68:71], v[144:159]
  ds_read_b64_tr_b16 a[228:229], v225 offset:24576
  ds_read_b64_tr_b16 a[230:231], v225 offset:26624
  s_waitcnt lgkmcnt(5)
  v_mfma_f32_32x32x16_bf16 v[160:175], a[248:251], v[68:71], v[160:175]
  ds_read_b64_tr_b16 a[232:233], v226 offset:24576
  ds_read_b64_tr_b16 a[234:235], v226 offset:26624
  v_mfma_f32_32x32x16_bf16 v[176:191], a[252:255], v[68:71], v[176:191]
  ds_read_b32 v254, v251 offset:4
  ds_read_b64_tr_b16 a[236:237], v227 offset:24576
  ds_read_b64_tr_b16 a[238:239], v227 offset:26624
  s_waitcnt lgkmcnt(5)
  v_mfma_f32_32x32x16_bf16 v[128:143], a[224:227], v[72:75], v[128:143]
  ds_read_b64_tr_b16 a[240:241], v224 offset:28672
  ds_read_b64_tr_b16 a[242:243], v224 offset:30720
  v_mfma_f32_32x32x16_bf16 v[144:159], a[228:231], v[72:75], v[144:159]
  ds_read_b64_tr_b16 a[244:245], v225 offset:28672
  ds_read_b64_tr_b16 a[246:247], v225 offset:30720
  s_waitcnt lgkmcnt(4)
  v_mfma_f32_32x32x16_bf16 v[160:175], a[232:235], v[72:75], v[160:175]
  v_readfirstlane_b32 s39, v254
  ds_read_b64_tr_b16 a[248:249], v226 offset:28672
  ds_read_b64_tr_b16 a[250:251], v226 offset:30720
  v_mfma_f32_32x32x16_bf16 v[176:191], a[236:239], v[72:75], v[176:191]
  ds_read_b64_tr_b16 a[252:253], v227 offset:28672
  ds_read_b64_tr_b16 a[254:255], v227 offset:30720
  s_waitcnt lgkmcnt(4)
  v_mfma_f32_32x32x16_bf16 v[128:143], a[240:243], v[76:79], v[128:143]
  s_getpc_b64 s[30:31]
  s_cmp_ge_u32 s39, 37
  s_cbranch_scc0 L_spin4
  ds_read_b64_tr_b16 a[224:225], v240 offset:49152
  ds_read_b64_tr_b16 a[226:227], v240 offset:51200
  v_mfma_f32_32x32x16_bf16 v[144:159], a[244:247], v[76:79], v[144:159]
  ds_read_b64_tr_b16 a[228:229], v241 offset:49152
  ds_read_b64_tr_b16 a[230:231], v241 offset:51200
  s_waitcnt lgkmcnt(4)
  v_mfma_f32_32x32x16_bf16 v[160:175], a[248:251], v[76:79], v[160:175]
  ds_read_b64_tr_b16 a[232:233], v242 offset:49152
  ds_read_b64_tr_b16 a[234:235], v242 offset:51200
  v_mbcnt_lo_u32_b32 v246, -1, 0
  v_mbcnt_hi_u32_b32 v246, -1, v246
  v_lshlrev_b32 v246, 4, v246
  v_mfma_f32_32x32x16_bf16 v[176:191], a[252:255], v[76:79], v[176:191]
  ds_add_u32 v251, v255 offset:8
  ds_read_b64_tr_b16 a[236:237], v243 offset:49152
  ds_read_b64_tr_b16 a[238:239], v243 offset:51200
  s_waitcnt lgkmcnt(5)
  v_mfma_f32_32x32x16_bf16 v[128:143], a[224:227], v[80:83], v[128:143]
  ds_read_b64_tr_b16 a[240:241], v240 offset:53248
  ds_read_b64_tr_b16 a[242:243], v240 offset:55296
  v_mfma_f32_32x32x16_bf16 v[144:159], a[228:231], v[80:83], v[144:159]
  ds_read_b64_tr_b16 a[244:245], v241 offset:53248
  ds_read_b64_tr_b16 a[246:247], v241 offset:55296
  s_waitcnt lgkmcnt(4)
  v_mfma_f32_32x32x16_bf16 v[160:175], a[232:235], v[80:83], v[160:175]
  ds_read_b64_tr_b16 a[248:249], v242 offset:53248
  ds_read_b64_tr_b16 a[250:251], v242 offset:55296
  v_mfma_f32_32x32x16_bf16 v[176:191], a[236:239], v[80:83], v[176:191]
  ds_read_b64_tr_b16 a[252:253], v243 offset:53248
  ds_read_b64_tr_b16 a[254:255], v243 offset:55296
  s_waitcnt lgkmcnt(4)
  v_mfma_f32_32x32x16_bf16 v[128:143], a[240:243], v[84:87], v[128:143]
  ds_read_b64_tr_b16 a[224:225], v240 offset:57344
  ds_read_b64_tr_b16 a[226:227], v240 offset:59392
  v_mfma_f32_32x32x16_bf16 v[144:159], a[244:247], v[84:87], v[144:159]
  ds_read_b64_tr_b16 a[228:229], v241 offset:57344
  ds_read_b64_tr_b16 a[230:231], v241 offset:59392
  s_waitcnt lgkmcnt(4)
  v_mfma_f32_32x32x16_bf16 v[160:175], a[248:251], v[84:87], v[160:175]
  ds_read_b64_tr_b16 a[232:233], v242 offset:57344
  ds_read_b64_tr_b16 a[234:235], v242 offset:59392
  v_mfma_f32_32x32x16_bf16 v[176:191], a[252:255], v[84:87], v[176:191]
  ds_read_b32 v254, v251 offset:4
  ds_read_b64_tr_b16 a[236:237], v243 offset:57344
  ds_read_b64_tr_b16 a[238:239], v243 offset:59392
  s_waitcnt lgkmcnt(5)
  v_mfma_f32_32x32x16_bf16 v[128:143], a[224:227], v[88:91], v[128:143]
  ds_read_b64_tr_b16 a[240:241], v240 offset:61440
  ds_read_b64_tr_b16 a[242:243], v240 offset:63488
  v_mfma_f32_32x32x16_bf16 v[144:159], a[228:231], v[88:91], v[144:159]
  ds_read_b64_tr_b16 a[244:245], v241 offset:61440
  ds_read_b64_tr_b16 a[246:247], v241 offset:63488
  s_waitcnt lgkmcnt(4)
  v_mfma_f32_32x32x16_bf16 v[160:175], a[232:235], v[88:91], v[160:175]
  v_readfirstlane_b32 s39, v254
  ds_read_b64_tr_b16 a[248:249], v242 offset:61440
  ds_read_b64_tr_b16 a[250:251], v242 offset:63488
  v_mfma_f32_32x32x16_bf16 v[176:191], a[236:239], v[88:91], v[176:191]
  ds_read_b64_tr_b16 a[252:253], v243 offset:61440
  ds_read_b64_tr_b16 a[254:255], v243 offset:63488
  s_waitcnt lgkmcnt(4)
  v_mfma_f32_32x32x16_bf16 v[128:143], a[240:243], v[92:95], v[128:143]
  s_getpc_b64 s[30:31]
  s_cmp_ge_u32 s39, 38
  s_cbranch_scc0 L_spin4
  ds_read_b64_tr_b16 a[224:225], v224 offset:0
  ds_read_b64_tr_b16 a[226:227], v224 offset:2048
  v_mfma_f32_32x32x16_bf16 v[144:159], a[244:247], v[92:95], v[144:159]
  ds_read_b64_tr_b16 a[228:229], v225 offset:0
  ds_read_b64_tr_b16 a[230:231], v225 offset:2048
  s_waitcnt lgkmcnt(4)
  v_mfma_f32_32x32x16_bf16 v[160:175], a[248:251], v[92:95], v[160:175]
  ds_read_b64_tr_b16 a[232:233], v226 offset:0
  ds_read_b64_tr_b16 a[234:235], v226 offset:2048
  v_mfma_f32_32x32x16_bf16 v[176:191], a[252:255], v[92:95], v[176:191]
  ds_add_u32 v251, v255 offset:8
  ds_read_b64_tr_b16 a[236:237], v227 offset:0
  ds_read_b64_tr_b16 a[238:239], v227 offset:2048
  s_waitcnt lgkmcnt(5)
  v_mfma_f32_32x32x16_bf16 v[128:143], a[224:227], v[96:99], v[128:143]
  ds_read_b64_tr_b16 a[240:241], v224 offset:4096
  ds_read_b64_tr_b16 a[242:243], v224 offset:6144
  v_mfma_f32_32x32x16_bf16 v[144:159], a[228:231], v[96:99], v[144:159]
  ds_read_b64_tr_b16 a[244:245], v225 offset:4096
  ds_read_b64_tr_b16 a[246:247], v225 offset:6144
  s_waitcnt lgkmcnt(4)
  v_mfma_f32_32x32x16_bf16 v[160:175], a[232:235], v[96:99], v[160:175]
  ds_read_b64_tr_b16 a[248:249], v226 offset:4096
  ds_read_b64_tr_b16 a[250:251], v226 offset:6144
  v_mfma_f32_32x32x16_bf16 v[176:191], a[236:239], v[96:99], v[176:191]
  ds_read_b64_tr_b16 a[252:253], v227 offset:4096
  ds_read_b64_tr_b16 a[254:255], v227 offset:6144
  s_waitcnt lgkmcnt(4)
  v_mfma_f32_32x32x16_bf16 v[128:143], a[240:243], v[100:103], v[128:143]
  ds_read_b64_tr_b16 a[224:225], v224 offset:8192
  ds_read_b64_tr_b16 a[226:227], v224 offset:10240
  v_mfma_f32_32x32x16_bf16 v[144:159], a[244:247], v[100:103], v[144:159]
  ds_read_b64_tr_b16 a[228:229], v225 offset:8192
  ds_read_b64_tr_b16 a[230:231], v225 offset:10240
  s_waitcnt lgkmcnt(4)
  v_mfma_f32_32x32x16_bf16 v[160:175], a[248:251], v[100:103], v[160:175]
  ds_read_b64_tr_b16 a[232:233], v226 offset:8192
  ds_read_b64_tr_b16 a[234:235], v226 offset:10240
  v_mfma_f32_32x32x16_bf16 v[176:191], a[252:255], v[100:103], v[176:191]
  ds_read_b32 v254, v251 offset:4
  ds_read_b64_tr_b16 a[236:237], v227 offset:8192
  ds_read_b64_tr_b16 a[238:239], v227 offset:10240
  s_waitcnt lgkmcnt(5)
  v_mfma_f32_32x32x16_bf16 v[128:143], a[224:227], v[104:107], v[128:143]
  ds_read_b64_tr_b16 a[240:241], v224 offset:12288
  ds_read_b64_tr_b16 a[242:243], v224 offset:14336
  v_mfma_f32_32x32x16_bf16 v[144:159], a[228:231], v[104:107], v[144:159]
  ds_read_b64_tr_b16 a[244:245], v225 offset:12288
  ds_read_b64_tr_b16 a[246:247], v225 offset:14336
  s_waitcnt lgkmcnt(4)
  v_mfma_f32_32x32x16_bf16 v[160:175], a[232:235], v[104:107], v[160:175]
  v_readfirstlane_b32 s39, v254
  ds_read_b64_tr_b16 a[248:249], v226 offset:12288
  ds_read_b64_tr_b16 a[250:251], v226 offset:14336
  v_mfma_f32_32x32x16_bf16 v[176:191], a[236:239], v[104:107], v[176:191]
  ds_read_b64_tr_b16 a[252:253], v227 offset:12288
  ds_read_b64_tr_b16 a[254:255], v227 offset:14336
  s_waitcnt lgkmcnt(4)
  v_mfma_f32_32x32x16_bf16 v[128:143], a[240:243], v[108:111], v[128:143]
  s_getpc_b64 s[30:31]
  s_cmp_ge_u32 s39, 39
  s_cbranch_scc0 L_spin4
  ds_read_b64_tr_b16 a[224:225], v240 offset:0
  ds_read_b64_tr_b16 a[226:227], v240 offset:2048
  v_mfma_f32_32x32x16_bf16 v[144:159], a[244:247], v[108:111], v[144:159]
  ds_read_b64_tr_b16 a[228:229], v240 offset:4096
  ds_read_b64_tr_b16 a[230:231], v240 offset:6144
  s_waitcnt lgkmcnt(4)
  v_mfma_f32_32x32x16_bf16 v[160:175], a[248:251], v[108:111], v[160:175]
  ds_read_b64_tr_b16 a[232:233], v240 offset:8192
  ds_read_b64_tr_b16 a[234:235], v240 offset:10240
  v_mfma_f32_32x32x16_bf16 v[176:191], a[252:255], v[108:111], v[176:191]
  ds_read_b64_tr_b16 a[236:237], v240 offset:12288
  ds_read_b64_tr_b16 a[238:239], v240 offset:14336
  s_waitcnt lgkmcnt(4)
  v_mfma_f32_32x32x16_bf16 v[128:143], a[224:227], v[112:115], v[128:143]
  ds_read_b64_tr_b16 a[240:241], v241 offset:0
  ds_read_b64_tr_b16 a[242:243], v241 offset:2048
  v_mfma_f32_32x32x16_bf16 v[128:143], a[228:231], v[116:119], v[128:143]
  ds_read_b64_tr_b16 a[244:245], v241 offset:4096
  ds_read_b64_tr_b16 a[246:247], v241 offset:6144
  s_waitcnt lgkmcnt(4)
  v_mfma_f32_32x32x16_bf16 v[128:143], a[232:235], v[120:123], v[128:143]
  ds_read_b64_tr_b16 a[248:249], v241 offset:8192
  ds_read_b64_tr_b16 a[250:251], v241 offset:10240
  v_mfma_f32_32x32x16_bf16 v[128:143], a[236:239], v[124:127], v[128:143]
  ds_read_b64_tr_b16 a[252:253], v241 offset:12288
  ds_read_b64_tr_b16 a[254:255], v241 offset:14336
  s_waitcnt lgkmcnt(4)
  v_mfma_f32_32x32x16_bf16 v[144:159], a[240:243], v[112:115], v[144:159]
  ds_read_b64_tr_b16 a[224:225], v242 offset:0
  ds_read_b64_tr_b16 a[226:227], v242 offset:2048
  v_mfma_f32_32x32x16_bf16 v[144:159], a[244:247], v[116:119], v[144:159]
  ds_read_b64_tr_b16 a[228:229], v242 offset:4096
  ds_read_b64_tr_b16 a[230:231], v242 offset:6144
  s_waitcnt lgkmcnt(4)
  v_mfma_f32_32x32x16_bf16 v[144:159], a[248:251], v[120:123], v[144:159]
  ds_read_b64_tr_b16 a[232:233], v242 offset:8192
  ds_read_b64_tr_b16 a[234:235], v242 offset:10240
  v_mul_f32 v128, v128, v247
  v_mul_f32 v129, v129, v247
  v_mul_f32 v130, v130, v247
  v_mfma_f32_32x32x16_bf16 v[144:159], a[252:255], v[124:127], v[144:159]
  ds_read_b32 v254, v251 offset:4
  ds_read_b64_tr_b16 a[236:237], v242 offset:12288
  ds_read_b64_tr_b16 a[238:239], v242 offset:14336
  v_mul_f32 v131, v131, v247
  v_mul_f32 v132, v132, v247
  s_waitcnt lgkmcnt(5)
  v_mfma_f32_32x32x16_bf16 v[160:175], a[224:227], v[112:115], v[160:175]
  ds_read_b64_tr_b16 a[240:241], v243 offset:0
  ds_read_b64_tr_b16 a[242:243], v243 offset:2048
  v_mul_f32 v133, v133, v247
  v_mul_f32 v134, v134, v247
  v_mul_f32 v135, v135, v247
  v_mfma_f32_32x32x16_bf16 v[160:175], a[228:231], v[116:119], v[160:175]
  ds_read_b64_tr_b16 a[244:245], v243 offset:4096
  ds_read_b64_tr_b16 a[246:247], v243 offset:6144
  v_cvt_pk_bf16_f32 v192, v128, v129
  v_cvt_pk_bf16_f32 v193, v130, v131
  v_cvt_pk_bf16_f32 v194, v132, v133
  s_waitcnt lgkmcnt(4)
  v_mfma_f32_32x32x16_bf16 v[160:175], a[232:235], v[120:123], v[160:175]
  v_readfirstlane_b32 s39, v254
  ds_read_b64_tr_b16 a[248:249], v243 offset:8192
  ds_read_b64_tr_b16 a[250:251], v243 offset:10240
  v_cvt_pk_bf16_f32 v195, v134, v135
  v_mul_f32 v136, v136, v247
  v_mfma_f32_32x32x16_bf16 v[160:175], a[236:239], v[124:127], v[160:175]
  ds_read_b64_tr_b16 a[252:253], v243 offset:12288
  ds_read_b64_tr_b16 a[254:255], v243 offset:14336
  v_mul_f32 v137, v137, v247
  v_mul_f32 v138, v138, v247
  v_mul_f32 v139, v139, v247
  s_waitcnt lgkmcnt(4)
  v_mfma_f32_32x32x16_bf16 v[176:191], a[240:243], v[112:115], v[176:191]
  s_getpc_b64 s[30:31]
  s_cmp_ge_u32 s39, 40
  s_cbranch_scc0 L_spin4
  ds_read_b64_tr_b16 a[224:225], v244 offset:16384
  ds_read_b64_tr_b16 a[226:227], v244 offset:17408
  v_mfma_f32_32x32x16_bf16 v[176:191], a[244:247], v[116:119], v[176:191]
  ds_read_b64_tr_b16 a[228:229], v244 offset:18432
  ds_read_b64_tr_b16 a[230:231], v244 offset:19456
  v_mul_f32 v140, v140, v247
  v_mul_f32 v141, v141, v247
  v_mul_f32 v142, v142, v247
  s_waitcnt lgkmcnt(4)
  v_mfma_f32_32x32x16_bf16 v[176:191], a[248:251], v[120:123], v[176:191]
  ds_read_b64_tr_b16 a[232:233], v244 offset:20480
  ds_read_b64_tr_b16 a[234:235], v244 offset:21504
  v_mul_f32 v143, v143, v247
  v_cvt_pk_bf16_f32 v196, v136, v137
  v_cvt_pk_bf16_f32 v197, v138, v139
  v_mfma_f32_32x32x16_bf16 v[176:191], a[252:255], v[124:127], v[176:191]
  ds_read_b64_tr_b16 a[236:237], v244 offset:22528
  ds_read_b64_tr_b16 a[238:239], v244 offset:23552
  v_cvt_pk_bf16_f32 v198, v140, v141
  v_cvt_pk_bf16_f32 v199, v142, v143
  v_mul_f32 v144, v144, v247
  s_waitcnt lgkmcnt(4)
  v_mfma_f32_32x32x16_bf16 a[0:15], a[224:227], v[192:195], a[0:15]
  ds_read_b64_tr_b16 a[240:241], v244 offset:24576
  ds_read_b64_tr_b16 a[242:243], v244 offset:25600
  v_mul_f32 v145, v145, v247
  v_mul_f32 v146, v146, v247
  v_mul_f32 v147, v147, v247
  v_mul_f32 v148, v148, v247
  v_mfma_f32_32x32x16_bf16 a[0:15], a[228:231], v[196:199], a[0:15]
  ds_read_b64_tr_b16 a[244:245], v244 offset:26624
  ds_read_b64_tr_b16 a[246:247], v244 offset:27648
  v_mul_f32 v149, v149, v247
  v_mul_f32 v150, v150, v247
  v_mul_f32 v151, v151, v247
  v_cvt_pk_bf16_f32 v200, v144, v145
  v_cvt_pk_bf16_f32 v201, v146, v147
  v_cvt_pk_bf16_f32 v202, v148, v149
  v_cvt_pk_bf16_f32 v203, v150, v151
  s_waitcnt lgkmcnt(4)
  s_nop 0
  v_mfma_f32_32x32x16_bf16 a[0:15], a[232:235], v[200:203], a[0:15]
  ds_read_b64_tr_b16 a[248:249], v244 offset:28672
  ds_read_b64_tr_b16 a[250:251], v244 offset:29696
  v_mul_f32 v152, v152, v247
  v_mul_f32 v153, v153, v247
  v_mul_f32 v154, v154, v247
  v_mul_f32 v155, v155, v247
  v_mul_f32 v156, v156, v247
  v_mul_f32 v157, v157, v247
  v_mul_f32 v158, v158, v247
  v_mul_f32 v159, v159, v247
  v_cvt_pk_bf16_f32 v204, v152, v153
  v_cvt_pk_bf16_f32 v205, v154, v155
  v_cvt_pk_bf16_f32 v206, v156, v157
  v_cvt_pk_bf16_f32 v207, v158, v159
  s_nop 1
  v_mfma_f32_32x32x16_bf16 a[0:15], a[236:239], v[204:207], a[0:15]
  ds_read_b64_tr_b16 a[252:253], v244 offset:30720
  ds_read_b64_tr_b16 a[254:255], v244 offset:31744
  v_mul_f32 v160, v160, v247
  v_mul_f32 v161, v161, v247
  v_mul_f32 v162, v162, v247
  v_mul_f32 v163, v163, v247
  v_mul_f32 v164, v164, v247
  v_mul_f32 v165, v165, v247
  v_mul_f32 v166, v166, v247
  v_mul_f32 v167, v167, v247
  v_cvt_pk_bf16_f32 v208, v160, v161
  v_cvt_pk_bf16_f32 v209, v162, v163
  v_cvt_pk_bf16_f32 v210, v164, v165
  v_cvt_pk_bf16_f32 v211, v166, v167
  s_waitcnt lgkmcnt(4)
  s_nop 0
  v_mfma_f32_32x32x16_bf16 a[0:15], a[240:243], v[208:211], a[0:15]
  ds_read_b64_tr_b16 a[224:225], v245 offset:16384
  ds_read_b64_tr_b16 a[226:227], v245 offset:17408
  v_mul_f32 v168, v168, v247
  v_mul_f32 v169, v169, v247
  v_mul_f32 v170, v170, v247
  v_mul_f32 v171, v171, v247
  v_mul_f32 v172, v172, v247
  v_mul_f32 v173, v173, v247
  v_mul_f32 v174, v174, v247
  v_mul_f32 v175, v175, v247
  v_cvt_pk_bf16_f32 v212, v168, v169
  v_cvt_pk_bf16_f32 v213, v170, v171
  v_cvt_pk_bf16_f32 v214, v172, v173
  v_cvt_pk_bf16_f32 v215, v174, v175
  s_nop 1
  v_mfma_f32_32x32x16_bf16 a[0:15], a[244:247], v[212:215], a[0:15]
  ds_read_b64_tr_b16 a[228:229], v245 offset:18432
  ds_read_b64_tr_b16 a[230:231], v245 offset:19456
  v_mul_f32 v176, v176, v247
  v_mul_f32 v177, v177, v247
  v_mul_f32 v178, v178, v247
  v_mul_f32 v179, v179, v247
  v_mul_f32 v180, v180, v247
  v_mul_f32 v181, v181, v247
  v_mul_f32 v182, v182, v247
  v_mul_f32 v183, v183, v247
  v_cvt_pk_bf16_f32 v216, v176, v177
  v_cvt_pk_bf16_f32 v217, v178, v179
  v_cvt_pk_bf16_f32 v218, v180, v181
  v_cvt_pk_bf16_f32 v219, v182, v183
  s_waitcnt lgkmcnt(4)
  s_nop 0
  v_mfma_f32_32x32x16_bf16 a[0:15], a[248:251], v[216:219], a[0:15]
  ds_read_b64_tr_b16 a[232:233], v245 offset:20480
  ds_read_b64_tr_b16 a[234:235], v245 offset:21504
  v_mul_f32 v184, v184, v247
  v_mul_f32 v185, v185, v247
  v_mul_f32 v186, v186, v247
  v_mul_f32 v187, v187, v247
  v_mul_f32 v188, v188, v247
  v_mul_f32 v189, v189, v247
  v_mul_f32 v190, v190, v247
  v_mul_f32 v191, v191, v247
  v_cvt_pk_bf16_f32 v220, v184, v185
  v_cvt_pk_bf16_f32 v221, v186, v187
  v_cvt_pk_bf16_f32 v222, v188, v189
  v_cvt_pk_bf16_f32 v223, v190, v191
  s_nop 1
  v_mfma_f32_32x32x16_bf16 a[0:15], a[252:255], v[220:223], a[0:15]
  ds_read_b32 v254, v251 offset:4
  ds_read_b64_tr_b16 a[236:237], v245 offset:22528
  ds_read_b64_tr_b16 a[238:239], v245 offset:23552
  s_waitcnt lgkmcnt(5)
  v_mfma_f32_32x32x16_bf16 a[16:31], a[224:227], v[192:195], a[16:31]
  ds_read_b64_tr_b16 a[240:241], v245 offset:24576
  ds_read_b64_tr_b16 a[242:243], v245 offset:25600
  v_mfma_f32_32x32x16_bf16 a[16:31], a[228:231], v[196:199], a[16:31]
  ds_read_b64_tr_b16 a[244:245], v245 offset:26624
  ds_read_b64_tr_b16 a[246:247], v245 offset:27648
  s_waitcnt lgkmcnt(4)
  v_mfma_f32_32x32x16_bf16 a[16:31], a[232:235], v[200:203], a[16:31]
  v_readfirstlane_b32 s39, v254
  ds_read_b64_tr_b16 a[248:249], v245 offset:28672
  ds_read_b64_tr_b16 a[250:251], v245 offset:29696
  v_accvgpr_read_b32 v128, a0
  v_accvgpr_read_b32 v129, a1
  v_cvt_pk_bf16_f32 v0, v128, v129
  v_mfma_f32_32x32x16_bf16 a[16:31], a[236:239], v[204:207], a[16:31]
  ds_read_b64_tr_b16 a[252:253], v245 offset:30720
  ds_read_b64_tr_b16 a[254:255], v245 offset:31744
  v_accvgpr_read_b32 v130, a2
  v_accvgpr_read_b32 v131, a3
  v_cvt_pk_bf16_f32 v1, v130, v131
  v_accvgpr_read_b32 v132, a4
  s_waitcnt lgkmcnt(4)
  v_mfma_f32_32x32x16_bf16 a[16:31], a[240:243], v[208:211], a[16:31]
  s_getpc_b64 s[30:31]
  s_cmp_ge_u32 s39, 41
  s_cbranch_scc0 L_spin4
  ds_read_b64_tr_b16 a[224:225], v244 offset:32768
  ds_read_b64_tr_b16 a[226:227], v244 offset:33792
  v_accvgpr_read_b32 v133, a5
  v_mfma_f32_32x32x16_bf16 a[16:31], a[244:247], v[212:215], a[16:31]
  ds_read_b64_tr_b16 a[228:229], v244 offset:34816
  ds_read_b64_tr_b16 a[230:231], v244 offset:35840
  v_cvt_pk_bf16_f32 v2, v132, v133
  v_accvgpr_read_b32 v134, a6
  v_accvgpr_read_b32 v135, a7
  v_cvt_pk_bf16_f32 v3, v134, v135
  s_waitcnt lgkmcnt(4)
  v_mfma_f32_32x32x16_bf16 a[16:31], a[248:251], v[216:219], a[16:31]
  ds_read_b64_tr_b16 a[232:233], v244 offset:36864
  ds_read_b64_tr_b16 a[234:235], v244 offset:37888
  v_accvgpr_read_b32 v136, a8
  v_accvgpr_read_b32 v137, a9
  v_cvt_pk_bf16_f32 v4, v136, v137
  v_accvgpr_read_b32 v138, a10
  v_mfma_f32_32x32x16_bf16 a[16:31], a[252:255], v[220:223], a[16:31]
  ds_read_b64_tr_b16 a[236:237], v244 offset:38912
  ds_read_b64_tr_b16 a[238:239], v244 offset:39936
  v_accvgpr_read_b32 v139, a11
  v_cvt_pk_bf16_f32 v5, v138, v139
  v_accvgpr_read_b32 v140, a12
  v_accvgpr_read_b32 v141, a13
  s_waitcnt lgkmcnt(4)
  v_mfma_f32_32x32x16_bf16 a[32:47], a[224:227], v[192:195], a[32:47]
  ds_read_b64_tr_b16 a[240:241], v244 offset:40960
  ds_read_b64_tr_b16 a[242:243], v244 offset:41984
  v_cvt_pk_bf16_f32 v6, v140, v141
  v_accvgpr_read_b32 v142, a14
  v_accvgpr_read_b32 v143, a15
  v_mfma_f32_32x32x16_bf16 a[32:47], a[228:231], v[196:199], a[32:47]
  ds_read_b64_tr_b16 a[244:245], v244 offset:43008
  ds_read_b64_tr_b16 a[246:247], v244 offset:44032
  v_cvt_pk_bf16_f32 v7, v142, v143
L_all:
  ds_read_b32 v254, v251 offset:4
  s_waitcnt lgkmcnt(0)
  v_readfirstlane_b32 s39, v254
  s_nop 3
  s_cmp_ge_u32 s39, 46
  s_cbranch_scc0 L_all
  v_mfma_f32_32x32x16_bf16 a[32:47], a[232:235], v[200:203], a[32:47]
  ds_read_b64_tr_b16 a[248:249], v244 offset:45056
  ds_read_b64_tr_b16 a[250:251], v244 offset:46080
  s_add_u32 s40, s44, 0
  buffer_store_dwordx4 v[0:3], v246, s[32:35], s40 offen sc1
  buffer_store_dwordx4 v[4:7], v246, s[32:35], s40 offen offset:1024 sc1
  v_mfma_f32_32x32x16_bf16 a[32:47], a[236:239], v[204:207], a[32:47]
  ds_read_b64_tr_b16 a[252:253], v244 offset:47104
  ds_read_b64_tr_b16 a[254:255], v244 offset:48128
  v_accvgpr_read_b32 v144, a16
  v_accvgpr_read_b32 v145, a17
  v_cvt_pk_bf16_f32 v8, v144, v145
  v_mfma_f32_32x32x16_bf16 a[32:47], a[240:243], v[208:211], a[32:47]
  ds_read_b64_tr_b16 a[224:225], v245 offset:32768
  ds_read_b64_tr_b16 a[226:227], v245 offset:33792
  v_accvgpr_read_b32 v146, a18
  v_accvgpr_read_b32 v147, a19
  v_cvt_pk_bf16_f32 v9, v146, v147
  v_mfma_f32_32x32x16_bf16 a[32:47], a[244:247], v[212:215], a[32:47]
  ds_read_b64_tr_b16 a[228:229], v245 offset:34816
  ds_read_b64_tr_b16 a[230:231], v245 offset:35840
  v_accvgpr_read_b32 v148, a20
  v_accvgpr_read_b32 v149, a21
  v_cvt_pk_bf16_f32 v10, v148, v149
  s_waitcnt lgkmcnt(4)
  v_mfma_f32_32x32x16_bf16 a[32:47], a[248:251], v[216:219], a[32:47]
  ds_read_b64_tr_b16 a[232:233], v245 offset:36864
  ds_read_b64_tr_b16 a[234:235], v245 offset:37888
  v_accvgpr_read_b32 v150, a22
  v_accvgpr_read_b32 v151, a23
  v_cvt_pk_bf16_f32 v11, v150, v151
  v_mfma_f32_32x32x16_bf16 a[32:47], a[252:255], v[220:223], a[32:47]
  ds_read_b32 v254, v251 offset:4
  ds_read_b64_tr_b16 a[236:237], v245 offset:38912
  ds_read_b64_tr_b16 a[238:239], v245 offset:39936
  v_accvgpr_read_b32 v152, a24
  v_accvgpr_read_b32 v153, a25
  s_waitcnt lgkmcnt(5)
  v_mfma_f32_32x32x16_bf16 a[48:63], a[224:227], v[192:195], a[48:63]
  ds_read_b64_tr_b16 a[240:241], v245 offset:40960
  ds_read_b64_tr_b16 a[242:243], v245 offset:41984
  v_cvt_pk_bf16_f32 v12, v152, v153
  v_accvgpr_read_b32 v154, a26
  v_accvgpr_read_b32 v155, a27
  v_mfma_f32_32x32x16_bf16 a[48:63], a[228:231], v[196:199], a[48:63]
  ds_read_b64_tr_b16 a[244:245], v245 offset:43008
  ds_read_b64_tr_b16 a[246:247], v245 offset:44032
  v_cvt_pk_bf16_f32 v13, v154, v155
  v_accvgpr_read_b32 v156, a28
  v_accvgpr_read_b32 v157, a29
  s_waitcnt lgkmcnt(4)
  v_mfma_f32_32x32x16_bf16 a[48:63], a[232:235], v[200:203], a[48:63]
  v_readfirstlane_b32 s39, v254
  ds_read_b64_tr_b16 a[248:249], v245 offset:45056
  ds_read_b64_tr_b16 a[250:251], v245 offset:46080
  v_cvt_pk_bf16_f32 v14, v156, v157
  v_accvgpr_read_b32 v158, a30
  v_mfma_f32_32x32x16_bf16 a[48:63], a[236:239], v[204:207], a[48:63]
  ds_read_b64_tr_b16 a[252:253], v245 offset:47104
  ds_read_b64_tr_b16 a[254:255], v245 offset:48128
  v_accvgpr_read_b32 v159, a31
  v_cvt_pk_bf16_f32 v15, v158, v159
  s_add_u32 s40, s44, 2048
  s_waitcnt lgkmcnt(4)
  v_mfma_f32_32x32x16_bf16 a[48:63], a[240:243], v[208:211], a[48:63]
  s_getpc_b64 s[30:31]
  s_cmp_ge_u32 s39, 42
  s_cbranch_scc0 L_spin4
  ds_read_b64_tr_b16 a[224:225], v232 offset:32768
  ds_read_b64_tr_b16 a[226:227], v232 offset:33792
  v_mfma_f32_32x32x16_bf16 a[48:63], a[244:247], v[212:215], a[48:63]
  ds_read_b64_tr_b16 a[228:229], v232 offset:34816
  ds_read_b64_tr_b16 a[230:231], v232 offset:35840
  buffer_store_dwordx4 v[8:11], v246, s[32:35], s40 offen sc1
  buffer_store_dwordx4 v[12:15], v246, s[32:35], s40 offen offset:1024 sc1
  v_accvgpr_read_b32 v160, a32
  s_waitcnt lgkmcnt(4)
  v_mfma_f32_32x32x16_bf16 a[48:63], a[248:251], v[216:219], a[48:63]
  ds_read_b64_tr_b16 a[232:233], v232 offset:36864
  ds_read_b64_tr_b16 a[234:235], v232 offset:37888
  v_accvgpr_read_b32 v161, a33
  v_cvt_pk_bf16_f32 v16, v160, v161
  v_accvgpr_read_b32 v162, a34
  v_mfma_f32_32x32x16_bf16 a[48:63], a[252:255], v[220:223], a[48:63]
  ds_read_b64_tr_b16 a[236:237], v232 offset:38912
  ds_read_b64_tr_b16 a[238:239], v232 offset:39936
  v_accvgpr_read_b32 v163, a35
  v_cvt_pk_bf16_f32 v17, v162, v163
  v_accvgpr_read_b32 v164, a36
  s_waitcnt lgkmcnt(4)
  v_mfma_f32_32x32x16_bf16 a[64:79], a[224:227], v[192:195], a[64:79]
  ds_read_b64_tr_b16 a[240:241], v232 offset:40960
  ds_read_b64_tr_b16 a[242:243], v232 offset:41984
  v_accvgpr_read_b32 v165, a37
  v_cvt_pk_bf16_f32 v18, v164, v165
  v_accvgpr_read_b32 v166, a38
  v_mfma_f32_32x32x16_bf16 a[64:79], a[228:231], v[196:199], a[64:79]
  ds_read_b64_tr_b16 a[244:245], v232 offset:43008
  ds_read_b64_tr_b16 a[246:247], v232 offset:44032
  v_accvgpr_read_b32 v167, a39
  v_cvt_pk_bf16_f32 v19, v166, v167
  v_accvgpr_read_b32 v168, a40
  s_waitcnt lgkmcnt(4)
  v_mfma_f32_32x32x16_bf16 a[64:79], a[232:235], v[200:203], a[64:79]
  ds_read_b64_tr_b16 a[248:249], v232 offset:45056
  ds_read_b64_tr_b16 a[250:251], v232 offset:46080
  v_accvgpr_read_b32 v169, a41
  v_cvt_pk_bf16_f32 v20, v168, v169
  v_accvgpr_read_b32 v170, a42
  v_mfma_f32_32x32x16_bf16 a[64:79], a[236:239], v[204:207], a[64:79]
  ds_read_b64_tr_b16 a[252:253], v232 offset:47104
  ds_read_b64_tr_b16 a[254:255], v232 offset:48128
  v_accvgpr_read_b32 v171, a43
  v_cvt_pk_bf16_f32 v21, v170, v171
  v_accvgpr_read_b32 v172, a44
  s_waitcnt lgkmcnt(4)
  v_mfma_f32_32x32x16_bf16 a[64:79], a[240:243], v[208:211], a[64:79]
  ds_read_b64_tr_b16 a[224:225], v233 offset:32768
  ds_read_b64_tr_b16 a[226:227], v233 offset:33792
  v_accvgpr_read_b32 v173, a45
  v_cvt_pk_bf16_f32 v22, v172, v173
  v_accvgpr_read_b32 v174, a46
  v_mfma_f32_32x32x16_bf16 a[64:79], a[244:247], v[212:215], a[64:79]
  ds_read_b64_tr_b16 a[228:229], v233 offset:34816
  ds_read_b64_tr_b16 a[230:231], v233 offset:35840
  v_accvgpr_read_b32 v175, a47
  v_cvt_pk_bf16_f32 v23, v174, v175
  s_add_u32 s40, s44, 4096
  s_waitcnt lgkmcnt(4)
  v_mfma_f32_32x32x16_bf16 a[64:79], a[248:251], v[216:219], a[64:79]
  ds_read_b64_tr_b16 a[232:233], v233 offset:36864
  ds_read_b64_tr_b16 a[234:235], v233 offset:37888
  buffer_store_dwordx4 v[16:19], v246, s[32:35], s40 offen sc1
  buffer_store_dwordx4 v[20:23], v246, s[32:35], s40 offen offset:1024 sc1
  v_accvgpr_read_b32 v176, a48
  v_mfma_f32_32x32x16_bf16 a[64:79], a[252:255], v[220:223], a[64:79]
  ds_read_b32 v254, v251 offset:4
  ds_read_b64_tr_b16 a[236:237], v233 offset:38912
  ds_read_b64_tr_b16 a[238:239], v233 offset:39936
  v_accvgpr_read_b32 v177, a49
  v_cvt_pk_bf16_f32 v24, v176, v177
  s_waitcnt lgkmcnt(5)
  v_mfma_f32_32x32x16_bf16 a[80:95], a[224:227], v[192:195], a[80:95]
  ds_read_b64_tr_b16 a[240:241], v233 offset:40960
  ds_read_b64_tr_b16 a[242:243], v233 offset:41984
  v_accvgpr_read_b32 v178, a50
  v_accvgpr_read_b32 v179, a51
  v_cvt_pk_bf16_f32 v25, v178, v179
  v_mfma_f32_32x32x16_bf16 a[80:95], a[228:231], v[196:199], a[80:95]
  ds_read_b64_tr_b16 a[244:245], v233 offset:43008
  ds_read_b64_tr_b16 a[246:247], v233 offset:44032
  v_accvgpr_read_b32 v180, a52
  v_accvgpr_read_b32 v181, a53
  v_cvt_pk_bf16_f32 v26, v180, v181
  s_waitcnt lgkmcnt(4)
  v_mfma_f32_32x32x16_bf16 a[80:95], a[232:235], v[200:203], a[80:95]
  v_readfirstlane_b32 s39, v254
  ds_read_b64_tr_b16 a[248:249], v233 offset:45056
  ds_read_b64_tr_b16 a[250:251], v233 offset:46080
  v_accvgpr_read_b32 v182, a54
  v_accvgpr_read_b32 v183, a55
  v_mfma_f32_32x32x16_bf16 a[80:95], a[236:239], v[204:207], a[80:95]
  ds_read_b64_tr_b16 a[252:253], v233 offset:47104
  ds_read_b64_tr_b16 a[254:255], v233 offset:48128
  v_cvt_pk_bf16_f32 v27, v182, v183
  v_accvgpr_read_b32 v184, a56
  v_accvgpr_read_b32 v185, a57
  s_waitcnt lgkmcnt(4)
  v_mfma_f32_32x32x16_bf16 a[80:95], a[240:243], v[208:211], a[80:95]
  s_getpc_b64 s[30:31]
  s_cmp_ge_u32 s39, 43
  s_cbranch_scc0 L_spin4
  ds_read_b64_tr_b16 a[224:225], v232 offset:49152
  ds_read_b64_tr_b16 a[226:227], v232 offset:50176
  v_mfma_f32_32x32x16_bf16 a[80:95], a[244:247], v[212:215], a[80:95]
  ds_read_b64_tr_b16 a[228:229], v232 offset:51200
  ds_read_b64_tr_b16 a[230:231], v232 offset:52224
  v_cvt_pk_bf16_f32 v28, v184, v185
  v_accvgpr_read_b32 v186, a58
  v_accvgpr_read_b32 v187, a59
  s_waitcnt lgkmcnt(4)
  v_mfma_f32_32x32x16_bf16 a[80:95], a[248:251], v[216:219], a[80:95]
  ds_read_b64_tr_b16 a[232:233], v232 offset:53248
  ds_read_b64_tr_b16 a[234:235], v232 offset:54272
  v_cvt_pk_bf16_f32 v29, v186, v187
  v_accvgpr_read_b32 v188, a60
  v_accvgpr_read_b32 v189, a61
  v_mfma_f32_32x32x16_bf16 a[80:95], a[252:255], v[220:223], a[80:95]
  ds_read_b64_tr_b16 a[236:237], v232 offset:55296
  ds_read_b64_tr_b16 a[238:239], v232 offset:56320
  v_cvt_pk_bf16_f32 v30, v188, v189
  v_accvgpr_read_b32 v190, a62
  v_accvgpr_read_b32 v191, a63
  s_waitcnt lgkmcnt(4)
  v_mfma_f32_32x32x16_bf16 a[96:111], a[224:227], v[192:195], a[96:111]
  ds_read_b64_tr_b16 a[240:241], v232 offset:57344
  ds_read_b64_tr_b16 a[242:243], v232 offset:58368
  v_cvt_pk_bf16_f32 v31, v190, v191
  s_add_u32 s40, s44, 6144
  buffer_store_dwordx4 v[24:27], v246, s[32:35], s40 offen sc1
  v_mfma_f32_32x32x16_bf16 a[96:111], a[228:231], v[196:199], a[96:111]
  ds_read_b64_tr_b16 a[244:245], v232 offset:59392
  ds_read_b64_tr_b16 a[246:247], v232 offset:60416
  buffer_store_dwordx4 v[28:31], v246, s[32:35], s40 offen offset:1024 sc1
  v_accvgpr_read_b32 v128, a64
  v_accvgpr_read_b32 v129, a65
  s_waitcnt lgkmcnt(4)
  v_mfma_f32_32x32x16_bf16 a[96:111], a[232:235], v[200:203], a[96:111]
  ds_read_b64_tr_b16 a[248:249], v232 offset:61440
  ds_read_b64_tr_b16 a[250:251], v232 offset:62464
  v_cvt_pk_bf16_f32 v32, v128, v129
  v_accvgpr_read_b32 v130, a66
  v_accvgpr_read_b32 v131, a67
  v_mfma_f32_32x32x16_bf16 a[96:111], a[236:239], v[204:207], a[96:111]
  ds_read_b64_tr_b16 a[252:253], v232 offset:63488
  ds_read_b64_tr_b16 a[254:255], v232 offset:64512
  v_cvt_pk_bf16_f32 v33, v130, v131
  v_accvgpr_read_b32 v132, a68
  v_accvgpr_read_b32 v133, a69
  s_waitcnt lgkmcnt(4)
  v_mfma_f32_32x32x16_bf16 a[96:111], a[240:243], v[208:211], a[96:111]
  ds_read_b64_tr_b16 a[224:225], v233 offset:49152
  ds_read_b64_tr_b16 a[226:227], v233 offset:50176
  v_cvt_pk_bf16_f32 v34, v132, v133
  v_accvgpr_read_b32 v134, a70
  v_accvgpr_read_b32 v135, a71
  v_mfma_f32_32x32x16_bf16 a[96:111], a[244:247], v[212:215], a[96:111]
  ds_read_b64_tr_b16 a[228:229], v233 offset:51200
  ds_read_b64_tr_b16 a[230:231], v233 offset:52224
  v_cvt_pk_bf16_f32 v35, v134, v135
  v_accvgpr_read_b32 v136, a72
  v_accvgpr_read_b32 v137, a73
  s_waitcnt lgkmcnt(4)
  v_mfma_f32_32x32x16_bf16 a[96:111], a[248:251], v[216:219], a[96:111]
  ds_read_b64_tr_b16 a[232:233], v233 offset:53248
  ds_read_b64_tr_b16 a[234:235], v233 offset:54272
  v_cvt_pk_bf16_f32 v36, v136, v137
  v_accvgpr_read_b32 v138, a74
  v_accvgpr_read_b32 v139, a75
  v_mfma_f32_32x32x16_bf16 a[96:111], a[252:255], v[220:223], a[96:111]
  ds_read_b32 v254, v251 offset:4
  ds_read_b64_tr_b16 a[236:237], v233 offset:55296
  ds_read_b64_tr_b16 a[238:239], v233 offset:56320
  v_cvt_pk_bf16_f32 v37, v138, v139
  v_accvgpr_read_b32 v140, a76
  s_waitcnt lgkmcnt(5)
  v_mfma_f32_32x32x16_bf16 a[112:127], a[224:227], v[192:195], a[112:127]
  ds_read_b64_tr_b16 a[240:241], v233 offset:57344
  ds_read_b64_tr_b16 a[242:243], v233 offset:58368
  v_accvgpr_read_b32 v141, a77
  v_cvt_pk_bf16_f32 v38, v140, v141
  v_accvgpr_read_b32 v142, a78
  v_mfma_f32_32x32x16_bf16 a[112:127], a[228:231], v[196:199], a[112:127]
  ds_read_b64_tr_b16 a[244:245], v233 offset:59392
  ds_read_b64_tr_b16 a[246:247], v233 offset:60416
  v_accvgpr_read_b32 v143, a79
  v_cvt_pk_bf16_f32 v39, v142, v143
  s_add_u32 s40, s44, 8192
  s_waitcnt lgkmcnt(4)
  v_mfma_f32_32x32x16_bf16 a[112:127], a[232:235], v[200:203], a[112:127]
  v_readfirstlane_b32 s39, v254
  ds_read_b64_tr_b16 a[248:249], v233 offset:61440
  ds_read_b64_tr_b16 a[250:251], v233 offset:62464
  buffer_store_dwordx4 v[32:35], v246, s[32:35], s40 offen sc1
  buffer_store_dwordx4 v[36:39], v246, s[32:35], s40 offen offset:1024 sc1
  v_mfma_f32_32x32x16_bf16 a[112:127], a[236:239], v[204:207], a[112:127]
  ds_read_b64_tr_b16 a[252:253], v233 offset:63488
  ds_read_b64_tr_b16 a[254:255], v233 offset:64512
  v_accvgpr_read_b32 v144, a80
  v_accvgpr_read_b32 v145, a81
  v_cvt_pk_bf16_f32 v40, v144, v145
  s_waitcnt lgkmcnt(4)
  v_mfma_f32_32x32x16_bf16 a[112:127], a[240:243], v[208:211], a[112:127]
  s_getpc_b64 s[30:31]
  s_cmp_ge_u32 s39, 44
  s_cbranch_scc0 L_spin4
  ds_read_b64_tr_b16 a[224:225], v234 offset:0
  ds_read_b64_tr_b16 a[226:227], v234 offset:1024
  v_mfma_f32_32x32x16_bf16 a[112:127], a[244:247], v[212:215], a[112:127]
  ds_read_b64_tr_b16 a[228:229], v234 offset:2048
  ds_read_b64_tr_b16 a[230:231], v234 offset:3072
  v_accvgpr_read_b32 v146, a82
  v_accvgpr_read_b32 v147, a83
  v_cvt_pk_bf16_f32 v41, v146, v147
  s_waitcnt lgkmcnt(4)
  v_mfma_f32_32x32x16_bf16 a[112:127], a[248:251], v[216:219], a[112:127]
  ds_read_b64_tr_b16 a[232:233], v234 offset:4096
  ds_read_b64_tr_b16 a[234:235], v234 offset:5120
  v_accvgpr_read_b32 v148, a84
  v_accvgpr_read_b32 v149, a85
  v_cvt_pk_bf16_f32 v42, v148, v149
  v_mfma_f32_32x32x16_bf16 a[112:127], a[252:255], v[220:223], a[112:127]
  ds_read_b64_tr_b16 a[236:237], v234 offset:6144
  ds_read_b64_tr_b16 a[238:239], v234 offset:7168
  v_accvgpr_read_b32 v150, a86
  v_accvgpr_read_b32 v151, a87
  v_cvt_pk_bf16_f32 v43, v150, v151
  s_waitcnt lgkmcnt(4)
  v_mfma_f32_32x32x16_bf16 a[128:143], a[224:227], v[192:195], a[128:143]
  ds_read_b64_tr_b16 a[240:241], v234 offset:8192
  ds_read_b64_tr_b16 a[242:243], v234 offset:9216
  v_accvgpr_read_b32 v152, a88
  v_accvgpr_read_b32 v153, a89
  v_cvt_pk_bf16_f32 v44, v152, v153
  v_mfma_f32_32x32x16_bf16 a[128:143], a[228:231], v[196:199], a[128:143]
  ds_read_b64_tr_b16 a[244:245], v234 offset:10240
  ds_read_b64_tr_b16 a[246:247], v234 offset:11264
  v_accvgpr_read_b32 v154, a90
  v_accvgpr_read_b32 v155, a91
  v_cvt_pk_bf16_f32 v45, v154, v155
  s_waitcnt lgkmcnt(4)
  v_mfma_f32_32x32x16_bf16 a[128:143], a[232:235], v[200:203], a[128:143]
  ds_read_b64_tr_b16 a[248:249], v234 offset:12288
  ds_read_b64_tr_b16 a[250:251], v234 offset:13312
  v_accvgpr_read_b32 v156, a92
  v_accvgpr_read_b32 v157, a93
  v_cvt_pk_bf16_f32 v46, v156, v157
  v_mfma_f32_32x32x16_bf16 a[128:143], a[236:239], v[204:207], a[128:143]
  ds_read_b64_tr_b16 a[252:253], v234 offset:14336
  ds_read_b64_tr_b16 a[254:255], v234 offset:15360
  v_accvgpr_read_b32 v158, a94
  v_accvgpr_read_b32 v159, a95
  v_cvt_pk_bf16_f32 v47, v158, v159
  s_waitcnt lgkmcnt(4)
  v_mfma_f32_32x32x16_bf16 a[128:143], a[240:243], v[208:211], a[128:143]
  ds_read_b64_tr_b16 a[224:225], v235 offset:0
  ds_read_b64_tr_b16 a[226:227], v235 offset:1024
  s_add_u32 s40, s44, 10240
  buffer_store_dwordx4 v[40:43], v246, s[32:35], s40 offen sc1
  buffer_store_dwordx4 v[44:47], v246, s[32:35], s40 offen offset:1024 sc1
  v_mfma_f32_32x32x16_bf16 a[128:143], a[244:247], v[212:215], a[128:143]
  ds_read_b64_tr_b16 a[228:229], v235 offset:2048
  ds_read_b64_tr_b16 a[230:231], v235 offset:3072
  v_accvgpr_read_b32 v160, a96
  v_accvgpr_read_b32 v161, a97
  v_cvt_pk_bf16_f32 v48, v160, v161
  s_waitcnt lgkmcnt(4)
  v_mfma_f32_32x32x16_bf16 a[128:143], a[248:251], v[216:219], a[128:143]
  ds_read_b64_tr_b16 a[232:233], v235 offset:4096
  ds_read_b64_tr_b16 a[234:235], v235 offset:5120
  v_accvgpr_read_b32 v162, a98
  v_accvgpr_read_b32 v163, a99
  v_cvt_pk_bf16_f32 v49, v162, v163
  v_mfma_f32_32x32x16_bf16 a[128:143], a[252:255], v[220:223], a[128:143]
  ds_read_b32 v254, v251 offset:4
  ds_read_b64_tr_b16 a[236:237], v235 offset:6144
  ds_read_b64_tr_b16 a[238:239], v235 offset:7168
  v_accvgpr_read_b32 v164, a100
  v_accvgpr_read_b32 v165, a101
  s_waitcnt lgkmcnt(5)
  v_mfma_f32_32x32x16_bf16 a[144:159], a[224:227], v[192:195], a[144:159]
  ds_read_b64_tr_b16 a[240:241], v235 offset:8192
  ds_read_b64_tr_b16 a[242:243], v235 offset:9216
  v_cvt_pk_bf16_f32 v50, v164, v165
  v_accvgpr_read_b32 v166, a102
  v_accvgpr_read_b32 v167, a103
  v_mfma_f32_32x32x16_bf16 a[144:159], a[228:231], v[196:199], a[144:159]
  ds_read_b64_tr_b16 a[244:245], v235 offset:10240
  ds_read_b64_tr_b16 a[246:247], v235 offset:11264
  v_cvt_pk_bf16_f32 v51, v166, v167
  v_accvgpr_read_b32 v168, a104
  v_accvgpr_read_b32 v169, a105
  s_waitcnt lgkmcnt(4)
  v_mfma_f32_32x32x16_bf16 a[144:159], a[232:235], v[200:203], a[144:159]
  v_readfirstlane_b32 s39, v254
  ds_read_b64_tr_b16 a[248:249], v235 offset:12288
  ds_read_b64_tr_b16 a[250:251], v235 offset:13312
  v_cvt_pk_bf16_f32 v52, v168, v169
  v_accvgpr_read_b32 v170, a106
  v_mfma_f32_32x32x16_bf16 a[144:159], a[236:239], v[204:207], a[144:159]
  ds_read_b64_tr_b16 a[252:253], v235 offset:14336
  ds_read_b64_tr_b16 a[254:255], v235 offset:15360
  v_accvgpr_read_b32 v171, a107
  v_cvt_pk_bf16_f32 v53, v170, v171
  v_accvgpr_read_b32 v172, a108
  s_waitcnt lgkmcnt(4)
  v_mfma_f32_32x32x16_bf16 a[144:159], a[240:243], v[208:211], a[144:159]
  s_getpc_b64 s[30:31]
  s_cmp_ge_u32 s39, 45
  s_cbranch_scc0 L_spin4
  ds_read_b64_tr_b16 a[224:225], v232 offset:16384
  ds_read_b64_tr_b16 a[226:227], v232 offset:17408
  v_mfma_f32_32x32x16_bf16 a[144:159], a[244:247], v[212:215], a[144:159]
  ds_read_b64_tr_b16 a[228:229], v232 offset:18432
  ds_read_b64_tr_b16 a[230:231], v232 offset:19456
  v_accvgpr_read_b32 v173, a109
  v_cvt_pk_bf16_f32 v54, v172, v173
  v_accvgpr_read_b32 v174, a110
  s_waitcnt lgkmcnt(4)
  v_mfma_f32_32x32x16_bf16 a[144:159], a[248:251], v[216:219], a[144:159]
  ds_read_b64_tr_b16 a[232:233], v232 offset:20480
  ds_read_b64_tr_b16 a[234:235], v232 offset:21504
  v_accvgpr_read_b32 v175, a111
  v_cvt_pk_bf16_f32 v55, v174, v175
  s_add_u32 s40, s44, 12288
  v_mfma_f32_32x32x16_bf16 a[144:159], a[252:255], v[220:223], a[144:159]
  ds_read_b64_tr_b16 a[236:237], v232 offset:22528
  ds_read_b64_tr_b16 a[238:239], v232 offset:23552
  buffer_store_dwordx4 v[48:51], v246, s[32:35], s40 offen sc1
  buffer_store_dwordx4 v[52:55], v246, s[32:35], s40 offen offset:1024 sc1
  v_accvgpr_read_b32 v176, a112
  s_waitcnt lgkmcnt(4)
  v_mfma_f32_32x32x16_bf16 a[160:175], a[224:227], v[192:195], a[160:175]
  ds_read_b64_tr_b16 a[240:241], v232 offset:24576
  ds_read_b64_tr_b16 a[242:243], v232 offset:25600
  v_accvgpr_read_b32 v177, a113
  v_cvt_pk_bf16_f32 v56, v176, v177
  v_accvgpr_read_b32 v178, a114
  v_mfma_f32_32x32x16_bf16 a[160:175], a[228:231], v[196:199], a[160:175]
  ds_read_b64_tr_b16 a[244:245], v232 offset:26624
  ds_read_b64_tr_b16 a[246:247], v232 offset:27648
  v_accvgpr_read_b32 v179, a115
  v_cvt_pk_bf16_f32 v57, v178, v179
  v_accvgpr_read_b32 v180, a116
  s_waitcnt lgkmcnt(4)
  v_mfma_f32_32x32x16_bf16 a[160:175], a[232:235], v[200:203], a[160:175]
  ds_read_b64_tr_b16 a[248:249], v232 offset:28672
  ds_read_b64_tr_b16 a[250:251], v232 offset:29696
  v_accvgpr_read_b32 v181, a117
  v_cvt_pk_bf16_f32 v58, v180, v181
  v_accvgpr_read_b32 v182, a118
  v_mfma_f32_32x32x16_bf16 a[160:175], a[236:239], v[204:207], a[160:175]
  ds_read_b64_tr_b16 a[252:253], v232 offset:30720
  ds_read_b64_tr_b16 a[254:255], v232 offset:31744
  v_accvgpr_read_b32 v183, a119
  v_cvt_pk_bf16_f32 v59, v182, v183
  v_accvgpr_read_b32 v184, a120
  s_waitcnt lgkmcnt(4)
  v_mfma_f32_32x32x16_bf16 a[160:175], a[240:243], v[208:211], a[160:175]
  ds_read_b64_tr_b16 a[224:225], v233 offset:16384
  ds_read_b64_tr_b16 a[226:227], v233 offset:17408
  v_accvgpr_read_b32 v185, a121
  v_cvt_pk_bf16_f32 v60, v184, v185
  v_accvgpr_read_b32 v186, a122
  v_mfma_f32_32x32x16_bf16 a[160:175], a[244:247], v[212:215], a[160:175]
  ds_read_b64_tr_b16 a[228:229], v233 offset:18432
  ds_read_b64_tr_b16 a[230:231], v233 offset:19456
  v_accvgpr_read_b32 v187, a123
  v_cvt_pk_bf16_f32 v61, v186, v187
  v_accvgpr_read_b32 v188, a124
  s_waitcnt lgkmcnt(4)
  v_mfma_f32_32x32x16_bf16 a[160:175], a[248:251], v[216:219], a[160:175]
  ds_read_b64_tr_b16 a[232:233], v233 offset:20480
  ds_read_b64_tr_b16 a[234:235], v233 offset:21504
  v_accvgpr_read_b32 v189, a125
  v_cvt_pk_bf16_f32 v62, v188, v189
  v_accvgpr_read_b32 v190, a126
  v_mfma_f32_32x32x16_bf16 a[160:175], a[252:255], v[220:223], a[160:175]
  ds_read_b32 v254, v251 offset:4
  ds_read_b64_tr_b16 a[236:237], v233 offset:22528
  ds_read_b64_tr_b16 a[238:239], v233 offset:23552
  v_accvgpr_read_b32 v191, a127
  v_cvt_pk_bf16_f32 v63, v190, v191
  s_waitcnt lgkmcnt(5)
  v_mfma_f32_32x32x16_bf16 a[176:191], a[224:227], v[192:195], a[176:191]
  ds_read_b64_tr_b16 a[240:241], v233 offset:24576
  ds_read_b64_tr_b16 a[242:243], v233 offset:25600
  s_add_u32 s40, s44, 14336
  buffer_store_dwordx4 v[56:59], v246, s[32:35], s40 offen sc1
  buffer_store_dwordx4 v[60:63], v246, s[32:35], s40 offen offset:1024 sc1
  v_mfma_f32_32x32x16_bf16 a[176:191], a[228:231], v[196:199], a[176:191]
  ds_read_b64_tr_b16 a[244:245], v233 offset:26624
  ds_read_b64_tr_b16 a[246:247], v233 offset:27648
  v_accvgpr_read_b32 v128, a128
  v_accvgpr_read_b32 v129, a129
  v_cvt_pk_bf16_f32 v64, v128, v129
  s_waitcnt lgkmcnt(4)
  v_mfma_f32_32x32x16_bf16 a[176:191], a[232:235], v[200:203], a[176:191]
  v_readfirstlane_b32 s39, v254
  ds_read_b64_tr_b16 a[248:249], v233 offset:28672
  ds_read_b64_tr_b16 a[250:251], v233 offset:29696
  v_accvgpr_read_b32 v130, a130
  v_accvgpr_read_b32 v131, a131
  v_mfma_f32_32x32x16_bf16 a[176:191], a[236:239], v[204:207], a[176:191]
  ds_read_b64_tr_b16 a[252:253], v233 offset:30720
  ds_read_b64_tr_b16 a[254:255], v233 offset:31744
  v_cvt_pk_bf16_f32 v65, v130, v131
  v_accvgpr_read_b32 v132, a132
  v_accvgpr_read_b32 v133, a133
  s_waitcnt lgkmcnt(4)
  v_mfma_f32_32x32x16_bf16 a[176:191], a[240:243], v[208:211], a[176:191]
  s_getpc_b64 s[30:31]
  s_cmp_ge_u32 s39, 46
  s_cbranch_scc0 L_spin4
  ds_read_b64_tr_b16 a[224:225], v244 offset:49152
  ds_read_b64_tr_b16 a[226:227], v244 offset:50176
  v_mfma_f32_32x32x16_bf16 a[176:191], a[244:247], v[212:215], a[176:191]
  ds_read_b64_tr_b16 a[228:229], v244 offset:51200
  ds_read_b64_tr_b16 a[230:231], v244 offset:52224
  v_cvt_pk_bf16_f32 v66, v132, v133
  v_accvgpr_read_b32 v134, a134
  v_accvgpr_read_b32 v135, a135
  s_waitcnt lgkmcnt(4)
  v_mfma_f32_32x32x16_bf16 a[176:191], a[248:251], v[216:219], a[176:191]
  ds_read_b64_tr_b16 a[232:233], v244 offset:53248
  ds_read_b64_tr_b16 a[234:235], v244 offset:54272
  v_cvt_pk_bf16_f32 v67, v134, v135
  v_accvgpr_read_b32 v136, a136
  v_accvgpr_read_b32 v137, a137
  v_mfma_f32_32x32x16_bf16 a[176:191], a[252:255], v[220:223], a[176:191]
  ds_read_b64_tr_b16 a[236:237], v244 offset:55296
  ds_read_b64_tr_b16 a[238:239], v244 offset:56320
  v_cvt_pk_bf16_f32 v68, v136, v137
  v_accvgpr_read_b32 v138, a138
  v_accvgpr_read_b32 v139, a139
  s_waitcnt lgkmcnt(4)
  v_mfma_f32_32x32x16_bf16 a[192:207], a[224:227], v[192:195], a[192:207]
  ds_read_b64_tr_b16 a[240:241], v244 offset:57344
  ds_read_b64_tr_b16 a[242:243], v244 offset:58368
  v_cvt_pk_bf16_f32 v69, v138, v139
  v_accvgpr_read_b32 v140, a140
  v_accvgpr_read_b32 v141, a141
  v_mfma_f32_32x32x16_bf16 a[192:207], a[228:231], v[196:199], a[192:207]
  ds_read_b64_tr_b16 a[244:245], v244 offset:59392
  ds_read_b64_tr_b16 a[246:247], v244 offset:60416
  v_cvt_pk_bf16_f32 v70, v140, v141
  v_accvgpr_read_b32 v142, a142
  v_accvgpr_read_b32 v143, a143
  s_waitcnt lgkmcnt(4)
  v_mfma_f32_32x32x16_bf16 a[192:207], a[232:235], v[200:203], a[192:207]
  ds_read_b64_tr_b16 a[248:249], v244 offset:61440
  ds_read_b64_tr_b16 a[250:251], v244 offset:62464
  v_cvt_pk_bf16_f32 v71, v142, v143
  s_add_u32 s40, s44, 16384
  buffer_store_dwordx4 v[64:67], v246, s[32:35], s40 offen sc1
  v_mfma_f32_32x32x16_bf16 a[192:207], a[236:239], v[204:207], a[192:207]
  ds_read_b64_tr_b16 a[252:253], v244 offset:63488
  ds_read_b64_tr_b16 a[254:255], v244 offset:64512
  buffer_store_dwordx4 v[68:71], v246, s[32:35], s40 offen offset:1024 sc1
  v_accvgpr_read_b32 v144, a144
  v_accvgpr_read_b32 v145, a145
  s_waitcnt lgkmcnt(4)
  v_mfma_f32_32x32x16_bf16 a[192:207], a[240:243], v[208:211], a[192:207]
  ds_read_b64_tr_b16 a[224:225], v245 offset:49152
  ds_read_b64_tr_b16 a[226:227], v245 offset:50176
  v_cvt_pk_bf16_f32 v72, v144, v145
  v_accvgpr_read_b32 v146, a146
  v_accvgpr_read_b32 v147, a147
  v_mfma_f32_32x32x16_bf16 a[192:207], a[244:247], v[212:215], a[192:207]
  ds_read_b64_tr_b16 a[228:229], v245 offset:51200
  ds_read_b64_tr_b16 a[230:231], v245 offset:52224
  v_cvt_pk_bf16_f32 v73, v146, v147
  v_accvgpr_read_b32 v148, a148
  v_accvgpr_read_b32 v149, a149
  s_waitcnt lgkmcnt(4)
  v_mfma_f32_32x32x16_bf16 a[192:207], a[248:251], v[216:219], a[192:207]
  ds_read_b64_tr_b16 a[232:233], v245 offset:53248
  ds_read_b64_tr_b16 a[234:235], v245 offset:54272
  v_cvt_pk_bf16_f32 v74, v148, v149
  v_accvgpr_read_b32 v150, a150
  v_accvgpr_read_b32 v151, a151
  v_mfma_f32_32x32x16_bf16 a[192:207], a[252:255], v[220:223], a[192:207]
  ds_read_b64_tr_b16 a[236:237], v245 offset:55296
  ds_read_b64_tr_b16 a[238:239], v245 offset:56320
  v_cvt_pk_bf16_f32 v75, v150, v151
  v_accvgpr_read_b32 v152, a152
  v_accvgpr_read_b32 v153, a153
  s_waitcnt lgkmcnt(4)
  v_mfma_f32_32x32x16_bf16 a[208:223], a[224:227], v[192:195], a[208:223]
  ds_read_b64_tr_b16 a[240:241], v245 offset:57344
  ds_read_b64_tr_b16 a[242:243], v245 offset:58368
  v_cvt_pk_bf16_f32 v76, v152, v153
  v_accvgpr_read_b32 v154, a154
  v_accvgpr_read_b32 v155, a155
  v_mfma_f32_32x32x16_bf16 a[208:223], a[228:231], v[196:199], a[208:223]
  ds_read_b64_tr_b16 a[244:245], v245 offset:59392
  ds_read_b64_tr_b16 a[246:247], v245 offset:60416
  v_cvt_pk_bf16_f32 v77, v154, v155
  v_accvgpr_read_b32 v156, a156
  v_accvgpr_read_b32 v157, a157
  s_waitcnt lgkmcnt(4)
  v_mfma_f32_32x32x16_bf16 a[208:223], a[232:235], v[200:203], a[208:223]
  ds_read_b64_tr_b16 a[248:249], v245 offset:61440
  ds_read_b64_tr_b16 a[250:251], v245 offset:62464
  v_cvt_pk_bf16_f32 v78, v156, v157
  v_accvgpr_read_b32 v158, a158
  v_accvgpr_read_b32 v159, a159
  v_mfma_f32_32x32x16_bf16 a[208:223], a[236:239], v[204:207], a[208:223]
  ds_read_b64_tr_b16 a[252:253], v245 offset:63488
  ds_read_b64_tr_b16 a[254:255], v245 offset:64512
  v_cvt_pk_bf16_f32 v79, v158, v159
  s_add_u32 s40, s44, 18432
  buffer_store_dwordx4 v[72:75], v246, s[32:35], s40 offen sc1
  s_waitcnt lgkmcnt(4)
  v_mfma_f32_32x32x16_bf16 a[208:223], a[240:243], v[208:211], a[208:223]
  buffer_store_dwordx4 v[76:79], v246, s[32:35], s40 offen offset:1024 sc1
  s_waitcnt vmcnt(4)
  ds_add_u32 v251, v255 offset:8
  v_accvgpr_read_b32 v160, a160
  v_accvgpr_read_b32 v161, a161
  v_mfma_f32_32x32x16_bf16 a[208:223], a[244:247], v[212:215], a[208:223]
  v_cvt_pk_bf16_f32 v80, v160, v161
  v_accvgpr_read_b32 v162, a162
  v_accvgpr_read_b32 v163, a163
  v_cvt_pk_bf16_f32 v81, v162, v163
  v_accvgpr_read_b32 v164, a164
  s_waitcnt lgkmcnt(1)
  v_mfma_f32_32x32x16_bf16 a[208:223], a[248:251], v[216:219], a[208:223]
  v_accvgpr_read_b32 v165, a165
  v_cvt_pk_bf16_f32 v82, v164, v165
  v_accvgpr_read_b32 v166, a166
  v_accvgpr_read_b32 v167, a167
  v_cvt_pk_bf16_f32 v83, v166, v167
  v_mfma_f32_32x32x16_bf16 a[208:223], a[252:255], v[220:223], a[208:223]
  v_accvgpr_read_b32 v168, a168
  v_accvgpr_read_b32 v169, a169
  v_cvt_pk_bf16_f32 v84, v168, v169
  v_accvgpr_read_b32 v170, a170
  v_accvgpr_read_b32 v171, a171
  v_cvt_pk_bf16_f32 v85, v170, v171
  v_accvgpr_read_b32 v172, a172
  v_accvgpr_read_b32 v173, a173
  v_cvt_pk_bf16_f32 v86, v172, v173
  v_accvgpr_read_b32 v174, a174
  v_accvgpr_read_b32 v175, a175
  v_cvt_pk_bf16_f32 v87, v174, v175
  s_add_u32 s40, s44, 20480
  buffer_store_dwordx4 v[80:83], v246, s[32:35], s40 offen sc1
  buffer_store_dwordx4 v[84:87], v246, s[32:35], s40 offen offset:1024 sc1
  v_accvgpr_read_b32 v176, a176
  v_accvgpr_read_b32 v177, a177
  v_cvt_pk_bf16_f32 v88, v176, v177
  v_accvgpr_read_b32 v178, a178
  v_accvgpr_read_b32 v179, a179
  v_cvt_pk_bf16_f32 v89, v178, v179
  v_accvgpr_read_b32 v180, a180
  v_accvgpr_read_b32 v181, a181
  v_cvt_pk_bf16_f32 v90, v180, v181
  v_accvgpr_read_b32 v182, a182
  v_accvgpr_read_b32 v183, a183
  v_cvt_pk_bf16_f32 v91, v182, v183
  v_accvgpr_read_b32 v184, a184
  v_accvgpr_read_b32 v185, a185
  v_cvt_pk_bf16_f32 v92, v184, v185
  v_accvgpr_read_b32 v186, a186
  v_accvgpr_read_b32 v187, a187
  v_cvt_pk_bf16_f32 v93, v186, v187
  v_accvgpr_read_b32 v188, a188
  v_accvgpr_read_b32 v189, a189
  v_cvt_pk_bf16_f32 v94, v188, v189
  v_accvgpr_read_b32 v190, a190
  v_accvgpr_read_b32 v191, a191
  v_cvt_pk_bf16_f32 v95, v190, v191
  s_add_u32 s40, s44, 22528
  buffer_store_dwordx4 v[88:91], v246, s[32:35], s40 offen sc1
  buffer_store_dwordx4 v[92:95], v246, s[32:35], s40 offen offset:1024 sc1
  v_accvgpr_read_b32 v128, a192
  v_accvgpr_read_b32 v129, a193
  v_cvt_pk_bf16_f32 v96, v128, v129
  v_accvgpr_read_b32 v130, a194
  v_accvgpr_read_b32 v131, a195
  v_cvt_pk_bf16_f32 v97, v130, v131
  v_accvgpr_read_b32 v132, a196
  v_accvgpr_read_b32 v133, a197
  v_cvt_pk_bf16_f32 v98, v132, v133
  v_accvgpr_read_b32 v134, a198
  v_accvgpr_read_b32 v135, a199
  v_cvt_pk_bf16_f32 v99, v134, v135
  v_accvgpr_read_b32 v136, a200
  v_accvgpr_read_b32 v137, a201
  v_cvt_pk_bf16_f32 v100, v136, v137
  v_accvgpr_read_b32 v138, a202
  v_accvgpr_read_b32 v139, a203
  v_cvt_pk_bf16_f32 v101, v138, v139
  v_accvgpr_read_b32 v140, a204
  v_accvgpr_read_b32 v141, a205
  v_cvt_pk_bf16_f32 v102, v140, v141
  v_accvgpr_read_b32 v142, a206
  v_accvgpr_read_b32 v143, a207
  v_cvt_pk_bf16_f32 v103, v142, v143
  s_add_u32 s40, s44, 24576
  buffer_store_dwordx4 v[96:99], v246, s[32:35], s40 offen sc1
  buffer_store_dwordx4 v[100:103], v246, s[32:35], s40 offen offset:1024 sc1
  v_accvgpr_read_b32 v144, a208
  v_accvgpr_read_b32 v145, a209
  v_cvt_pk_bf16_f32 v104, v144, v145
  v_accvgpr_read_b32 v146, a210
  v_accvgpr_read_b32 v147, a211
  v_cvt_pk_bf16_f32 v105, v146, v147
  v_accvgpr_read_b32 v148, a212
  v_accvgpr_read_b32 v149, a213
  v_cvt_pk_bf16_f32 v106, v148, v149
  v_accvgpr_read_b32 v150, a214
  v_accvgpr_read_b32 v151, a215
  v_cvt_pk_bf16_f32 v107, v150, v151
  v_accvgpr_read_b32 v152, a216
  v_accvgpr_read_b32 v153, a217
  v_cvt_pk_bf16_f32 v108, v152, v153
  v_accvgpr_read_b32 v154, a218
  v_accvgpr_read_b32 v155, a219
  v_cvt_pk_bf16_f32 v109, v154, v155
  v_accvgpr_read_b32 v156, a220
  v_accvgpr_read_b32 v157, a221
  v_cvt_pk_bf16_f32 v110, v156, v157
  v_accvgpr_read_b32 v158, a222
  v_accvgpr_read_b32 v159, a223
  v_cvt_pk_bf16_f32 v111, v158, v159
  s_add_u32 s40, s44, 26624
  buffer_store_dwordx4 v[104:107], v246, s[32:35], s40 offen sc1
  buffer_store_dwordx4 v[108:111], v246, s[32:35], s40 offen offset:1024 sc1
  v_mbcnt_lo_u32_b32 v0, -1, 0
  v_mbcnt_hi_u32_b32 v0, -1, v0
  s_lshr_b32 s36, s11, 4
  s_and_b32 s37, s11, 15
  s_mul_i32 s38, s36, 1376256
  s_add_u32 s16, s86, s38
  s_addc_u32 s17, s87, 0
  s_and_b32 s17, s17, 0xffff
  s_mov_b32 s18, 1376256
  s_mov_b32 s19, 0x20000
  s_mov_b32 s20, s80
  s_and_b32 s21, s81, 0xffff
  s_mov_b32 s22, 1376256
  s_mov_b32 s23, 0x20000
  s_lshl_b32 s38, s36, 8
  s_add_u32 s38, s38, 33554432
  s_add_u32 s74, s86, s38
  s_addc_u32 s75, s87, 0
  v_and_b32 v2, 7, v0
  v_lshrrev_b32 v3, 3, v0
  v_mov_b32 v12, 147468
  ds_read_b32 v14, v12
  s_lshl_b32 s45, s37, 2
  v_mov_b32 v15, s45
  s_waitcnt vmcnt(0) lgkmcnt(0)
  v_mov_b32 v12, 147516
  v_mov_b32 v13, 1
  s_mov_b64 exec, 1
  ds_add_rtn_u32 v13, v12, v13
  s_waitcnt lgkmcnt(0)
  v_readfirstlane_b32 s44, v13
  v_readfirstlane_b32 s45, v14
  s_nop 3
  s_cmp_eq_u32 s44, 2
  s_cbranch_scc0 L_notlast
  s_cmp_lg_u32 s45, 0
  s_cbranch_scc1 L_havenonce3
L_getnonce3:
  v_mov_b32 v14, 0
  global_load_dword v14, v14, s[82:83] sc0 sc1
  s_waitcnt vmcnt(0)
  v_readfirstlane_b32 s45, v14
  s_nop 3
  s_cmp_eq_u32 s45, 0
  s_cbranch_scc1 L_getnonce3
L_havenonce3:
  global_store_dword v15, v14, s[74:75] offset:128 sc0 sc1
L_notlast:
  s_mov_b64 exec, -1
  s_lshl_b32 s41, s3, 4
  s_add_u32 s41, s41, s37
  s_cmp_ge_u32 s41, 36
  s_cbranch_scc1 L_end
  s_mul_hi_u32 s39, s41, 0x55555556
  s_mul_i32 s40, s39, 3
  s_sub_u32 s40, s41, s40
  s_add_u32 s40, s40, 4
  s_lshl_b32 s39, s39, 3
  s_lshl_b32 s40, s40, 3
  v_add_u32 v4, s39, v2
  v_add_u32 v5, s40, v3
  v_lshrrev_b32 v6, 5, v4
  v_mul_u32_u24 v6, 28672, v6
  v_lshrrev_b32 v7, 1, v5
  v_lshl_add_u32 v6, v7, 10, v6
  v_and_b32 v7, 1, v5
  v_lshlrev_b32 v7, 5, v7
  v_and_b32 v9, 31, v4
  v_add_u32 v7, v7, v9
  v_lshl_add_u32 v10, v7, 4, v6
  s_and_b32 s39, s36, 7
  s_mul_i32 s39, s39, 96
  v_add_u32 v6, s39, v4
  v_mul_u32_u24 v6, 1792, v6
  s_lshr_b32 s39, s36, 3
  s_mul_i32 s39, s39, 896
  v_lshl_add_u32 v6, v5, 4, v6
  v_add_u32 v11, s39, v6
  s_cmp_eq_u32 s3, 0
  s_cbranch_scc0 L_cwait
  v_readfirstlane_b32 s44, v253
  v_and_b32 v12, 15, v0
  v_lshlrev_b32 v12, 2, v12
  s_nop 1
  s_cmp_lg_u32 s44, 0
  s_cbranch_scc1 L_havenonce2
L_getnonce2:
  v_mov_b32 v13, 0
  global_load_dword v13, v13, s[82:83] sc0 sc1
  s_waitcnt vmcnt(0)
  v_readfirstlane_b32 s44, v13
  s_nop 3
  s_cmp_eq_u32 s44, 0
  s_cbranch_scc1 L_getnonce2
L_havenonce2:
L_poll2:
  global_load_dword v13, v12, s[74:75] offset:128 sc0 sc1
  s_waitcnt vmcnt(0)
  v_cmp_ne_u32 vcc, s44, v13
  s_cbranch_vccz L_polled2
  s_sleep 1
  s_branch L_poll2
L_polled2:
  v_mov_b32 v12, 147512
  v_mov_b32 v13, 1
  ds_write_b32 v12, v13
  s_branch L_cgo
L_cwait:
  v_mov_b32 v12, 147512
L_cspin:
  ds_read_b32 v13, v12
  s_waitcnt lgkmcnt(0)
  v_readfirstlane_b32 s44, v13
  s_nop 3
  s_cmp_eq_u32 s44, 0
  s_cbranch_scc1 L_cspin
L_cgo:
  s_mov_b32 s24, 0x00003f80
  s_mov_b32 s25, 0x3f800000
  s_mov_b32 s42, 0
  buffer_load_dwordx4 v[32:35], v10, s[16:19], s42 offen sc1
  s_mov_b32 s42, 86016
  buffer_load_dwordx4 v[36:39], v10, s[16:19], s42 offen sc1
  s_mov_b32 s42, 172032
  buffer_load_dwordx4 v[40:43], v10, s[16:19], s42 offen sc1
  s_mov_b32 s42, 258048
  buffer_load_dwordx4 v[44:47], v10, s[16:19], s42 offen sc1
  s_mov_b32 s42, 344064
  buffer_load_dwordx4 v[48:51], v10, s[16:19], s42 offen sc1
  s_mov_b32 s42, 430080
  buffer_load_dwordx4 v[52:55], v10, s[16:19], s42 offen sc1
  s_mov_b32 s42, 516096
  buffer_load_dwordx4 v[56:59], v10, s[16:19], s42 offen sc1
  s_mov_b32 s42, 602112
  buffer_load_dwordx4 v[60:63], v10, s[16:19], s42 offen sc1
  s_mov_b32 s42, 688128
  buffer_load_dwordx4 v[64:67], v10, s[16:19], s42 offen sc1
  s_mov_b32 s42, 774144
  buffer_load_dwordx4 v[68:71], v10, s[16:19], s42 offen sc1
  s_mov_b32 s42, 860160
  buffer_load_dwordx4 v[72:75], v10, s[16:19], s42 offen sc1
  s_mov_b32 s42, 946176
  buffer_load_dwordx4 v[76:79], v10, s[16:19], s42 offen sc1
  s_mov_b32 s42, 1032192
  buffer_load_dwordx4 v[80:83], v10, s[16:19], s42 offen sc1
  s_mov_b32 s42, 1118208
  buffer_load_dwordx4 v[84:87], v10, s[16:19], s42 offen sc1
  s_mov_b32 s42, 1204224
  buffer_load_dwordx4 v[88:91], v10, s[16:19], s42 offen sc1
  s_mov_b32 s42, 1290240
  buffer_load_dwordx4 v[92:95], v10, s[16:19], s42 offen sc1
  s_waitcnt vmcnt(15)
  v_lshlrev_b32 v16, 16, v32
  v_and_b32 v17, 0xffff0000, v32
  v_lshlrev_b32 v18, 16, v33
  v_and_b32 v19, 0xffff0000, v33
  v_lshlrev_b32 v20, 16, v34
  v_and_b32 v21, 0xffff0000, v34
  v_lshlrev_b32 v22, 16, v35
  v_and_b32 v23, 0xffff0000, v35
  s_waitcnt vmcnt(14)
  v_dot2c_f32_bf16 v16, s24, v36
  v_dot2c_f32_bf16 v17, s25, v36
  v_dot2c_f32_bf16 v18, s24, v37
  v_dot2c_f32_bf16 v19, s25, v37
  v_dot2c_f32_bf16 v20, s24, v38
  v_dot2c_f32_bf16 v21, s25, v38
  v_dot2c_f32_bf16 v22, s24, v39
  v_dot2c_f32_bf16 v23, s25, v39
  s_waitcnt vmcnt(13)
  v_dot2c_f32_bf16 v16, s24, v40
  v_dot2c_f32_bf16 v17, s25, v40
  v_dot2c_f32_bf16 v18, s24, v41
  v_dot2c_f32_bf16 v19, s25, v41
  v_dot2c_f32_bf16 v20, s24, v42
  v_dot2c_f32_bf16 v21, s25, v42
  v_dot2c_f32_bf16 v22, s24, v43
  v_dot2c_f32_bf16 v23, s25, v43
  s_waitcnt vmcnt(12)
  v_dot2c_f32_bf16 v16, s24, v44
  v_dot2c_f32_bf16 v17, s25, v44
  v_dot2c_f32_bf16 v18, s24, v45
  v_dot2c_f32_bf16 v19, s25, v45
  v_dot2c_f32_bf16 v20, s24, v46
  v_dot2c_f32_bf16 v21, s25, v46
  v_dot2c_f32_bf16 v22, s24, v47
  v_dot2c_f32_bf16 v23, s25, v47
  s_waitcnt vmcnt(11)
  v_dot2c_f32_bf16 v16, s24, v48
  v_dot2c_f32_bf16 v17, s25, v48
  v_dot2c_f32_bf16 v18, s24, v49
  v_dot2c_f32_bf16 v19, s25, v49
  v_dot2c_f32_bf16 v20, s24, v50
  v_dot2c_f32_bf16 v21, s25, v50
  v_dot2c_f32_bf16 v22, s24, v51
  v_dot2c_f32_bf16 v23, s25, v51
  s_waitcnt vmcnt(10)
  v_dot2c_f32_bf16 v16, s24, v52
  v_dot2c_f32_bf16 v17, s25, v52
  v_dot2c_f32_bf16 v18, s24, v53
  v_dot2c_f32_bf16 v19, s25, v53
  v_dot2c_f32_bf16 v20, s24, v54
  v_dot2c_f32_bf16 v21, s25, v54
  v_dot2c_f32_bf16 v22, s24, v55
  v_dot2c_f32_bf16 v23, s25, v55
  s_waitcnt vmcnt(9)
  v_dot2c_f32_bf16 v16, s24, v56
  v_dot2c_f32_bf16 v17, s25, v56
  v_dot2c_f32_bf16 v18, s24, v57
  v_dot2c_f32_bf16 v19, s25, v57
  v_dot2c_f32_bf16 v20, s24, v58
  v_dot2c_f32_bf16 v21, s25, v58
  v_dot2c_f32_bf16 v22, s24, v59
  v_dot2c_f32_bf16 v23, s25, v59
  s_waitcnt vmcnt(8)
  v_dot2c_f32_bf16 v16, s24, v60
  v_dot2c_f32_bf16 v17, s25, v60
  v_dot2c_f32_bf16 v18, s24, v61
  v_dot2c_f32_bf16 v19, s25, v61
  v_dot2c_f32_bf16 v20, s24, v62
  v_dot2c_f32_bf16 v21, s25, v62
  v_dot2c_f32_bf16 v22, s24, v63
  v_dot2c_f32_bf16 v23, s25, v63
  s_waitcnt vmcnt(7)
  v_dot2c_f32_bf16 v16, s24, v64
  v_dot2c_f32_bf16 v17, s25, v64
  v_dot2c_f32_bf16 v18, s24, v65
  v_dot2c_f32_bf16 v19, s25, v65
  v_dot2c_f32_bf16 v20, s24, v66
  v_dot2c_f32_bf16 v21, s25, v66
  v_dot2c_f32_bf16 v22, s24, v67
  v_dot2c_f32_bf16 v23, s25, v67
  s_waitcnt vmcnt(6)
  v_dot2c_f32_bf16 v16, s24, v68
  v_dot2c_f32_bf16 v17, s25, v68
  v_dot2c_f32_bf16 v18, s24, v69
  v_dot2c_f32_bf16 v19, s25, v69
  v_dot2c_f32_bf16 v20, s24, v70
  v_dot2c_f32_bf16 v21, s25, v70
  v_dot2c_f32_bf16 v22, s24, v71
  v_dot2c_f32_bf16 v23, s25, v71
  s_waitcnt vmcnt(5)
  v_dot2c_f32_bf16 v16, s24, v72
  v_dot2c_f32_bf16 v17, s25, v72
  v_dot2c_f32_bf16 v18, s24, v73
  v_dot2c_f32_bf16 v19, s25, v73
  v_dot2c_f32_bf16 v20, s24, v74
  v_dot2c_f32_bf16 v21, s25, v74
  v_dot2c_f32_bf16 v22, s24, v75
  v_dot2c_f32_bf16 v23, s25, v75
  s_waitcnt vmcnt(4)
  v_dot2c_f32_bf16 v16, s24, v76
  v_dot2c_f32_bf16 v17, s25, v76
  v_dot2c_f32_bf16 v18, s24, v77
  v_dot2c_f32_bf16 v19, s25, v77
  v_dot2c_f32_bf16 v20, s24, v78
  v_dot2c_f32_bf16 v21, s25, v78
  v_dot2c_f32_bf16 v22, s24, v79
  v_dot2c_f32_bf16 v23, s25, v79
  s_waitcnt vmcnt(3)
  v_dot2c_f32_bf16 v16, s24, v80
  v_dot2c_f32_bf16 v17, s25, v80
  v_dot2c_f32_bf16 v18, s24, v81
  v_dot2c_f32_bf16 v19, s25, v81
  v_dot2c_f32_bf16 v20, s24, v82
  v_dot2c_f32_bf16 v21, s25, v82
  v_dot2c_f32_bf16 v22, s24, v83
  v_dot2c_f32_bf16 v23, s25, v83
  s_waitcnt vmcnt(2)
  v_dot2c_f32_bf16 v16, s24, v84
  v_dot2c_f32_bf16 v17, s25, v84
  v_dot2c_f32_bf16 v18, s24, v85
  v_dot2c_f32_bf16 v19, s25, v85
  v_dot2c_f32_bf16 v20, s24, v86
  v_dot2c_f32_bf16 v21, s25, v86
  v_dot2c_f32_bf16 v22, s24, v87
  v_dot2c_f32_bf16 v23, s25, v87
  s_waitcnt vmcnt(1)
  v_dot2c_f32_bf16 v16, s24, v88
  v_dot2c_f32_bf16 v17, s25, v88
  v_dot2c_f32_bf16 v18, s24, v89
  v_dot2c_f32_bf16 v19, s25, v89
  v_dot2c_f32_bf16 v20, s24, v90
  v_dot2c_f32_bf16 v21, s25, v90
  v_dot2c_f32_bf16 v22, s24, v91
  v_dot2c_f32_bf16 v23, s25, v91
  s_waitcnt vmcnt(0)
  v_dot2c_f32_bf16 v16, s24, v92
  v_dot2c_f32_bf16 v17, s25, v92
  v_dot2c_f32_bf16 v18, s24, v93
  v_dot2c_f32_bf16 v19, s25, v93
  v_dot2c_f32_bf16 v20, s24, v94
  v_dot2c_f32_bf16 v21, s25, v94
  v_dot2c_f32_bf16 v22, s24, v95
  v_dot2c_f32_bf16 v23, s25, v95
  s_nop 3
  v_cvt_pk_bf16_f32 v24, v16, v17
  v_cvt_pk_bf16_f32 v25, v18, v19
  v_cvt_pk_bf16_f32 v26, v20, v21
  v_cvt_pk_bf16_f32 v27, v22, v23
  buffer_store_dwordx4 v[24:27], v11, s[20:23], 0 offen
  s_nop 1
  s_endpgm
L_rare_1:
  s_mov_b32 s41, 1
  s_branch L_rare
L_rare_2:
  s_mov_b32 s41, 2
  s_branch L_rare
L_rare_3:
  s_mov_b32 s41, 3
  s_branch L_rare
L_rare_4:
  s_mov_b32 s41, 4
  s_branch L_rare
L_rare_5:
  s_mov_b32 s41, 5
  s_branch L_rare
L_rare_6:
  s_mov_b32 s41, 6
  s_branch L_rare
L_rare_7:
  s_mov_b32 s41, 7
  s_branch L_rare
L_rare_8:
  s_mov_b32 s41, 8
  s_branch L_rare
L_rare_9:
  s_mov_b32 s41, 9
  s_branch L_rare
L_rare_10:
  s_mov_b32 s41, 10
  s_branch L_rare
L_rare_11:
  s_mov_b32 s41, 11
  s_branch L_rare
L_rare_12:
  s_mov_b32 s41, 12
  s_branch L_rare
L_rare_13:
  s_mov_b32 s41, 13
  s_branch L_rare
L_rare_14:
  s_mov_b32 s41, 14
  s_branch L_rare
L_rare_15:
  s_mov_b32 s41, 15
L_rare:
  s_nop 15
  v_mov_b32 v250, v249
  s_nop 1
  v_permlane32_swap_b32 v249, v250
  v_max_f32 v249, v249, v250
  v_max_f32 v249, 0, v249
  v_sub_f32 v250, 0, v249
  v_exp_f32 v250, v250
  v_add_f32 v248, v248, v249
  v_mul_f32 v246, v246, v250
  v_lshlrev_b32 v252, 16, v0
  v_and_b32 v247, 0xffff0000, v0
  v_mul_f32 v252, v252, v250
  v_mul_f32 v247, v247, v250
  v_cvt_pk_bf16_f32 v0, v252, v247
  v_lshlrev_b32 v252, 16, v1
  v_and_b32 v247, 0xffff0000, v1
  v_mul_f32 v252, v252, v250
  v_mul_f32 v247, v247, v250
  v_cvt_pk_bf16_f32 v1, v252, v247
  v_lshlrev_b32 v252, 16, v2
  v_and_b32 v247, 0xffff0000, v2
  v_mul_f32 v252, v252, v250
  v_mul_f32 v247, v247, v250
  v_cvt_pk_bf16_f32 v2, v252, v247
  v_lshlrev_b32 v252, 16, v3
  v_and_b32 v247, 0xffff0000, v3
  v_mul_f32 v252, v252, v250
  v_mul_f32 v247, v247, v250
  v_cvt_pk_bf16_f32 v3, v252, v247
  v_lshlrev_b32 v252, 16, v4
  v_and_b32 v247, 0xffff0000, v4
  v_mul_f32 v252, v252, v250
  v_mul_f32 v247, v247, v250
  v_cvt_pk_bf16_f32 v4, v252, v247
  v_lshlrev_b32 v252, 16, v5
  v_and_b32 v247, 0xffff0000, v5
  v_mul_f32 v252, v252, v250
  v_mul_f32 v247, v247, v250
  v_cvt_pk_bf16_f32 v5, v252, v247
  v_lshlrev_b32 v252, 16, v6
  v_and_b32 v247, 0xffff0000, v6
  v_mul_f32 v252, v252, v250
  v_mul_f32 v247, v247, v250
  v_cvt_pk_bf16_f32 v6, v252, v247
  v_lshlrev_b32 v252, 16, v7
  v_and_b32 v247, 0xffff0000, v7
  v_mul_f32 v252, v252, v250
  v_mul_f32 v247, v247, v250
  v_cvt_pk_bf16_f32 v7, v252, v247
  v_lshlrev_b32 v252, 16, v8
  v_and_b32 v247, 0xffff0000, v8
  v_mul_f32 v252, v252, v250
  v_mul_f32 v247, v247, v250
  v_cvt_pk_bf16_f32 v8, v252, v247
  v_lshlrev_b32 v252, 16, v9
  v_and_b32 v247, 0xffff0000, v9
  v_mul_f32 v252, v252, v250
  v_mul_f32 v247, v247, v250
  v_cvt_pk_bf16_f32 v9, v252, v247
  v_lshlrev_b32 v252, 16, v10
  v_and_b32 v247, 0xffff0000, v10
  v_mul_f32 v252, v252, v250
  v_mul_f32 v247, v247, v250
  v_cvt_pk_bf16_f32 v10, v252, v247
  v_lshlrev_b32 v252, 16, v11
  v_and_b32 v247, 0xffff0000, v11
  v_mul_f32 v252, v252, v250
  v_mul_f32 v247, v247, v250
  v_cvt_pk_bf16_f32 v11, v252, v247
  v_lshlrev_b32 v252, 16, v12
  v_and_b32 v247, 0xffff0000, v12
  v_mul_f32 v252, v252, v250
  v_mul_f32 v247, v247, v250
  v_cvt_pk_bf16_f32 v12, v252, v247
  v_lshlrev_b32 v252, 16, v13
  v_and_b32 v247, 0xffff0000, v13
  v_mul_f32 v252, v252, v250
  v_mul_f32 v247, v247, v250
  v_cvt_pk_bf16_f32 v13, v252, v247
  v_lshlrev_b32 v252, 16, v14
  v_and_b32 v247, 0xffff0000, v14
  v_mul_f32 v252, v252, v250
  v_mul_f32 v247, v247, v250
  v_cvt_pk_bf16_f32 v14, v252, v247
  v_lshlrev_b32 v252, 16, v15
  v_and_b32 v247, 0xffff0000, v15
  v_mul_f32 v252, v252, v250
  v_mul_f32 v247, v247, v250
  v_cvt_pk_bf16_f32 v15, v252, v247
  v_lshlrev_b32 v252, 16, v16
  v_and_b32 v247, 0xffff0000, v16
  v_mul_f32 v252, v252, v250
  v_mul_f32 v247, v247, v250
  v_cvt_pk_bf16_f32 v16, v252, v247
  v_lshlrev_b32 v252, 16, v17
  v_and_b32 v247, 0xffff0000, v17
  v_mul_f32 v252, v252, v250
  v_mul_f32 v247, v247, v250
  v_cvt_pk_bf16_f32 v17, v252, v247
  v_lshlrev_b32 v252, 16, v18
  v_and_b32 v247, 0xffff0000, v18
  v_mul_f32 v252, v252, v250
  v_mul_f32 v247, v247, v250
  v_cvt_pk_bf16_f32 v18, v252, v247
  v_lshlrev_b32 v252, 16, v19
  v_and_b32 v247, 0xffff0000, v19
  v_mul_f32 v252, v252, v250
  v_mul_f32 v247, v247, v250
  v_cvt_pk_bf16_f32 v19, v252, v247
  v_lshlrev_b32 v252, 16, v20
  v_and_b32 v247, 0xffff0000, v20
  v_mul_f32 v252, v252, v250
  v_mul_f32 v247, v247, v250
  v_cvt_pk_bf16_f32 v20, v252, v247
  v_lshlrev_b32 v252, 16, v21
  v_and_b32 v247, 0xffff0000, v21
  v_mul_f32 v252, v252, v250
  v_mul_f32 v247, v247, v250
  v_cvt_pk_bf16_f32 v21, v252, v247
  v_lshlrev_b32 v252, 16, v22
  v_and_b32 v247, 0xffff0000, v22
  v_mul_f32 v252, v252, v250
  v_mul_f32 v247, v247, v250
  v_cvt_pk_bf16_f32 v22, v252, v247
  v_lshlrev_b32 v252, 16, v23
  v_and_b32 v247, 0xffff0000, v23
  v_mul_f32 v252, v252, v250
  v_mul_f32 v247, v247, v250
  v_cvt_pk_bf16_f32 v23, v252, v247
  v_lshlrev_b32 v252, 16, v24
  v_and_b32 v247, 0xffff0000, v24
  v_mul_f32 v252, v252, v250
  v_mul_f32 v247, v247, v250
  v_cvt_pk_bf16_f32 v24, v252, v247
  v_lshlrev_b32 v252, 16, v25
  v_and_b32 v247, 0xffff0000, v25
  v_mul_f32 v252, v252, v250
  v_mul_f32 v247, v247, v250
  v_cvt_pk_bf16_f32 v25, v252, v247
  v_lshlrev_b32 v252, 16, v26
  v_and_b32 v247, 0xffff0000, v26
  v_mul_f32 v252, v252, v250
  v_mul_f32 v247, v247, v250
  v_cvt_pk_bf16_f32 v26, v252, v247
  v_lshlrev_b32 v252, 16, v27
  v_and_b32 v247, 0xffff0000, v27
  v_mul_f32 v252, v252, v250
  v_mul_f32 v247, v247, v250
  v_cvt_pk_bf16_f32 v27, v252, v247
  v_lshlrev_b32 v252, 16, v28
  v_and_b32 v247, 0xffff0000, v28
  v_mul_f32 v252, v252, v250
  v_mul_f32 v247, v247, v250
  v_cvt_pk_bf16_f32 v28, v252, v247
  v_lshlrev_b32 v252, 16, v29
  v_and_b32 v247, 0xffff0000, v29
  v_mul_f32 v252, v252, v250
  v_mul_f32 v247, v247, v250
  v_cvt_pk_bf16_f32 v29, v252, v247
  v_lshlrev_b32 v252, 16, v30
  v_and_b32 v247, 0xffff0000, v30
  v_mul_f32 v252, v252, v250
  v_mul_f32 v247, v247, v250
  v_cvt_pk_bf16_f32 v30, v252, v247
  v_lshlrev_b32 v252, 16, v31
  v_and_b32 v247, 0xffff0000, v31
  v_mul_f32 v252, v252, v250
  v_mul_f32 v247, v247, v250
  v_cvt_pk_bf16_f32 v31, v252, v247
  v_lshlrev_b32 v252, 16, v32
  v_and_b32 v247, 0xffff0000, v32
  v_mul_f32 v252, v252, v250
  v_mul_f32 v247, v247, v250
  v_cvt_pk_bf16_f32 v32, v252, v247
  v_lshlrev_b32 v252, 16, v33
  v_and_b32 v247, 0xffff0000, v33
  v_mul_f32 v252, v252, v250
  v_mul_f32 v247, v247, v250
  v_cvt_pk_bf16_f32 v33, v252, v247
  v_lshlrev_b32 v252, 16, v34
  v_and_b32 v247, 0xffff0000, v34
  v_mul_f32 v252, v252, v250
  v_mul_f32 v247, v247, v250
  v_cvt_pk_bf16_f32 v34, v252, v247
  v_lshlrev_b32 v252, 16, v35
  v_and_b32 v247, 0xffff0000, v35
  v_mul_f32 v252, v252, v250
  v_mul_f32 v247, v247, v250
  v_cvt_pk_bf16_f32 v35, v252, v247
  v_lshlrev_b32 v252, 16, v36
  v_and_b32 v247, 0xffff0000, v36
  v_mul_f32 v252, v252, v250
  v_mul_f32 v247, v247, v250
  v_cvt_pk_bf16_f32 v36, v252, v247
  v_lshlrev_b32 v252, 16, v37
  v_and_b32 v247, 0xffff0000, v37
  v_mul_f32 v252, v252, v250
  v_mul_f32 v247, v247, v250
  v_cvt_pk_bf16_f32 v37, v252, v247
  v_lshlrev_b32 v252, 16, v38
  v_and_b32 v247, 0xffff0000, v38
  v_mul_f32 v252, v252, v250
  v_mul_f32 v247, v247, v250
  v_cvt_pk_bf16_f32 v38, v252, v247
  v_lshlrev_b32 v252, 16, v39
  v_and_b32 v247, 0xffff0000, v39
  v_mul_f32 v252, v252, v250
  v_mul_f32 v247, v247, v250
  v_cvt_pk_bf16_f32 v39, v252, v247
  v_lshlrev_b32 v252, 16, v40
  v_and_b32 v247, 0xffff0000, v40
  v_mul_f32 v252, v252, v250
  v_mul_f32 v247, v247, v250
  v_cvt_pk_bf16_f32 v40, v252, v247
  v_lshlrev_b32 v252, 16, v41
  v_and_b32 v247, 0xffff0000, v41
  v_mul_f32 v252, v252, v250
  v_mul_f32 v247, v247, v250
  v_cvt_pk_bf16_f32 v41, v252, v247
  v_lshlrev_b32 v252, 16, v42
  v_and_b32 v247, 0xffff0000, v42
  v_mul_f32 v252, v252, v250
  v_mul_f32 v247, v247, v250
  v_cvt_pk_bf16_f32 v42, v252, v247
  v_lshlrev_b32 v252, 16, v43
  v_and_b32 v247, 0xffff0000, v43
  v_mul_f32 v252, v252, v250
  v_mul_f32 v247, v247, v250
  v_cvt_pk_bf16_f32 v43, v252, v247
  v_lshlrev_b32 v252, 16, v44
  v_and_b32 v247, 0xffff0000, v44
  v_mul_f32 v252, v252, v250
  v_mul_f32 v247, v247, v250
  v_cvt_pk_bf16_f32 v44, v252, v247
  v_lshlrev_b32 v252, 16, v45
  v_and_b32 v247, 0xffff0000, v45
  v_mul_f32 v252, v252, v250
  v_mul_f32 v247, v247, v250
  v_cvt_pk_bf16_f32 v45, v252, v247
  v_lshlrev_b32 v252, 16, v46
  v_and_b32 v247, 0xffff0000, v46
  v_mul_f32 v252, v252, v250
  v_mul_f32 v247, v247, v250
  v_cvt_pk_bf16_f32 v46, v252, v247
  v_lshlrev_b32 v252, 16, v47
  v_and_b32 v247, 0xffff0000, v47
  v_mul_f32 v252, v252, v250
  v_mul_f32 v247, v247, v250
  v_cvt_pk_bf16_f32 v47, v252, v247
  v_lshlrev_b32 v252, 16, v48
  v_and_b32 v247, 0xffff0000, v48
  v_mul_f32 v252, v252, v250
  v_mul_f32 v247, v247, v250
  v_cvt_pk_bf16_f32 v48, v252, v247
  v_lshlrev_b32 v252, 16, v49
  v_and_b32 v247, 0xffff0000, v49
  v_mul_f32 v252, v252, v250
  v_mul_f32 v247, v247, v250
  v_cvt_pk_bf16_f32 v49, v252, v247
  v_lshlrev_b32 v252, 16, v50
  v_and_b32 v247, 0xffff0000, v50
  v_mul_f32 v252, v252, v250
  v_mul_f32 v247, v247, v250
  v_cvt_pk_bf16_f32 v50, v252, v247
  v_lshlrev_b32 v252, 16, v51
  v_and_b32 v247, 0xffff0000, v51
  v_mul_f32 v252, v252, v250
  v_mul_f32 v247, v247, v250
  v_cvt_pk_bf16_f32 v51, v252, v247
  v_lshlrev_b32 v252, 16, v52
  v_and_b32 v247, 0xffff0000, v52
  v_mul_f32 v252, v252, v250
  v_mul_f32 v247, v247, v250
  v_cvt_pk_bf16_f32 v52, v252, v247
  v_lshlrev_b32 v252, 16, v53
  v_and_b32 v247, 0xffff0000, v53
  v_mul_f32 v252, v252, v250
  v_mul_f32 v247, v247, v250
  v_cvt_pk_bf16_f32 v53, v252, v247
  v_lshlrev_b32 v252, 16, v54
  v_and_b32 v247, 0xffff0000, v54
  v_mul_f32 v252, v252, v250
  v_mul_f32 v247, v247, v250
  v_cvt_pk_bf16_f32 v54, v252, v247
  v_lshlrev_b32 v252, 16, v55
  v_and_b32 v247, 0xffff0000, v55
  v_mul_f32 v252, v252, v250
  v_mul_f32 v247, v247, v250
  v_cvt_pk_bf16_f32 v55, v252, v247
  v_lshlrev_b32 v252, 16, v56
  v_and_b32 v247, 0xffff0000, v56
  v_mul_f32 v252, v252, v250
  v_mul_f32 v247, v247, v250
  v_cvt_pk_bf16_f32 v56, v252, v247
  v_lshlrev_b32 v252, 16, v57
  v_and_b32 v247, 0xffff0000, v57
  v_mul_f32 v252, v252, v250
  v_mul_f32 v247, v247, v250
  v_cvt_pk_bf16_f32 v57, v252, v247
  v_lshlrev_b32 v252, 16, v58
  v_and_b32 v247, 0xffff0000, v58
  v_mul_f32 v252, v252, v250
  v_mul_f32 v247, v247, v250
  v_cvt_pk_bf16_f32 v58, v252, v247
  v_lshlrev_b32 v252, 16, v59
  v_and_b32 v247, 0xffff0000, v59
  v_mul_f32 v252, v252, v250
  v_mul_f32 v247, v247, v250
  v_cvt_pk_bf16_f32 v59, v252, v247
  v_lshlrev_b32 v252, 16, v60
  v_and_b32 v247, 0xffff0000, v60
  v_mul_f32 v252, v252, v250
  v_mul_f32 v247, v247, v250
  v_cvt_pk_bf16_f32 v60, v252, v247
  v_lshlrev_b32 v252, 16, v61
  v_and_b32 v247, 0xffff0000, v61
  v_mul_f32 v252, v252, v250
  v_mul_f32 v247, v247, v250
  v_cvt_pk_bf16_f32 v61, v252, v247
  v_lshlrev_b32 v252, 16, v62
  v_and_b32 v247, 0xffff0000, v62
  v_mul_f32 v252, v252, v250
  v_mul_f32 v247, v247, v250
  v_cvt_pk_bf16_f32 v62, v252, v247
  v_lshlrev_b32 v252, 16, v63
  v_and_b32 v247, 0xffff0000, v63
  v_mul_f32 v252, v252, v250
  v_mul_f32 v247, v247, v250
  v_cvt_pk_bf16_f32 v63, v252, v247
  v_lshlrev_b32 v252, 16, v64
  v_and_b32 v247, 0xffff0000, v64
  v_mul_f32 v252, v252, v250
  v_mul_f32 v247, v247, v250
  v_cvt_pk_bf16_f32 v64, v252, v247
  v_lshlrev_b32 v252, 16, v65
  v_and_b32 v247, 0xffff0000, v65
  v_mul_f32 v252, v252, v250
  v_mul_f32 v247, v247, v250
  v_cvt_pk_bf16_f32 v65, v252, v247
  v_lshlrev_b32 v252, 16, v66
  v_and_b32 v247, 0xffff0000, v66
  v_mul_f32 v252, v252, v250
  v_mul_f32 v247, v247, v250
  v_cvt_pk_bf16_f32 v66, v252, v247
  v_lshlrev_b32 v252, 16, v67
  v_and_b32 v247, 0xffff0000, v67
  v_mul_f32 v252, v252, v250
  v_mul_f32 v247, v247, v250
  v_cvt_pk_bf16_f32 v67, v252, v247
  v_lshlrev_b32 v252, 16, v68
  v_and_b32 v247, 0xffff0000, v68
  v_mul_f32 v252, v252, v250
  v_mul_f32 v247, v247, v250
  v_cvt_pk_bf16_f32 v68, v252, v247
  v_lshlrev_b32 v252, 16, v69
  v_and_b32 v247, 0xffff0000, v69
  v_mul_f32 v252, v252, v250
  v_mul_f32 v247, v247, v250
  v_cvt_pk_bf16_f32 v69, v252, v247
  v_lshlrev_b32 v252, 16, v70
  v_and_b32 v247, 0xffff0000, v70
  v_mul_f32 v252, v252, v250
  v_mul_f32 v247, v247, v250
  v_cvt_pk_bf16_f32 v70, v252, v247
  v_lshlrev_b32 v252, 16, v71
  v_and_b32 v247, 0xffff0000, v71
  v_mul_f32 v252, v252, v250
  v_mul_f32 v247, v247, v250
  v_cvt_pk_bf16_f32 v71, v252, v247
  v_lshlrev_b32 v252, 16, v72
  v_and_b32 v247, 0xffff0000, v72
  v_mul_f32 v252, v252, v250
  v_mul_f32 v247, v247, v250
  v_cvt_pk_bf16_f32 v72, v252, v247
  v_lshlrev_b32 v252, 16, v73
  v_and_b32 v247, 0xffff0000, v73
  v_mul_f32 v252, v252, v250
  v_mul_f32 v247, v247, v250
  v_cvt_pk_bf16_f32 v73, v252, v247
  v_lshlrev_b32 v252, 16, v74
  v_and_b32 v247, 0xffff0000, v74
  v_mul_f32 v252, v252, v250
  v_mul_f32 v247, v247, v250
  v_cvt_pk_bf16_f32 v74, v252, v247
  v_lshlrev_b32 v252, 16, v75
  v_and_b32 v247, 0xffff0000, v75
  v_mul_f32 v252, v252, v250
  v_mul_f32 v247, v247, v250
  v_cvt_pk_bf16_f32 v75, v252, v247
  v_lshlrev_b32 v252, 16, v76
  v_and_b32 v247, 0xffff0000, v76
  v_mul_f32 v252, v252, v250
  v_mul_f32 v247, v247, v250
  v_cvt_pk_bf16_f32 v76, v252, v247
  v_lshlrev_b32 v252, 16, v77
  v_and_b32 v247, 0xffff0000, v77
  v_mul_f32 v252, v252, v250
  v_mul_f32 v247, v247, v250
  v_cvt_pk_bf16_f32 v77, v252, v247
  v_lshlrev_b32 v252, 16, v78
  v_and_b32 v247, 0xffff0000, v78
  v_mul_f32 v252, v252, v250
  v_mul_f32 v247, v247, v250
  v_cvt_pk_bf16_f32 v78, v252, v247
  v_lshlrev_b32 v252, 16, v79
  v_and_b32 v247, 0xffff0000, v79
  v_mul_f32 v252, v252, v250
  v_mul_f32 v247, v247, v250
  v_cvt_pk_bf16_f32 v79, v252, v247
  v_lshlrev_b32 v252, 16, v80
  v_and_b32 v247, 0xffff0000, v80
  v_mul_f32 v252, v252, v250
  v_mul_f32 v247, v247, v250
  v_cvt_pk_bf16_f32 v80, v252, v247
  v_lshlrev_b32 v252, 16, v81
  v_and_b32 v247, 0xffff0000, v81
  v_mul_f32 v252, v252, v250
  v_mul_f32 v247, v247, v250
  v_cvt_pk_bf16_f32 v81, v252, v247
  v_lshlrev_b32 v252, 16, v82
  v_and_b32 v247, 0xffff0000, v82
  v_mul_f32 v252, v252, v250
  v_mul_f32 v247, v247, v250
  v_cvt_pk_bf16_f32 v82, v252, v247
  v_lshlrev_b32 v252, 16, v83
  v_and_b32 v247, 0xffff0000, v83
  v_mul_f32 v252, v252, v250
  v_mul_f32 v247, v247, v250
  v_cvt_pk_bf16_f32 v83, v252, v247
  v_lshlrev_b32 v252, 16, v84
  v_and_b32 v247, 0xffff0000, v84
  v_mul_f32 v252, v252, v250
  v_mul_f32 v247, v247, v250
  v_cvt_pk_bf16_f32 v84, v252, v247
  v_lshlrev_b32 v252, 16, v85
  v_and_b32 v247, 0xffff0000, v85
  v_mul_f32 v252, v252, v250
  v_mul_f32 v247, v247, v250
  v_cvt_pk_bf16_f32 v85, v252, v247
  v_lshlrev_b32 v252, 16, v86
  v_and_b32 v247, 0xffff0000, v86
  v_mul_f32 v252, v252, v250
  v_mul_f32 v247, v247, v250
  v_cvt_pk_bf16_f32 v86, v252, v247
  v_lshlrev_b32 v252, 16, v87
  v_and_b32 v247, 0xffff0000, v87
  v_mul_f32 v252, v252, v250
  v_mul_f32 v247, v247, v250
  v_cvt_pk_bf16_f32 v87, v252, v247
  v_lshlrev_b32 v252, 16, v88
  v_and_b32 v247, 0xffff0000, v88
  v_mul_f32 v252, v252, v250
  v_mul_f32 v247, v247, v250
  v_cvt_pk_bf16_f32 v88, v252, v247
  v_lshlrev_b32 v252, 16, v89
  v_and_b32 v247, 0xffff0000, v89
  v_mul_f32 v252, v252, v250
  v_mul_f32 v247, v247, v250
  v_cvt_pk_bf16_f32 v89, v252, v247
  v_lshlrev_b32 v252, 16, v90
  v_and_b32 v247, 0xffff0000, v90
  v_mul_f32 v252, v252, v250
  v_mul_f32 v247, v247, v250
  v_cvt_pk_bf16_f32 v90, v252, v247
  v_lshlrev_b32 v252, 16, v91
  v_and_b32 v247, 0xffff0000, v91
  v_mul_f32 v252, v252, v250
  v_mul_f32 v247, v247, v250
  v_cvt_pk_bf16_f32 v91, v252, v247
  v_lshlrev_b32 v252, 16, v92
  v_and_b32 v247, 0xffff0000, v92
  v_mul_f32 v252, v252, v250
  v_mul_f32 v247, v247, v250
  v_cvt_pk_bf16_f32 v92, v252, v247
  v_lshlrev_b32 v252, 16, v93
  v_and_b32 v247, 0xffff0000, v93
  v_mul_f32 v252, v252, v250
  v_mul_f32 v247, v247, v250
  v_cvt_pk_bf16_f32 v93, v252, v247
  v_lshlrev_b32 v252, 16, v94
  v_and_b32 v247, 0xffff0000, v94
  v_mul_f32 v252, v252, v250
  v_mul_f32 v247, v247, v250
  v_cvt_pk_bf16_f32 v94, v252, v247
  v_lshlrev_b32 v252, 16, v95
  v_and_b32 v247, 0xffff0000, v95
  v_mul_f32 v252, v252, v250
  v_mul_f32 v247, v247, v250
  v_cvt_pk_bf16_f32 v95, v252, v247
  v_lshlrev_b32 v252, 16, v96
  v_and_b32 v247, 0xffff0000, v96
  v_mul_f32 v252, v252, v250
  v_mul_f32 v247, v247, v250
  v_cvt_pk_bf16_f32 v96, v252, v247
  v_lshlrev_b32 v252, 16, v97
  v_and_b32 v247, 0xffff0000, v97
  v_mul_f32 v252, v252, v250
  v_mul_f32 v247, v247, v250
  v_cvt_pk_bf16_f32 v97, v252, v247
  v_lshlrev_b32 v252, 16, v98
  v_and_b32 v247, 0xffff0000, v98
  v_mul_f32 v252, v252, v250
  v_mul_f32 v247, v247, v250
  v_cvt_pk_bf16_f32 v98, v252, v247
  v_lshlrev_b32 v252, 16, v99
  v_and_b32 v247, 0xffff0000, v99
  v_mul_f32 v252, v252, v250
  v_mul_f32 v247, v247, v250
  v_cvt_pk_bf16_f32 v99, v252, v247
  v_lshlrev_b32 v252, 16, v100
  v_and_b32 v247, 0xffff0000, v100
  v_mul_f32 v252, v252, v250
  v_mul_f32 v247, v247, v250
  v_cvt_pk_bf16_f32 v100, v252, v247
  v_lshlrev_b32 v252, 16, v101
  v_and_b32 v247, 0xffff0000, v101
  v_mul_f32 v252, v252, v250
  v_mul_f32 v247, v247, v250
  v_cvt_pk_bf16_f32 v101, v252, v247
  v_lshlrev_b32 v252, 16, v102
  v_and_b32 v247, 0xffff0000, v102
  v_mul_f32 v252, v252, v250
  v_mul_f32 v247, v247, v250
  v_cvt_pk_bf16_f32 v102, v252, v247
  v_lshlrev_b32 v252, 16, v103
  v_and_b32 v247, 0xffff0000, v103
  v_mul_f32 v252, v252, v250
  v_mul_f32 v247, v247, v250
  v_cvt_pk_bf16_f32 v103, v252, v247
  v_lshlrev_b32 v252, 16, v104
  v_and_b32 v247, 0xffff0000, v104
  v_mul_f32 v252, v252, v250
  v_mul_f32 v247, v247, v250
  v_cvt_pk_bf16_f32 v104, v252, v247
  v_lshlrev_b32 v252, 16, v105
  v_and_b32 v247, 0xffff0000, v105
  v_mul_f32 v252, v252, v250
  v_mul_f32 v247, v247, v250
  v_cvt_pk_bf16_f32 v105, v252, v247
  v_lshlrev_b32 v252, 16, v106
  v_and_b32 v247, 0xffff0000, v106
  v_mul_f32 v252, v252, v250
  v_mul_f32 v247, v247, v250
  v_cvt_pk_bf16_f32 v106, v252, v247
  v_lshlrev_b32 v252, 16, v107
  v_and_b32 v247, 0xffff0000, v107
  v_mul_f32 v252, v252, v250
  v_mul_f32 v247, v247, v250
  v_cvt_pk_bf16_f32 v107, v252, v247
  v_lshlrev_b32 v252, 16, v108
  v_and_b32 v247, 0xffff0000, v108
  v_mul_f32 v252, v252, v250
  v_mul_f32 v247, v247, v250
  v_cvt_pk_bf16_f32 v108, v252, v247
  v_lshlrev_b32 v252, 16, v109
  v_and_b32 v247, 0xffff0000, v109
  v_mul_f32 v252, v252, v250
  v_mul_f32 v247, v247, v250
  v_cvt_pk_bf16_f32 v109, v252, v247
  v_lshlrev_b32 v252, 16, v110
  v_and_b32 v247, 0xffff0000, v110
  v_mul_f32 v252, v252, v250
  v_mul_f32 v247, v247, v250
  v_cvt_pk_bf16_f32 v110, v252, v247
  v_lshlrev_b32 v252, 16, v111
  v_and_b32 v247, 0xffff0000, v111
  v_mul_f32 v252, v252, v250
  v_mul_f32 v247, v247, v250
  v_cvt_pk_bf16_f32 v111, v252, v247
  v_lshlrev_b32 v252, 16, v112
  v_and_b32 v247, 0xffff0000, v112
  v_mul_f32 v252, v252, v250
  v_mul_f32 v247, v247, v250
  v_cvt_pk_bf16_f32 v112, v252, v247
  v_lshlrev_b32 v252, 16, v113
  v_and_b32 v247, 0xffff0000, v113
  v_mul_f32 v252, v252, v250
  v_mul_f32 v247, v247, v250
  v_cvt_pk_bf16_f32 v113, v252, v247
  v_lshlrev_b32 v252, 16, v114
  v_and_b32 v247, 0xffff0000, v114
  v_mul_f32 v252, v252, v250
  v_mul_f32 v247, v247, v250
  v_cvt_pk_bf16_f32 v114, v252, v247
  v_lshlrev_b32 v252, 16, v115
  v_and_b32 v247, 0xffff0000, v115
  v_mul_f32 v252, v252, v250
  v_mul_f32 v247, v247, v250
  v_cvt_pk_bf16_f32 v115, v252, v247
  v_lshlrev_b32 v252, 16, v116
  v_and_b32 v247, 0xffff0000, v116
  v_mul_f32 v252, v252, v250
  v_mul_f32 v247, v247, v250
  v_cvt_pk_bf16_f32 v116, v252, v247
  v_lshlrev_b32 v252, 16, v117
  v_and_b32 v247, 0xffff0000, v117
  v_mul_f32 v252, v252, v250
  v_mul_f32 v247, v247, v250
  v_cvt_pk_bf16_f32 v117, v252, v247
  v_lshlrev_b32 v252, 16, v118
  v_and_b32 v247, 0xffff0000, v118
  v_mul_f32 v252, v252, v250
  v_mul_f32 v247, v247, v250
  v_cvt_pk_bf16_f32 v118, v252, v247
  v_lshlrev_b32 v252, 16, v119
  v_and_b32 v247, 0xffff0000, v119
  v_mul_f32 v252, v252, v250
  v_mul_f32 v247, v247, v250
  v_cvt_pk_bf16_f32 v119, v252, v247
  v_lshlrev_b32 v252, 16, v120
  v_and_b32 v247, 0xffff0000, v120
  v_mul_f32 v252, v252, v250
  v_mul_f32 v247, v247, v250
  v_cvt_pk_bf16_f32 v120, v252, v247
  v_lshlrev_b32 v252, 16, v121
  v_and_b32 v247, 0xffff0000, v121
  v_mul_f32 v252, v252, v250
  v_mul_f32 v247, v247, v250
  v_cvt_pk_bf16_f32 v121, v252, v247
  v_lshlrev_b32 v252, 16, v122
  v_and_b32 v247, 0xffff0000, v122
  v_mul_f32 v252, v252, v250
  v_mul_f32 v247, v247, v250
  v_cvt_pk_bf16_f32 v122, v252, v247
  v_lshlrev_b32 v252, 16, v123
  v_and_b32 v247, 0xffff0000, v123
  v_mul_f32 v252, v252, v250
  v_mul_f32 v247, v247, v250
  v_cvt_pk_bf16_f32 v123, v252, v247
  v_lshlrev_b32 v252, 16, v124
  v_and_b32 v247, 0xffff0000, v124
  v_mul_f32 v252, v252, v250
  v_mul_f32 v247, v247, v250
  v_cvt_pk_bf16_f32 v124, v252, v247
  v_lshlrev_b32 v252, 16, v125
  v_and_b32 v247, 0xffff0000, v125
  v_mul_f32 v252, v252, v250
  v_mul_f32 v247, v247, v250
  v_cvt_pk_bf16_f32 v125, v252, v247
  v_lshlrev_b32 v252, 16, v126
  v_and_b32 v247, 0xffff0000, v126
  v_mul_f32 v252, v252, v250
  v_mul_f32 v247, v247, v250
  v_cvt_pk_bf16_f32 v126, v252, v247
  v_lshlrev_b32 v252, 16, v127
  v_and_b32 v247, 0xffff0000, v127
  v_mul_f32 v252, v252, v250
  v_mul_f32 v247, v247, v250
  v_cvt_pk_bf16_f32 v127, v252, v247
  s_cmp_eq_u32 s41, 15
  s_cbranch_scc1 L_rare_last
  s_nop 15
  s_nop 15
  v_sub_f32 v192, v192, v249
  v_sub_f32 v193, v193, v249
  v_sub_f32 v194, v194, v249
  v_sub_f32 v195, v195, v249
  v_sub_f32 v196, v196, v249
  v_sub_f32 v197, v197, v249
  v_sub_f32 v198, v198, v249
  v_sub_f32 v199, v199, v249
  v_sub_f32 v200, v200, v249
  v_sub_f32 v201, v201, v249
  v_sub_f32 v202, v202, v249
  v_sub_f32 v203, v203, v249
  v_sub_f32 v204, v204, v249
  v_sub_f32 v205, v205, v249
  v_sub_f32 v206, v206, v249
  v_sub_f32 v207, v207, v249
  v_sub_f32 v208, v208, v249
  v_sub_f32 v209, v209, v249
  v_sub_f32 v210, v210, v249
  v_sub_f32 v211, v211, v249
  v_sub_f32 v212, v212, v249
  v_sub_f32 v213, v213, v249
  v_sub_f32 v214, v214, v249
  v_sub_f32 v215, v215, v249
  v_sub_f32 v216, v216, v249
  v_sub_f32 v217, v217, v249
  v_sub_f32 v218, v218, v249
  v_sub_f32 v219, v219, v249
  v_sub_f32 v220, v220, v249
  v_sub_f32 v221, v221, v249
  v_sub_f32 v222, v222, v249
  v_sub_f32 v223, v223, v249
  v_sub_f32 v128, 0, v248
  v_sub_f32 v129, 0, v248
  v_sub_f32 v130, 0, v248
  v_sub_f32 v131, 0, v248
  v_sub_f32 v132, 0, v248
  v_sub_f32 v133, 0, v248
  v_sub_f32 v134, 0, v248
  v_sub_f32 v135, 0, v248
  v_sub_f32 v136, 0, v248
  v_sub_f32 v137, 0, v248
  v_sub_f32 v138, 0, v248
  v_sub_f32 v139, 0, v248
  v_sub_f32 v140, 0, v248
  v_sub_f32 v141, 0, v248
  v_sub_f32 v142, 0, v248
  v_sub_f32 v143, 0, v248
  s_branch L_rare_ret
L_rare_last:
  v_sub_f32 v208, v208, v249
  v_sub_f32 v209, v209, v249
  v_sub_f32 v210, v210, v249
  v_sub_f32 v211, v211, v249
  v_sub_f32 v212, v212, v249
  v_sub_f32 v213, v213, v249
  v_sub_f32 v214, v214, v249
  v_sub_f32 v215, v215, v249
  v_sub_f32 v216, v216, v249
  v_sub_f32 v217, v217, v249
  v_sub_f32 v218, v218, v249
  v_sub_f32 v219, v219, v249
  v_sub_f32 v220, v220, v249
  v_sub_f32 v221, v221, v249
  v_sub_f32 v222, v222, v249
  v_sub_f32 v223, v223, v249
  v_mul_f32 v128, v128, v250
  v_mul_f32 v129, v129, v250
  v_mul_f32 v130, v130, v250
  v_mul_f32 v131, v131, v250
  v_mul_f32 v132, v132, v250
  v_mul_f32 v133, v133, v250
  v_mul_f32 v134, v134, v250
  v_mul_f32 v135, v135, v250
  v_mul_f32 v136, v136, v250
  v_mul_f32 v137, v137, v250
  v_mul_f32 v138, v138, v250
  v_mul_f32 v139, v139, v250
  v_mul_f32 v140, v140, v250
  v_mul_f32 v141, v141, v250
  v_mul_f32 v142, v142, v250
  v_mul_f32 v143, v143, v250
  v_mul_f32 v144, v144, v250
  v_mul_f32 v145, v145, v250
  v_mul_f32 v146, v146, v250
  v_mul_f32 v147, v147, v250
  v_mul_f32 v148, v148, v250
  v_mul_f32 v149, v149, v250
  v_mul_f32 v150, v150, v250
  v_mul_f32 v151, v151, v250
  v_mul_f32 v152, v152, v250
  v_mul_f32 v153, v153, v250
  v_mul_f32 v154, v154, v250
  v_mul_f32 v155, v155, v250
  v_mul_f32 v156, v156, v250
  v_mul_f32 v157, v157, v250
  v_mul_f32 v158, v158, v250
  v_mul_f32 v159, v159, v250
  v_mul_f32 v160, v160, v250
  v_mul_f32 v161, v161, v250
  v_mul_f32 v162, v162, v250
  v_mul_f32 v163, v163, v250
  v_mul_f32 v164, v164, v250
  v_mul_f32 v165, v165, v250
  v_mul_f32 v166, v166, v250
  v_mul_f32 v167, v167, v250
  v_mul_f32 v168, v168, v250
  v_mul_f32 v169, v169, v250
  v_mul_f32 v170, v170, v250
  v_mul_f32 v171, v171, v250
  v_mul_f32 v172, v172, v250
  v_mul_f32 v173, v173, v250
  v_mul_f32 v174, v174, v250
  v_mul_f32 v175, v175, v250
  v_mul_f32 v176, v176, v250
  v_mul_f32 v177, v177, v250
  v_mul_f32 v178, v178, v250
  v_mul_f32 v179, v179, v250
  v_mul_f32 v180, v180, v250
  v_mul_f32 v181, v181, v250
  v_mul_f32 v182, v182, v250
  v_mul_f32 v183, v183, v250
  v_mul_f32 v184, v184, v250
  v_mul_f32 v185, v185, v250
  v_mul_f32 v186, v186, v250
  v_mul_f32 v187, v187, v250
  v_mul_f32 v188, v188, v250
  v_mul_f32 v189, v189, v250
  v_mul_f32 v190, v190, v250
  v_mul_f32 v191, v191, v250
L_rare_ret:
  s_nop 7
  s_cmp_eq_u32 s41, 1
  s_cbranch_scc1 L_ret_1
  s_cmp_eq_u32 s41, 2
  s_cbranch_scc1 L_ret_2
  s_cmp_eq_u32 s41, 3
  s_cbranch_scc1 L_ret_3
  s_cmp_eq_u32 s41, 4
  s_cbranch_scc1 L_ret_4
  s_cmp_eq_u32 s41, 5
  s_cbranch_scc1 L_ret_5
  s_cmp_eq_u32 s41, 6
  s_cbranch_scc1 L_ret_6
  s_cmp_eq_u32 s41, 7
  s_cbranch_scc1 L_ret_7
  s_cmp_eq_u32 s41, 8
  s_cbranch_scc1 L_ret_8
  s_cmp_eq_u32 s41, 9
  s_cbranch_scc1 L_ret_9
  s_cmp_eq_u32 s41, 10
  s_cbranch_scc1 L_ret_10
  s_cmp_eq_u32 s41, 11
  s_cbranch_scc1 L_ret_11
  s_cmp_eq_u32 s41, 12
  s_cbranch_scc1 L_ret_12
  s_cmp_eq_u32 s41, 13
  s_cbranch_scc1 L_ret_13
  s_cmp_eq_u32 s41, 14
  s_cbranch_scc1 L_ret_14
  s_branch L_ret_15
L_kend:
  s_endpgm
.section .rodata,"a"
.p2align 6
.amdhsa_kernel concat_heads__gqa_block_cached__mha_block_cached__near_ridge_kernel
  .amdhsa_next_free_vgpr 512
  .amdhsa_next_free_sgpr 102
  .amdhsa_accum_offset 256
  .amdhsa_group_segment_fixed_size 0
  .amdhsa_kernarg_size 104
  .amdhsa_user_sgpr_count 2
  .amdhsa_user_sgpr_kernarg_segment_ptr 1
  .amdhsa_system_sgpr_workgroup_id_x 1
  .amdhsa_float_denorm_mode_32 3
.end_amdhsa_kernel
.text
```
